```python
import torch

def _softmax(x, axis=-1):
    return torch.softmax(x, dim=axis)

def _gelu(x):
    return torch.nn.functional.gelu(x, approximate='tanh')

def _silu(x):
    return torch.nn.functional.silu(x)

def _sigmoid(x):
    return torch.sigmoid(x)

def _layernorm(x, axis=-1, eps=1e-05):
    m = x.mean(dim=axis, keepdim=True)
    v = x.var(dim=axis, keepdim=True, unbiased=False)
    return (x - m) / torch.sqrt(v + eps)

def _scatter_add(tgt, idx, src, axis=0):
    return tgt.clone().index_add_(axis, idx, src)

def _segment_sum(src, seg, n):
    out = torch.zeros((n,) + src.shape[1:], dtype=src.dtype)
    return out.index_add_(0, seg, src)

def _pad(x, pw):
    flat = tuple((v for pair in reversed(pw) for v in pair))
    return torch.nn.functional.pad(x, flat)
kernel_name = 'gated_mix__ssm_conv_s5__memory_aug_recurrent_mem_tr__prompt'

def setup_inputs():

    _w = lambda a: (lambda t: t.to(torch.bfloat16) if t.is_floating_point() else t)(torch.as_tensor(a))

    def _A_setup():
        B, S, D = (1, 2048, 512)
        P = D
        Lambda_re = -0.5 * (lambda _x: torch.exp(torch.as_tensor(_x)))((lambda *s: torch.randn(*s, dtype=torch.bfloat16) * 0.8)(P))
        Lambda_im = (lambda *s: torch.randn(*s, dtype=torch.bfloat16) * 0.8)(P) * 1.0
        B_re = (lambda *s: torch.randn(*s, dtype=torch.bfloat16) * 0.8)(P, D) * D ** (-0.5)
        B_im = (lambda *s: torch.randn(*s, dtype=torch.bfloat16) * 0.8)(P, D) * D ** (-0.5)
        C_re = (lambda *s: torch.randn(*s, dtype=torch.bfloat16) * 0.8)(D, P) * P ** (-0.5)
        C_im = (lambda *s: torch.randn(*s, dtype=torch.bfloat16) * 0.8)(D, P) * P ** (-0.5)
        log_dt = (lambda *s: torch.randn(*s, dtype=torch.bfloat16) * 0.8)(P) * 0.3 - 2.0
        Dskip = (lambda *s: torch.randn(*s, dtype=torch.bfloat16) * 0.8)(D)
        return {'x': _w((lambda *s: torch.randn(*s, dtype=torch.bfloat16) * 0.05)(B, S, D)), 'Lambda_re': _w(Lambda_re), 'Lambda_im': _w(Lambda_im), 'B_re': _w(B_re), 'B_im': _w(B_im), 'C_re': _w(C_re), 'C_im': _w(C_im), 'log_dt': _w(log_dt), 'Dskip': _w(Dskip)}
    _A_in = _A_setup()

    def _B_setup():
        B, S, Dm = (1, 2048, 512)
        H, Dh = (32, 128)
        M, seg = (8, 32)
        seg = min(seg, S)
        S = S // seg * seg
        return {'x': _w((lambda *s: torch.randn(*s, dtype=torch.bfloat16) * 0.05)(B, S, Dm)), 'mem0': _w((lambda *s: torch.randn(*s, dtype=torch.bfloat16) * 0.8)(B, M, Dm)), 'Wq': _w((lambda *s: torch.randn(*s, dtype=torch.bfloat16) * 3.2)(Dm, H, Dh) * Dm ** (-0.5)), 'Wk': _w((lambda *s: torch.randn(*s, dtype=torch.bfloat16) * 3.2)(Dm, H, Dh) * Dm ** (-0.5)), 'Wv': _w((lambda *s: torch.randn(*s, dtype=torch.bfloat16) * 0.8)(Dm, H, Dh) * Dm ** (-0.5)), 'Wo': _w((lambda *s: torch.randn(*s, dtype=torch.bfloat16) * 0.8)(H, Dh, Dm) * (H * Dh) ** (-0.5)), 'seg_len': seg}
    _B_in = _B_setup()
    return {'A_x': _A_in['x'], 'A_Lambda_re': _A_in['Lambda_re'], 'A_Lambda_im': _A_in['Lambda_im'], 'A_B_re': _A_in['B_re'], 'A_B_im': _A_in['B_im'], 'A_C_re': _A_in['C_re'], 'A_C_im': _A_in['C_im'], 'A_log_dt': _A_in['log_dt'], 'A_Dskip': _A_in['Dskip'], 'B_x': _B_in['x'], 'B_mem0': _B_in['mem0'], 'B_Wq': _B_in['Wq'], 'B_Wk': _B_in['Wk'], 'B_Wv': _B_in['Wv'], 'B_Wo': _B_in['Wo'], 'B_seg_len': _B_in['seg_len'], 'gate_w': _w((lambda *s: torch.randn(*s, dtype=torch.bfloat16) * 0.05)(512) * 16.0)}

def reference(A_x, A_Lambda_re, A_Lambda_im, A_B_re, A_B_im, A_C_re, A_C_im, A_log_dt, A_Dskip, B_x, B_mem0, B_Wq, B_Wk, B_Wv, B_Wo, B_seg_len, gate_w):

    def _A_ref(x, Lambda_re, Lambda_im, B_re, B_im, C_re, C_im, log_dt, Dskip):
        Bsz, L, H = x.shape
        Lam = Lambda_re + 1j * Lambda_im
        Bmat = B_re + 1j * B_im
        Cmat = C_re + 1j * C_im
        dt = torch.exp(log_dt)
        Lam_bar = torch.exp(dt * Lam)
        B_bar = ((Lam_bar - 1.0) / Lam)[:, None] * Bmat
        Bu = torch.einsum('bld,pd->blp', x + 0j, B_bar)
        h = torch.zeros_like(Bu[:, 0, :])
        hs = []
        for t in range(L):
            h = Lam_bar[None, :] * h + Bu[:, t, :]
            hs.append(h)
        hseq = torch.stack(hs, 1)
        y = 2.0 * torch.einsum('blp,dp->bld', hseq, Cmat).real + x * Dskip[None, None, :]
        return y

    def _B_ref(x, mem0, Wq, Wk, Wv, Wo, seg_len):
        B, S, Dm = x.shape
        H, Dh = (Wq.shape[1], Wq.shape[2])
        M = mem0.shape[1]
        scale = Dh ** (-0.5)
        n_seg = S // seg_len
        L = M + seg_len
        idx = torch.arange(L)
        mask = (idx[:, None] < M) | (idx[:, None] >= idx[None, :])
        mem = mem0
        outs = []
        for s in range(n_seg):
            xs = x[:, s * seg_len:(s + 1) * seg_len, :].clone()
            h = torch.concatenate([mem, xs], axis=1)
            q = torch.einsum('btd,dhe->bhte', h, Wq)
            k = torch.einsum('btd,dhe->bhte', h, Wk)
            v = torch.einsum('btd,dhe->bhte', h, Wv)
            scores = torch.einsum('bhqe,bhke->bhqk', q, k) * scale
            scores = torch.where(mask[None, None], scores, -1000000000.0)
            p = _softmax(scores, axis=-1)
            o = torch.einsum('bhqk,bhke->bhqe', p, v)
            o = torch.einsum('bhte,hed->btd', o, Wo)
            mem = o[:, :M, :].clone()
            outs.append(o[:, M:, :])
        return torch.concatenate(outs, axis=1)
    x = A_x
    g = _sigmoid((x * gate_w).sum(-1, keepdims=True))
    a = _A_ref(x, A_Lambda_re, A_Lambda_im, A_B_re, A_B_im, A_C_re, A_C_im, A_log_dt, A_Dskip)
    b = _B_ref(x, B_mem0, B_Wq, B_Wk, B_Wv, B_Wo, B_seg_len)
    return g * a + (1 - g) * b
```

```asm
; @launch grid=(256,1,1) block=(256,1,1) lds=163840
.amdgcn_target "amdgcn-amd-amdhsa--gfx950"
.text
.globl gated_mix__ssm_conv_s5__memory_aug_recurrent_mem_tr__prompt_kernel
.p2align 8
.type gated_mix__ssm_conv_s5__memory_aug_recurrent_mem_tr__prompt_kernel,@function
gated_mix__ssm_conv_s5__memory_aug_recurrent_mem_tr__prompt_kernel:
    s_load_dwordx2 s[8:9], s[0:1], 152
    s_load_dwordx2 s[12:13], s[0:1], 144
    v_lshrrev_b32 v1, 6, v0
    s_cmp_ge_u32 s2, 256
    s_cbranch_scc1 L_exit
    v_readfirstlane_b32 s3, v1
    s_getreg_b32 s4, hwreg(HW_REG_XCC_ID)
    s_and_b32 s4, s4, 7
    s_lshl_b32 s4, s4, 2
    s_lshr_b32 s4, 0x65430721, s4
    s_and_b32 s4, s4, 7
    s_lshr_b32 s5, s2, 3
    s_mov_b32 s98, 0
    s_cmp_eq_u32 s4, 0
    s_cbranch_scc0 L_other
L_chain:
    s_load_dwordx2 s[28:29], s[0:1], 112
    s_load_dwordx2 s[16:17], s[0:1], 88
    s_load_dwordx2 s[20:21], s[0:1], 96
    s_load_dwordx2 s[24:25], s[0:1], 104
    s_load_dwordx2 s[32:33], s[0:1], 80
    v_and_b32 v120, 63, v0
    v_and_b32 v121, 15, v120
    v_lshrrev_b32 v122, 4, v120
    v_lshlrev_b32 v0, 4, v120
    v_lshrrev_b32 v112, 1, v122
    v_and_b32 v113, 1, v122
    v_lshlrev_b32 v114, 11, v122
    v_lshrrev_b32 v115, 1, v121
    v_lshl_add_u32 v114, v115, 4, v114
    v_and_b32 v115, 1, v121
    v_lshl_add_u32 v114, v115, 7, v114
    s_lshl_b32 s45, s5, 17
    s_lshl_b32 s46, s3, 8
    s_add_u32 s45, s45, s46
    v_add_u32 v13, s45, v114
    s_lshl_b32 s76, s3, 15
    s_waitcnt lgkmcnt(0)
    s_mov_b32 s30, 0x400000
    s_mov_b32 s31, 0x20000
    s_mov_b32 s18, 0x400000
    s_mov_b32 s19, 0x20000
    s_mov_b32 s22, 0x400000
    s_mov_b32 s23, 0x20000
    s_mov_b32 s26, 0x400000
    s_mov_b32 s27, 0x20000
    s_mov_b32 s34, 0x2000
    s_mov_b32 s35, 0x20000
    s_mov_b32 s10, 0x10000000
    s_mov_b32 s11, 0x20000
    s_mov_b32 s14, 0x100
    s_mov_b32 s15, 0x20000
    s_add_u32 s45, s76, 0x0
    s_and_b32 s45, s45, 0x1ffff
    buffer_load_dwordx4 v[32:35], v13, s[28:31], s45 offen
    s_add_u32 s45, s76, 0x4000
    s_and_b32 s45, s45, 0x1ffff
    buffer_load_dwordx4 v[36:39], v13, s[28:31], s45 offen
    s_add_u32 s45, s76, 0x400
    s_and_b32 s45, s45, 0x1ffff
    buffer_load_dwordx4 v[40:43], v13, s[28:31], s45 offen
    s_add_u32 s45, s76, 0x4400
    s_and_b32 s45, s45, 0x1ffff
    buffer_load_dwordx4 v[44:47], v13, s[28:31], s45 offen
    s_add_u32 s45, s76, 0x2000
    s_and_b32 s45, s45, 0x1ffff
    buffer_load_dwordx4 v[48:51], v13, s[28:31], s45 offen
    s_add_u32 s45, s76, 0x6000
    s_and_b32 s45, s45, 0x1ffff
    buffer_load_dwordx4 v[52:55], v13, s[28:31], s45 offen
    s_add_u32 s45, s76, 0x2400
    s_and_b32 s45, s45, 0x1ffff
    buffer_load_dwordx4 v[56:59], v13, s[28:31], s45 offen
    s_add_u32 s45, s76, 0x6400
    s_and_b32 s45, s45, 0x1ffff
    buffer_load_dwordx4 v[60:63], v13, s[28:31], s45 offen
    s_add_u32 s45, s76, 0x8000
    s_and_b32 s45, s45, 0x1ffff
    buffer_load_dwordx4 v[64:67], v13, s[28:31], s45 offen
    s_add_u32 s45, s76, 0xc000
    s_and_b32 s45, s45, 0x1ffff
    buffer_load_dwordx4 v[68:71], v13, s[28:31], s45 offen
    s_add_u32 s45, s76, 0x8400
    s_and_b32 s45, s45, 0x1ffff
    buffer_load_dwordx4 v[72:75], v13, s[28:31], s45 offen
    s_cmp_eq_u32 s98, 1
    s_cbranch_scc1 L_ch_cl
    v_lshrrev_b32 v114, 1, v0
    s_lshl_b32 s45, s3, 9
    v_add_u32 v114, s45, v114
    s_mov_b32 s96, 0x804c4000
    s_mov_b32 s97, 0xd8ccc08c
    s_lshl_b32 s7, s4, 3
    s_lshr_b64 s[96:97], s[96:97], s7
    s_and_b32 s96, s96, 255
    s_add_u32 s7, s96, 4
    s_cmp_eq_u32 s3, 0
    s_cbranch_scc0 L_ch_nc
    s_lshl_b32 s97, 1, s5
    v_mov_b32 v126, s97
    s_mov_b64 exec, 1
    buffer_atomic_or v126, off, s[12:15], s96 sc0
    s_mov_b64 exec, -1
L_ch_nc:
    s_lshr_b32 s96, s2, 2
    s_and_b32 s96, s96, 1
    s_xor_b32 s96, s96, 1
    v_mov_b32 v116, s96
    v_mov_b32 v117, s96
    s_lshl_b32 s96, s2, 11
    s_add_u32 s96, s96, 0x100000
    buffer_store_dwordx2 v[116:117], v114, s[8:11], s96 offen sc1
L_ch_cl:
    v_lshlrev_b32 v114, 18, v112
    v_lshl_add_u32 v114, v113, 16, v114
    v_lshrrev_b32 v115, 3, v121
    v_lshl_add_u32 v114, v115, 17, v114
    v_bfe_u32 v115, v121, 2, 1
    v_lshl_add_u32 v114, v115, 13, v114
    v_and_b32 v115, 3, v121
    v_lshl_add_u32 v114, v115, 4, v114
    s_lshl_b32 s45, s5, 8
    s_lshl_b32 s46, s3, 6
    s_add_u32 s45, s45, s46
    v_add_u32 v12, s45, v114
    s_lshl_b32 s45, s3, 10
    v_add_u32 v14, s45, v0
    v_lshlrev_b32 v114, 3, v115
    v_sub_u32 v15, v14, v114
    v_lshrrev_b32 v124, 2, v121
    v_lshlrev_b32 v114, 7, v122
    v_lshl_add_u32 v114, v121, 2, v114
    s_lshl_b32 s45, s3, 9
    s_add_u32 s45, s45, 4096
    v_add_u32 v9, s45, v114
    v_bfe_u32 v123, v121, 1, 1
    v_and_b32 v125, 1, v121
    v_lshl_add_u32 v114, v112, 2, v124
    v_lshl_add_u32 v114, v114, 1, v125
    v_lshl_add_u32 v114, v114, 1, v113
    v_lshl_add_u32 v114, v114, 1, v123
    v_lshlrev_b32 v7, 4, v114
    v_lshl_add_u32 v124, v124, 1, v125
    v_lshlrev_b32 v114, 4, v122
    v_lshl_add_u32 v10, v124, 6, v114
    s_mul_i32 s45, s3, 36864
    s_add_u32 s45, s45, 16384
    v_add_u32 v1, s45, v0
    v_mov_b32 v2, 0x44444444
    v_mov_b32 v114, 0xE4E4EEEE
    v_cmp_eq_u32 vcc, 1, v123
    v_mov_b32 v115, 0xffff
    v_mov_b32 v116, 0xffff0000
    v_cndmask_b32 v2, v2, v114, vcc
    v_cndmask_b32 v114, v115, v116, vcc
    v_cmp_gt_u32 vcc, 32, v120
    s_nop 1
    v_cndmask_b32 v17, 0, v114, vcc
    v_cndmask_b32 v21, v114, 0, vcc
    v_mul_u32_u24 v114, 5120, v122
    v_lshl_add_u32 v114, v121, 3, v114
    s_mul_i32 s45, s3, 40960
    s_lshl_b32 s46, s5, 7
    s_add_u32 s45, s45, s46
    v_add_u32 v3, s45, v114
    v_lshrrev_b32 v117, 3, v121
    v_and_b32 v115, 7, v121
    v_lshlrev_b32 v114, 6, v122
    v_lshl_add_u32 v114, v115, 3, v114
    v_lshl_add_u32 v114, v117, 7, v114
    s_lshl_b32 s45, s5, 8
    s_add_u32 s45, s45, 32768
    v_add_u32 v114, s45, v114
    v_mul_u32_u24 v116, 768, v121
    s_lshl_b32 s45, s5, 3
    s_add_u32 s45, s45, 40960
    v_add_u32 v116, s45, v116
    v_mov_b32 v118, 0x40000000
    v_cmp_gt_u32 vcc, 34, v120
    s_nop 1
    v_cndmask_b32 v116, v118, v116, vcc
    v_cmp_gt_u32 vcc, 32, v120
    v_lshlrev_b32 v119, 10, v122
    v_lshl_add_u32 v119, v121, 3, v119
    v_cndmask_b32 v6, v116, v114, vcc
    v_cndmask_b32 v8, v118, v119, vcc
    v_mov_b32 v114, 0x3f80
    v_lshlrev_b32 v115, 4, v125
    v_lshlrev_b32 v114, v115, v114
    v_lshrrev_b32 v115, 1, v121
    v_lshlrev_b32 v116, 1, v122
    v_cmp_eq_u32 vcc, v115, v116
    v_lshl_add_u32 v116, v113, 1, v112
    v_lshl_add_u32 v116, v116, 1, 1
    v_cndmask_b32 v4, 0, v114, vcc
    v_cmp_eq_u32 vcc, v115, v116
    v_lshlrev_b32 v25, 3, v120
    v_and_b32 v25, 0xf8, v25
    v_cndmask_b32 v5, 0, v114, vcc
    v_and_b32 v29, 0x380, v0
    v_add_u32 v29, v29, v0
    v_lshl_add_u32 v114, v122, 1, v123
    v_lshlrev_b32 v114, 5, v114
    v_lshl_add_u32 v114, v124, 10, v114
    s_and_b32 s45, s3, 1
    s_lshl_b32 s45, s45, 9
    s_lshr_b32 s46, s3, 1
    s_lshl_b32 s46, s46, 3
    s_add_u32 s45, s45, s46
    v_add_u32 v18, s45, v114
    s_lshl_b32 s45, s3, 11
    v_add_u32 v19, s45, v7
    v_mov_b32 v114, 0x3f80
    v_lshrrev_b32 v115, 2, v121
    v_lshlrev_b32 v115, 4, v115
    v_lshlrev_b32 v114, v115, v114
    v_and_b32 v115, 11, v121
    v_cmp_eq_u32 vcc, 0, v115
    s_nop 1
    v_cndmask_b32 v116, 0, v114, vcc
    v_cmp_eq_u32 vcc, 1, v115
    s_nop 1
    v_cndmask_b32 v117, 0, v114, vcc
    v_cmp_eq_u32 vcc, 2, v115
    s_nop 1
    v_cndmask_b32 v118, 0, v114, vcc
    v_cmp_eq_u32 vcc, 3, v115
    s_nop 1
    v_cndmask_b32 v119, 0, v114, vcc
    ds_write_b128 v0, v[116:119] offset:15360
    s_mov_b32 s50, 0x10000
    s_mov_b32 s51, 0x15000
    s_mov_b32 s2, 0x38000
    s_mov_b32 s99, 0x3d000
    s_mul_i32 s40, s5, 5120
    s_add_u32 s40, s40, 0x10000
    s_add_u32 s41, s40, 163840
    s_and_b32 s42, s5, 1
    s_mul_i32 s42, s42, 768
    s_add_u32 s42, s42, 40960
    s_lshl_b32 s38, s5, 14
    s_lshl_b32 s45, s3, 12
    s_add_u32 s38, s38, s45
    s_add_u32 s38, s38, 0x1000000
    s_cmp_eq_u32 s3, 0
    s_cselect_b32 s6, 0, 128
    s_add_u32 s6, s6, 0x8000
    s_add_u32 s43, s6, 1024
    s_add_u32 s44, s6, 2048
    s_add_u32 s55, s6, 3072
    s_and_b32 s39, s5, 3
    s_lshl_b32 s39, s39, 11
    s_lshr_b32 s45, s5, 2
    s_lshl_b32 s45, s45, 7
    s_add_u32 s39, s39, s45
    s_add_u32 s39, s39, 0x100000
    s_mov_b32 s58, 0x3f803f80
    s_mov_b32 s59, 0x3f803f80
    s_mov_b32 s56, 0x33333333
    s_mov_b32 s57, 0x33333333
    s_mov_b32 s48, 0x3e0293ee
    s_mov_b32 s49, 0xbe0293ee
    s_mov_b32 s36, 0
    s_mov_b32 s54, 0
    s_mov_b32 m0, 8192
    s_lshl_b32 s37, s5, 9
    s_add_u32 s37, s37, 4096
    s_add_u32 s52, s37, 256
    s_getpc_b64 s[72:73]
L_c_pc:
    s_add_u32 s72, s72, L_hot-L_c_pc
    s_addc_u32 s73, s73, 0
    s_mov_b32 s74, L_chain_fin-L_hot+256
    s_mov_b32 s75, 0x20000
    s_mov_b32 s47, 0x05040100
    s_mov_b32 s53, 0x07060302
    s_mov_b32 vcc_lo, 0x55555555
    s_mov_b32 vcc_hi, 0x55555555
    s_waitcnt vmcnt(10)
    v_mov_b32_dpp v22, v32 quad_perm:[1,0,3,2] row_mask:0xf bank_mask:0xf
    v_cndmask_b32_dpp v32, v33, v32, vcc quad_perm:[1,0,3,2] row_mask:0xf bank_mask:0xf
    v_cndmask_b32 v33, v33, v22, vcc
    v_mov_b32_dpp v22, v34 quad_perm:[1,0,3,2] row_mask:0xf bank_mask:0xf
    v_cndmask_b32_dpp v34, v35, v34, vcc quad_perm:[1,0,3,2] row_mask:0xf bank_mask:0xf
    v_cndmask_b32 v35, v35, v22, vcc
    s_barrier
    s_add_u32 s45, s76, 0xc400
    s_and_b32 s45, s45, 0x1ffff
    buffer_load_dwordx4 v[76:79], v13, s[28:31], s45 offen
    s_waitcnt vmcnt(10)
    v_mov_b32_dpp v22, v36 quad_perm:[1,0,3,2] row_mask:0xf bank_mask:0xf
    v_cndmask_b32_dpp v36, v37, v36, vcc quad_perm:[1,0,3,2] row_mask:0xf bank_mask:0xf
    v_cndmask_b32 v37, v37, v22, vcc
    v_mov_b32_dpp v22, v38 quad_perm:[1,0,3,2] row_mask:0xf bank_mask:0xf
    v_cndmask_b32_dpp v38, v39, v38, vcc quad_perm:[1,0,3,2] row_mask:0xf bank_mask:0xf
    v_cndmask_b32 v39, v39, v22, vcc
    v_perm_b32 v240, v36, v32, s47
    v_perm_b32 v241, v36, v32, s53
    v_perm_b32 v248, v37, v33, s47
    v_perm_b32 v249, v37, v33, s53
    v_perm_b32 v176, v38, v34, s47
    v_perm_b32 v177, v38, v34, s53
    v_perm_b32 v224, v39, v35, s47
    v_perm_b32 v225, v39, v35, s53
    s_barrier
    s_add_u32 s45, s76, 0xa000
    s_and_b32 s45, s45, 0x1ffff
    buffer_load_dwordx4 v[32:35], v13, s[28:31], s45 offen
    s_waitcnt vmcnt(10)
    v_mov_b32_dpp v22, v40 quad_perm:[1,0,3,2] row_mask:0xf bank_mask:0xf
    v_cndmask_b32_dpp v40, v41, v40, vcc quad_perm:[1,0,3,2] row_mask:0xf bank_mask:0xf
    v_cndmask_b32 v41, v41, v22, vcc
    v_mov_b32_dpp v22, v42 quad_perm:[1,0,3,2] row_mask:0xf bank_mask:0xf
    v_cndmask_b32_dpp v42, v43, v42, vcc quad_perm:[1,0,3,2] row_mask:0xf bank_mask:0xf
    v_cndmask_b32 v43, v43, v22, vcc
    s_barrier
    s_add_u32 s45, s76, 0xe000
    s_and_b32 s45, s45, 0x1ffff
    buffer_load_dwordx4 v[36:39], v13, s[28:31], s45 offen
    s_waitcnt vmcnt(10)
    v_mov_b32_dpp v22, v44 quad_perm:[1,0,3,2] row_mask:0xf bank_mask:0xf
    v_cndmask_b32_dpp v44, v45, v44, vcc quad_perm:[1,0,3,2] row_mask:0xf bank_mask:0xf
    v_cndmask_b32 v45, v45, v22, vcc
    v_mov_b32_dpp v22, v46 quad_perm:[1,0,3,2] row_mask:0xf bank_mask:0xf
    v_cndmask_b32_dpp v46, v47, v46, vcc quad_perm:[1,0,3,2] row_mask:0xf bank_mask:0xf
    v_cndmask_b32 v47, v47, v22, vcc
    v_perm_b32 v242, v44, v40, s47
    v_perm_b32 v243, v44, v40, s53
    v_perm_b32 v250, v45, v41, s47
    v_perm_b32 v251, v45, v41, s53
    v_perm_b32 v178, v46, v42, s47
    v_perm_b32 v179, v46, v42, s53
    v_perm_b32 v226, v47, v43, s47
    v_perm_b32 v227, v47, v43, s53
    s_barrier
    s_add_u32 s45, s76, 0xa400
    s_and_b32 s45, s45, 0x1ffff
    buffer_load_dwordx4 v[40:43], v13, s[28:31], s45 offen
    s_waitcnt vmcnt(10)
    v_mov_b32_dpp v22, v48 quad_perm:[1,0,3,2] row_mask:0xf bank_mask:0xf
    v_cndmask_b32_dpp v48, v49, v48, vcc quad_perm:[1,0,3,2] row_mask:0xf bank_mask:0xf
    v_cndmask_b32 v49, v49, v22, vcc
    v_mov_b32_dpp v22, v50 quad_perm:[1,0,3,2] row_mask:0xf bank_mask:0xf
    v_cndmask_b32_dpp v50, v51, v50, vcc quad_perm:[1,0,3,2] row_mask:0xf bank_mask:0xf
    v_cndmask_b32 v51, v51, v22, vcc
    s_barrier
    s_add_u32 s45, s76, 0xe400
    s_and_b32 s45, s45, 0x1ffff
    buffer_load_dwordx4 v[44:47], v13, s[28:31], s45 offen
    s_waitcnt vmcnt(10)
    v_mov_b32_dpp v22, v52 quad_perm:[1,0,3,2] row_mask:0xf bank_mask:0xf
    v_cndmask_b32_dpp v52, v53, v52, vcc quad_perm:[1,0,3,2] row_mask:0xf bank_mask:0xf
    v_cndmask_b32 v53, v53, v22, vcc
    v_mov_b32_dpp v22, v54 quad_perm:[1,0,3,2] row_mask:0xf bank_mask:0xf
    v_cndmask_b32_dpp v54, v55, v54, vcc quad_perm:[1,0,3,2] row_mask:0xf bank_mask:0xf
    v_cndmask_b32 v55, v55, v22, vcc
    v_perm_b32 v244, v52, v48, s47
    v_perm_b32 v245, v52, v48, s53
    v_perm_b32 v252, v53, v49, s47
    v_perm_b32 v253, v53, v49, s53
    v_perm_b32 v180, v54, v50, s47
    v_perm_b32 v181, v54, v50, s53
    v_perm_b32 v228, v55, v51, s47
    v_perm_b32 v229, v55, v51, s53
    s_barrier
    s_add_u32 s45, s76, 0x10000
    s_and_b32 s45, s45, 0x1ffff
    buffer_load_dwordx4 v[48:51], v13, s[28:31], s45 offen
    s_waitcnt vmcnt(10)
    v_mov_b32_dpp v22, v56 quad_perm:[1,0,3,2] row_mask:0xf bank_mask:0xf
    v_cndmask_b32_dpp v56, v57, v56, vcc quad_perm:[1,0,3,2] row_mask:0xf bank_mask:0xf
    v_cndmask_b32 v57, v57, v22, vcc
    v_mov_b32_dpp v22, v58 quad_perm:[1,0,3,2] row_mask:0xf bank_mask:0xf
    v_cndmask_b32_dpp v58, v59, v58, vcc quad_perm:[1,0,3,2] row_mask:0xf bank_mask:0xf
    v_cndmask_b32 v59, v59, v22, vcc
    s_barrier
    s_add_u32 s45, s76, 0x14000
    s_and_b32 s45, s45, 0x1ffff
    buffer_load_dwordx4 v[52:55], v13, s[28:31], s45 offen
    s_waitcnt vmcnt(10)
    v_mov_b32_dpp v22, v60 quad_perm:[1,0,3,2] row_mask:0xf bank_mask:0xf
    v_cndmask_b32_dpp v60, v61, v60, vcc quad_perm:[1,0,3,2] row_mask:0xf bank_mask:0xf
    v_cndmask_b32 v61, v61, v22, vcc
    v_mov_b32_dpp v22, v62 quad_perm:[1,0,3,2] row_mask:0xf bank_mask:0xf
    v_cndmask_b32_dpp v62, v63, v62, vcc quad_perm:[1,0,3,2] row_mask:0xf bank_mask:0xf
    v_cndmask_b32 v63, v63, v22, vcc
    v_perm_b32 v246, v60, v56, s47
    v_perm_b32 v247, v60, v56, s53
    v_perm_b32 v254, v61, v57, s47
    v_perm_b32 v255, v61, v57, s53
    v_perm_b32 v182, v62, v58, s47
    v_perm_b32 v183, v62, v58, s53
    v_perm_b32 v230, v63, v59, s47
    v_perm_b32 v231, v63, v59, s53
    s_barrier
    s_add_u32 s45, s76, 0x10400
    s_and_b32 s45, s45, 0x1ffff
    buffer_load_dwordx4 v[56:59], v13, s[28:31], s45 offen
    s_waitcnt vmcnt(10)
    v_mov_b32_dpp v22, v64 quad_perm:[1,0,3,2] row_mask:0xf bank_mask:0xf
    v_cndmask_b32_dpp v64, v65, v64, vcc quad_perm:[1,0,3,2] row_mask:0xf bank_mask:0xf
    v_cndmask_b32 v65, v65, v22, vcc
    v_mov_b32_dpp v22, v66 quad_perm:[1,0,3,2] row_mask:0xf bank_mask:0xf
    v_cndmask_b32_dpp v66, v67, v66, vcc quad_perm:[1,0,3,2] row_mask:0xf bank_mask:0xf
    v_cndmask_b32 v67, v67, v22, vcc
    s_barrier
    s_add_u32 s45, s76, 0x14400
    s_and_b32 s45, s45, 0x1ffff
    buffer_load_dwordx4 v[60:63], v13, s[28:31], s45 offen
    s_waitcnt vmcnt(10)
    v_mov_b32_dpp v22, v68 quad_perm:[1,0,3,2] row_mask:0xf bank_mask:0xf
    v_cndmask_b32_dpp v68, v69, v68, vcc quad_perm:[1,0,3,2] row_mask:0xf bank_mask:0xf
    v_cndmask_b32 v69, v69, v22, vcc
    v_mov_b32_dpp v22, v70 quad_perm:[1,0,3,2] row_mask:0xf bank_mask:0xf
    v_cndmask_b32_dpp v70, v71, v70, vcc quad_perm:[1,0,3,2] row_mask:0xf bank_mask:0xf
    v_cndmask_b32 v71, v71, v22, vcc
    v_perm_b32 v128, v68, v64, s47
    v_perm_b32 v129, v68, v64, s53
    v_perm_b32 v152, v69, v65, s47
    v_perm_b32 v153, v69, v65, s53
    v_perm_b32 v184, v70, v66, s47
    v_perm_b32 v185, v70, v66, s53
    v_perm_b32 v232, v71, v67, s47
    v_perm_b32 v233, v71, v67, s53
    s_barrier
    s_add_u32 s45, s76, 0x12000
    s_and_b32 s45, s45, 0x1ffff
    buffer_load_dwordx4 v[64:67], v13, s[28:31], s45 offen
    s_waitcnt vmcnt(10)
    v_mov_b32_dpp v22, v72 quad_perm:[1,0,3,2] row_mask:0xf bank_mask:0xf
    v_cndmask_b32_dpp v72, v73, v72, vcc quad_perm:[1,0,3,2] row_mask:0xf bank_mask:0xf
    v_cndmask_b32 v73, v73, v22, vcc
    v_mov_b32_dpp v22, v74 quad_perm:[1,0,3,2] row_mask:0xf bank_mask:0xf
    v_cndmask_b32_dpp v74, v75, v74, vcc quad_perm:[1,0,3,2] row_mask:0xf bank_mask:0xf
    v_cndmask_b32 v75, v75, v22, vcc
    s_barrier
    s_add_u32 s45, s76, 0x16000
    s_and_b32 s45, s45, 0x1ffff
    buffer_load_dwordx4 v[68:71], v13, s[28:31], s45 offen
    s_waitcnt vmcnt(10)
    v_mov_b32_dpp v22, v76 quad_perm:[1,0,3,2] row_mask:0xf bank_mask:0xf
    v_cndmask_b32_dpp v76, v77, v76, vcc quad_perm:[1,0,3,2] row_mask:0xf bank_mask:0xf
    v_cndmask_b32 v77, v77, v22, vcc
    v_mov_b32_dpp v22, v78 quad_perm:[1,0,3,2] row_mask:0xf bank_mask:0xf
    v_cndmask_b32_dpp v78, v79, v78, vcc quad_perm:[1,0,3,2] row_mask:0xf bank_mask:0xf
    v_cndmask_b32 v79, v79, v22, vcc
    v_perm_b32 v130, v76, v72, s47
    v_perm_b32 v131, v76, v72, s53
    v_perm_b32 v154, v77, v73, s47
    v_perm_b32 v155, v77, v73, s53
    v_perm_b32 v186, v78, v74, s47
    v_perm_b32 v187, v78, v74, s53
    v_perm_b32 v234, v79, v75, s47
    v_perm_b32 v235, v79, v75, s53
    s_barrier
    s_add_u32 s45, s76, 0x12400
    s_and_b32 s45, s45, 0x1ffff
    buffer_load_dwordx4 v[72:75], v13, s[28:31], s45 offen
    s_waitcnt vmcnt(10)
    v_mov_b32_dpp v22, v32 quad_perm:[1,0,3,2] row_mask:0xf bank_mask:0xf
    v_cndmask_b32_dpp v32, v33, v32, vcc quad_perm:[1,0,3,2] row_mask:0xf bank_mask:0xf
    v_cndmask_b32 v33, v33, v22, vcc
    v_mov_b32_dpp v22, v34 quad_perm:[1,0,3,2] row_mask:0xf bank_mask:0xf
    v_cndmask_b32_dpp v34, v35, v34, vcc quad_perm:[1,0,3,2] row_mask:0xf bank_mask:0xf
    v_cndmask_b32 v35, v35, v22, vcc
    s_barrier
    s_add_u32 s45, s76, 0x16400
    s_and_b32 s45, s45, 0x1ffff
    buffer_load_dwordx4 v[76:79], v13, s[28:31], s45 offen
    s_lshl_b32 s96, s4, 5
    s_add_u32 s96, s96, s5
    s_cmp_eq_u32 s98, 1
    s_cbranch_scc1 L_ch_cf_ok
    v_mov_b32 v113, 163836
    s_cmp_eq_u32 s3, 0
    s_cbranch_scc0 L_ch_cf_b
    s_waitcnt vmcnt(11)
    v_readfirstlane_b32 s97, v126
    v_mov_b32 v112, s96
    s_nop 2
    s_bitcmp1_b32 s97, s5
    s_cbranch_scc1 L_lost
    ds_write_b32 v113, v112
    s_waitcnt lgkmcnt(0)
L_ch_cf_b:
    s_barrier
    ds_read_b32 v112, v113
    s_waitcnt lgkmcnt(0)
    v_readfirstlane_b32 s97, v112
    s_barrier
    s_cmp_eq_u32 s97, s96
    s_cbranch_scc0 L_restart
L_ch_cf_ok:
    s_lshl_b32 s96, s96, 7
    s_lshl_b32 s97, s3, 3
    s_add_u32 s96, s96, s97
    v_mov_b64 v[112:113], 0
    buffer_store_dwordx2 v[112:113], off, s[8:11], s96 sc1
    v_mov_b64 v[112:113], 0
    buffer_store_dwordx2 v[112:113], v3, s[8:11], s50 offen sc1
    buffer_store_dwordx2 v[112:113], v3, s[8:11], s51 offen sc1
    buffer_store_dwordx2 v[112:113], v3, s[8:11], s2 offen sc1
    buffer_store_dwordx2 v[112:113], v3, s[8:11], s99 offen sc1
    buffer_store_dwordx2 v[112:113], v6, s[8:11], 0 offen sc1
    s_waitcnt vmcnt(16)
    v_mov_b32_dpp v22, v36 quad_perm:[1,0,3,2] row_mask:0xf bank_mask:0xf
    v_cndmask_b32_dpp v36, v37, v36, vcc quad_perm:[1,0,3,2] row_mask:0xf bank_mask:0xf
    v_cndmask_b32 v37, v37, v22, vcc
    v_mov_b32_dpp v22, v38 quad_perm:[1,0,3,2] row_mask:0xf bank_mask:0xf
    v_cndmask_b32_dpp v38, v39, v38, vcc quad_perm:[1,0,3,2] row_mask:0xf bank_mask:0xf
    v_cndmask_b32 v39, v39, v22, vcc
    v_perm_b32 v132, v36, v32, s47
    v_perm_b32 v133, v36, v32, s53
    v_perm_b32 v156, v37, v33, s47
    v_perm_b32 v157, v37, v33, s53
    v_perm_b32 v188, v38, v34, s47
    v_perm_b32 v189, v38, v34, s53
    v_perm_b32 v236, v39, v35, s47
    v_perm_b32 v237, v39, v35, s53
    s_barrier
    s_add_u32 s45, s76, 0x18000
    s_and_b32 s45, s45, 0x1ffff
    buffer_load_dwordx4 v[32:35], v13, s[28:31], s45 offen
    s_waitcnt vmcnt(16)
    v_mov_b32_dpp v22, v40 quad_perm:[1,0,3,2] row_mask:0xf bank_mask:0xf
    v_cndmask_b32_dpp v40, v41, v40, vcc quad_perm:[1,0,3,2] row_mask:0xf bank_mask:0xf
    v_cndmask_b32 v41, v41, v22, vcc
    v_mov_b32_dpp v22, v42 quad_perm:[1,0,3,2] row_mask:0xf bank_mask:0xf
    v_cndmask_b32_dpp v42, v43, v42, vcc quad_perm:[1,0,3,2] row_mask:0xf bank_mask:0xf
    v_cndmask_b32 v43, v43, v22, vcc
    s_barrier
    s_add_u32 s45, s76, 0x1c000
    s_and_b32 s45, s45, 0x1ffff
    buffer_load_dwordx4 v[36:39], v13, s[28:31], s45 offen
    s_waitcnt vmcnt(16)
    v_mov_b32_dpp v22, v44 quad_perm:[1,0,3,2] row_mask:0xf bank_mask:0xf
    v_cndmask_b32_dpp v44, v45, v44, vcc quad_perm:[1,0,3,2] row_mask:0xf bank_mask:0xf
    v_cndmask_b32 v45, v45, v22, vcc
    v_mov_b32_dpp v22, v46 quad_perm:[1,0,3,2] row_mask:0xf bank_mask:0xf
    v_cndmask_b32_dpp v46, v47, v46, vcc quad_perm:[1,0,3,2] row_mask:0xf bank_mask:0xf
    v_cndmask_b32 v47, v47, v22, vcc
    v_perm_b32 v134, v44, v40, s47
    v_perm_b32 v135, v44, v40, s53
    v_perm_b32 v158, v45, v41, s47
    v_perm_b32 v159, v45, v41, s53
    v_perm_b32 v190, v46, v42, s47
    v_perm_b32 v191, v46, v42, s53
    v_perm_b32 v238, v47, v43, s47
    v_perm_b32 v239, v47, v43, s53
    s_barrier
    s_add_u32 s45, s76, 0x18400
    s_and_b32 s45, s45, 0x1ffff
    buffer_load_dwordx4 v[40:43], v13, s[28:31], s45 offen
    s_waitcnt vmcnt(16)
    v_mov_b32_dpp v22, v48 quad_perm:[1,0,3,2] row_mask:0xf bank_mask:0xf
    v_cndmask_b32_dpp v48, v49, v48, vcc quad_perm:[1,0,3,2] row_mask:0xf bank_mask:0xf
    v_cndmask_b32 v49, v49, v22, vcc
    v_mov_b32_dpp v22, v50 quad_perm:[1,0,3,2] row_mask:0xf bank_mask:0xf
    v_cndmask_b32_dpp v50, v51, v50, vcc quad_perm:[1,0,3,2] row_mask:0xf bank_mask:0xf
    v_cndmask_b32 v51, v51, v22, vcc
    s_barrier
    s_add_u32 s45, s76, 0x1c400
    s_and_b32 s45, s45, 0x1ffff
    buffer_load_dwordx4 v[44:47], v13, s[28:31], s45 offen
    s_waitcnt vmcnt(16)
    v_mov_b32_dpp v22, v52 quad_perm:[1,0,3,2] row_mask:0xf bank_mask:0xf
    v_cndmask_b32_dpp v52, v53, v52, vcc quad_perm:[1,0,3,2] row_mask:0xf bank_mask:0xf
    v_cndmask_b32 v53, v53, v22, vcc
    v_mov_b32_dpp v22, v54 quad_perm:[1,0,3,2] row_mask:0xf bank_mask:0xf
    v_cndmask_b32_dpp v54, v55, v54, vcc quad_perm:[1,0,3,2] row_mask:0xf bank_mask:0xf
    v_cndmask_b32 v55, v55, v22, vcc
    v_perm_b32 v136, v52, v48, s47
    v_perm_b32 v137, v52, v48, s53
    v_perm_b32 v160, v53, v49, s47
    v_perm_b32 v161, v53, v49, s53
    v_perm_b32 v192, v54, v50, s47
    v_perm_b32 v193, v54, v50, s53
    v_perm_b32 v208, v55, v51, s47
    v_perm_b32 v209, v55, v51, s53
    s_barrier
    s_add_u32 s45, s76, 0x1a000
    s_and_b32 s45, s45, 0x1ffff
    buffer_load_dwordx4 v[48:51], v13, s[28:31], s45 offen
    s_waitcnt vmcnt(16)
    v_mov_b32_dpp v22, v56 quad_perm:[1,0,3,2] row_mask:0xf bank_mask:0xf
    v_cndmask_b32_dpp v56, v57, v56, vcc quad_perm:[1,0,3,2] row_mask:0xf bank_mask:0xf
    v_cndmask_b32 v57, v57, v22, vcc
    v_mov_b32_dpp v22, v58 quad_perm:[1,0,3,2] row_mask:0xf bank_mask:0xf
    v_cndmask_b32_dpp v58, v59, v58, vcc quad_perm:[1,0,3,2] row_mask:0xf bank_mask:0xf
    v_cndmask_b32 v59, v59, v22, vcc
    s_barrier
    s_add_u32 s45, s76, 0x1e000
    s_and_b32 s45, s45, 0x1ffff
    buffer_load_dwordx4 v[52:55], v13, s[28:31], s45 offen
    s_waitcnt vmcnt(16)
    v_mov_b32_dpp v22, v60 quad_perm:[1,0,3,2] row_mask:0xf bank_mask:0xf
    v_cndmask_b32_dpp v60, v61, v60, vcc quad_perm:[1,0,3,2] row_mask:0xf bank_mask:0xf
    v_cndmask_b32 v61, v61, v22, vcc
    v_mov_b32_dpp v22, v62 quad_perm:[1,0,3,2] row_mask:0xf bank_mask:0xf
    v_cndmask_b32_dpp v62, v63, v62, vcc quad_perm:[1,0,3,2] row_mask:0xf bank_mask:0xf
    v_cndmask_b32 v63, v63, v22, vcc
    v_perm_b32 v138, v60, v56, s47
    v_perm_b32 v139, v60, v56, s53
    v_perm_b32 v162, v61, v57, s47
    v_perm_b32 v163, v61, v57, s53
    v_perm_b32 v194, v62, v58, s47
    v_perm_b32 v195, v62, v58, s53
    v_perm_b32 v210, v63, v59, s47
    v_perm_b32 v211, v63, v59, s53
    s_barrier
    s_add_u32 s45, s76, 0x1a400
    s_and_b32 s45, s45, 0x1ffff
    buffer_load_dwordx4 v[56:59], v13, s[28:31], s45 offen
    s_waitcnt vmcnt(16)
    v_mov_b32_dpp v22, v64 quad_perm:[1,0,3,2] row_mask:0xf bank_mask:0xf
    v_cndmask_b32_dpp v64, v65, v64, vcc quad_perm:[1,0,3,2] row_mask:0xf bank_mask:0xf
    v_cndmask_b32 v65, v65, v22, vcc
    v_mov_b32_dpp v22, v66 quad_perm:[1,0,3,2] row_mask:0xf bank_mask:0xf
    v_cndmask_b32_dpp v66, v67, v66, vcc quad_perm:[1,0,3,2] row_mask:0xf bank_mask:0xf
    v_cndmask_b32 v67, v67, v22, vcc
    s_barrier
    s_add_u32 s45, s76, 0x1e400
    s_and_b32 s45, s45, 0x1ffff
    buffer_load_dwordx4 v[60:63], v13, s[28:31], s45 offen
    s_waitcnt vmcnt(16)
    v_mov_b32_dpp v22, v68 quad_perm:[1,0,3,2] row_mask:0xf bank_mask:0xf
    v_cndmask_b32_dpp v68, v69, v68, vcc quad_perm:[1,0,3,2] row_mask:0xf bank_mask:0xf
    v_cndmask_b32 v69, v69, v22, vcc
    v_mov_b32_dpp v22, v70 quad_perm:[1,0,3,2] row_mask:0xf bank_mask:0xf
    v_cndmask_b32_dpp v70, v71, v70, vcc quad_perm:[1,0,3,2] row_mask:0xf bank_mask:0xf
    v_cndmask_b32 v71, v71, v22, vcc
    v_perm_b32 v140, v68, v64, s47
    v_perm_b32 v141, v68, v64, s53
    v_perm_b32 v164, v69, v65, s47
    v_perm_b32 v165, v69, v65, s53
    v_perm_b32 v196, v70, v66, s47
    v_perm_b32 v197, v70, v66, s53
    v_perm_b32 v212, v71, v67, s47
    v_perm_b32 v213, v71, v67, s53
    s_barrier
    s_mov_b32 s45, 0x0
    buffer_load_dwordx4 v[64:67], v12, s[20:23], s45 offen
    s_waitcnt vmcnt(16)
    v_mov_b32_dpp v22, v72 quad_perm:[1,0,3,2] row_mask:0xf bank_mask:0xf
    v_cndmask_b32_dpp v72, v73, v72, vcc quad_perm:[1,0,3,2] row_mask:0xf bank_mask:0xf
    v_cndmask_b32 v73, v73, v22, vcc
    v_mov_b32_dpp v22, v74 quad_perm:[1,0,3,2] row_mask:0xf bank_mask:0xf
    v_cndmask_b32_dpp v74, v75, v74, vcc quad_perm:[1,0,3,2] row_mask:0xf bank_mask:0xf
    v_cndmask_b32 v75, v75, v22, vcc
    s_barrier
    s_mov_b32 s45, 0x4000
    buffer_load_dwordx4 v[68:71], v12, s[20:23], s45 offen
    s_waitcnt vmcnt(16)
    v_mov_b32_dpp v22, v76 quad_perm:[1,0,3,2] row_mask:0xf bank_mask:0xf
    v_cndmask_b32_dpp v76, v77, v76, vcc quad_perm:[1,0,3,2] row_mask:0xf bank_mask:0xf
    v_cndmask_b32 v77, v77, v22, vcc
    v_mov_b32_dpp v22, v78 quad_perm:[1,0,3,2] row_mask:0xf bank_mask:0xf
    v_cndmask_b32_dpp v78, v79, v78, vcc quad_perm:[1,0,3,2] row_mask:0xf bank_mask:0xf
    v_cndmask_b32 v79, v79, v22, vcc
    v_perm_b32 v142, v76, v72, s47
    v_perm_b32 v143, v76, v72, s53
    v_perm_b32 v166, v77, v73, s47
    v_perm_b32 v167, v77, v73, s53
    v_perm_b32 v198, v78, v74, s47
    v_perm_b32 v199, v78, v74, s53
    v_perm_b32 v214, v79, v75, s47
    v_perm_b32 v215, v79, v75, s53
    s_barrier
    s_mov_b32 s45, 0x80000
    buffer_load_dwordx4 v[72:75], v12, s[20:23], s45 offen
    s_waitcnt vmcnt(10)
    v_mov_b32_dpp v22, v32 quad_perm:[1,0,3,2] row_mask:0xf bank_mask:0xf
    v_cndmask_b32_dpp v32, v33, v32, vcc quad_perm:[1,0,3,2] row_mask:0xf bank_mask:0xf
    v_cndmask_b32 v33, v33, v22, vcc
    v_mov_b32_dpp v22, v34 quad_perm:[1,0,3,2] row_mask:0xf bank_mask:0xf
    v_cndmask_b32_dpp v34, v35, v34, vcc quad_perm:[1,0,3,2] row_mask:0xf bank_mask:0xf
    v_cndmask_b32 v35, v35, v22, vcc
    s_barrier
    s_mov_b32 s45, 0x84000
    buffer_load_dwordx4 v[76:79], v12, s[20:23], s45 offen
    s_barrier
    s_cmp_eq_u32 s3, 0
    s_cbranch_scc0 L_ch_id
    v_mov_b32 v23, 1
    s_mov_b64 exec, 1
    buffer_atomic_add v23, off, s[12:15], s7
    s_mov_b64 exec, -1
L_ch_id:
    s_waitcnt vmcnt(10)
    v_mov_b32_dpp v22, v36 quad_perm:[1,0,3,2] row_mask:0xf bank_mask:0xf
    v_cndmask_b32_dpp v36, v37, v36, vcc quad_perm:[1,0,3,2] row_mask:0xf bank_mask:0xf
    v_cndmask_b32 v37, v37, v22, vcc
    v_mov_b32_dpp v22, v38 quad_perm:[1,0,3,2] row_mask:0xf bank_mask:0xf
    v_cndmask_b32_dpp v38, v39, v38, vcc quad_perm:[1,0,3,2] row_mask:0xf bank_mask:0xf
    v_cndmask_b32 v39, v39, v22, vcc
    v_perm_b32 v144, v36, v32, s47
    v_perm_b32 v145, v36, v32, s53
    v_perm_b32 v168, v37, v33, s47
    v_perm_b32 v169, v37, v33, s53
    v_perm_b32 v200, v38, v34, s47
    v_perm_b32 v201, v38, v34, s53
    v_perm_b32 v216, v39, v35, s47
    v_perm_b32 v217, v39, v35, s53
    s_barrier
    s_mov_b32 s45, 0x8000
    buffer_load_dwordx4 v[32:35], v12, s[20:23], s45 offen
    s_waitcnt vmcnt(10)
    v_mov_b32_dpp v22, v40 quad_perm:[1,0,3,2] row_mask:0xf bank_mask:0xf
    v_cndmask_b32_dpp v40, v41, v40, vcc quad_perm:[1,0,3,2] row_mask:0xf bank_mask:0xf
    v_cndmask_b32 v41, v41, v22, vcc
    v_mov_b32_dpp v22, v42 quad_perm:[1,0,3,2] row_mask:0xf bank_mask:0xf
    v_cndmask_b32_dpp v42, v43, v42, vcc quad_perm:[1,0,3,2] row_mask:0xf bank_mask:0xf
    v_cndmask_b32 v43, v43, v22, vcc
    s_barrier
    s_mov_b32 s45, 0xc000
    buffer_load_dwordx4 v[36:39], v12, s[20:23], s45 offen
    s_waitcnt vmcnt(10)
    v_mov_b32_dpp v22, v44 quad_perm:[1,0,3,2] row_mask:0xf bank_mask:0xf
    v_cndmask_b32_dpp v44, v45, v44, vcc quad_perm:[1,0,3,2] row_mask:0xf bank_mask:0xf
    v_cndmask_b32 v45, v45, v22, vcc
    v_mov_b32_dpp v22, v46 quad_perm:[1,0,3,2] row_mask:0xf bank_mask:0xf
    v_cndmask_b32_dpp v46, v47, v46, vcc quad_perm:[1,0,3,2] row_mask:0xf bank_mask:0xf
    v_cndmask_b32 v47, v47, v22, vcc
    v_perm_b32 v146, v44, v40, s47
    v_perm_b32 v147, v44, v40, s53
    v_perm_b32 v170, v45, v41, s47
    v_perm_b32 v171, v45, v41, s53
    v_perm_b32 v202, v46, v42, s47
    v_perm_b32 v203, v46, v42, s53
    v_perm_b32 v218, v47, v43, s47
    v_perm_b32 v219, v47, v43, s53
    s_barrier
    s_mov_b32 s45, 0x88000
    buffer_load_dwordx4 v[40:43], v12, s[20:23], s45 offen
    s_waitcnt vmcnt(10)
    v_mov_b32_dpp v22, v48 quad_perm:[1,0,3,2] row_mask:0xf bank_mask:0xf
    v_cndmask_b32_dpp v48, v49, v48, vcc quad_perm:[1,0,3,2] row_mask:0xf bank_mask:0xf
    v_cndmask_b32 v49, v49, v22, vcc
    v_mov_b32_dpp v22, v50 quad_perm:[1,0,3,2] row_mask:0xf bank_mask:0xf
    v_cndmask_b32_dpp v50, v51, v50, vcc quad_perm:[1,0,3,2] row_mask:0xf bank_mask:0xf
    v_cndmask_b32 v51, v51, v22, vcc
    s_barrier
    s_mov_b32 s45, 0x8c000
    buffer_load_dwordx4 v[44:47], v12, s[20:23], s45 offen
    s_waitcnt vmcnt(10)
    v_mov_b32_dpp v22, v52 quad_perm:[1,0,3,2] row_mask:0xf bank_mask:0xf
    v_cndmask_b32_dpp v52, v53, v52, vcc quad_perm:[1,0,3,2] row_mask:0xf bank_mask:0xf
    v_cndmask_b32 v53, v53, v22, vcc
    v_mov_b32_dpp v22, v54 quad_perm:[1,0,3,2] row_mask:0xf bank_mask:0xf
    v_cndmask_b32_dpp v54, v55, v54, vcc quad_perm:[1,0,3,2] row_mask:0xf bank_mask:0xf
    v_cndmask_b32 v55, v55, v22, vcc
    v_perm_b32 v148, v52, v48, s47
    v_perm_b32 v149, v52, v48, s53
    v_perm_b32 v172, v53, v49, s47
    v_perm_b32 v173, v53, v49, s53
    v_perm_b32 v204, v54, v50, s47
    v_perm_b32 v205, v54, v50, s53
    v_perm_b32 v220, v55, v51, s47
    v_perm_b32 v221, v55, v51, s53
    s_barrier
    s_mov_b32 s45, 0x100000
    buffer_load_dwordx4 v[48:51], v12, s[20:23], s45 offen
    s_waitcnt vmcnt(10)
    v_mov_b32_dpp v22, v56 quad_perm:[1,0,3,2] row_mask:0xf bank_mask:0xf
    v_cndmask_b32_dpp v56, v57, v56, vcc quad_perm:[1,0,3,2] row_mask:0xf bank_mask:0xf
    v_cndmask_b32 v57, v57, v22, vcc
    v_mov_b32_dpp v22, v58 quad_perm:[1,0,3,2] row_mask:0xf bank_mask:0xf
    v_cndmask_b32_dpp v58, v59, v58, vcc quad_perm:[1,0,3,2] row_mask:0xf bank_mask:0xf
    v_cndmask_b32 v59, v59, v22, vcc
    s_barrier
    s_mov_b32 s45, 0x104000
    buffer_load_dwordx4 v[52:55], v12, s[20:23], s45 offen
    s_waitcnt vmcnt(10)
    v_mov_b32_dpp v22, v60 quad_perm:[1,0,3,2] row_mask:0xf bank_mask:0xf
    v_cndmask_b32_dpp v60, v61, v60, vcc quad_perm:[1,0,3,2] row_mask:0xf bank_mask:0xf
    v_cndmask_b32 v61, v61, v22, vcc
    v_mov_b32_dpp v22, v62 quad_perm:[1,0,3,2] row_mask:0xf bank_mask:0xf
    v_cndmask_b32_dpp v62, v63, v62, vcc quad_perm:[1,0,3,2] row_mask:0xf bank_mask:0xf
    v_cndmask_b32 v63, v63, v22, vcc
    v_perm_b32 v150, v60, v56, s47
    v_perm_b32 v151, v60, v56, s53
    v_perm_b32 v174, v61, v57, s47
    v_perm_b32 v175, v61, v57, s53
    v_perm_b32 v206, v62, v58, s47
    v_perm_b32 v207, v62, v58, s53
    v_perm_b32 v222, v63, v59, s47
    v_perm_b32 v223, v63, v59, s53
    ds_write_b128 v1, v[208:211] offset:24576
    ds_write_b128 v1, v[212:215] offset:25600
    ds_write_b128 v1, v[216:219] offset:26624
    ds_write_b128 v1, v[220:223] offset:27648
    ds_write_b128 v1, v[224:227] offset:28672
    ds_write_b128 v1, v[228:231] offset:29696
    ds_write_b128 v1, v[232:235] offset:30720
    ds_write_b128 v1, v[236:239] offset:31744
    ds_write_b128 v1, v[240:243] offset:32768
    ds_write_b128 v1, v[244:247] offset:33792
    ds_write_b128 v1, v[248:251] offset:34816
    ds_write_b128 v1, v[252:255] offset:35840
    s_waitcnt lgkmcnt(0)
    s_barrier
    s_mov_b32 s45, 0x180000
    buffer_load_dwordx4 v[56:59], v12, s[20:23], s45 offen
    s_waitcnt vmcnt(10)
    ds_write_b128 v14, v[64:67] offset:8192
    ds_read_b64_tr_b16 v[240:241], v15 offset:8192
    ds_read_b64_tr_b16 v[248:249], v15 offset:8224
    s_barrier
    s_mov_b32 s45, 0x184000
    buffer_load_dwordx4 v[60:63], v12, s[20:23], s45 offen
    s_waitcnt vmcnt(10)
    ds_write_b128 v14, v[68:71] offset:8192
    ds_read_b64_tr_b16 v[242:243], v15 offset:8192
    ds_read_b64_tr_b16 v[250:251], v15 offset:8224
    s_waitcnt lgkmcnt(5)
    s_barrier
    s_mov_b32 s45, 0x108000
    buffer_load_dwordx4 v[64:67], v12, s[20:23], s45 offen
    s_waitcnt vmcnt(10)
    ds_write_b128 v14, v[72:75] offset:8192
    ds_read_b64_tr_b16 v[244:245], v15 offset:8192
    ds_read_b64_tr_b16 v[252:253], v15 offset:8224
    s_barrier
    s_mov_b32 s45, 0x10c000
    buffer_load_dwordx4 v[68:71], v12, s[20:23], s45 offen
    s_waitcnt vmcnt(10)
    ds_write_b128 v14, v[76:79] offset:8192
    ds_read_b64_tr_b16 v[246:247], v15 offset:8192
    ds_read_b64_tr_b16 v[254:255], v15 offset:8224
    s_waitcnt lgkmcnt(5)
    s_waitcnt lgkmcnt(0)
    ds_write_b128 v1, v[240:243] offset:4096
    ds_write_b128 v1, v[244:247] offset:5120
    ds_write_b128 v1, v[248:251] offset:6144
    ds_write_b128 v1, v[252:255] offset:7168
    s_barrier
    s_mov_b32 s45, 0x188000
    buffer_load_dwordx4 v[72:75], v12, s[20:23], s45 offen
    s_waitcnt vmcnt(10)
    ds_write_b128 v14, v[32:35] offset:8192
    ds_read_b64_tr_b16 v[240:241], v15 offset:8192
    ds_read_b64_tr_b16 a[128:129], v15 offset:8224
    s_barrier
    s_mov_b32 s45, 0x18c000
    buffer_load_dwordx4 v[76:79], v12, s[20:23], s45 offen
    s_waitcnt vmcnt(10)
    ds_write_b128 v14, v[36:39] offset:8192
    ds_read_b64_tr_b16 v[242:243], v15 offset:8192
    ds_read_b64_tr_b16 a[130:131], v15 offset:8224
    s_waitcnt lgkmcnt(5)
    s_barrier
    s_mov_b32 s45, 0x200000
    buffer_load_dwordx4 v[32:35], v12, s[20:23], s45 offen
    s_waitcnt vmcnt(10)
    ds_write_b128 v14, v[40:43] offset:8192
    ds_read_b64_tr_b16 v[244:245], v15 offset:8192
    ds_read_b64_tr_b16 a[132:133], v15 offset:8224
    s_barrier
    s_mov_b32 s45, 0x204000
    buffer_load_dwordx4 v[36:39], v12, s[20:23], s45 offen
    s_waitcnt vmcnt(10)
    ds_write_b128 v14, v[44:47] offset:8192
    ds_read_b64_tr_b16 v[246:247], v15 offset:8192
    ds_read_b64_tr_b16 a[134:135], v15 offset:8224
    s_waitcnt lgkmcnt(5)
    s_waitcnt lgkmcnt(0)
    ds_write_b128 v1, v[240:243] offset:8192
    ds_write_b128 v1, v[244:247] offset:9216
    s_barrier
    s_mov_b32 s45, 0x280000
    buffer_load_dwordx4 v[40:43], v12, s[20:23], s45 offen
    s_waitcnt vmcnt(10)
    ds_write_b128 v14, v[48:51] offset:8192
    ds_read_b64_tr_b16 a[80:81], v15 offset:8192
    ds_read_b64_tr_b16 a[88:89], v15 offset:8224
    s_barrier
    s_mov_b32 s45, 0x284000
    buffer_load_dwordx4 v[44:47], v12, s[20:23], s45 offen
    s_waitcnt vmcnt(10)
    ds_write_b128 v14, v[52:55] offset:8192
    ds_read_b64_tr_b16 a[82:83], v15 offset:8192
    ds_read_b64_tr_b16 a[90:91], v15 offset:8224
    s_waitcnt lgkmcnt(5)
    s_barrier
    s_mov_b32 s45, 0x208000
    buffer_load_dwordx4 v[48:51], v12, s[20:23], s45 offen
    s_waitcnt vmcnt(10)
    ds_write_b128 v14, v[56:59] offset:8192
    ds_read_b64_tr_b16 a[84:85], v15 offset:8192
    ds_read_b64_tr_b16 a[92:93], v15 offset:8224
    s_barrier
    s_mov_b32 s45, 0x20c000
    buffer_load_dwordx4 v[52:55], v12, s[20:23], s45 offen
    s_waitcnt vmcnt(10)
    ds_write_b128 v14, v[60:63] offset:8192
    ds_read_b64_tr_b16 a[86:87], v15 offset:8192
    ds_read_b64_tr_b16 a[94:95], v15 offset:8224
    s_waitcnt lgkmcnt(5)
    s_barrier
    s_mov_b32 s45, 0x288000
    buffer_load_dwordx4 v[56:59], v12, s[20:23], s45 offen
    s_waitcnt vmcnt(10)
    ds_write_b128 v14, v[64:67] offset:8192
    ds_read_b64_tr_b16 v[240:241], v15 offset:8192
    ds_read_b64_tr_b16 a[136:137], v15 offset:8224
    s_barrier
    s_mov_b32 s45, 0x28c000
    buffer_load_dwordx4 v[60:63], v12, s[20:23], s45 offen
    s_waitcnt vmcnt(10)
    ds_write_b128 v14, v[68:71] offset:8192
    ds_read_b64_tr_b16 v[242:243], v15 offset:8192
    ds_read_b64_tr_b16 a[138:139], v15 offset:8224
    s_waitcnt lgkmcnt(5)
    s_barrier
    s_mov_b32 s45, 0x300000
    buffer_load_dwordx4 v[64:67], v12, s[20:23], s45 offen
    s_waitcnt vmcnt(10)
    ds_write_b128 v14, v[72:75] offset:8192
    ds_read_b64_tr_b16 v[244:245], v15 offset:8192
    ds_read_b64_tr_b16 a[140:141], v15 offset:8224
    s_barrier
    s_mov_b32 s45, 0x304000
    buffer_load_dwordx4 v[68:71], v12, s[20:23], s45 offen
    s_waitcnt vmcnt(10)
    ds_write_b128 v14, v[76:79] offset:8192
    ds_read_b64_tr_b16 v[246:247], v15 offset:8192
    ds_read_b64_tr_b16 a[142:143], v15 offset:8224
    s_waitcnt lgkmcnt(5)
    s_waitcnt lgkmcnt(0)
    ds_write_b128 v1, v[240:243] offset:10240
    ds_write_b128 v1, v[244:247] offset:11264
    s_barrier
    s_mov_b32 s45, 0x380000
    buffer_load_dwordx4 v[72:75], v12, s[20:23], s45 offen
    s_waitcnt vmcnt(10)
    ds_write_b128 v14, v[32:35] offset:8192
    ds_read_b64_tr_b16 a[96:97], v15 offset:8192
    ds_read_b64_tr_b16 a[104:105], v15 offset:8224
    s_barrier
    s_mov_b32 s45, 0x384000
    buffer_load_dwordx4 v[76:79], v12, s[20:23], s45 offen
    s_waitcnt vmcnt(10)
    ds_write_b128 v14, v[36:39] offset:8192
    ds_read_b64_tr_b16 a[98:99], v15 offset:8192
    ds_read_b64_tr_b16 a[106:107], v15 offset:8224
    s_waitcnt lgkmcnt(5)
    s_barrier
    s_mov_b32 s45, 0x308000
    buffer_load_dwordx4 v[32:35], v12, s[20:23], s45 offen
    s_waitcnt vmcnt(10)
    ds_write_b128 v14, v[40:43] offset:8192
    ds_read_b64_tr_b16 a[100:101], v15 offset:8192
    ds_read_b64_tr_b16 a[108:109], v15 offset:8224
    s_barrier
    s_mov_b32 s45, 0x30c000
    buffer_load_dwordx4 v[36:39], v12, s[20:23], s45 offen
    s_waitcnt vmcnt(10)
    ds_write_b128 v14, v[44:47] offset:8192
    ds_read_b64_tr_b16 a[102:103], v15 offset:8192
    ds_read_b64_tr_b16 a[110:111], v15 offset:8224
    s_waitcnt lgkmcnt(5)
    s_barrier
    s_mov_b32 s45, 0x388000
    buffer_load_dwordx4 v[40:43], v12, s[20:23], s45 offen
    s_waitcnt vmcnt(10)
    ds_write_b128 v14, v[48:51] offset:8192
    ds_read_b64_tr_b16 v[240:241], v15 offset:8192
    ds_read_b64_tr_b16 a[144:145], v15 offset:8224
    s_barrier
    s_mov_b32 s45, 0x38c000
    buffer_load_dwordx4 v[44:47], v12, s[20:23], s45 offen
    s_waitcnt vmcnt(10)
    ds_write_b128 v14, v[52:55] offset:8192
    ds_read_b64_tr_b16 v[242:243], v15 offset:8192
    ds_read_b64_tr_b16 a[146:147], v15 offset:8224
    s_waitcnt lgkmcnt(5)
    s_barrier
    s_mov_b32 s45, 0x0
    buffer_load_dwordx4 v[48:51], v12, s[24:27], s45 offen
    s_waitcnt vmcnt(10)
    ds_write_b128 v14, v[56:59] offset:8192
    ds_read_b64_tr_b16 v[244:245], v15 offset:8192
    ds_read_b64_tr_b16 a[148:149], v15 offset:8224
    s_barrier
    s_mov_b32 s45, 0x4000
    buffer_load_dwordx4 v[52:55], v12, s[24:27], s45 offen
    s_waitcnt vmcnt(10)
    ds_write_b128 v14, v[60:63] offset:8192
    ds_read_b64_tr_b16 v[246:247], v15 offset:8192
    ds_read_b64_tr_b16 a[150:151], v15 offset:8224
    s_waitcnt lgkmcnt(5)
    s_waitcnt lgkmcnt(0)
    ds_write_b128 v1, v[240:243] offset:12288
    ds_write_b128 v1, v[244:247] offset:13312
    s_barrier
    s_mov_b32 s45, 0x80000
    buffer_load_dwordx4 v[56:59], v12, s[24:27], s45 offen
    s_waitcnt vmcnt(10)
    ds_write_b128 v14, v[64:67] offset:8192
    ds_read_b64_tr_b16 a[112:113], v15 offset:8192
    ds_read_b64_tr_b16 a[120:121], v15 offset:8224
    s_barrier
    s_mov_b32 s45, 0x84000
    buffer_load_dwordx4 v[60:63], v12, s[24:27], s45 offen
    s_waitcnt vmcnt(10)
    ds_write_b128 v14, v[68:71] offset:8192
    ds_read_b64_tr_b16 a[114:115], v15 offset:8192
    ds_read_b64_tr_b16 a[122:123], v15 offset:8224
    s_waitcnt lgkmcnt(5)
    s_barrier
    s_mov_b32 s45, 0x8000
    buffer_load_dwordx4 v[64:67], v12, s[24:27], s45 offen
    s_waitcnt vmcnt(10)
    ds_write_b128 v14, v[72:75] offset:8192
    ds_read_b64_tr_b16 a[116:117], v15 offset:8192
    ds_read_b64_tr_b16 a[124:125], v15 offset:8224
    s_barrier
    s_mov_b32 s45, 0xc000
    buffer_load_dwordx4 v[68:71], v12, s[24:27], s45 offen
    s_waitcnt vmcnt(10)
    ds_write_b128 v14, v[76:79] offset:8192
    ds_read_b64_tr_b16 a[118:119], v15 offset:8192
    ds_read_b64_tr_b16 a[126:127], v15 offset:8224
    s_waitcnt lgkmcnt(5)
    s_barrier
    s_mov_b32 s45, 0x88000
    buffer_load_dwordx4 v[72:75], v12, s[24:27], s45 offen
    s_waitcnt vmcnt(10)
    ds_write_b128 v14, v[32:35] offset:8192
    ds_read_b64_tr_b16 v[240:241], v15 offset:8192
    ds_read_b64_tr_b16 a[152:153], v15 offset:8224
    s_barrier
    s_mov_b32 s45, 0x8c000
    buffer_load_dwordx4 v[76:79], v12, s[24:27], s45 offen
    v_lshlrev_b32 v94, 3, v0
    v_lshlrev_b32 v91, 3, v0
    v_and_b32 v91, 0x80, v91
    v_lshrrev_b32 v90, 2, v0
    s_lshl_b32 s45, s3, 13
    v_lshl_add_u32 v92, v120, 7, s45
    s_cmp_eq_u32 s3, 1
    s_cselect_b32 s76, s40, 32768
    s_cmp_eq_u32 s3, 2
    s_cselect_b32 s76, s41, s76
    s_cmp_eq_u32 s3, 3
    s_cselect_b32 s76, 40960, s76
    s_waitcnt vmcnt(10)
    ds_write_b128 v14, v[36:39] offset:8192
    ds_read_b64_tr_b16 v[242:243], v15 offset:8192
    ds_read_b64_tr_b16 a[154:155], v15 offset:8224
    s_waitcnt lgkmcnt(5)
    s_barrier
    s_mov_b32 s45, 0x100000
    buffer_load_dwordx4 v[32:35], v12, s[24:27], s45 offen
    s_waitcnt vmcnt(10)
    ds_write_b128 v14, v[40:43] offset:8192
    ds_read_b64_tr_b16 v[244:245], v15 offset:8192
    ds_read_b64_tr_b16 a[156:157], v15 offset:8224
    s_barrier
    s_mov_b32 s45, 0x104000
    buffer_load_dwordx4 v[36:39], v12, s[24:27], s45 offen
    s_waitcnt vmcnt(10)
    ds_write_b128 v14, v[44:47] offset:8192
    ds_read_b64_tr_b16 v[246:247], v15 offset:8192
    ds_read_b64_tr_b16 a[158:159], v15 offset:8224
    s_waitcnt lgkmcnt(5)
    s_waitcnt lgkmcnt(0)
    ds_write_b128 v1, v[240:243] offset:14336
    ds_write_b128 v1, v[244:247] offset:15360
    s_barrier
    s_mov_b32 s45, 0x180000
    buffer_load_dwordx4 v[40:43], v12, s[24:27], s45 offen
    s_waitcnt vmcnt(10)
    ds_write_b128 v14, v[48:51] offset:8192
    ds_read_b64_tr_b16 a[160:161], v15 offset:8192
    ds_read_b64_tr_b16 a[168:169], v15 offset:8224
    s_barrier
    s_mov_b32 s45, 0x184000
    buffer_load_dwordx4 v[44:47], v12, s[24:27], s45 offen
    s_waitcnt vmcnt(10)
    ds_write_b128 v14, v[52:55] offset:8192
    ds_read_b64_tr_b16 a[162:163], v15 offset:8192
    ds_read_b64_tr_b16 a[170:171], v15 offset:8224
    s_waitcnt lgkmcnt(5)
    s_barrier
    s_mov_b32 s45, 0x108000
    buffer_load_dwordx4 v[48:51], v12, s[24:27], s45 offen
    s_waitcnt vmcnt(10)
    ds_write_b128 v14, v[56:59] offset:8192
    ds_read_b64_tr_b16 a[164:165], v15 offset:8192
    ds_read_b64_tr_b16 a[172:173], v15 offset:8224
    s_barrier
    s_mov_b32 s45, 0x10c000
    buffer_load_dwordx4 v[52:55], v12, s[24:27], s45 offen
    s_waitcnt vmcnt(10)
    ds_write_b128 v14, v[60:63] offset:8192
    ds_read_b64_tr_b16 a[166:167], v15 offset:8192
    ds_read_b64_tr_b16 a[174:175], v15 offset:8224
    s_waitcnt lgkmcnt(5)
    s_barrier
    s_mov_b32 s45, 0x188000
    buffer_load_dwordx4 v[56:59], v12, s[24:27], s45 offen
    s_waitcnt vmcnt(10)
    ds_write_b128 v14, v[64:67] offset:8192
    ds_read_b64_tr_b16 a[224:225], v15 offset:8192
    ds_read_b64_tr_b16 v[248:249], v15 offset:8224
    s_barrier
    s_mov_b32 s45, 0x18c000
    buffer_load_dwordx4 v[60:63], v12, s[24:27], s45 offen
    s_waitcnt vmcnt(10)
    ds_write_b128 v14, v[68:71] offset:8192
    ds_read_b64_tr_b16 a[226:227], v15 offset:8192
    ds_read_b64_tr_b16 v[250:251], v15 offset:8224
    s_waitcnt lgkmcnt(5)
    s_barrier
    s_mov_b32 s45, 0x200000
    buffer_load_dwordx4 v[64:67], v12, s[24:27], s45 offen
    s_waitcnt vmcnt(10)
    ds_write_b128 v14, v[72:75] offset:8192
    ds_read_b64_tr_b16 a[228:229], v15 offset:8192
    ds_read_b64_tr_b16 v[252:253], v15 offset:8224
    s_barrier
    s_mov_b32 s45, 0x204000
    buffer_load_dwordx4 v[68:71], v12, s[24:27], s45 offen
    s_waitcnt vmcnt(10)
    ds_write_b128 v14, v[76:79] offset:8192
    ds_read_b64_tr_b16 a[230:231], v15 offset:8192
    ds_read_b64_tr_b16 v[254:255], v15 offset:8224
    s_waitcnt lgkmcnt(5)
    s_waitcnt lgkmcnt(0)
    ds_write_b128 v1, v[248:251] offset:16384
    ds_write_b128 v1, v[252:255] offset:17408
    s_barrier
    s_mov_b32 s45, 0x280000
    buffer_load_dwordx4 v[72:75], v12, s[24:27], s45 offen
    s_waitcnt vmcnt(10)
    ds_write_b128 v14, v[32:35] offset:8192
    ds_read_b64_tr_b16 a[176:177], v15 offset:8192
    ds_read_b64_tr_b16 a[184:185], v15 offset:8224
    s_barrier
    s_mov_b32 s45, 0x284000
    buffer_load_dwordx4 v[76:79], v12, s[24:27], s45 offen
    s_waitcnt vmcnt(10)
    ds_write_b128 v14, v[36:39] offset:8192
    ds_read_b64_tr_b16 a[178:179], v15 offset:8192
    ds_read_b64_tr_b16 a[186:187], v15 offset:8224
    s_waitcnt lgkmcnt(5)
    s_barrier
    s_mov_b32 s45, 0x208000
    buffer_load_dwordx4 v[32:35], v12, s[24:27], s45 offen
    s_waitcnt vmcnt(10)
    ds_write_b128 v14, v[40:43] offset:8192
    ds_read_b64_tr_b16 a[180:181], v15 offset:8192
    ds_read_b64_tr_b16 a[188:189], v15 offset:8224
    s_barrier
    s_mov_b32 s45, 0x20c000
    buffer_load_dwordx4 v[36:39], v12, s[24:27], s45 offen
    s_waitcnt vmcnt(10)
    ds_write_b128 v14, v[44:47] offset:8192
    ds_read_b64_tr_b16 a[182:183], v15 offset:8192
    ds_read_b64_tr_b16 a[190:191], v15 offset:8224
    s_waitcnt lgkmcnt(5)
    s_barrier
    s_mov_b32 s45, 0x288000
    buffer_load_dwordx4 v[40:43], v12, s[24:27], s45 offen
    s_waitcnt vmcnt(10)
    ds_write_b128 v14, v[48:51] offset:8192
    ds_read_b64_tr_b16 a[232:233], v15 offset:8192
    ds_read_b64_tr_b16 v[248:249], v15 offset:8224
    s_barrier
    s_mov_b32 s45, 0x28c000
    buffer_load_dwordx4 v[44:47], v12, s[24:27], s45 offen
    s_waitcnt vmcnt(10)
    ds_write_b128 v14, v[52:55] offset:8192
    ds_read_b64_tr_b16 a[234:235], v15 offset:8192
    ds_read_b64_tr_b16 v[250:251], v15 offset:8224
    s_waitcnt lgkmcnt(5)
    s_barrier
    s_mov_b32 s45, 0x300000
    buffer_load_dwordx4 v[48:51], v12, s[24:27], s45 offen
    s_waitcnt vmcnt(10)
    ds_write_b128 v14, v[56:59] offset:8192
    ds_read_b64_tr_b16 a[236:237], v15 offset:8192
    ds_read_b64_tr_b16 v[252:253], v15 offset:8224
    s_barrier
    s_mov_b32 s45, 0x304000
    buffer_load_dwordx4 v[52:55], v12, s[24:27], s45 offen
    s_waitcnt vmcnt(10)
    ds_write_b128 v14, v[60:63] offset:8192
    ds_read_b64_tr_b16 a[238:239], v15 offset:8192
    ds_read_b64_tr_b16 v[254:255], v15 offset:8224
    s_waitcnt lgkmcnt(5)
    s_waitcnt lgkmcnt(0)
    ds_write_b128 v1, v[248:251] offset:18432
    ds_write_b128 v1, v[252:255] offset:19456
    s_barrier
    s_mov_b32 s45, 0x380000
    buffer_load_dwordx4 v[56:59], v12, s[24:27], s45 offen
    s_waitcnt vmcnt(10)
    ds_write_b128 v14, v[64:67] offset:8192
    ds_read_b64_tr_b16 a[192:193], v15 offset:8192
    ds_read_b64_tr_b16 a[200:201], v15 offset:8224
    s_barrier
    s_mov_b32 s45, 0x384000
    buffer_load_dwordx4 v[60:63], v12, s[24:27], s45 offen
    s_waitcnt vmcnt(10)
    ds_write_b128 v14, v[68:71] offset:8192
    ds_read_b64_tr_b16 a[194:195], v15 offset:8192
    ds_read_b64_tr_b16 a[202:203], v15 offset:8224
    s_waitcnt lgkmcnt(5)
    s_barrier
    s_mov_b32 s45, 0x308000
    buffer_load_dwordx4 v[64:67], v12, s[24:27], s45 offen
    s_waitcnt vmcnt(10)
    ds_write_b128 v14, v[72:75] offset:8192
    ds_read_b64_tr_b16 a[196:197], v15 offset:8192
    ds_read_b64_tr_b16 a[204:205], v15 offset:8224
    s_barrier
    s_mov_b32 s45, 0x30c000
    buffer_load_dwordx4 v[68:71], v12, s[24:27], s45 offen
    s_waitcnt vmcnt(10)
    ds_write_b128 v14, v[76:79] offset:8192
    ds_read_b64_tr_b16 a[198:199], v15 offset:8192
    ds_read_b64_tr_b16 a[206:207], v15 offset:8224
    s_waitcnt lgkmcnt(5)
    s_barrier
    s_mov_b32 s45, 0x388000
    buffer_load_dwordx4 v[72:75], v12, s[24:27], s45 offen
    s_waitcnt vmcnt(10)
    ds_write_b128 v14, v[32:35] offset:8192
    ds_read_b64_tr_b16 a[240:241], v15 offset:8192
    ds_read_b64_tr_b16 v[248:249], v15 offset:8224
    s_barrier
    s_mov_b32 s45, 0x38c000
    buffer_load_dwordx4 v[76:79], v12, s[24:27], s45 offen
    s_waitcnt vmcnt(10)
    ds_write_b128 v14, v[36:39] offset:8192
    ds_read_b64_tr_b16 a[242:243], v15 offset:8192
    ds_read_b64_tr_b16 v[250:251], v15 offset:8224
    s_waitcnt lgkmcnt(5)
    s_barrier
    s_mov_b32 s45, 0x0
    buffer_load_dwordx4 v[32:35], v12, s[16:19], s45 offen
    s_waitcnt vmcnt(10)
    ds_write_b128 v14, v[40:43] offset:8192
    ds_read_b64_tr_b16 a[244:245], v15 offset:8192
    ds_read_b64_tr_b16 v[252:253], v15 offset:8224
    s_barrier
    s_mov_b32 s45, 0x4000
    buffer_load_dwordx4 v[36:39], v12, s[16:19], s45 offen
    s_waitcnt vmcnt(10)
    ds_write_b128 v14, v[44:47] offset:8192
    ds_read_b64_tr_b16 a[246:247], v15 offset:8192
    ds_read_b64_tr_b16 v[254:255], v15 offset:8224
    s_waitcnt lgkmcnt(5)
    s_waitcnt lgkmcnt(0)
    ds_write_b128 v1, v[248:251] offset:20480
    ds_write_b128 v1, v[252:255] offset:21504
    s_barrier
    s_mov_b32 s45, 0x80000
    buffer_load_dwordx4 v[40:43], v12, s[16:19], s45 offen
    s_waitcnt vmcnt(10)
    ds_write_b128 v14, v[48:51] offset:8192
    ds_read_b64_tr_b16 a[208:209], v15 offset:8192
    ds_read_b64_tr_b16 a[216:217], v15 offset:8224
    s_barrier
    s_mov_b32 s45, 0x84000
    buffer_load_dwordx4 v[44:47], v12, s[16:19], s45 offen
    s_waitcnt vmcnt(10)
    ds_write_b128 v14, v[52:55] offset:8192
    ds_read_b64_tr_b16 a[210:211], v15 offset:8192
    ds_read_b64_tr_b16 a[218:219], v15 offset:8224
    s_waitcnt lgkmcnt(5)
    s_barrier
    s_mov_b32 s45, 0x8000
    buffer_load_dwordx4 v[48:51], v12, s[16:19], s45 offen
    s_waitcnt vmcnt(10)
    ds_write_b128 v14, v[56:59] offset:8192
    ds_read_b64_tr_b16 a[212:213], v15 offset:8192
    ds_read_b64_tr_b16 a[220:221], v15 offset:8224
    s_barrier
    s_mov_b32 s45, 0xc000
    buffer_load_dwordx4 v[52:55], v12, s[16:19], s45 offen
    s_waitcnt vmcnt(10)
    ds_write_b128 v14, v[60:63] offset:8192
    ds_read_b64_tr_b16 a[214:215], v15 offset:8192
    ds_read_b64_tr_b16 a[222:223], v15 offset:8224
    s_waitcnt lgkmcnt(5)
    s_barrier
    buffer_load_dword v88, v90, s[12:15], 0 offen sc1
    s_mov_b32 s45, 0x88000
    buffer_load_dwordx4 v[56:59], v12, s[16:19], s45 offen
    s_waitcnt vmcnt(11)
    ds_write_b128 v14, v[64:67] offset:8192
    ds_read_b64_tr_b16 a[248:249], v15 offset:8192
    ds_read_b64_tr_b16 v[248:249], v15 offset:8224
    s_barrier
    s_mov_b32 s45, 0x8c000
    buffer_load_dwordx4 v[60:63], v12, s[16:19], s45 offen
    s_waitcnt vmcnt(11)
    ds_write_b128 v14, v[68:71] offset:8192
    ds_read_b64_tr_b16 a[250:251], v15 offset:8192
    ds_read_b64_tr_b16 v[250:251], v15 offset:8224
    s_waitcnt lgkmcnt(5)
    s_barrier
    s_mov_b32 s45, 0x100000
    buffer_load_dwordx4 v[64:67], v12, s[16:19], s45 offen
    s_waitcnt vmcnt(11)
    ds_write_b128 v14, v[72:75] offset:8192
    ds_read_b64_tr_b16 a[252:253], v15 offset:8192
    ds_read_b64_tr_b16 v[252:253], v15 offset:8224
    s_barrier
    s_mov_b32 s45, 0x104000
    buffer_load_dwordx4 v[68:71], v12, s[16:19], s45 offen
    s_waitcnt vmcnt(11)
    ds_write_b128 v14, v[76:79] offset:8192
    ds_read_b64_tr_b16 a[254:255], v15 offset:8192
    ds_read_b64_tr_b16 v[254:255], v15 offset:8224
    s_waitcnt lgkmcnt(5)
    s_waitcnt lgkmcnt(0)
    ds_write_b128 v1, v[248:251] offset:22528
    ds_write_b128 v1, v[252:255] offset:23552
    s_barrier
    s_mov_b32 s45, 0x180000
    buffer_load_dwordx4 v[72:75], v12, s[16:19], s45 offen
    s_waitcnt vmcnt(11)
    ds_write_b128 v14, v[32:35] offset:8192
    ds_read_b64_tr_b16 v[240:241], v15 offset:8192
    ds_read_b64_tr_b16 v[248:249], v15 offset:8224
    s_barrier
    s_mov_b32 s45, 0x184000
    buffer_load_dwordx4 v[76:79], v12, s[16:19], s45 offen
    s_waitcnt vmcnt(11)
    ds_write_b128 v14, v[36:39] offset:8192
    ds_read_b64_tr_b16 v[242:243], v15 offset:8192
    ds_read_b64_tr_b16 v[250:251], v15 offset:8224
    s_waitcnt lgkmcnt(5)
    s_barrier
    s_mov_b32 s45, 0x108000
    buffer_load_dwordx4 v[32:35], v12, s[16:19], s45 offen
    s_waitcnt vmcnt(11)
    ds_write_b128 v14, v[40:43] offset:8192
    ds_read_b64_tr_b16 v[244:245], v15 offset:8192
    ds_read_b64_tr_b16 v[252:253], v15 offset:8224
    s_barrier
    s_mov_b32 s45, 0x10c000
    buffer_load_dwordx4 v[36:39], v12, s[16:19], s45 offen
    s_waitcnt vmcnt(11)
    ds_write_b128 v14, v[44:47] offset:8192
    ds_read_b64_tr_b16 v[246:247], v15 offset:8192
    ds_read_b64_tr_b16 v[254:255], v15 offset:8224
    s_waitcnt lgkmcnt(5)
    s_waitcnt lgkmcnt(0)
    ds_write_b128 v1, v[240:243] offset:0
    ds_write_b128 v1, v[244:247] offset:1024
    ds_write_b128 v1, v[248:251] offset:2048
    ds_write_b128 v1, v[252:255] offset:3072
    s_barrier
    s_mov_b32 s45, 0x188000
    buffer_load_dwordx4 v[40:43], v12, s[16:19], s45 offen
    s_waitcnt vmcnt(11)
    ds_write_b128 v14, v[48:51] offset:8192
    ds_read_b64_tr_b16 a[16:17], v15 offset:8192
    ds_read_b64_tr_b16 a[24:25], v15 offset:8224
    s_barrier
    buffer_load_dword v93, v92, s[72:75], 0 offen
    s_mov_b32 s45, 0x18c000
    buffer_load_dwordx4 v[44:47], v12, s[16:19], s45 offen
    s_waitcnt vmcnt(12)
    ds_write_b128 v14, v[52:55] offset:8192
    ds_read_b64_tr_b16 a[18:19], v15 offset:8192
    ds_read_b64_tr_b16 a[26:27], v15 offset:8224
    s_waitcnt lgkmcnt(5)
    s_barrier
    s_mov_b32 s45, 0x200000
    buffer_load_dwordx4 v[48:51], v12, s[16:19], s45 offen
    s_waitcnt vmcnt(11)
    ds_write_b128 v14, v[56:59] offset:8192
    ds_read_b64_tr_b16 a[20:21], v15 offset:8192
    ds_read_b64_tr_b16 a[28:29], v15 offset:8224
    s_barrier
    s_mov_b32 s45, 0x204000
    buffer_load_dwordx4 v[52:55], v12, s[16:19], s45 offen
    s_waitcnt vmcnt(11)
    ds_write_b128 v14, v[60:63] offset:8192
    ds_read_b64_tr_b16 a[22:23], v15 offset:8192
    ds_read_b64_tr_b16 a[30:31], v15 offset:8224
    s_waitcnt lgkmcnt(5)
    s_barrier
    buffer_load_dword v89, v91, s[8:11], s37 offen sc1
    buffer_load_dwordx2 v[80:81], v18, s[32:35], 0 offen offset:0
    buffer_load_dwordx2 v[82:83], v18, s[32:35], 0 offen offset:16
    buffer_load_dwordx2 v[84:85], v18, s[32:35], 0 offen offset:256
    buffer_load_dwordx2 v[86:87], v18, s[32:35], 0 offen offset:272
    s_mov_b32 s45, 0x280000
    buffer_load_dwordx4 v[56:59], v12, s[16:19], s45 offen
    s_waitcnt vmcnt(16)
    ds_write_b128 v14, v[64:67] offset:8192
    ds_read_b64_tr_b16 v[208:209], v15 offset:8192
    ds_read_b64_tr_b16 v[216:217], v15 offset:8224
    s_barrier
    s_mov_b32 s45, 0x284000
    buffer_load_dwordx4 v[60:63], v12, s[16:19], s45 offen
    s_waitcnt vmcnt(16)
    ds_write_b128 v14, v[68:71] offset:8192
    ds_read_b64_tr_b16 v[210:211], v15 offset:8192
    ds_read_b64_tr_b16 v[218:219], v15 offset:8224
    s_waitcnt lgkmcnt(5)
    s_barrier
    s_mov_b32 s45, 0x208000
    buffer_load_dwordx4 v[64:67], v12, s[16:19], s45 offen
    s_waitcnt vmcnt(16)
    ds_write_b128 v14, v[72:75] offset:8192
    ds_read_b64_tr_b16 v[212:213], v15 offset:8192
    ds_read_b64_tr_b16 v[220:221], v15 offset:8224
    s_barrier
    s_mov_b32 s45, 0x20c000
    buffer_load_dwordx4 v[68:71], v12, s[16:19], s45 offen
    s_waitcnt vmcnt(16)
    ds_write_b128 v14, v[76:79] offset:8192
    ds_read_b64_tr_b16 v[214:215], v15 offset:8192
    ds_read_b64_tr_b16 v[222:223], v15 offset:8224
    s_waitcnt lgkmcnt(5)
    s_barrier
    s_mov_b32 s45, 0x288000
    buffer_load_dwordx4 v[72:75], v12, s[16:19], s45 offen
    s_waitcnt vmcnt(16)
    ds_write_b128 v14, v[32:35] offset:8192
    ds_read_b64_tr_b16 a[32:33], v15 offset:8192
    ds_read_b64_tr_b16 a[40:41], v15 offset:8224
    s_barrier
    s_mov_b32 s45, 0x28c000
    buffer_load_dwordx4 v[76:79], v12, s[16:19], s45 offen
    s_waitcnt vmcnt(16)
    ds_write_b128 v14, v[36:39] offset:8192
    ds_read_b64_tr_b16 a[34:35], v15 offset:8192
    ds_read_b64_tr_b16 a[42:43], v15 offset:8224
    s_waitcnt lgkmcnt(5)
    s_barrier
    s_mov_b32 s45, 0x300000
    buffer_load_dwordx4 v[32:35], v12, s[16:19], s45 offen
    s_waitcnt vmcnt(16)
    ds_write_b128 v14, v[40:43] offset:8192
    ds_read_b64_tr_b16 a[36:37], v15 offset:8192
    ds_read_b64_tr_b16 a[44:45], v15 offset:8224
    s_barrier
    s_mov_b32 s45, 0x304000
    buffer_load_dwordx4 v[36:39], v12, s[16:19], s45 offen
    s_waitcnt vmcnt(15)
    ds_write_b128 v14, v[44:47] offset:8192
    ds_read_b64_tr_b16 a[38:39], v15 offset:8192
    ds_read_b64_tr_b16 a[46:47], v15 offset:8224
    s_waitcnt lgkmcnt(5)
    s_barrier
    s_mov_b32 s45, 0x380000
    buffer_load_dwordx4 v[40:43], v12, s[16:19], s45 offen
    s_waitcnt vmcnt(15)
    ds_write_b128 v14, v[48:51] offset:8192
    ds_read_b64_tr_b16 v[224:225], v15 offset:8192
    ds_read_b64_tr_b16 v[232:233], v15 offset:8224
    s_barrier
    s_mov_b32 s45, 0x384000
    buffer_load_dwordx4 v[44:47], v12, s[16:19], s45 offen
    s_waitcnt vmcnt(15)
    ds_write_b128 v14, v[52:55] offset:8192
    ds_read_b64_tr_b16 v[226:227], v15 offset:8192
    ds_read_b64_tr_b16 v[234:235], v15 offset:8224
    s_waitcnt lgkmcnt(5)
    s_barrier
    s_mov_b32 s45, 0x308000
    buffer_load_dwordx4 v[48:51], v12, s[16:19], s45 offen
    s_waitcnt vmcnt(10)
    ds_write_b128 v14, v[56:59] offset:8192
    ds_read_b64_tr_b16 v[228:229], v15 offset:8192
    ds_read_b64_tr_b16 v[236:237], v15 offset:8224
    s_barrier
    s_mov_b32 s45, 0x30c000
    buffer_load_dwordx4 v[52:55], v12, s[16:19], s45 offen
    s_waitcnt vmcnt(10)
    ds_write_b128 v14, v[60:63] offset:8192
    ds_read_b64_tr_b16 v[230:231], v15 offset:8192
    ds_read_b64_tr_b16 v[238:239], v15 offset:8224
    s_waitcnt lgkmcnt(5)
    s_barrier
    buffer_load_dwordx4 v[96:99], v0, s[8:11], s38 offen offset:0 sc1
    buffer_load_dwordx4 v[100:103], v0, s[8:11], s38 offen offset:1024 sc1
    buffer_load_dwordx4 v[104:107], v0, s[8:11], s38 offen offset:2048 sc1
    buffer_load_dwordx4 v[108:111], v0, s[8:11], s38 offen offset:3072 sc1
    buffer_load_dword v93, v94, s[8:11], s76 offen sc1
    s_mov_b32 s45, 0x388000
    buffer_load_dwordx4 v[56:59], v12, s[16:19], s45 offen
    s_waitcnt vmcnt(15)
    ds_write_b128 v14, v[64:67] offset:8192
    ds_read_b64_tr_b16 a[48:49], v15 offset:8192
    ds_read_b64_tr_b16 a[56:57], v15 offset:8224
    s_barrier
    s_mov_b32 s45, 0x38c000
    buffer_load_dwordx4 v[60:63], v12, s[16:19], s45 offen
    s_waitcnt vmcnt(15)
    ds_write_b128 v14, v[68:71] offset:8192
    ds_read_b64_tr_b16 a[50:51], v15 offset:8192
    ds_read_b64_tr_b16 a[58:59], v15 offset:8224
    s_waitcnt lgkmcnt(5)
    s_barrier
    s_waitcnt vmcnt(14)
    ds_write_b128 v14, v[72:75] offset:8192
    ds_read_b64_tr_b16 a[52:53], v15 offset:8192
    ds_read_b64_tr_b16 a[60:61], v15 offset:8224
    s_barrier
    s_waitcnt vmcnt(13)
    ds_write_b128 v14, v[76:79] offset:8192
    ds_read_b64_tr_b16 a[54:55], v15 offset:8192
    ds_read_b64_tr_b16 a[62:63], v15 offset:8224
    s_waitcnt lgkmcnt(5)
    s_barrier
    s_waitcnt vmcnt(12)
    ds_write_b128 v14, v[32:35] offset:8192
    ds_read_b64_tr_b16 a[0:1], v15 offset:8192
    ds_read_b64_tr_b16 a[8:9], v15 offset:8224
    s_barrier
    s_waitcnt vmcnt(11)
    ds_write_b128 v14, v[36:39] offset:8192
    ds_read_b64_tr_b16 a[2:3], v15 offset:8192
    ds_read_b64_tr_b16 a[10:11], v15 offset:8224
    s_waitcnt lgkmcnt(5)
    s_barrier
    s_waitcnt vmcnt(10)
    ds_write_b128 v14, v[40:43] offset:8192
    ds_read_b64_tr_b16 a[4:5], v15 offset:8192
    ds_read_b64_tr_b16 a[12:13], v15 offset:8224
    s_barrier
    s_waitcnt vmcnt(9)
    ds_write_b128 v14, v[44:47] offset:8192
    ds_read_b64_tr_b16 a[6:7], v15 offset:8192
    ds_read_b64_tr_b16 a[14:15], v15 offset:8224
    s_waitcnt lgkmcnt(5)
    s_barrier
    s_waitcnt vmcnt(8)
    ds_write_b128 v14, v[48:51] offset:8192
    ds_read_b64_tr_b16 a[64:65], v15 offset:8192
    ds_read_b64_tr_b16 a[72:73], v15 offset:8224
    s_barrier
    s_waitcnt vmcnt(7)
    ds_write_b128 v14, v[52:55] offset:8192
    ds_read_b64_tr_b16 a[66:67], v15 offset:8192
    ds_read_b64_tr_b16 a[74:75], v15 offset:8224
    s_waitcnt lgkmcnt(5)
    s_barrier
    s_waitcnt vmcnt(1)
    ds_write_b128 v14, v[56:59] offset:8192
    ds_read_b64_tr_b16 a[68:69], v15 offset:8192
    ds_read_b64_tr_b16 a[76:77], v15 offset:8224
    s_barrier
    s_waitcnt vmcnt(0)
    ds_write_b128 v14, v[60:63] offset:8192
    ds_read_b64_tr_b16 a[70:71], v15 offset:8192
    ds_read_b64_tr_b16 a[78:79], v15 offset:8224
    s_waitcnt lgkmcnt(5)
    s_barrier
    s_mov_b32 s53, 0
    s_mov_b32 s16, 0xff00ff00
    s_mov_b32 s17, 0
    ds_write_b128 v19, v[80:83] offset:0
    ds_write_b128 v19, v[84:87] offset:1024
    v_cmp_ne_u32 vcc, 32, v88
    s_nop 3
    s_and_b32 vcc_lo, vcc_lo, 0x120002
    s_and_b32 vcc_hi, vcc_hi, 0x920012
    s_or_b64 vcc, vcc, vcc
    s_cbranch_vccnz L_ch_late
    v_cmp_eq_u32 vcc, 0, v89
    s_cbranch_vccz L_ch_early
L_ch_late:
    v_lshrrev_b32 v73, 2, v0
    s_mov_b32 s54, 0
L_ch_wi:
    buffer_load_dword v72, v73, s[12:15], 0 offen sc1
    s_waitcnt vmcnt(0)
    v_cmp_ne_u32 vcc, 32, v72
    s_nop 3
    s_and_b32 vcc_lo, vcc_lo, 0x120002
    s_and_b32 vcc_hi, vcc_hi, 0x920012
    s_or_b64 vcc, vcc, vcc
    s_cbranch_vccz L_ch_wi_ok
    s_sleep 8
    s_add_u32 s54, s54, 1
    s_cmp_lt_u32 s54, 0x40000
    s_cbranch_scc1 L_ch_wi
    s_endpgm
L_ch_wi_ok:
    s_mov_b32 s54, 0
L_ch_kv0:
    buffer_load_dword v72, v91, s[8:11], s37 offen sc1
    s_waitcnt vmcnt(0)
    v_cmp_eq_u32 vcc, 0, v72
    s_cbranch_vccz L_ch_kv0_ok
    s_sleep 2
    s_add_u32 s54, s54, 1
    s_cmp_lt_u32 s54, 0x40000
    s_cbranch_scc1 L_ch_kv0
    s_endpgm
L_ch_kv0_ok:
    buffer_load_dwordx4 v[96:99], v0, s[8:11], s38 offen offset:0 sc1
    buffer_load_dwordx4 v[100:103], v0, s[8:11], s38 offen offset:1024 sc1
    buffer_load_dwordx4 v[104:107], v0, s[8:11], s38 offen offset:2048 sc1
    buffer_load_dwordx4 v[108:111], v0, s[8:11], s38 offen offset:3072 sc1
    s_waitcnt vmcnt(0)
L_ch_early:
    s_waitcnt lgkmcnt(0)
    v_mov_b64 v[32:33], v[96:97]
    v_mov_b64 v[34:35], v[98:99]
    v_mov_b64 v[36:37], v[100:101]
    v_mov_b64 v[38:39], v[102:103]
    v_mov_b64 v[18:19], v[104:105]
    v_mov_b64 v[22:23], v[106:107]
    v_mov_b64 v[26:27], v[108:109]
    v_mov_b64 v[30:31], v[110:111]
    ds_read_b128 v[96:99], v1 offset:0
    ds_read_b128 v[100:103], v1 offset:1024
    ds_read_b128 v[104:107], v1 offset:2048
    ds_read_b128 v[108:111], v1 offset:3072
    ds_read_b128 v[112:115], v1 offset:4096
    ds_read_b128 v[116:119], v1 offset:5120
    ds_read_b128 v[120:123], v1 offset:6144
    ds_read_b128 v[124:127], v1 offset:7168
    v_mov_b64 v[40:41], 0
    v_mov_b64 v[42:43], 0
    v_mov_b64 v[44:45], 0
    v_mov_b64 v[46:47], 0
    v_mov_b64 v[48:49], 0
    v_mov_b64 v[50:51], 0
    v_mov_b64 v[52:53], 0
    v_mov_b64 v[54:55], 0
    v_mov_b64 v[56:57], 0
    v_mov_b64 v[58:59], 0
    v_mov_b64 v[60:61], 0
    v_mov_b64 v[62:63], 0
    s_add_u32 s38, s38, 0x80000
    s_waitcnt lgkmcnt(0)
    s_cmp_eq_u32 s3, 1
    s_cbranch_scc1 L_step1_0
    s_cmp_eq_u32 s3, 2
    s_cbranch_scc1 L_step2_0
    s_cmp_eq_u32 s3, 3
    s_cbranch_scc1 L_step3_0
    s_branch L_step0_0
L_hot:
.p2align 6
L_p2f0_1:
    buffer_load_dwordx4 v29, s[8:11], s44 offen offset:2048 sc1 lds
    buffer_load_dwordx4 v29, s[8:11], s55 offen offset:3072 sc1 lds
L_p2ok0_1:
    s_waitcnt vmcnt(8)
L_step0_0:
    s_barrier
    ds_read_b128 v[64:67], v7 offset:0
    ds_read_b128 v[68:71], v7 offset:1024
    s_waitcnt lgkmcnt(1)
    v_smfmac_f32_16x16x64_bf16 v[40:43], v[64:67], v[96:103], v2
    v_smfmac_f32_16x16x64_bf16 v[44:47], v[64:67], v[104:111], v2
    buffer_store_dwordx2 v[14:15], v8, s[8:11], s39 offen sc1
    v_smfmac_f32_16x16x64_bf16 v[48:51], v[64:67], v[112:119], v2
    buffer_load_dwordx4 v[240:243], v0, s[8:11], s38 offen offset:0 sc1
    v_smfmac_f32_16x16x64_bf16 v[52:55], v[64:67], v[120:127], v2
    ds_read_b128 v[96:99], v1 offset:8192
    s_waitcnt lgkmcnt(1)
    v_smfmac_f32_16x16x64_bf16 v[40:43], v[68:71], v[208:215], v2
    ds_read_b128 v[100:103], v1 offset:9216
    v_smfmac_f32_16x16x64_bf16 v[44:47], v[68:71], v[216:223], v2
    ds_read_b128 v[104:107], v1 offset:10240
    v_smfmac_f32_16x16x64_bf16 v[48:51], v[68:71], a[80:87], v2
    buffer_load_dwordx4 v[244:247], v0, s[8:11], s38 offen offset:1024 sc1
    v_smfmac_f32_16x16x64_bf16 v[52:55], v[68:71], a[88:95], v2
    s_waitcnt vmcnt(3)
    s_barrier
    ds_read_b128 v[72:75], v7 offset:2048
    v_smfmac_f32_16x16x64_bf16 v[56:59], v[64:67], a[160:167], v2
    ds_read_b128 v[76:79], v7 offset:3072
    v_smfmac_f32_16x16x64_bf16 v[56:59], v[68:71], a[176:183], v2
    ds_read_b128 v[108:111], v1 offset:11264
    v_smfmac_f32_16x16x64_bf16 v[60:63], v[64:67], a[168:175], v2
    ds_read_b128 v[112:115], v1 offset:12288
    v_smfmac_f32_16x16x64_bf16 v[60:63], v[68:71], a[184:191], v2
    ds_read_b128 v[116:119], v1 offset:13312
    s_waitcnt lgkmcnt(4)
    v_smfmac_f32_16x16x64_bf16 v[40:43], v[72:75], v[224:231], v2
    buffer_load_dwordx4 v[248:251], v0, s[8:11], s38 offen offset:2048 sc1
    v_smfmac_f32_16x16x64_bf16 v[44:47], v[72:75], v[232:239], v2
    ds_read_b128 v[120:123], v1 offset:14336
    v_bitop3_b32 v12, v64, v66, v68 bitop3:0xfe
    v_smfmac_f32_16x16x64_bf16 v[48:51], v[72:75], a[96:103], v2
    s_barrier
    ds_read_b128 v[80:83], v7 offset:4096
    v_bitop3_b32 v12, v12, v70, v72 bitop3:0xfe
    v_smfmac_f32_16x16x64_bf16 v[52:55], v[72:75], a[104:111], v2
    ds_read_b128 v[84:87], v7 offset:5120
    s_waitcnt lgkmcnt(6)
    v_smfmac_f32_16x16x64_bf16 v[40:43], v[76:79], a[0:7], v2
    ds_read_b128 v[88:91], v7 offset:6144
    v_bitop3_b32 v12, v12, v74, v76 bitop3:0xfe
    v_smfmac_f32_16x16x64_bf16 v[44:47], v[76:79], a[8:15], v2
    ds_read_b128 v[92:95], v7 offset:7168
    v_smfmac_f32_16x16x64_bf16 v[48:51], v[76:79], a[112:119], v2
    ds_read_b128 v[124:127], v1 offset:15360
    v_smfmac_f32_16x16x64_bf16 v[52:55], v[76:79], a[120:127], v2
    s_waitcnt lgkmcnt(4)
    v_bitop3_b32 v12, v12, v78, v80 bitop3:0xfe
    v_smfmac_f32_16x16x64_bf16 v[40:43], v[80:83], a[16:23], v2
    buffer_load_dwordx4 v[252:255], v0, s[8:11], s38 offen offset:3072 sc1
    s_waitcnt lgkmcnt(3)
    v_bitop3_b32 v12, v12, v82, v84 bitop3:0xfe
    v_smfmac_f32_16x16x64_bf16 v[40:43], v[84:87], a[32:39], v2
    s_waitcnt lgkmcnt(2)
    v_bitop3_b32 v12, v12, v86, v88 bitop3:0xfe
    v_smfmac_f32_16x16x64_bf16 v[40:43], v[88:91], a[48:55], v2
    s_waitcnt lgkmcnt(1)
    v_bitop3_b32 v12, v12, v90, v92 bitop3:0xfe
    v_smfmac_f32_16x16x64_bf16 v[40:43], v[92:95], a[64:71], v2
    v_bitop3_b32 v12, v12, v94, 1 bitop3:0xa8
    v_smfmac_f32_16x16x64_bf16 v[48:51], v[80:83], v[96:103], v2
    v_cmp_ne_u32 vcc, 0, v12
    v_smfmac_f32_16x16x64_bf16 v[48:51], v[84:87], v[104:111], v2
    v_add_f32 v40, v40, v42
    v_smfmac_f32_16x16x64_bf16 v[48:51], v[88:91], v[112:119], v2
    s_waitcnt lgkmcnt(0)
    v_add_f32 v41, v41, v43
    v_smfmac_f32_16x16x64_bf16 v[48:51], v[92:95], v[120:127], v2
    ds_read_b128 v[96:99], v1 offset:16384
    v_mul_f32 v40, s48, v40
    v_smfmac_f32_16x16x64_bf16 v[44:47], v[80:83], a[24:31], v2
    ds_read_b128 v[100:103], v1 offset:17408
    v_mul_f32 v41, s48, v41
    v_smfmac_f32_16x16x64_bf16 v[44:47], v[84:87], a[40:47], v2
    ds_read_b128 v[104:107], v1 offset:18432
    v_cvt_pk_bf16_f32 v42, v40, v41
    v_smfmac_f32_16x16x64_bf16 v[44:47], v[88:91], a[56:63], v2
    ds_read_b128 v[108:111], v1 offset:19456
    v_add_f32 v48, v48, v50
    v_smfmac_f32_16x16x64_bf16 v[44:47], v[92:95], a[72:79], v2
    ds_read_b128 v[112:115], v1 offset:20480
    v_add_f32 v49, v49, v51
    v_smfmac_f32_16x16x64_bf16 v[52:55], v[80:83], a[128:135], v2
    ds_read_b128 v[116:119], v1 offset:21504
    v_cvt_pk_bf16_f32 v43, v48, v49
    v_smfmac_f32_16x16x64_bf16 v[52:55], v[84:87], a[136:143], v2
    ds_read_b128 v[120:123], v1 offset:22528
    v_add_f32 v44, v44, v46
    v_smfmac_f32_16x16x64_bf16 v[52:55], v[88:91], a[144:151], v2
    ds_read_b128 v[124:127], v1 offset:23552
    v_add_f32 v45, v45, v47
    v_smfmac_f32_16x16x64_bf16 v[52:55], v[92:95], a[152:159], v2
    s_cbranch_vccnz L_rec0_0
L_norec0_0:
    v_mul_f32 v44, s48, v44
    v_mfma_f32_16x16x16_bf16 v[48:51], v[42:43], v[4:5], 0
    v_mul_f32 v45, s48, v45
    v_cvt_pk_bf16_f32 v46, v44, v45
    s_nop 1
    v_add_f32 v52, v52, v54
    v_add_f32 v53, v53, v55
    v_cvt_pk_bf16_f32 v47, v52, v53
    s_mov_b64 vcc, s[56:57]
    v_cvt_pk_bf16_f32 v40, v48, v49
    v_mfma_f32_16x16x16_bf16 v[52:55], v[46:47], v[4:5], 0
    v_cvt_pk_bf16_f32 v41, v50, v51
    v_smfmac_f32_16x16x64_bf16 v[56:59], v[72:75], a[192:199], v2
    s_mov_b32 m0, 0
    s_nop 2
    v_cvt_pk_bf16_f32 v42, v52, v53
    v_cvt_pk_bf16_f32 v43, v54, v55
    s_nop 1
    v_mfma_f32_16x16x32_bf16 v[44:47], v[32:35], v[40:43], 0
    v_mfma_f32_16x16x32_bf16 v[48:51], v[36:39], v[40:43], 0
    v_mov_b64 v[32:33], 0
    v_mov_b64 v[34:35], 0
    v_mfma_f32_16x16x32_bf16 v[52:55], v[40:43], v[40:43], 0
    v_mov_b64 v[36:37], 0
    v_mov_b64 v[38:39], 0
    s_nop 0
    v_cndmask_b32_dpp v44, v48, v44, vcc quad_perm:[0,1,0,1] row_mask:0xf bank_mask:0xf
    v_cndmask_b32_dpp v45, v49, v45, vcc quad_perm:[0,1,0,1] row_mask:0xf bank_mask:0xf
    v_cndmask_b32_dpp v46, v50, v46, vcc quad_perm:[0,1,0,1] row_mask:0xf bank_mask:0xf
    v_cndmask_b32_dpp v47, v51, v47, vcc quad_perm:[0,1,0,1] row_mask:0xf bank_mask:0xf
    v_cndmask_b32_dpp v12, v55, v54, vcc quad_perm:[0,1,0,1] row_mask:0xf bank_mask:0xf
    v_smfmac_f32_16x16x64_bf16 v[56:59], v[76:79], a[208:215], v2
    ds_write_b128 v0, v[44:47] offset:8192
    v_smfmac_f32_16x16x64_bf16 v[56:59], v[80:83], a[224:231], v2
    ds_write_addtid_b32 v12 offset:12288
    v_smfmac_f32_16x16x64_bf16 v[56:59], v[84:87], a[232:239], v2
    v_smfmac_f32_16x16x64_bf16 v[56:59], v[88:91], a[240:247], v2
    v_smfmac_f32_16x16x64_bf16 v[56:59], v[92:95], a[248:255], v2
    s_waitcnt lgkmcnt(0)
    s_barrier
    ds_read_addtid_b32 v13 offset:12544
    ds_read_addtid_b32 v14 offset:12800
    v_smfmac_f32_16x16x64_bf16 v[60:63], v[72:75], a[200:207], v2
    ds_read_addtid_b32 v15 offset:13056
    ds_read_b128 v[40:43], v0 offset:9216
    v_smfmac_f32_16x16x64_bf16 v[60:63], v[76:79], a[216:223], v2
    ds_read_b128 v[48:51], v0 offset:10240
    ds_read_b128 v[52:55], v0 offset:11264
    v_add_f32 v56, v56, v58
    v_smfmac_f32_16x16x64_bf16 v[60:63], v[80:83], v[96:103], v2
    v_add_f32 v57, v57, v59
    v_smfmac_f32_16x16x64_bf16 v[60:63], v[84:87], v[104:111], v2
    v_cvt_pk_bf16_f32 v16, v56, v57
    v_smfmac_f32_16x16x64_bf16 v[60:63], v[88:91], v[112:119], v2
    s_waitcnt lgkmcnt(1)
    v_cvt_pk_bf16_f32 v20, v56, v57
    v_add_f32 v12, v12, v13
    v_add_f32 v14, v14, v15
    v_add_f32 v12, v12, v14
    v_pk_add_f32 v[44:45], v[44:45], v[40:41]
    v_pk_add_f32 v[46:47], v[46:47], v[42:43]
    v_pk_add_f32 v[44:45], v[44:45], v[48:49]
    v_pk_add_f32 v[46:47], v[46:47], v[50:51]
    s_waitcnt lgkmcnt(0)
    v_pk_add_f32 v[44:45], v[44:45], v[52:53]
    v_pk_add_f32 v[46:47], v[46:47], v[54:55]
    v_max3_f32 v40, v44, v45, v12
    v_max3_f32 v40, v40, v46, v47
    v_smfmac_f32_16x16x64_bf16 v[60:63], v[92:95], v[120:127], v2
    ds_read_b128 v[96:99], v1 offset:32768
    ds_read_b128 v[100:103], v1 offset:33792
    v_max_f32_dpp v40, v40, v40 quad_perm:[2,3,0,1] row_mask:0xf bank_mask:0xf
    v_mov_b32 v41, v40
    v_mov_b64 v[52:53], s[58:59]
    v_mov_b64 v[54:55], s[58:59]
    v_permlane16_swap_b32 v40, v41
    v_max_f32 v40, v40, v41
    v_mov_b32 v41, v40
    v_add_f32 v60, v60, v62
    v_add_f32 v61, v61, v63
    v_permlane32_swap_b32 v40, v41
    v_max_f32 v40, v40, v41
    v_sub_f32 v12, v12, v40
    v_pk_add_f32 v[44:45], v[44:45], v[40:41] op_sel_hi:[1,0] neg_lo:[0,1] neg_hi:[0,1]
    v_pk_add_f32 v[46:47], v[46:47], v[40:41] op_sel_hi:[1,0] neg_lo:[0,1] neg_hi:[0,1]
    v_exp_f32 v12, v12
    v_exp_f32 v44, v44
    v_exp_f32 v45, v45
    v_exp_f32 v46, v46
    v_exp_f32 v47, v47
    v_cvt_pk_bf16_f32 v12, v12, v12
    v_cvt_pk_bf16_f32 v49, v44, v45
    v_cvt_pk_bf16_f32 v51, v46, v47
    v_and_b32 v48, v12, v17
    v_and_b32 v50, v12, v21
    v_cvt_pk_bf16_f32 v24, v60, v61
    v_cvt_pk_bf16_f32 v28, v60, v61
    v_mfma_f32_16x16x32_bf16 v[40:43], v[48:51], v[52:55], 0
    v_mov_b64 v[64:65], 0
    v_mov_b64 v[66:67], 0
    v_smfmac_f32_16x16x64_bf16 v[32:35], v[48:51], v[16:23], v2 abid:1
    ds_read_b128 v[104:107], v1 offset:34816
    ds_read_b128 v[108:111], v1 offset:35840
    v_mov_b64 v[68:69], 0
    v_smfmac_f32_16x16x64_bf16 v[36:39], v[48:51], v[24:31], v2 abid:1
    v_add_f32 v40, v40, v42
    v_add_f32 v41, v41, v43
    v_rcp_f32 v40, v40
    v_rcp_f32 v41, v41
    v_pk_add_f32 v[32:33], v[32:33], v[34:35]
    v_pk_add_f32 v[36:37], v[36:37], v[38:39]
    v_pk_mul_f32 v[32:33], v[32:33], v[40:41]
    v_pk_mul_f32 v[36:37], v[36:37], v[40:41]
    v_cvt_pk_bf16_f32 v32, v32, v36
    v_cvt_pk_bf16_f32 v33, v33, v37
    v_mfma_f32_32x32x16_bf16 v[80:95], v[64:67], v[64:67], 0
    ds_write2_b32 v9, v32, v33 offset0:0 offset1:16
    ds_read_b128 v[40:43], v10 offset:4096
    v_mov_b64 v[70:71], 0
    v_mov_b64 v[72:73], 0
    v_mov_b64 v[74:75], 0
    v_mov_b64 v[76:77], 0
    v_mov_b64 v[78:79], 0
    s_waitcnt lgkmcnt(1)
    s_barrier
    ds_read_b128 v[44:47], v10 offset:4608
    s_waitcnt lgkmcnt(1)
    v_smfmac_f32_16x16x64_bf16 v[64:67], v[40:43], v[96:103], v2
    ds_read_b128 v[48:51], v10 offset:5120
    ds_read_b128 v[52:55], v10 offset:5632
    v_smfmac_f32_16x16x64_bf16 v[68:71], v[40:43], v[104:111], v2
    s_waitcnt lgkmcnt(2)
    v_smfmac_f32_16x16x64_bf16 v[64:67], v[44:47], v[128:135], v2
    ds_read_b128 v[112:115], v1 offset:28672
    s_waitcnt lgkmcnt(2)
    v_smfmac_f32_16x16x64_bf16 v[64:67], v[48:51], v[136:143], v2
    ds_read_b128 v[116:119], v1 offset:29696
    s_waitcnt lgkmcnt(2)
    v_smfmac_f32_16x16x64_bf16 v[64:67], v[52:55], v[144:151], v2
    ds_read_b128 v[120:123], v1 offset:30720
    v_smfmac_f32_16x16x64_bf16 v[68:71], v[44:47], v[152:159], v2
    ds_read_b128 v[124:127], v1 offset:31744
    v_smfmac_f32_16x16x64_bf16 v[68:71], v[48:51], v[160:167], v2
    ds_read_b128 v[96:99], v1 offset:24576
    v_cvt_pk_bf16_f32 v56, v64, v65
    v_or_b32 v56, 1, v56
    v_cvt_pk_bf16_f32 v57, v66, v67
    v_smfmac_f32_16x16x64_bf16 v[68:71], v[52:55], v[168:175], v2
    buffer_store_dwordx2 v[56:57], v3, s[8:11], s50 offen
    ds_read_b128 v[100:103], v1 offset:25600
    v_smfmac_f32_16x16x64_bf16 v[72:75], v[40:43], v[176:183], v2
    ds_read_b128 v[104:107], v1 offset:26624
    v_smfmac_f32_16x16x64_bf16 v[72:75], v[44:47], v[184:191], v2
    ds_read_b128 v[108:111], v1 offset:27648
    v_cvt_pk_bf16_f32 v58, v68, v69
    v_or_b32 v58, 1, v58
    v_cvt_pk_bf16_f32 v59, v70, v71
    v_smfmac_f32_16x16x64_bf16 v[72:75], v[48:51], v[192:199], v2
    buffer_store_dwordx2 v[58:59], v3, s[8:11], s51 offen
    v_smfmac_f32_16x16x64_bf16 v[72:75], v[52:55], v[200:207], v2
    s_waitcnt lgkmcnt(4)
    v_smfmac_f32_16x16x64_bf16 v[76:79], v[40:43], v[112:119], v2
    v_smfmac_f32_16x16x64_bf16 v[76:79], v[44:47], v[120:127], v2
    s_waitcnt lgkmcnt(0)
    v_cvt_pk_bf16_f32 v60, v72, v73
    v_or_b32 v60, 1, v60
    v_cvt_pk_bf16_f32 v61, v74, v75
    v_smfmac_f32_16x16x64_bf16 v[76:79], v[48:51], v[96:103], v2
    buffer_store_dwordx2 v[60:61], v3, s[8:11], s2 offen
    v_smfmac_f32_16x16x64_bf16 v[76:79], v[52:55], v[104:111], v2
    s_add_u32 s36, s36, 1
    s_cmp_lt_u32 s36, 62
    s_cselect_b32 s45, 0x80000, 0
    s_add_u32 s38, s38, s45
    s_mov_b32 s54, 0
    s_add_u32 s39, s39, 0x2000
    s_nop 1
    v_cvt_pk_bf16_f32 v62, v76, v77
    v_or_b32 v62, 1, v62
    v_cvt_pk_bf16_f32 v63, v78, v79
    buffer_store_dwordx2 v[62:63], v3, s[8:11], s99 offen
    s_nop 15
    s_nop 15
    s_nop 7
    buffer_load_dwordx4 v[64:67], v0, s[8:11], s40 offen offset:0 sc1
    buffer_load_dwordx4 v[68:71], v0, s[8:11], s40 offen offset:1024 sc1
    buffer_load_dwordx4 v[72:75], v0, s[8:11], s40 offen offset:2048 sc1
    buffer_load_dwordx4 v[76:79], v0, s[8:11], s40 offen offset:3072 sc1
    s_nop 15
    buffer_load_dwordx4 v[80:83], v0, s[8:11], s41 offen offset:0 sc1
    buffer_load_dwordx4 v[84:87], v0, s[8:11], s41 offen offset:1024 sc1
    buffer_load_dwordx4 v[88:91], v0, s[8:11], s41 offen offset:2048 sc1
    buffer_load_dwordx4 v[92:95], v0, s[8:11], s41 offen offset:3072 sc1
    ds_read_b128 v[32:35], v0 offset:15360
    ds_read_b128 v[96:99], v1 offset:0
    ds_read_b128 v[100:103], v1 offset:1024
    ds_read_b128 v[104:107], v1 offset:2048
    ds_read_b128 v[108:111], v1 offset:3072
    ds_read_b128 v[112:115], v1 offset:4096
    ds_read_b128 v[116:119], v1 offset:5120
    ds_read_b128 v[120:123], v1 offset:6144
    ds_read_b128 v[124:127], v1 offset:7168
    v_mov_b64 v[40:41], 0
    v_mov_b64 v[42:43], 0
    v_mov_b64 v[44:45], 0
    v_mov_b64 v[46:47], 0
    v_mov_b64 v[48:49], 0
    v_mov_b64 v[50:51], 0
    v_mov_b64 v[52:53], 0
    v_mov_b64 v[54:55], 0
    s_waitcnt vmcnt(7) lgkmcnt(0)
    v_mfma_f32_16x16x32_bf16 v[36:39], v[32:35], v[64:67], 0
    s_waitcnt vmcnt(6)
    v_mfma_f32_16x16x32_bf16 v[36:39], v[32:35], v[68:71], v[36:39]
    v_bitop3_b32 v28, v64, v66, v68 bitop3:0x80
    s_waitcnt vmcnt(5)
    v_mfma_f32_16x16x32_bf16 v[36:39], v[32:35], v[72:75], v[36:39]
    v_bitop3_b32 v28, v28, v70, v72 bitop3:0x80
    s_waitcnt vmcnt(4)
    v_mfma_f32_16x16x32_bf16 v[36:39], v[32:35], v[76:79], v[36:39]
    v_bitop3_b32 v28, v28, v74, v76 bitop3:0x80
    s_waitcnt vmcnt(3)
    v_mfma_f32_16x16x32_bf16 v[12:15], v[32:35], v[80:83], 0
    v_bitop3_b32 v28, v28, v78, v80 bitop3:0x80
    s_waitcnt vmcnt(2)
    v_mfma_f32_16x16x32_bf16 v[12:15], v[32:35], v[84:87], v[12:15]
    v_bitop3_b32 v28, v28, v82, v84 bitop3:0x80
    s_waitcnt vmcnt(1)
    v_mfma_f32_16x16x32_bf16 v[12:15], v[32:35], v[88:91], v[12:15]
    v_bitop3_b32 v28, v28, v86, v88 bitop3:0x80
    v_add_f32_dpp v36, v36, v36 row_ror:8 row_mask:0xf bank_mask:0x3
    s_waitcnt vmcnt(0)
    v_mfma_f32_16x16x32_bf16 v[12:15], v[32:35], v[92:95], v[12:15]
    v_bitop3_b32 v28, v28, v90, v92 bitop3:0x80
    v_bitop3_b32 v28, v28, v94, 1 bitop3:0x80
    v_cmp_eq_u32 vcc, 0, v28
    v_add_f32_dpp v37, v37, v37 row_ror:8 row_mask:0xf bank_mask:0x3
    v_add_f32_dpp v38, v38, v38 row_ror:8 row_mask:0xf bank_mask:0x3
    v_add_f32_dpp v39, v39, v39 row_ror:8 row_mask:0xf bank_mask:0x3
L_p1ok0_0:
    s_nop 0
    v_add_f32_dpp v36, v12, v12 row_ror:8 row_mask:0xf bank_mask:0xc
    v_add_f32_dpp v37, v13, v13 row_ror:8 row_mask:0xf bank_mask:0xc
    v_add_f32_dpp v38, v14, v14 row_ror:8 row_mask:0xf bank_mask:0xc
    v_add_f32_dpp v39, v15, v15 row_ror:8 row_mask:0xf bank_mask:0xc
    v_cvt_pk_bf16_f32 v14, v36, v37
    v_cvt_pk_bf16_f32 v15, v38, v39
    v_or_b32 v14, 1, v14
    s_cbranch_vccnz L_p1b0_0
    buffer_store_dwordx2 v[14:15], v6, s[8:11], 0 offen
    s_cmp_eq_u32 s36, 63
    s_cbranch_scc1 L_chain_fin
    v_mov_b64 v[32:33], v[240:241]
    v_mov_b64 v[34:35], v[242:243]
    v_mov_b64 v[36:37], v[244:245]
    v_mov_b64 v[38:39], v[246:247]
    v_mov_b64 v[18:19], v[248:249]
    v_mov_b64 v[22:23], v[250:251]
    v_mov_b64 v[26:27], v[252:253]
    v_mov_b64 v[30:31], v[254:255]
    v_mov_b64 v[56:57], 0
    v_mov_b64 v[58:59], 0
    v_mov_b64 v[60:61], 0
    v_mov_b64 v[62:63], 0
    s_nop 12
    buffer_load_dword v16, v25, s[8:11], s42 offen sc1
    s_nop 5
    buffer_load_dwordx4 v29, s[8:11], s6 offen offset:0 sc1 lds
    buffer_load_dwordx4 v29, s[8:11], s43 offen offset:1024 sc1 lds
    s_nop 3
    buffer_load_dword v20, v25, s[8:11], s42 offen sc1
    s_nop 5
    buffer_load_dwordx4 v29, s[8:11], s6 offen offset:0 sc1 lds
    buffer_load_dwordx4 v29, s[8:11], s43 offen offset:1024 sc1 lds
    s_nop 3
    buffer_load_dword v24, v25, s[8:11], s42 offen sc1
    s_nop 5
    buffer_load_dwordx4 v29, s[8:11], s6 offen offset:0 sc1 lds
    buffer_load_dwordx4 v29, s[8:11], s43 offen offset:1024 sc1 lds
    buffer_load_dwordx4 v29, s[8:11], s44 offen offset:2048 sc1 lds
    buffer_load_dwordx4 v29, s[8:11], s55 offen offset:3072 sc1 lds
    s_waitcnt vmcnt(10)
    v_cmp_ne_u32 vcc, 1, v16
    s_cbranch_vccz L_p2ok0_0
    buffer_load_dword v16, v25, s[8:11], s42 offen sc1
    s_nop 1
    buffer_load_dwordx4 v29, s[8:11], s6 offen offset:0 sc1 lds
    buffer_load_dwordx4 v29, s[8:11], s43 offen offset:1024 sc1 lds
    s_waitcnt vmcnt(10)
    v_cmp_ne_u32 vcc, 1, v20
    s_cbranch_vccz L_p2ok0_0
    buffer_load_dword v20, v25, s[8:11], s42 offen sc1
    s_nop 1
    buffer_load_dwordx4 v29, s[8:11], s6 offen offset:0 sc1 lds
    buffer_load_dwordx4 v29, s[8:11], s43 offen offset:1024 sc1 lds
    s_waitcnt vmcnt(10)
    v_cmp_ne_u32 vcc, 1, v24
    s_cbranch_vccz L_p2ok0_0
    buffer_load_dword v24, v25, s[8:11], s42 offen sc1
    s_nop 1
    buffer_load_dwordx4 v29, s[8:11], s6 offen offset:0 sc1 lds
    buffer_load_dwordx4 v29, s[8:11], s43 offen offset:1024 sc1 lds
L_p20_0:
    s_waitcnt vmcnt(8)
    v_cmp_ne_u32 vcc, 1, v16
    s_cbranch_vccz L_p2f0_0
    buffer_load_dword v16, v25, s[8:11], s42 offen sc1
    s_nop 1
    buffer_load_dwordx4 v29, s[8:11], s6 offen offset:0 sc1 lds
    buffer_load_dwordx4 v29, s[8:11], s43 offen offset:1024 sc1 lds
    s_waitcnt vmcnt(8)
    v_cmp_ne_u32 vcc, 1, v20
    s_cbranch_vccz L_p2f0_0
    buffer_load_dword v20, v25, s[8:11], s42 offen sc1
    s_nop 1
    buffer_load_dwordx4 v29, s[8:11], s6 offen offset:0 sc1 lds
    buffer_load_dwordx4 v29, s[8:11], s43 offen offset:1024 sc1 lds
    s_waitcnt vmcnt(8)
    v_cmp_ne_u32 vcc, 1, v24
    s_cbranch_vccz L_p2f0_0
    buffer_load_dword v24, v25, s[8:11], s42 offen sc1
    s_nop 1
    buffer_load_dwordx4 v29, s[8:11], s6 offen offset:0 sc1 lds
    buffer_load_dwordx4 v29, s[8:11], s43 offen offset:1024 sc1 lds
    s_add_u32 s54, s54, 1
    s_cmp_lt_u32 s54, 12
    s_cbranch_scc1 L_p20_0
    s_branch L_p2d0_0
L_p1b0_0:
L_p1c0_0:
    buffer_load_dwordx4 v[64:67], v0, s[8:11], s40 offen offset:0 sc1
    buffer_load_dwordx4 v[68:71], v0, s[8:11], s40 offen offset:1024 sc1
    buffer_load_dwordx4 v[72:75], v0, s[8:11], s40 offen offset:2048 sc1
    buffer_load_dwordx4 v[76:79], v0, s[8:11], s40 offen offset:3072 sc1
    buffer_load_dwordx4 v[80:83], v0, s[8:11], s41 offen offset:0 sc1
    buffer_load_dwordx4 v[84:87], v0, s[8:11], s41 offen offset:1024 sc1
    buffer_load_dwordx4 v[88:91], v0, s[8:11], s41 offen offset:2048 sc1
    buffer_load_dwordx4 v[92:95], v0, s[8:11], s41 offen offset:3072 sc1
    s_waitcnt vmcnt(7) lgkmcnt(0)
    v_mfma_f32_16x16x32_bf16 v[36:39], v[32:35], v[64:67], 0
    s_waitcnt vmcnt(6)
    v_mfma_f32_16x16x32_bf16 v[36:39], v[32:35], v[68:71], v[36:39]
    v_bitop3_b32 v28, v64, v66, v68 bitop3:0x80
    s_waitcnt vmcnt(5)
    v_mfma_f32_16x16x32_bf16 v[36:39], v[32:35], v[72:75], v[36:39]
    v_bitop3_b32 v28, v28, v70, v72 bitop3:0x80
    s_waitcnt vmcnt(4)
    v_mfma_f32_16x16x32_bf16 v[36:39], v[32:35], v[76:79], v[36:39]
    v_bitop3_b32 v28, v28, v74, v76 bitop3:0x80
    s_waitcnt vmcnt(3)
    v_mfma_f32_16x16x32_bf16 v[12:15], v[32:35], v[80:83], 0
    v_bitop3_b32 v28, v28, v78, v80 bitop3:0x80
    s_waitcnt vmcnt(2)
    v_mfma_f32_16x16x32_bf16 v[12:15], v[32:35], v[84:87], v[12:15]
    v_bitop3_b32 v28, v28, v82, v84 bitop3:0x80
    s_waitcnt vmcnt(1)
    v_mfma_f32_16x16x32_bf16 v[12:15], v[32:35], v[88:91], v[12:15]
    v_bitop3_b32 v28, v28, v86, v88 bitop3:0x80
    v_add_f32_dpp v36, v36, v36 row_ror:8 row_mask:0xf bank_mask:0x3
    s_waitcnt vmcnt(0)
    v_mfma_f32_16x16x32_bf16 v[12:15], v[32:35], v[92:95], v[12:15]
    v_bitop3_b32 v28, v28, v90, v92 bitop3:0x80
    v_bitop3_b32 v28, v28, v94, 1 bitop3:0x80
    v_cmp_eq_u32 vcc, 0, v28
    v_add_f32_dpp v37, v37, v37 row_ror:8 row_mask:0xf bank_mask:0x3
    v_add_f32_dpp v38, v38, v38 row_ror:8 row_mask:0xf bank_mask:0x3
    v_add_f32_dpp v39, v39, v39 row_ror:8 row_mask:0xf bank_mask:0x3
    s_cbranch_vccz L_p1ok0_0
    s_add_u32 s54, s54, 1
    s_and_b32 s45, s54, 63
    s_cbranch_scc1 L_p1c0_0
    buffer_wbl2 sc1
    s_waitcnt vmcnt(0)
    buffer_inv sc1
    s_waitcnt vmcnt(0)
    s_cmp_lt_u32 s54, 0x40000
    s_cbranch_scc1 L_p1c0_0
    s_endpgm
L_p2f0_0:
    buffer_load_dwordx4 v29, s[8:11], s44 offen offset:2048 sc1 lds
    buffer_load_dwordx4 v29, s[8:11], s55 offen offset:3072 sc1 lds
L_p2ok0_0:
    s_waitcnt vmcnt(8)
L_step0_1:
    s_barrier
    ds_read_b128 v[64:67], v7 offset:0
    ds_read_b128 v[68:71], v7 offset:1024
    s_waitcnt lgkmcnt(1)
    v_smfmac_f32_16x16x64_bf16 v[40:43], v[64:67], v[96:103], v2
    v_smfmac_f32_16x16x64_bf16 v[44:47], v[64:67], v[104:111], v2
    buffer_store_dwordx2 v[14:15], v8, s[8:11], s39 offen sc1
    v_smfmac_f32_16x16x64_bf16 v[48:51], v[64:67], v[112:119], v2
    buffer_load_dwordx4 v[240:243], v0, s[8:11], s38 offen offset:0 sc1
    v_smfmac_f32_16x16x64_bf16 v[52:55], v[64:67], v[120:127], v2
    ds_read_b128 v[96:99], v1 offset:8192
    s_waitcnt lgkmcnt(1)
    v_smfmac_f32_16x16x64_bf16 v[40:43], v[68:71], v[208:215], v2
    ds_read_b128 v[100:103], v1 offset:9216
    v_smfmac_f32_16x16x64_bf16 v[44:47], v[68:71], v[216:223], v2
    ds_read_b128 v[104:107], v1 offset:10240
    v_smfmac_f32_16x16x64_bf16 v[48:51], v[68:71], a[80:87], v2
    buffer_load_dwordx4 v[244:247], v0, s[8:11], s38 offen offset:1024 sc1
    v_smfmac_f32_16x16x64_bf16 v[52:55], v[68:71], a[88:95], v2
    s_waitcnt vmcnt(3)
    s_barrier
    ds_read_b128 v[72:75], v7 offset:2048
    v_smfmac_f32_16x16x64_bf16 v[56:59], v[64:67], a[160:167], v2
    ds_read_b128 v[76:79], v7 offset:3072
    v_smfmac_f32_16x16x64_bf16 v[56:59], v[68:71], a[176:183], v2
    ds_read_b128 v[108:111], v1 offset:11264
    v_smfmac_f32_16x16x64_bf16 v[60:63], v[64:67], a[168:175], v2
    ds_read_b128 v[112:115], v1 offset:12288
    v_smfmac_f32_16x16x64_bf16 v[60:63], v[68:71], a[184:191], v2
    ds_read_b128 v[116:119], v1 offset:13312
    s_waitcnt lgkmcnt(4)
    v_smfmac_f32_16x16x64_bf16 v[40:43], v[72:75], v[224:231], v2
    buffer_load_dwordx4 v[248:251], v0, s[8:11], s38 offen offset:2048 sc1
    v_smfmac_f32_16x16x64_bf16 v[44:47], v[72:75], v[232:239], v2
    ds_read_b128 v[120:123], v1 offset:14336
    v_bitop3_b32 v12, v64, v66, v68 bitop3:0x80
    v_smfmac_f32_16x16x64_bf16 v[48:51], v[72:75], a[96:103], v2
    s_barrier
    ds_read_b128 v[80:83], v7 offset:4096
    v_bitop3_b32 v12, v12, v70, v72 bitop3:0x80
    v_smfmac_f32_16x16x64_bf16 v[52:55], v[72:75], a[104:111], v2
    ds_read_b128 v[84:87], v7 offset:5120
    s_waitcnt lgkmcnt(6)
    v_smfmac_f32_16x16x64_bf16 v[40:43], v[76:79], a[0:7], v2
    ds_read_b128 v[88:91], v7 offset:6144
    v_bitop3_b32 v12, v12, v74, v76 bitop3:0x80
    v_smfmac_f32_16x16x64_bf16 v[44:47], v[76:79], a[8:15], v2
    ds_read_b128 v[92:95], v7 offset:7168
    v_smfmac_f32_16x16x64_bf16 v[48:51], v[76:79], a[112:119], v2
    ds_read_b128 v[124:127], v1 offset:15360
    v_smfmac_f32_16x16x64_bf16 v[52:55], v[76:79], a[120:127], v2
    s_waitcnt lgkmcnt(4)
    v_bitop3_b32 v12, v12, v78, v80 bitop3:0x80
    v_smfmac_f32_16x16x64_bf16 v[40:43], v[80:83], a[16:23], v2
    buffer_load_dwordx4 v[252:255], v0, s[8:11], s38 offen offset:3072 sc1
    s_waitcnt lgkmcnt(3)
    v_bitop3_b32 v12, v12, v82, v84 bitop3:0x80
    v_smfmac_f32_16x16x64_bf16 v[40:43], v[84:87], a[32:39], v2
    s_waitcnt lgkmcnt(2)
    v_bitop3_b32 v12, v12, v86, v88 bitop3:0x80
    v_smfmac_f32_16x16x64_bf16 v[40:43], v[88:91], a[48:55], v2
    s_waitcnt lgkmcnt(1)
    v_bitop3_b32 v12, v12, v90, v92 bitop3:0x80
    v_smfmac_f32_16x16x64_bf16 v[40:43], v[92:95], a[64:71], v2
    v_bitop3_b32 v12, v12, v94, 1 bitop3:0x80
    v_smfmac_f32_16x16x64_bf16 v[48:51], v[80:83], v[96:103], v2
    v_cmp_eq_u32 vcc, 0, v12
    v_smfmac_f32_16x16x64_bf16 v[48:51], v[84:87], v[104:111], v2
    v_add_f32 v40, v40, v42
    v_smfmac_f32_16x16x64_bf16 v[48:51], v[88:91], v[112:119], v2
    s_waitcnt lgkmcnt(0)
    v_add_f32 v41, v41, v43
    v_smfmac_f32_16x16x64_bf16 v[48:51], v[92:95], v[120:127], v2
    ds_read_b128 v[96:99], v1 offset:16384
    v_mul_f32 v40, s48, v40
    v_smfmac_f32_16x16x64_bf16 v[44:47], v[80:83], a[24:31], v2
    ds_read_b128 v[100:103], v1 offset:17408
    v_mul_f32 v41, s48, v41
    v_smfmac_f32_16x16x64_bf16 v[44:47], v[84:87], a[40:47], v2
    ds_read_b128 v[104:107], v1 offset:18432
    v_cvt_pk_bf16_f32 v42, v40, v41
    v_smfmac_f32_16x16x64_bf16 v[44:47], v[88:91], a[56:63], v2
    ds_read_b128 v[108:111], v1 offset:19456
    v_add_f32 v48, v48, v50
    v_smfmac_f32_16x16x64_bf16 v[44:47], v[92:95], a[72:79], v2
    ds_read_b128 v[112:115], v1 offset:20480
    v_add_f32 v49, v49, v51
    v_smfmac_f32_16x16x64_bf16 v[52:55], v[80:83], a[128:135], v2
    ds_read_b128 v[116:119], v1 offset:21504
    v_cvt_pk_bf16_f32 v43, v48, v49
    v_smfmac_f32_16x16x64_bf16 v[52:55], v[84:87], a[136:143], v2
    ds_read_b128 v[120:123], v1 offset:22528
    v_add_f32 v44, v44, v46
    v_smfmac_f32_16x16x64_bf16 v[52:55], v[88:91], a[144:151], v2
    ds_read_b128 v[124:127], v1 offset:23552
    v_add_f32 v45, v45, v47
    v_smfmac_f32_16x16x64_bf16 v[52:55], v[92:95], a[152:159], v2
    s_cbranch_vccnz L_rec0_1
L_norec0_1:
    v_mul_f32 v44, s48, v44
    v_mfma_f32_16x16x16_bf16 v[48:51], v[42:43], v[4:5], 0
    v_mul_f32 v45, s48, v45
    v_cvt_pk_bf16_f32 v46, v44, v45
    s_nop 1
    v_add_f32 v52, v52, v54
    v_add_f32 v53, v53, v55
    v_cvt_pk_bf16_f32 v47, v52, v53
    s_mov_b64 vcc, s[56:57]
    v_cvt_pk_bf16_f32 v40, v48, v49
    v_mfma_f32_16x16x16_bf16 v[52:55], v[46:47], v[4:5], 0
    v_cvt_pk_bf16_f32 v41, v50, v51
    v_smfmac_f32_16x16x64_bf16 v[56:59], v[72:75], a[192:199], v2
    s_mov_b32 m0, 0
    s_nop 2
    v_cvt_pk_bf16_f32 v42, v52, v53
    v_cvt_pk_bf16_f32 v43, v54, v55
    s_nop 1
    v_mfma_f32_16x16x32_bf16 v[44:47], v[32:35], v[40:43], 0
    v_mfma_f32_16x16x32_bf16 v[48:51], v[36:39], v[40:43], 0
    v_mov_b64 v[32:33], 0
    v_mov_b64 v[34:35], 0
    v_mfma_f32_16x16x32_bf16 v[52:55], v[40:43], v[40:43], 0
    v_mov_b64 v[36:37], 0
    v_mov_b64 v[38:39], 0
    s_nop 0
    v_cndmask_b32_dpp v44, v48, v44, vcc quad_perm:[0,1,0,1] row_mask:0xf bank_mask:0xf
    v_cndmask_b32_dpp v45, v49, v45, vcc quad_perm:[0,1,0,1] row_mask:0xf bank_mask:0xf
    v_cndmask_b32_dpp v46, v50, v46, vcc quad_perm:[0,1,0,1] row_mask:0xf bank_mask:0xf
    v_cndmask_b32_dpp v47, v51, v47, vcc quad_perm:[0,1,0,1] row_mask:0xf bank_mask:0xf
    v_cndmask_b32_dpp v12, v55, v54, vcc quad_perm:[0,1,0,1] row_mask:0xf bank_mask:0xf
    v_smfmac_f32_16x16x64_bf16 v[56:59], v[76:79], a[208:215], v2
    ds_write_b128 v0, v[44:47] offset:8192
    v_smfmac_f32_16x16x64_bf16 v[56:59], v[80:83], a[224:231], v2
    ds_write_addtid_b32 v12 offset:12288
    v_smfmac_f32_16x16x64_bf16 v[56:59], v[84:87], a[232:239], v2
    v_smfmac_f32_16x16x64_bf16 v[56:59], v[88:91], a[240:247], v2
    v_smfmac_f32_16x16x64_bf16 v[56:59], v[92:95], a[248:255], v2
    s_waitcnt lgkmcnt(0)
    s_barrier
    ds_read_addtid_b32 v13 offset:12544
    ds_read_addtid_b32 v14 offset:12800
    v_smfmac_f32_16x16x64_bf16 v[60:63], v[72:75], a[200:207], v2
    ds_read_addtid_b32 v15 offset:13056
    ds_read_b128 v[40:43], v0 offset:9216
    v_smfmac_f32_16x16x64_bf16 v[60:63], v[76:79], a[216:223], v2
    ds_read_b128 v[48:51], v0 offset:10240
    ds_read_b128 v[52:55], v0 offset:11264
    v_add_f32 v56, v56, v58
    v_smfmac_f32_16x16x64_bf16 v[60:63], v[80:83], v[96:103], v2
    v_add_f32 v57, v57, v59
    v_smfmac_f32_16x16x64_bf16 v[60:63], v[84:87], v[104:111], v2
    v_cvt_pk_bf16_f32 v16, v56, v57
    v_smfmac_f32_16x16x64_bf16 v[60:63], v[88:91], v[112:119], v2
    s_waitcnt lgkmcnt(1)
    v_cvt_pk_bf16_f32 v20, v56, v57
    v_add_f32 v12, v12, v13
    v_add_f32 v14, v14, v15
    v_add_f32 v12, v12, v14
    v_pk_add_f32 v[44:45], v[44:45], v[40:41]
    v_pk_add_f32 v[46:47], v[46:47], v[42:43]
    v_pk_add_f32 v[44:45], v[44:45], v[48:49]
    v_pk_add_f32 v[46:47], v[46:47], v[50:51]
    s_waitcnt lgkmcnt(0)
    v_pk_add_f32 v[44:45], v[44:45], v[52:53]
    v_pk_add_f32 v[46:47], v[46:47], v[54:55]
    v_max3_f32 v40, v44, v45, v12
    v_max3_f32 v40, v40, v46, v47
    v_smfmac_f32_16x16x64_bf16 v[60:63], v[92:95], v[120:127], v2
    ds_read_b128 v[96:99], v1 offset:32768
    ds_read_b128 v[100:103], v1 offset:33792
    v_max_f32_dpp v40, v40, v40 quad_perm:[2,3,0,1] row_mask:0xf bank_mask:0xf
    v_mov_b32 v41, v40
    v_mov_b64 v[52:53], s[58:59]
    v_mov_b64 v[54:55], s[58:59]
    v_permlane16_swap_b32 v40, v41
    v_max_f32 v40, v40, v41
    v_mov_b32 v41, v40
    v_add_f32 v60, v60, v62
    v_add_f32 v61, v61, v63
    v_permlane32_swap_b32 v40, v41
    v_max_f32 v40, v40, v41
    v_sub_f32 v12, v12, v40
    v_pk_add_f32 v[44:45], v[44:45], v[40:41] op_sel_hi:[1,0] neg_lo:[0,1] neg_hi:[0,1]
    v_pk_add_f32 v[46:47], v[46:47], v[40:41] op_sel_hi:[1,0] neg_lo:[0,1] neg_hi:[0,1]
    v_exp_f32 v12, v12
    v_exp_f32 v44, v44
    v_exp_f32 v45, v45
    v_exp_f32 v46, v46
    v_exp_f32 v47, v47
    v_cvt_pk_bf16_f32 v12, v12, v12
    v_cvt_pk_bf16_f32 v49, v44, v45
    v_cvt_pk_bf16_f32 v51, v46, v47
    v_and_b32 v48, v12, v17
    v_and_b32 v50, v12, v21
    v_cvt_pk_bf16_f32 v24, v60, v61
    v_cvt_pk_bf16_f32 v28, v60, v61
    v_mfma_f32_16x16x32_bf16 v[40:43], v[48:51], v[52:55], 0
    v_mov_b64 v[64:65], 0
    v_mov_b64 v[66:67], 0
    v_smfmac_f32_16x16x64_bf16 v[32:35], v[48:51], v[16:23], v2 abid:1
    ds_read_b128 v[104:107], v1 offset:34816
    ds_read_b128 v[108:111], v1 offset:35840
    v_mov_b64 v[68:69], 0
    v_smfmac_f32_16x16x64_bf16 v[36:39], v[48:51], v[24:31], v2 abid:1
    v_add_f32 v40, v40, v42
    v_add_f32 v41, v41, v43
    v_rcp_f32 v40, v40
    v_rcp_f32 v41, v41
    v_pk_add_f32 v[32:33], v[32:33], v[34:35]
    v_pk_add_f32 v[36:37], v[36:37], v[38:39]
    v_pk_mul_f32 v[32:33], v[32:33], v[40:41]
    v_pk_mul_f32 v[36:37], v[36:37], v[40:41]
    v_cvt_pk_bf16_f32 v32, v32, v36
    v_cvt_pk_bf16_f32 v33, v33, v37
    v_mfma_f32_32x32x16_bf16 v[80:95], v[64:67], v[64:67], 0
    ds_write2_b32 v9, v32, v33 offset0:0 offset1:16
    ds_read_b128 v[40:43], v10 offset:4096
    v_mov_b64 v[70:71], 0
    v_mov_b64 v[72:73], 0
    v_mov_b64 v[74:75], 0
    v_mov_b64 v[76:77], 0
    v_mov_b64 v[78:79], 0
    s_waitcnt lgkmcnt(1)
    s_barrier
    ds_read_b128 v[44:47], v10 offset:4608
    s_waitcnt lgkmcnt(1)
    v_smfmac_f32_16x16x64_bf16 v[64:67], v[40:43], v[96:103], v2
    ds_read_b128 v[48:51], v10 offset:5120
    ds_read_b128 v[52:55], v10 offset:5632
    v_smfmac_f32_16x16x64_bf16 v[68:71], v[40:43], v[104:111], v2
    s_waitcnt lgkmcnt(2)
    v_smfmac_f32_16x16x64_bf16 v[64:67], v[44:47], v[128:135], v2
    ds_read_b128 v[112:115], v1 offset:28672
    s_waitcnt lgkmcnt(2)
    v_smfmac_f32_16x16x64_bf16 v[64:67], v[48:51], v[136:143], v2
    ds_read_b128 v[116:119], v1 offset:29696
    s_waitcnt lgkmcnt(2)
    v_smfmac_f32_16x16x64_bf16 v[64:67], v[52:55], v[144:151], v2
    ds_read_b128 v[120:123], v1 offset:30720
    v_smfmac_f32_16x16x64_bf16 v[68:71], v[44:47], v[152:159], v2
    ds_read_b128 v[124:127], v1 offset:31744
    v_smfmac_f32_16x16x64_bf16 v[68:71], v[48:51], v[160:167], v2
    ds_read_b128 v[96:99], v1 offset:24576
    v_cvt_pk_bf16_f32 v56, v64, v65
    v_and_b32 v56, -2, v56
    v_cvt_pk_bf16_f32 v57, v66, v67
    v_smfmac_f32_16x16x64_bf16 v[68:71], v[52:55], v[168:175], v2
    buffer_store_dwordx2 v[56:57], v3, s[8:11], s50 offen
    ds_read_b128 v[100:103], v1 offset:25600
    v_smfmac_f32_16x16x64_bf16 v[72:75], v[40:43], v[176:183], v2
    ds_read_b128 v[104:107], v1 offset:26624
    v_smfmac_f32_16x16x64_bf16 v[72:75], v[44:47], v[184:191], v2
    ds_read_b128 v[108:111], v1 offset:27648
    v_cvt_pk_bf16_f32 v58, v68, v69
    v_and_b32 v58, -2, v58
    v_cvt_pk_bf16_f32 v59, v70, v71
    v_smfmac_f32_16x16x64_bf16 v[72:75], v[48:51], v[192:199], v2
    buffer_store_dwordx2 v[58:59], v3, s[8:11], s51 offen
    v_smfmac_f32_16x16x64_bf16 v[72:75], v[52:55], v[200:207], v2
    s_waitcnt lgkmcnt(4)
    v_smfmac_f32_16x16x64_bf16 v[76:79], v[40:43], v[112:119], v2
    v_smfmac_f32_16x16x64_bf16 v[76:79], v[44:47], v[120:127], v2
    s_waitcnt lgkmcnt(0)
    v_cvt_pk_bf16_f32 v60, v72, v73
    v_and_b32 v60, -2, v60
    v_cvt_pk_bf16_f32 v61, v74, v75
    v_smfmac_f32_16x16x64_bf16 v[76:79], v[48:51], v[96:103], v2
    buffer_store_dwordx2 v[60:61], v3, s[8:11], s2 offen
    v_smfmac_f32_16x16x64_bf16 v[76:79], v[52:55], v[104:111], v2
    s_add_u32 s36, s36, 1
    s_cmp_lt_u32 s36, 62
    s_cselect_b32 s45, 0x80000, 0
    s_add_u32 s38, s38, s45
    s_mov_b32 s54, 0
    s_add_u32 s39, s39, 0x2000
    s_nop 1
    v_cvt_pk_bf16_f32 v62, v76, v77
    v_and_b32 v62, -2, v62
    v_cvt_pk_bf16_f32 v63, v78, v79
    buffer_store_dwordx2 v[62:63], v3, s[8:11], s99 offen
    s_nop 15
    s_nop 15
    s_nop 7
    buffer_load_dwordx4 v[64:67], v0, s[8:11], s40 offen offset:0 sc1
    buffer_load_dwordx4 v[68:71], v0, s[8:11], s40 offen offset:1024 sc1
    buffer_load_dwordx4 v[72:75], v0, s[8:11], s40 offen offset:2048 sc1
    buffer_load_dwordx4 v[76:79], v0, s[8:11], s40 offen offset:3072 sc1
    s_nop 15
    buffer_load_dwordx4 v[80:83], v0, s[8:11], s41 offen offset:0 sc1
    buffer_load_dwordx4 v[84:87], v0, s[8:11], s41 offen offset:1024 sc1
    buffer_load_dwordx4 v[88:91], v0, s[8:11], s41 offen offset:2048 sc1
    buffer_load_dwordx4 v[92:95], v0, s[8:11], s41 offen offset:3072 sc1
    ds_read_b128 v[32:35], v0 offset:15360
    ds_read_b128 v[96:99], v1 offset:0
    ds_read_b128 v[100:103], v1 offset:1024
    ds_read_b128 v[104:107], v1 offset:2048
    ds_read_b128 v[108:111], v1 offset:3072
    ds_read_b128 v[112:115], v1 offset:4096
    ds_read_b128 v[116:119], v1 offset:5120
    ds_read_b128 v[120:123], v1 offset:6144
    ds_read_b128 v[124:127], v1 offset:7168
    v_mov_b64 v[40:41], 0
    v_mov_b64 v[42:43], 0
    v_mov_b64 v[44:45], 0
    v_mov_b64 v[46:47], 0
    v_mov_b64 v[48:49], 0
    v_mov_b64 v[50:51], 0
    v_mov_b64 v[52:53], 0
    v_mov_b64 v[54:55], 0
    s_waitcnt vmcnt(7) lgkmcnt(0)
    v_mfma_f32_16x16x32_bf16 v[36:39], v[32:35], v[64:67], 0
    s_waitcnt vmcnt(6)
    v_mfma_f32_16x16x32_bf16 v[36:39], v[32:35], v[68:71], v[36:39]
    v_bitop3_b32 v28, v64, v66, v68 bitop3:0xfe
    s_waitcnt vmcnt(5)
    v_mfma_f32_16x16x32_bf16 v[36:39], v[32:35], v[72:75], v[36:39]
    v_bitop3_b32 v28, v28, v70, v72 bitop3:0xfe
    s_waitcnt vmcnt(4)
    v_mfma_f32_16x16x32_bf16 v[36:39], v[32:35], v[76:79], v[36:39]
    v_bitop3_b32 v28, v28, v74, v76 bitop3:0xfe
    s_waitcnt vmcnt(3)
    v_mfma_f32_16x16x32_bf16 v[12:15], v[32:35], v[80:83], 0
    v_bitop3_b32 v28, v28, v78, v80 bitop3:0xfe
    s_waitcnt vmcnt(2)
    v_mfma_f32_16x16x32_bf16 v[12:15], v[32:35], v[84:87], v[12:15]
    v_bitop3_b32 v28, v28, v82, v84 bitop3:0xfe
    s_waitcnt vmcnt(1)
    v_mfma_f32_16x16x32_bf16 v[12:15], v[32:35], v[88:91], v[12:15]
    v_bitop3_b32 v28, v28, v86, v88 bitop3:0xfe
    v_add_f32_dpp v36, v36, v36 row_ror:8 row_mask:0xf bank_mask:0x3
    s_waitcnt vmcnt(0)
    v_mfma_f32_16x16x32_bf16 v[12:15], v[32:35], v[92:95], v[12:15]
    v_bitop3_b32 v28, v28, v90, v92 bitop3:0xfe
    v_bitop3_b32 v28, v28, v94, 1 bitop3:0xa8
    v_cmp_ne_u32 vcc, 0, v28
    v_add_f32_dpp v37, v37, v37 row_ror:8 row_mask:0xf bank_mask:0x3
    v_add_f32_dpp v38, v38, v38 row_ror:8 row_mask:0xf bank_mask:0x3
    v_add_f32_dpp v39, v39, v39 row_ror:8 row_mask:0xf bank_mask:0x3
L_p1ok0_1:
    s_nop 0
    v_add_f32_dpp v36, v12, v12 row_ror:8 row_mask:0xf bank_mask:0xc
    v_add_f32_dpp v37, v13, v13 row_ror:8 row_mask:0xf bank_mask:0xc
    v_add_f32_dpp v38, v14, v14 row_ror:8 row_mask:0xf bank_mask:0xc
    v_add_f32_dpp v39, v15, v15 row_ror:8 row_mask:0xf bank_mask:0xc
    v_cvt_pk_bf16_f32 v14, v36, v37
    v_cvt_pk_bf16_f32 v15, v38, v39
    v_and_b32 v14, -2, v14
    s_cbranch_vccnz L_p1b0_1
    buffer_store_dwordx2 v[14:15], v6, s[8:11], 0 offen
    v_mov_b64 v[32:33], v[240:241]
    v_mov_b64 v[34:35], v[242:243]
    v_mov_b64 v[36:37], v[244:245]
    v_mov_b64 v[38:39], v[246:247]
    v_mov_b64 v[18:19], v[248:249]
    v_mov_b64 v[22:23], v[250:251]
    v_mov_b64 v[26:27], v[252:253]
    v_mov_b64 v[30:31], v[254:255]
    v_mov_b64 v[56:57], 0
    v_mov_b64 v[58:59], 0
    v_mov_b64 v[60:61], 0
    v_mov_b64 v[62:63], 0
    s_nop 15
    buffer_load_dword v16, v25, s[8:11], s42 offen sc1
    s_nop 5
    buffer_load_dwordx4 v29, s[8:11], s6 offen offset:0 sc1 lds
    buffer_load_dwordx4 v29, s[8:11], s43 offen offset:1024 sc1 lds
    s_nop 3
    buffer_load_dword v20, v25, s[8:11], s42 offen sc1
    s_nop 5
    buffer_load_dwordx4 v29, s[8:11], s6 offen offset:0 sc1 lds
    buffer_load_dwordx4 v29, s[8:11], s43 offen offset:1024 sc1 lds
    s_nop 3
    buffer_load_dword v24, v25, s[8:11], s42 offen sc1
    s_nop 5
    buffer_load_dwordx4 v29, s[8:11], s6 offen offset:0 sc1 lds
    buffer_load_dwordx4 v29, s[8:11], s43 offen offset:1024 sc1 lds
    buffer_load_dwordx4 v29, s[8:11], s44 offen offset:2048 sc1 lds
    buffer_load_dwordx4 v29, s[8:11], s55 offen offset:3072 sc1 lds
    s_waitcnt vmcnt(10)
    v_cmp_ne_u32 vcc, 0, v16
    s_cbranch_vccz L_p2ok0_1
    buffer_load_dword v16, v25, s[8:11], s42 offen sc1
    s_nop 1
    buffer_load_dwordx4 v29, s[8:11], s6 offen offset:0 sc1 lds
    buffer_load_dwordx4 v29, s[8:11], s43 offen offset:1024 sc1 lds
    s_waitcnt vmcnt(10)
    v_cmp_ne_u32 vcc, 0, v20
    s_cbranch_vccz L_p2ok0_1
    buffer_load_dword v20, v25, s[8:11], s42 offen sc1
    s_nop 1
    buffer_load_dwordx4 v29, s[8:11], s6 offen offset:0 sc1 lds
    buffer_load_dwordx4 v29, s[8:11], s43 offen offset:1024 sc1 lds
    s_waitcnt vmcnt(10)
    v_cmp_ne_u32 vcc, 0, v24
    s_cbranch_vccz L_p2ok0_1
    buffer_load_dword v24, v25, s[8:11], s42 offen sc1
    s_nop 1
    buffer_load_dwordx4 v29, s[8:11], s6 offen offset:0 sc1 lds
    buffer_load_dwordx4 v29, s[8:11], s43 offen offset:1024 sc1 lds
L_p20_1:
    s_waitcnt vmcnt(8)
    v_cmp_ne_u32 vcc, 0, v16
    s_cbranch_vccz L_p2f0_1
    buffer_load_dword v16, v25, s[8:11], s42 offen sc1
    s_nop 1
    buffer_load_dwordx4 v29, s[8:11], s6 offen offset:0 sc1 lds
    buffer_load_dwordx4 v29, s[8:11], s43 offen offset:1024 sc1 lds
    s_waitcnt vmcnt(8)
    v_cmp_ne_u32 vcc, 0, v20
    s_cbranch_vccz L_p2f0_1
    buffer_load_dword v20, v25, s[8:11], s42 offen sc1
    s_nop 1
    buffer_load_dwordx4 v29, s[8:11], s6 offen offset:0 sc1 lds
    buffer_load_dwordx4 v29, s[8:11], s43 offen offset:1024 sc1 lds
    s_waitcnt vmcnt(8)
    v_cmp_ne_u32 vcc, 0, v24
    s_cbranch_vccz L_p2f0_1
    buffer_load_dword v24, v25, s[8:11], s42 offen sc1
    s_nop 1
    buffer_load_dwordx4 v29, s[8:11], s6 offen offset:0 sc1 lds
    buffer_load_dwordx4 v29, s[8:11], s43 offen offset:1024 sc1 lds
    s_add_u32 s54, s54, 1
    s_cmp_lt_u32 s54, 12
    s_cbranch_scc1 L_p20_1
    s_branch L_p2d0_1
L_p1b0_1:
L_p1c0_1:
    buffer_load_dwordx4 v[64:67], v0, s[8:11], s40 offen offset:0 sc1
    buffer_load_dwordx4 v[68:71], v0, s[8:11], s40 offen offset:1024 sc1
    buffer_load_dwordx4 v[72:75], v0, s[8:11], s40 offen offset:2048 sc1
    buffer_load_dwordx4 v[76:79], v0, s[8:11], s40 offen offset:3072 sc1
    buffer_load_dwordx4 v[80:83], v0, s[8:11], s41 offen offset:0 sc1
    buffer_load_dwordx4 v[84:87], v0, s[8:11], s41 offen offset:1024 sc1
    buffer_load_dwordx4 v[88:91], v0, s[8:11], s41 offen offset:2048 sc1
    buffer_load_dwordx4 v[92:95], v0, s[8:11], s41 offen offset:3072 sc1
    s_waitcnt vmcnt(7) lgkmcnt(0)
    v_mfma_f32_16x16x32_bf16 v[36:39], v[32:35], v[64:67], 0
    s_waitcnt vmcnt(6)
    v_mfma_f32_16x16x32_bf16 v[36:39], v[32:35], v[68:71], v[36:39]
    v_bitop3_b32 v28, v64, v66, v68 bitop3:0xfe
    s_waitcnt vmcnt(5)
    v_mfma_f32_16x16x32_bf16 v[36:39], v[32:35], v[72:75], v[36:39]
    v_bitop3_b32 v28, v28, v70, v72 bitop3:0xfe
    s_waitcnt vmcnt(4)
    v_mfma_f32_16x16x32_bf16 v[36:39], v[32:35], v[76:79], v[36:39]
    v_bitop3_b32 v28, v28, v74, v76 bitop3:0xfe
    s_waitcnt vmcnt(3)
    v_mfma_f32_16x16x32_bf16 v[12:15], v[32:35], v[80:83], 0
    v_bitop3_b32 v28, v28, v78, v80 bitop3:0xfe
    s_waitcnt vmcnt(2)
    v_mfma_f32_16x16x32_bf16 v[12:15], v[32:35], v[84:87], v[12:15]
    v_bitop3_b32 v28, v28, v82, v84 bitop3:0xfe
    s_waitcnt vmcnt(1)
    v_mfma_f32_16x16x32_bf16 v[12:15], v[32:35], v[88:91], v[12:15]
    v_bitop3_b32 v28, v28, v86, v88 bitop3:0xfe
    v_add_f32_dpp v36, v36, v36 row_ror:8 row_mask:0xf bank_mask:0x3
    s_waitcnt vmcnt(0)
    v_mfma_f32_16x16x32_bf16 v[12:15], v[32:35], v[92:95], v[12:15]
    v_bitop3_b32 v28, v28, v90, v92 bitop3:0xfe
    v_bitop3_b32 v28, v28, v94, 1 bitop3:0xa8
    v_cmp_ne_u32 vcc, 0, v28
    v_add_f32_dpp v37, v37, v37 row_ror:8 row_mask:0xf bank_mask:0x3
    v_add_f32_dpp v38, v38, v38 row_ror:8 row_mask:0xf bank_mask:0x3
    v_add_f32_dpp v39, v39, v39 row_ror:8 row_mask:0xf bank_mask:0x3
    s_cbranch_vccz L_p1ok0_1
    s_add_u32 s54, s54, 1
    s_and_b32 s45, s54, 63
    s_cbranch_scc1 L_p1c0_1
    buffer_wbl2 sc1
    s_waitcnt vmcnt(0)
    buffer_inv sc1
    s_waitcnt vmcnt(0)
    s_cmp_lt_u32 s54, 0x40000
    s_cbranch_scc1 L_p1c0_1
    s_endpgm
.p2align 6
L_step1_0:
    s_barrier
    ds_read_b128 v[64:67], v7 offset:0
    ds_read_b128 v[68:71], v7 offset:1024
    buffer_load_dwordx4 v29, s[8:11], s6 offen offset:0 sc1 lds
    buffer_load_dwordx4 v29, s[8:11], s43 offen offset:1024 sc1 lds
    s_waitcnt lgkmcnt(1)
    v_smfmac_f32_16x16x64_bf16 v[40:43], v[64:67], v[96:103], v2
    v_smfmac_f32_16x16x64_bf16 v[44:47], v[64:67], v[104:111], v2
    ds_read_b128 v[96:99], v1 offset:8192
    v_smfmac_f32_16x16x64_bf16 v[48:51], v[64:67], v[112:119], v2
    ds_read_b128 v[100:103], v1 offset:9216
    v_smfmac_f32_16x16x64_bf16 v[52:55], v[64:67], v[120:127], v2
    buffer_load_dwordx4 v[240:243], v0, s[8:11], s38 offen offset:0 sc1
    s_waitcnt lgkmcnt(2)
    v_smfmac_f32_16x16x64_bf16 v[40:43], v[68:71], v[208:215], v2
    ds_read_b128 v[104:107], v1 offset:10240
    v_smfmac_f32_16x16x64_bf16 v[44:47], v[68:71], v[216:223], v2
    ds_read_b128 v[108:111], v1 offset:11264
    v_smfmac_f32_16x16x64_bf16 v[48:51], v[68:71], a[80:87], v2
    ds_read_b128 v[112:115], v1 offset:12288
    v_smfmac_f32_16x16x64_bf16 v[52:55], v[68:71], a[88:95], v2
    s_barrier
    ds_read_b128 v[72:75], v7 offset:2048
    v_smfmac_f32_16x16x64_bf16 v[56:59], v[64:67], a[160:167], v2
    ds_read_b128 v[76:79], v7 offset:3072
    v_smfmac_f32_16x16x64_bf16 v[56:59], v[68:71], a[176:183], v2
    buffer_load_dwordx4 v[244:247], v0, s[8:11], s38 offen offset:1024 sc1
    v_smfmac_f32_16x16x64_bf16 v[60:63], v[64:67], a[168:175], v2
    ds_read_b128 v[116:119], v1 offset:13312
    v_smfmac_f32_16x16x64_bf16 v[60:63], v[68:71], a[184:191], v2
    ds_read_b128 v[120:123], v1 offset:14336
    s_waitcnt lgkmcnt(3)
    v_smfmac_f32_16x16x64_bf16 v[40:43], v[72:75], v[224:231], v2
    ds_read_b128 v[124:127], v1 offset:15360
    v_smfmac_f32_16x16x64_bf16 v[44:47], v[72:75], v[232:239], v2
    buffer_load_dwordx4 v[248:251], v0, s[8:11], s38 offen offset:2048 sc1
    v_bitop3_b32 v12, v64, v66, v68 bitop3:0xfe
    v_smfmac_f32_16x16x64_bf16 v[48:51], v[72:75], a[96:103], v2
    s_waitcnt vmcnt(3)
    s_barrier
    ds_read_b128 v[80:83], v7 offset:4096
    v_bitop3_b32 v12, v12, v70, v72 bitop3:0xfe
    v_smfmac_f32_16x16x64_bf16 v[52:55], v[72:75], a[104:111], v2
    ds_read_b128 v[84:87], v7 offset:5120
    s_waitcnt lgkmcnt(5)
    v_smfmac_f32_16x16x64_bf16 v[40:43], v[76:79], a[0:7], v2
    ds_read_b128 v[88:91], v7 offset:6144
    v_bitop3_b32 v12, v12, v74, v76 bitop3:0xfe
    v_smfmac_f32_16x16x64_bf16 v[44:47], v[76:79], a[8:15], v2
    ds_read_b128 v[92:95], v7 offset:7168
    v_smfmac_f32_16x16x64_bf16 v[48:51], v[76:79], a[112:119], v2
    v_smfmac_f32_16x16x64_bf16 v[52:55], v[76:79], a[120:127], v2
    s_waitcnt lgkmcnt(3)
    v_bitop3_b32 v12, v12, v78, v80 bitop3:0xfe
    v_smfmac_f32_16x16x64_bf16 v[40:43], v[80:83], a[16:23], v2
    s_waitcnt lgkmcnt(2)
    v_bitop3_b32 v12, v12, v82, v84 bitop3:0xfe
    v_smfmac_f32_16x16x64_bf16 v[40:43], v[84:87], a[32:39], v2
    buffer_load_dwordx4 v[252:255], v0, s[8:11], s38 offen offset:3072 sc1
    s_waitcnt lgkmcnt(1)
    v_bitop3_b32 v12, v12, v86, v88 bitop3:0xfe
    v_smfmac_f32_16x16x64_bf16 v[40:43], v[88:91], a[48:55], v2
    s_waitcnt lgkmcnt(0)
    v_bitop3_b32 v12, v12, v90, v92 bitop3:0xfe
    v_smfmac_f32_16x16x64_bf16 v[40:43], v[92:95], a[64:71], v2
    v_bitop3_b32 v12, v12, v94, 1 bitop3:0xa8
    v_smfmac_f32_16x16x64_bf16 v[48:51], v[80:83], v[96:103], v2
    v_cmp_ne_u32 vcc, 0, v12
    v_smfmac_f32_16x16x64_bf16 v[48:51], v[84:87], v[104:111], v2
    v_add_f32 v40, v40, v42
    v_smfmac_f32_16x16x64_bf16 v[48:51], v[88:91], v[112:119], v2
    v_add_f32 v41, v41, v43
    v_smfmac_f32_16x16x64_bf16 v[48:51], v[92:95], v[120:127], v2
    ds_read_b128 v[96:99], v1 offset:16384
    v_mul_f32 v40, s48, v40
    v_smfmac_f32_16x16x64_bf16 v[44:47], v[80:83], a[24:31], v2
    ds_read_b128 v[100:103], v1 offset:17408
    v_mul_f32 v41, s48, v41
    v_smfmac_f32_16x16x64_bf16 v[44:47], v[84:87], a[40:47], v2
    ds_read_b128 v[104:107], v1 offset:18432
    v_cvt_pk_bf16_f32 v42, v40, v41
    v_smfmac_f32_16x16x64_bf16 v[44:47], v[88:91], a[56:63], v2
    ds_read_b128 v[108:111], v1 offset:19456
    v_add_f32 v48, v48, v50
    v_smfmac_f32_16x16x64_bf16 v[44:47], v[92:95], a[72:79], v2
    ds_read_b128 v[112:115], v1 offset:20480
    v_add_f32 v49, v49, v51
    v_smfmac_f32_16x16x64_bf16 v[52:55], v[80:83], a[128:135], v2
    ds_read_b128 v[116:119], v1 offset:21504
    v_cvt_pk_bf16_f32 v43, v48, v49
    v_smfmac_f32_16x16x64_bf16 v[52:55], v[84:87], a[136:143], v2
    ds_read_b128 v[120:123], v1 offset:22528
    v_add_f32 v44, v44, v46
    v_smfmac_f32_16x16x64_bf16 v[52:55], v[88:91], a[144:151], v2
    ds_read_b128 v[124:127], v1 offset:23552
    v_add_f32 v45, v45, v47
    v_smfmac_f32_16x16x64_bf16 v[52:55], v[92:95], a[152:159], v2
    s_cbranch_vccnz L_rec1_0
L_norec1_0:
    v_mul_f32 v44, s48, v44
    v_mfma_f32_16x16x16_bf16 v[48:51], v[42:43], v[4:5], 0
    v_mul_f32 v45, s48, v45
    v_cvt_pk_bf16_f32 v46, v44, v45
    s_nop 1
    v_add_f32 v52, v52, v54
    v_add_f32 v53, v53, v55
    v_cvt_pk_bf16_f32 v47, v52, v53
    s_mov_b64 vcc, s[56:57]
    v_cvt_pk_bf16_f32 v40, v48, v49
    v_mfma_f32_16x16x16_bf16 v[52:55], v[46:47], v[4:5], 0
    v_cvt_pk_bf16_f32 v41, v50, v51
    v_smfmac_f32_16x16x64_bf16 v[56:59], v[72:75], a[192:199], v2
    s_mov_b32 m0, 4096
    s_nop 2
    v_cvt_pk_bf16_f32 v42, v52, v53
    v_cvt_pk_bf16_f32 v43, v54, v55
    s_nop 1
    v_mfma_f32_16x16x32_bf16 v[44:47], v[32:35], v[40:43], 0
    v_mfma_f32_16x16x32_bf16 v[48:51], v[36:39], v[40:43], 0
    v_mov_b64 v[32:33], 0
    v_mov_b64 v[34:35], 0
    v_mfma_f32_16x16x32_bf16 v[52:55], v[40:43], v[40:43], 0
    v_mov_b64 v[36:37], 0
    v_mov_b64 v[38:39], 0
    s_nop 0
    v_cndmask_b32_dpp v44, v48, v44, vcc quad_perm:[0,1,0,1] row_mask:0xf bank_mask:0xf
    v_cndmask_b32_dpp v45, v49, v45, vcc quad_perm:[0,1,0,1] row_mask:0xf bank_mask:0xf
    v_cndmask_b32_dpp v46, v50, v46, vcc quad_perm:[0,1,0,1] row_mask:0xf bank_mask:0xf
    v_cndmask_b32_dpp v47, v51, v47, vcc quad_perm:[0,1,0,1] row_mask:0xf bank_mask:0xf
    v_cndmask_b32_dpp v12, v55, v54, vcc quad_perm:[0,1,0,1] row_mask:0xf bank_mask:0xf
    v_smfmac_f32_16x16x64_bf16 v[56:59], v[76:79], a[208:215], v2
    ds_write_b128 v0, v[44:47] offset:9216
    v_smfmac_f32_16x16x64_bf16 v[56:59], v[80:83], a[224:231], v2
    ds_write_addtid_b32 v12 offset:8448
    v_smfmac_f32_16x16x64_bf16 v[56:59], v[84:87], a[232:239], v2
    v_smfmac_f32_16x16x64_bf16 v[56:59], v[88:91], a[240:247], v2
    v_smfmac_f32_16x16x64_bf16 v[56:59], v[92:95], a[248:255], v2
    s_waitcnt lgkmcnt(0)
    s_barrier
    ds_read_addtid_b32 v13 offset:8704
    ds_read_addtid_b32 v14 offset:8960
    v_smfmac_f32_16x16x64_bf16 v[60:63], v[72:75], a[200:207], v2
    ds_read_addtid_b32 v15 offset:8192
    ds_read_b128 v[40:43], v0 offset:10240
    v_smfmac_f32_16x16x64_bf16 v[60:63], v[76:79], a[216:223], v2
    ds_read_b128 v[48:51], v0 offset:11264
    ds_read_b128 v[52:55], v0 offset:8192
    v_add_f32 v56, v56, v58
    v_smfmac_f32_16x16x64_bf16 v[60:63], v[80:83], v[96:103], v2
    v_add_f32 v57, v57, v59
    v_smfmac_f32_16x16x64_bf16 v[60:63], v[84:87], v[104:111], v2
    v_cvt_pk_bf16_f32 v16, v56, v57
    v_smfmac_f32_16x16x64_bf16 v[60:63], v[88:91], v[112:119], v2
    s_waitcnt lgkmcnt(1)
    v_cvt_pk_bf16_f32 v20, v56, v57
    v_add_f32 v12, v12, v13
    v_add_f32 v14, v14, v15
    v_add_f32 v12, v12, v14
    v_pk_add_f32 v[44:45], v[44:45], v[40:41]
    v_pk_add_f32 v[46:47], v[46:47], v[42:43]
    v_pk_add_f32 v[44:45], v[44:45], v[48:49]
    v_pk_add_f32 v[46:47], v[46:47], v[50:51]
    s_waitcnt lgkmcnt(0)
    v_pk_add_f32 v[44:45], v[44:45], v[52:53]
    v_pk_add_f32 v[46:47], v[46:47], v[54:55]
    v_max3_f32 v40, v44, v45, v12
    v_max3_f32 v40, v40, v46, v47
    v_smfmac_f32_16x16x64_bf16 v[60:63], v[92:95], v[120:127], v2
    ds_read_b128 v[96:99], v1 offset:32768
    ds_read_b128 v[100:103], v1 offset:33792
    v_max_f32_dpp v40, v40, v40 quad_perm:[2,3,0,1] row_mask:0xf bank_mask:0xf
    v_mov_b32 v41, v40
    v_mov_b64 v[52:53], s[58:59]
    v_mov_b64 v[54:55], s[58:59]
    v_permlane16_swap_b32 v40, v41
    v_max_f32 v40, v40, v41
    v_mov_b32 v41, v40
    v_add_f32 v60, v60, v62
    v_add_f32 v61, v61, v63
    v_permlane32_swap_b32 v40, v41
    v_max_f32 v40, v40, v41
    v_sub_f32 v12, v12, v40
    v_pk_add_f32 v[44:45], v[44:45], v[40:41] op_sel_hi:[1,0] neg_lo:[0,1] neg_hi:[0,1]
    v_pk_add_f32 v[46:47], v[46:47], v[40:41] op_sel_hi:[1,0] neg_lo:[0,1] neg_hi:[0,1]
    v_exp_f32 v12, v12
    v_exp_f32 v44, v44
    v_exp_f32 v45, v45
    v_exp_f32 v46, v46
    v_exp_f32 v47, v47
    v_cvt_pk_bf16_f32 v12, v12, v12
    v_cvt_pk_bf16_f32 v49, v44, v45
    v_cvt_pk_bf16_f32 v51, v46, v47
    v_and_b32 v48, v12, v17
    v_and_b32 v50, v12, v21
    v_cvt_pk_bf16_f32 v24, v60, v61
    v_cvt_pk_bf16_f32 v28, v60, v61
    v_mfma_f32_16x16x32_bf16 v[40:43], v[48:51], v[52:55], 0
    v_mov_b64 v[64:65], 0
    v_mov_b64 v[66:67], 0
    v_smfmac_f32_16x16x64_bf16 v[32:35], v[48:51], v[16:23], v2 abid:1
    ds_read_b128 v[104:107], v1 offset:34816
    ds_read_b128 v[108:111], v1 offset:35840
    v_mov_b64 v[68:69], 0
    v_smfmac_f32_16x16x64_bf16 v[36:39], v[48:51], v[24:31], v2 abid:1
    v_add_f32 v40, v40, v42
    v_add_f32 v41, v41, v43
    v_rcp_f32 v40, v40
    v_rcp_f32 v41, v41
    v_pk_add_f32 v[32:33], v[32:33], v[34:35]
    v_pk_add_f32 v[36:37], v[36:37], v[38:39]
    v_pk_mul_f32 v[32:33], v[32:33], v[40:41]
    v_pk_mul_f32 v[36:37], v[36:37], v[40:41]
    v_cvt_pk_bf16_f32 v32, v32, v36
    v_cvt_pk_bf16_f32 v33, v33, v37
    v_mfma_f32_32x32x16_bf16 v[80:95], v[64:67], v[64:67], 0
    ds_write2_b32 v9, v32, v33 offset0:0 offset1:16
    ds_read_b128 v[40:43], v10 offset:4608
    v_mov_b64 v[70:71], 0
    v_mov_b64 v[72:73], 0
    v_mov_b64 v[74:75], 0
    v_mov_b64 v[76:77], 0
    v_mov_b64 v[78:79], 0
    s_waitcnt lgkmcnt(1)
    s_barrier
    ds_read_b128 v[44:47], v10 offset:5120
    s_waitcnt lgkmcnt(1)
    v_smfmac_f32_16x16x64_bf16 v[64:67], v[40:43], v[96:103], v2
    ds_read_b128 v[48:51], v10 offset:5632
    ds_read_b128 v[52:55], v10 offset:4096
    v_smfmac_f32_16x16x64_bf16 v[68:71], v[40:43], v[104:111], v2
    s_waitcnt lgkmcnt(2)
    v_smfmac_f32_16x16x64_bf16 v[64:67], v[44:47], v[128:135], v2
    ds_read_b128 v[112:115], v1 offset:28672
    s_waitcnt lgkmcnt(2)
    v_smfmac_f32_16x16x64_bf16 v[64:67], v[48:51], v[136:143], v2
    ds_read_b128 v[116:119], v1 offset:29696
    s_waitcnt lgkmcnt(2)
    v_smfmac_f32_16x16x64_bf16 v[64:67], v[52:55], v[144:151], v2
    ds_read_b128 v[120:123], v1 offset:30720
    v_smfmac_f32_16x16x64_bf16 v[68:71], v[44:47], v[152:159], v2
    ds_read_b128 v[124:127], v1 offset:31744
    v_smfmac_f32_16x16x64_bf16 v[68:71], v[48:51], v[160:167], v2
    ds_read_b128 v[96:99], v1 offset:24576
    v_cvt_pk_bf16_f32 v56, v64, v65
    v_or_b32 v56, 1, v56
    v_cvt_pk_bf16_f32 v57, v66, v67
    v_smfmac_f32_16x16x64_bf16 v[68:71], v[52:55], v[168:175], v2
    buffer_store_dwordx2 v[56:57], v3, s[8:11], s50 offen
    ds_read_b128 v[100:103], v1 offset:25600
    v_smfmac_f32_16x16x64_bf16 v[72:75], v[40:43], v[176:183], v2
    ds_read_b128 v[104:107], v1 offset:26624
    v_smfmac_f32_16x16x64_bf16 v[72:75], v[44:47], v[184:191], v2
    ds_read_b128 v[108:111], v1 offset:27648
    v_cvt_pk_bf16_f32 v58, v68, v69
    v_or_b32 v58, 1, v58
    v_cvt_pk_bf16_f32 v59, v70, v71
    v_smfmac_f32_16x16x64_bf16 v[72:75], v[48:51], v[192:199], v2
    buffer_store_dwordx2 v[58:59], v3, s[8:11], s51 offen
    v_smfmac_f32_16x16x64_bf16 v[72:75], v[52:55], v[200:207], v2
    s_waitcnt lgkmcnt(4)
    v_smfmac_f32_16x16x64_bf16 v[76:79], v[40:43], v[112:119], v2
    v_smfmac_f32_16x16x64_bf16 v[76:79], v[44:47], v[120:127], v2
    s_waitcnt lgkmcnt(0)
    v_cvt_pk_bf16_f32 v60, v72, v73
    v_or_b32 v60, 1, v60
    v_cvt_pk_bf16_f32 v61, v74, v75
    v_smfmac_f32_16x16x64_bf16 v[76:79], v[48:51], v[96:103], v2
    buffer_store_dwordx2 v[60:61], v3, s[8:11], s2 offen
    v_smfmac_f32_16x16x64_bf16 v[76:79], v[52:55], v[104:111], v2
    s_add_u32 s36, s36, 1
    s_cmp_lt_u32 s36, 62
    s_cselect_b32 s45, 0x80000, 0
    s_add_u32 s38, s38, s45
    s_mov_b32 s54, 0
    s_add_u32 s39, s39, 0x2000
    s_nop 1
    v_cvt_pk_bf16_f32 v62, v76, v77
    v_or_b32 v62, 1, v62
    v_cvt_pk_bf16_f32 v63, v78, v79
    s_nop 1
    buffer_store_dwordx2 v[62:63], v3, s[8:11], s99 offen
    s_cmp_eq_u32 s36, 63
    s_cbranch_scc1 L_chain_end
    ds_read_b128 v[96:99], v1 offset:0
    ds_read_b128 v[100:103], v1 offset:1024
    ds_read_b128 v[104:107], v1 offset:2048
    ds_read_b128 v[108:111], v1 offset:3072
    ds_read_b128 v[112:115], v1 offset:4096
    ds_read_b128 v[116:119], v1 offset:5120
    ds_read_b128 v[120:123], v1 offset:6144
    ds_read_b128 v[124:127], v1 offset:7168
    v_mov_b64 v[40:41], 0
    v_mov_b64 v[42:43], 0
    v_mov_b64 v[44:45], 0
    v_mov_b64 v[46:47], 0
    v_mov_b64 v[48:49], 0
    v_mov_b64 v[50:51], 0
    v_mov_b64 v[52:53], 0
    v_mov_b64 v[54:55], 0
    v_mov_b64 v[56:57], 0
    v_mov_b64 v[58:59], 0
    v_mov_b64 v[60:61], 0
    v_mov_b64 v[62:63], 0
    s_waitcnt vmcnt(4)
    v_mov_b64 v[32:33], v[240:241]
    v_mov_b64 v[34:35], v[242:243]
    v_mov_b64 v[36:37], v[244:245]
    v_mov_b64 v[38:39], v[246:247]
    v_mov_b64 v[18:19], v[248:249]
    v_mov_b64 v[22:23], v[250:251]
    v_mov_b64 v[26:27], v[252:253]
    v_mov_b64 v[30:31], v[254:255]
    s_waitcnt lgkmcnt(0)
L_step1_1:
    s_barrier
    ds_read_b128 v[64:67], v7 offset:0
    ds_read_b128 v[68:71], v7 offset:1024
    buffer_load_dwordx4 v29, s[8:11], s6 offen offset:0 sc1 lds
    buffer_load_dwordx4 v29, s[8:11], s43 offen offset:1024 sc1 lds
    s_waitcnt lgkmcnt(1)
    v_smfmac_f32_16x16x64_bf16 v[40:43], v[64:67], v[96:103], v2
    v_smfmac_f32_16x16x64_bf16 v[44:47], v[64:67], v[104:111], v2
    ds_read_b128 v[96:99], v1 offset:8192
    v_smfmac_f32_16x16x64_bf16 v[48:51], v[64:67], v[112:119], v2
    ds_read_b128 v[100:103], v1 offset:9216
    v_smfmac_f32_16x16x64_bf16 v[52:55], v[64:67], v[120:127], v2
    buffer_load_dwordx4 v[240:243], v0, s[8:11], s38 offen offset:0 sc1
    s_waitcnt lgkmcnt(2)
    v_smfmac_f32_16x16x64_bf16 v[40:43], v[68:71], v[208:215], v2
    ds_read_b128 v[104:107], v1 offset:10240
    v_smfmac_f32_16x16x64_bf16 v[44:47], v[68:71], v[216:223], v2
    ds_read_b128 v[108:111], v1 offset:11264
    v_smfmac_f32_16x16x64_bf16 v[48:51], v[68:71], a[80:87], v2
    ds_read_b128 v[112:115], v1 offset:12288
    v_smfmac_f32_16x16x64_bf16 v[52:55], v[68:71], a[88:95], v2
    s_barrier
    ds_read_b128 v[72:75], v7 offset:2048
    v_smfmac_f32_16x16x64_bf16 v[56:59], v[64:67], a[160:167], v2
    ds_read_b128 v[76:79], v7 offset:3072
    v_smfmac_f32_16x16x64_bf16 v[56:59], v[68:71], a[176:183], v2
    buffer_load_dwordx4 v[244:247], v0, s[8:11], s38 offen offset:1024 sc1
    v_smfmac_f32_16x16x64_bf16 v[60:63], v[64:67], a[168:175], v2
    ds_read_b128 v[116:119], v1 offset:13312
    v_smfmac_f32_16x16x64_bf16 v[60:63], v[68:71], a[184:191], v2
    ds_read_b128 v[120:123], v1 offset:14336
    s_waitcnt lgkmcnt(3)
    v_smfmac_f32_16x16x64_bf16 v[40:43], v[72:75], v[224:231], v2
    ds_read_b128 v[124:127], v1 offset:15360
    v_smfmac_f32_16x16x64_bf16 v[44:47], v[72:75], v[232:239], v2
    buffer_load_dwordx4 v[248:251], v0, s[8:11], s38 offen offset:2048 sc1
    v_bitop3_b32 v12, v64, v66, v68 bitop3:0x80
    v_smfmac_f32_16x16x64_bf16 v[48:51], v[72:75], a[96:103], v2
    s_waitcnt vmcnt(3)
    s_barrier
    ds_read_b128 v[80:83], v7 offset:4096
    v_bitop3_b32 v12, v12, v70, v72 bitop3:0x80
    v_smfmac_f32_16x16x64_bf16 v[52:55], v[72:75], a[104:111], v2
    ds_read_b128 v[84:87], v7 offset:5120
    s_waitcnt lgkmcnt(5)
    v_smfmac_f32_16x16x64_bf16 v[40:43], v[76:79], a[0:7], v2
    ds_read_b128 v[88:91], v7 offset:6144
    v_bitop3_b32 v12, v12, v74, v76 bitop3:0x80
    v_smfmac_f32_16x16x64_bf16 v[44:47], v[76:79], a[8:15], v2
    ds_read_b128 v[92:95], v7 offset:7168
    v_smfmac_f32_16x16x64_bf16 v[48:51], v[76:79], a[112:119], v2
    v_smfmac_f32_16x16x64_bf16 v[52:55], v[76:79], a[120:127], v2
    s_waitcnt lgkmcnt(3)
    v_bitop3_b32 v12, v12, v78, v80 bitop3:0x80
    v_smfmac_f32_16x16x64_bf16 v[40:43], v[80:83], a[16:23], v2
    s_waitcnt lgkmcnt(2)
    v_bitop3_b32 v12, v12, v82, v84 bitop3:0x80
    v_smfmac_f32_16x16x64_bf16 v[40:43], v[84:87], a[32:39], v2
    buffer_load_dwordx4 v[252:255], v0, s[8:11], s38 offen offset:3072 sc1
    s_waitcnt lgkmcnt(1)
    v_bitop3_b32 v12, v12, v86, v88 bitop3:0x80
    v_smfmac_f32_16x16x64_bf16 v[40:43], v[88:91], a[48:55], v2
    s_waitcnt lgkmcnt(0)
    v_bitop3_b32 v12, v12, v90, v92 bitop3:0x80
    v_smfmac_f32_16x16x64_bf16 v[40:43], v[92:95], a[64:71], v2
    v_bitop3_b32 v12, v12, v94, 1 bitop3:0x80
    v_smfmac_f32_16x16x64_bf16 v[48:51], v[80:83], v[96:103], v2
    v_cmp_eq_u32 vcc, 0, v12
    v_smfmac_f32_16x16x64_bf16 v[48:51], v[84:87], v[104:111], v2
    v_add_f32 v40, v40, v42
    v_smfmac_f32_16x16x64_bf16 v[48:51], v[88:91], v[112:119], v2
    v_add_f32 v41, v41, v43
    v_smfmac_f32_16x16x64_bf16 v[48:51], v[92:95], v[120:127], v2
    ds_read_b128 v[96:99], v1 offset:16384
    v_mul_f32 v40, s48, v40
    v_smfmac_f32_16x16x64_bf16 v[44:47], v[80:83], a[24:31], v2
    ds_read_b128 v[100:103], v1 offset:17408
    v_mul_f32 v41, s48, v41
    v_smfmac_f32_16x16x64_bf16 v[44:47], v[84:87], a[40:47], v2
    ds_read_b128 v[104:107], v1 offset:18432
    v_cvt_pk_bf16_f32 v42, v40, v41
    v_smfmac_f32_16x16x64_bf16 v[44:47], v[88:91], a[56:63], v2
    ds_read_b128 v[108:111], v1 offset:19456
    v_add_f32 v48, v48, v50
    v_smfmac_f32_16x16x64_bf16 v[44:47], v[92:95], a[72:79], v2
    ds_read_b128 v[112:115], v1 offset:20480
    v_add_f32 v49, v49, v51
    v_smfmac_f32_16x16x64_bf16 v[52:55], v[80:83], a[128:135], v2
    ds_read_b128 v[116:119], v1 offset:21504
    v_cvt_pk_bf16_f32 v43, v48, v49
    v_smfmac_f32_16x16x64_bf16 v[52:55], v[84:87], a[136:143], v2
    ds_read_b128 v[120:123], v1 offset:22528
    v_add_f32 v44, v44, v46
    v_smfmac_f32_16x16x64_bf16 v[52:55], v[88:91], a[144:151], v2
    ds_read_b128 v[124:127], v1 offset:23552
    v_add_f32 v45, v45, v47
    v_smfmac_f32_16x16x64_bf16 v[52:55], v[92:95], a[152:159], v2
    s_cbranch_vccnz L_rec1_1
L_norec1_1:
    v_mul_f32 v44, s48, v44
    v_mfma_f32_16x16x16_bf16 v[48:51], v[42:43], v[4:5], 0
    v_mul_f32 v45, s48, v45
    v_cvt_pk_bf16_f32 v46, v44, v45
    s_nop 1
    v_add_f32 v52, v52, v54
    v_add_f32 v53, v53, v55
    v_cvt_pk_bf16_f32 v47, v52, v53
    s_mov_b64 vcc, s[56:57]
    v_cvt_pk_bf16_f32 v40, v48, v49
    v_mfma_f32_16x16x16_bf16 v[52:55], v[46:47], v[4:5], 0
    v_cvt_pk_bf16_f32 v41, v50, v51
    v_smfmac_f32_16x16x64_bf16 v[56:59], v[72:75], a[192:199], v2
    s_mov_b32 m0, 4096
    s_nop 2
    v_cvt_pk_bf16_f32 v42, v52, v53
    v_cvt_pk_bf16_f32 v43, v54, v55
    s_nop 1
    v_mfma_f32_16x16x32_bf16 v[44:47], v[32:35], v[40:43], 0
    v_mfma_f32_16x16x32_bf16 v[48:51], v[36:39], v[40:43], 0
    v_mov_b64 v[32:33], 0
    v_mov_b64 v[34:35], 0
    v_mfma_f32_16x16x32_bf16 v[52:55], v[40:43], v[40:43], 0
    v_mov_b64 v[36:37], 0
    v_mov_b64 v[38:39], 0
    s_nop 0
    v_cndmask_b32_dpp v44, v48, v44, vcc quad_perm:[0,1,0,1] row_mask:0xf bank_mask:0xf
    v_cndmask_b32_dpp v45, v49, v45, vcc quad_perm:[0,1,0,1] row_mask:0xf bank_mask:0xf
    v_cndmask_b32_dpp v46, v50, v46, vcc quad_perm:[0,1,0,1] row_mask:0xf bank_mask:0xf
    v_cndmask_b32_dpp v47, v51, v47, vcc quad_perm:[0,1,0,1] row_mask:0xf bank_mask:0xf
    v_cndmask_b32_dpp v12, v55, v54, vcc quad_perm:[0,1,0,1] row_mask:0xf bank_mask:0xf
    v_smfmac_f32_16x16x64_bf16 v[56:59], v[76:79], a[208:215], v2
    ds_write_b128 v0, v[44:47] offset:9216
    v_smfmac_f32_16x16x64_bf16 v[56:59], v[80:83], a[224:231], v2
    ds_write_addtid_b32 v12 offset:8448
    v_smfmac_f32_16x16x64_bf16 v[56:59], v[84:87], a[232:239], v2
    v_smfmac_f32_16x16x64_bf16 v[56:59], v[88:91], a[240:247], v2
    v_smfmac_f32_16x16x64_bf16 v[56:59], v[92:95], a[248:255], v2
    s_waitcnt lgkmcnt(0)
    s_barrier
    ds_read_addtid_b32 v13 offset:8704
    ds_read_addtid_b32 v14 offset:8960
    v_smfmac_f32_16x16x64_bf16 v[60:63], v[72:75], a[200:207], v2
    ds_read_addtid_b32 v15 offset:8192
    ds_read_b128 v[40:43], v0 offset:10240
    v_smfmac_f32_16x16x64_bf16 v[60:63], v[76:79], a[216:223], v2
    ds_read_b128 v[48:51], v0 offset:11264
    ds_read_b128 v[52:55], v0 offset:8192
    v_add_f32 v56, v56, v58
    v_smfmac_f32_16x16x64_bf16 v[60:63], v[80:83], v[96:103], v2
    v_add_f32 v57, v57, v59
    v_smfmac_f32_16x16x64_bf16 v[60:63], v[84:87], v[104:111], v2
    v_cvt_pk_bf16_f32 v16, v56, v57
    v_smfmac_f32_16x16x64_bf16 v[60:63], v[88:91], v[112:119], v2
    s_waitcnt lgkmcnt(1)
    v_cvt_pk_bf16_f32 v20, v56, v57
    v_add_f32 v12, v12, v13
    v_add_f32 v14, v14, v15
    v_add_f32 v12, v12, v14
    v_pk_add_f32 v[44:45], v[44:45], v[40:41]
    v_pk_add_f32 v[46:47], v[46:47], v[42:43]
    v_pk_add_f32 v[44:45], v[44:45], v[48:49]
    v_pk_add_f32 v[46:47], v[46:47], v[50:51]
    s_waitcnt lgkmcnt(0)
    v_pk_add_f32 v[44:45], v[44:45], v[52:53]
    v_pk_add_f32 v[46:47], v[46:47], v[54:55]
    v_max3_f32 v40, v44, v45, v12
    v_max3_f32 v40, v40, v46, v47
    v_smfmac_f32_16x16x64_bf16 v[60:63], v[92:95], v[120:127], v2
    ds_read_b128 v[96:99], v1 offset:32768
    ds_read_b128 v[100:103], v1 offset:33792
    v_max_f32_dpp v40, v40, v40 quad_perm:[2,3,0,1] row_mask:0xf bank_mask:0xf
    v_mov_b32 v41, v40
    v_mov_b64 v[52:53], s[58:59]
    v_mov_b64 v[54:55], s[58:59]
    v_permlane16_swap_b32 v40, v41
    v_max_f32 v40, v40, v41
    v_mov_b32 v41, v40
    v_add_f32 v60, v60, v62
    v_add_f32 v61, v61, v63
    v_permlane32_swap_b32 v40, v41
    v_max_f32 v40, v40, v41
    v_sub_f32 v12, v12, v40
    v_pk_add_f32 v[44:45], v[44:45], v[40:41] op_sel_hi:[1,0] neg_lo:[0,1] neg_hi:[0,1]
    v_pk_add_f32 v[46:47], v[46:47], v[40:41] op_sel_hi:[1,0] neg_lo:[0,1] neg_hi:[0,1]
    v_exp_f32 v12, v12
    v_exp_f32 v44, v44
    v_exp_f32 v45, v45
    v_exp_f32 v46, v46
    v_exp_f32 v47, v47
    v_cvt_pk_bf16_f32 v12, v12, v12
    v_cvt_pk_bf16_f32 v49, v44, v45
    v_cvt_pk_bf16_f32 v51, v46, v47
    v_and_b32 v48, v12, v17
    v_and_b32 v50, v12, v21
    v_cvt_pk_bf16_f32 v24, v60, v61
    v_cvt_pk_bf16_f32 v28, v60, v61
    v_mfma_f32_16x16x32_bf16 v[40:43], v[48:51], v[52:55], 0
    v_mov_b64 v[64:65], 0
    v_mov_b64 v[66:67], 0
    v_smfmac_f32_16x16x64_bf16 v[32:35], v[48:51], v[16:23], v2 abid:1
    ds_read_b128 v[104:107], v1 offset:34816
    ds_read_b128 v[108:111], v1 offset:35840
    v_mov_b64 v[68:69], 0
    v_smfmac_f32_16x16x64_bf16 v[36:39], v[48:51], v[24:31], v2 abid:1
    v_add_f32 v40, v40, v42
    v_add_f32 v41, v41, v43
    v_rcp_f32 v40, v40
    v_rcp_f32 v41, v41
    v_pk_add_f32 v[32:33], v[32:33], v[34:35]
    v_pk_add_f32 v[36:37], v[36:37], v[38:39]
    v_pk_mul_f32 v[32:33], v[32:33], v[40:41]
    v_pk_mul_f32 v[36:37], v[36:37], v[40:41]
    v_cvt_pk_bf16_f32 v32, v32, v36
    v_cvt_pk_bf16_f32 v33, v33, v37
    v_mfma_f32_32x32x16_bf16 v[80:95], v[64:67], v[64:67], 0
    ds_write2_b32 v9, v32, v33 offset0:0 offset1:16
    ds_read_b128 v[40:43], v10 offset:4608
    v_mov_b64 v[70:71], 0
    v_mov_b64 v[72:73], 0
    v_mov_b64 v[74:75], 0
    v_mov_b64 v[76:77], 0
    v_mov_b64 v[78:79], 0
    s_waitcnt lgkmcnt(1)
    s_barrier
    ds_read_b128 v[44:47], v10 offset:5120
    s_waitcnt lgkmcnt(1)
    v_smfmac_f32_16x16x64_bf16 v[64:67], v[40:43], v[96:103], v2
    ds_read_b128 v[48:51], v10 offset:5632
    ds_read_b128 v[52:55], v10 offset:4096
    v_smfmac_f32_16x16x64_bf16 v[68:71], v[40:43], v[104:111], v2
    s_waitcnt lgkmcnt(2)
    v_smfmac_f32_16x16x64_bf16 v[64:67], v[44:47], v[128:135], v2
    ds_read_b128 v[112:115], v1 offset:28672
    s_waitcnt lgkmcnt(2)
    v_smfmac_f32_16x16x64_bf16 v[64:67], v[48:51], v[136:143], v2
    ds_read_b128 v[116:119], v1 offset:29696
    s_waitcnt lgkmcnt(2)
    v_smfmac_f32_16x16x64_bf16 v[64:67], v[52:55], v[144:151], v2
    ds_read_b128 v[120:123], v1 offset:30720
    v_smfmac_f32_16x16x64_bf16 v[68:71], v[44:47], v[152:159], v2
    ds_read_b128 v[124:127], v1 offset:31744
    v_smfmac_f32_16x16x64_bf16 v[68:71], v[48:51], v[160:167], v2
    ds_read_b128 v[96:99], v1 offset:24576
    v_cvt_pk_bf16_f32 v56, v64, v65
    v_and_b32 v56, -2, v56
    v_cvt_pk_bf16_f32 v57, v66, v67
    v_smfmac_f32_16x16x64_bf16 v[68:71], v[52:55], v[168:175], v2
    buffer_store_dwordx2 v[56:57], v3, s[8:11], s50 offen
    ds_read_b128 v[100:103], v1 offset:25600
    v_smfmac_f32_16x16x64_bf16 v[72:75], v[40:43], v[176:183], v2
    ds_read_b128 v[104:107], v1 offset:26624
    v_smfmac_f32_16x16x64_bf16 v[72:75], v[44:47], v[184:191], v2
    ds_read_b128 v[108:111], v1 offset:27648
    v_cvt_pk_bf16_f32 v58, v68, v69
    v_and_b32 v58, -2, v58
    v_cvt_pk_bf16_f32 v59, v70, v71
    v_smfmac_f32_16x16x64_bf16 v[72:75], v[48:51], v[192:199], v2
    buffer_store_dwordx2 v[58:59], v3, s[8:11], s51 offen
    v_smfmac_f32_16x16x64_bf16 v[72:75], v[52:55], v[200:207], v2
    s_waitcnt lgkmcnt(4)
    v_smfmac_f32_16x16x64_bf16 v[76:79], v[40:43], v[112:119], v2
    v_smfmac_f32_16x16x64_bf16 v[76:79], v[44:47], v[120:127], v2
    s_waitcnt lgkmcnt(0)
    v_cvt_pk_bf16_f32 v60, v72, v73
    v_and_b32 v60, -2, v60
    v_cvt_pk_bf16_f32 v61, v74, v75
    v_smfmac_f32_16x16x64_bf16 v[76:79], v[48:51], v[96:103], v2
    buffer_store_dwordx2 v[60:61], v3, s[8:11], s2 offen
    v_smfmac_f32_16x16x64_bf16 v[76:79], v[52:55], v[104:111], v2
    s_add_u32 s36, s36, 1
    s_cmp_lt_u32 s36, 62
    s_cselect_b32 s45, 0x80000, 0
    s_add_u32 s38, s38, s45
    s_mov_b32 s54, 0
    s_add_u32 s39, s39, 0x2000
    s_nop 1
    v_cvt_pk_bf16_f32 v62, v76, v77
    v_and_b32 v62, -2, v62
    v_cvt_pk_bf16_f32 v63, v78, v79
    s_nop 1
    buffer_store_dwordx2 v[62:63], v3, s[8:11], s99 offen
    ds_read_b128 v[96:99], v1 offset:0
    ds_read_b128 v[100:103], v1 offset:1024
    ds_read_b128 v[104:107], v1 offset:2048
    ds_read_b128 v[108:111], v1 offset:3072
    ds_read_b128 v[112:115], v1 offset:4096
    ds_read_b128 v[116:119], v1 offset:5120
    ds_read_b128 v[120:123], v1 offset:6144
    ds_read_b128 v[124:127], v1 offset:7168
    v_mov_b64 v[40:41], 0
    v_mov_b64 v[42:43], 0
    v_mov_b64 v[44:45], 0
    v_mov_b64 v[46:47], 0
    v_mov_b64 v[48:49], 0
    v_mov_b64 v[50:51], 0
    v_mov_b64 v[52:53], 0
    v_mov_b64 v[54:55], 0
    v_mov_b64 v[56:57], 0
    v_mov_b64 v[58:59], 0
    v_mov_b64 v[60:61], 0
    v_mov_b64 v[62:63], 0
    s_waitcnt vmcnt(4)
    v_mov_b64 v[32:33], v[240:241]
    v_mov_b64 v[34:35], v[242:243]
    v_mov_b64 v[36:37], v[244:245]
    v_mov_b64 v[38:39], v[246:247]
    v_mov_b64 v[18:19], v[248:249]
    v_mov_b64 v[22:23], v[250:251]
    v_mov_b64 v[26:27], v[252:253]
    v_mov_b64 v[30:31], v[254:255]
    s_waitcnt lgkmcnt(0)
    s_branch L_step1_0
.p2align 6
L_step2_0:
    s_barrier
    ds_read_b128 v[64:67], v7 offset:0
    ds_read_b128 v[68:71], v7 offset:1024
    buffer_load_dwordx4 v29, s[8:11], s44 offen offset:2048 sc1 lds
    s_waitcnt lgkmcnt(1)
    v_smfmac_f32_16x16x64_bf16 v[40:43], v[64:67], v[96:103], v2
    v_smfmac_f32_16x16x64_bf16 v[44:47], v[64:67], v[104:111], v2
    ds_read_b128 v[96:99], v1 offset:8192
    v_smfmac_f32_16x16x64_bf16 v[48:51], v[64:67], v[112:119], v2
    ds_read_b128 v[100:103], v1 offset:9216
    v_smfmac_f32_16x16x64_bf16 v[52:55], v[64:67], v[120:127], v2
    ds_read_b128 v[104:107], v1 offset:10240
    s_waitcnt lgkmcnt(3)
    v_smfmac_f32_16x16x64_bf16 v[40:43], v[68:71], v[208:215], v2
    buffer_load_dwordx4 v[240:243], v0, s[8:11], s38 offen offset:0 sc1
    v_smfmac_f32_16x16x64_bf16 v[44:47], v[68:71], v[216:223], v2
    ds_read_b128 v[108:111], v1 offset:11264
    v_smfmac_f32_16x16x64_bf16 v[48:51], v[68:71], a[80:87], v2
    ds_read_b128 v[112:115], v1 offset:12288
    v_smfmac_f32_16x16x64_bf16 v[52:55], v[68:71], a[88:95], v2
    s_barrier
    ds_read_b128 v[72:75], v7 offset:2048
    v_smfmac_f32_16x16x64_bf16 v[56:59], v[64:67], a[160:167], v2
    ds_read_b128 v[76:79], v7 offset:3072
    v_smfmac_f32_16x16x64_bf16 v[56:59], v[68:71], a[176:183], v2
    ds_read_b128 v[116:119], v1 offset:13312
    v_smfmac_f32_16x16x64_bf16 v[60:63], v[64:67], a[168:175], v2
    buffer_load_dwordx4 v[244:247], v0, s[8:11], s38 offen offset:1024 sc1
    v_smfmac_f32_16x16x64_bf16 v[60:63], v[68:71], a[184:191], v2
    ds_read_b128 v[120:123], v1 offset:14336
    s_waitcnt lgkmcnt(3)
    v_smfmac_f32_16x16x64_bf16 v[40:43], v[72:75], v[224:231], v2
    ds_read_b128 v[124:127], v1 offset:15360
    v_smfmac_f32_16x16x64_bf16 v[44:47], v[72:75], v[232:239], v2
    v_bitop3_b32 v12, v64, v66, v68 bitop3:0xfe
    v_smfmac_f32_16x16x64_bf16 v[48:51], v[72:75], a[96:103], v2
    s_waitcnt vmcnt(2)
    s_barrier
    ds_read_b128 v[80:83], v7 offset:4096
    v_bitop3_b32 v12, v12, v70, v72 bitop3:0xfe
    v_smfmac_f32_16x16x64_bf16 v[52:55], v[72:75], a[104:111], v2
    ds_read_b128 v[84:87], v7 offset:5120
    s_waitcnt lgkmcnt(5)
    v_smfmac_f32_16x16x64_bf16 v[40:43], v[76:79], a[0:7], v2
    ds_read_b128 v[88:91], v7 offset:6144
    v_bitop3_b32 v12, v12, v74, v76 bitop3:0xfe
    v_smfmac_f32_16x16x64_bf16 v[44:47], v[76:79], a[8:15], v2
    ds_read_b128 v[92:95], v7 offset:7168
    v_smfmac_f32_16x16x64_bf16 v[48:51], v[76:79], a[112:119], v2
    buffer_load_dwordx4 v[248:251], v0, s[8:11], s38 offen offset:2048 sc1
    v_smfmac_f32_16x16x64_bf16 v[52:55], v[76:79], a[120:127], v2
    s_waitcnt lgkmcnt(3)
    v_bitop3_b32 v12, v12, v78, v80 bitop3:0xfe
    v_smfmac_f32_16x16x64_bf16 v[40:43], v[80:83], a[16:23], v2
    s_waitcnt lgkmcnt(2)
    v_bitop3_b32 v12, v12, v82, v84 bitop3:0xfe
    v_smfmac_f32_16x16x64_bf16 v[40:43], v[84:87], a[32:39], v2
    s_waitcnt lgkmcnt(1)
    v_bitop3_b32 v12, v12, v86, v88 bitop3:0xfe
    v_smfmac_f32_16x16x64_bf16 v[40:43], v[88:91], a[48:55], v2
    buffer_load_dwordx4 v[252:255], v0, s[8:11], s38 offen offset:3072 sc1
    s_waitcnt lgkmcnt(0)
    v_bitop3_b32 v12, v12, v90, v92 bitop3:0xfe
    v_smfmac_f32_16x16x64_bf16 v[40:43], v[92:95], a[64:71], v2
    v_bitop3_b32 v12, v12, v94, 1 bitop3:0xa8
    v_smfmac_f32_16x16x64_bf16 v[48:51], v[80:83], v[96:103], v2
    v_cmp_ne_u32 vcc, 0, v12
    v_smfmac_f32_16x16x64_bf16 v[48:51], v[84:87], v[104:111], v2
    v_add_f32 v40, v40, v42
    v_smfmac_f32_16x16x64_bf16 v[48:51], v[88:91], v[112:119], v2
    v_add_f32 v41, v41, v43
    v_smfmac_f32_16x16x64_bf16 v[48:51], v[92:95], v[120:127], v2
    ds_read_b128 v[96:99], v1 offset:16384
    v_mul_f32 v40, s48, v40
    v_smfmac_f32_16x16x64_bf16 v[44:47], v[80:83], a[24:31], v2
    ds_read_b128 v[100:103], v1 offset:17408
    v_mul_f32 v41, s48, v41
    v_smfmac_f32_16x16x64_bf16 v[44:47], v[84:87], a[40:47], v2
    ds_read_b128 v[104:107], v1 offset:18432
    v_cvt_pk_bf16_f32 v42, v40, v41
    v_smfmac_f32_16x16x64_bf16 v[44:47], v[88:91], a[56:63], v2
    ds_read_b128 v[108:111], v1 offset:19456
    v_add_f32 v48, v48, v50
    v_smfmac_f32_16x16x64_bf16 v[44:47], v[92:95], a[72:79], v2
    ds_read_b128 v[112:115], v1 offset:20480
    v_add_f32 v49, v49, v51
    v_smfmac_f32_16x16x64_bf16 v[52:55], v[80:83], a[128:135], v2
    ds_read_b128 v[116:119], v1 offset:21504
    v_cvt_pk_bf16_f32 v43, v48, v49
    v_smfmac_f32_16x16x64_bf16 v[52:55], v[84:87], a[136:143], v2
    ds_read_b128 v[120:123], v1 offset:22528
    v_add_f32 v44, v44, v46
    v_smfmac_f32_16x16x64_bf16 v[52:55], v[88:91], a[144:151], v2
    ds_read_b128 v[124:127], v1 offset:23552
    v_add_f32 v45, v45, v47
    v_smfmac_f32_16x16x64_bf16 v[52:55], v[92:95], a[152:159], v2
    s_cbranch_vccnz L_rec2_0
L_norec2_0:
    v_mul_f32 v44, s48, v44
    v_mfma_f32_16x16x16_bf16 v[48:51], v[42:43], v[4:5], 0
    v_mul_f32 v45, s48, v45
    v_cvt_pk_bf16_f32 v46, v44, v45
    s_nop 1
    v_add_f32 v52, v52, v54
    v_add_f32 v53, v53, v55
    v_cvt_pk_bf16_f32 v47, v52, v53
    s_mov_b64 vcc, s[56:57]
    v_cvt_pk_bf16_f32 v40, v48, v49
    v_mfma_f32_16x16x16_bf16 v[52:55], v[46:47], v[4:5], 0
    v_cvt_pk_bf16_f32 v41, v50, v51
    v_smfmac_f32_16x16x64_bf16 v[56:59], v[72:75], a[192:199], v2
    s_mov_b32 m0, 4096
    s_nop 2
    v_cvt_pk_bf16_f32 v42, v52, v53
    v_cvt_pk_bf16_f32 v43, v54, v55
    s_nop 1
    v_mfma_f32_16x16x32_bf16 v[44:47], v[32:35], v[40:43], 0
    v_mfma_f32_16x16x32_bf16 v[48:51], v[36:39], v[40:43], 0
    v_mov_b64 v[32:33], 0
    v_mov_b64 v[34:35], 0
    v_mfma_f32_16x16x32_bf16 v[52:55], v[40:43], v[40:43], 0
    v_mov_b64 v[36:37], 0
    v_mov_b64 v[38:39], 0
    s_nop 0
    v_cndmask_b32_dpp v44, v48, v44, vcc quad_perm:[0,1,0,1] row_mask:0xf bank_mask:0xf
    v_cndmask_b32_dpp v45, v49, v45, vcc quad_perm:[0,1,0,1] row_mask:0xf bank_mask:0xf
    v_cndmask_b32_dpp v46, v50, v46, vcc quad_perm:[0,1,0,1] row_mask:0xf bank_mask:0xf
    v_cndmask_b32_dpp v47, v51, v47, vcc quad_perm:[0,1,0,1] row_mask:0xf bank_mask:0xf
    v_cndmask_b32_dpp v12, v55, v54, vcc quad_perm:[0,1,0,1] row_mask:0xf bank_mask:0xf
    v_smfmac_f32_16x16x64_bf16 v[56:59], v[76:79], a[208:215], v2
    ds_write_b128 v0, v[44:47] offset:10240
    v_smfmac_f32_16x16x64_bf16 v[56:59], v[80:83], a[224:231], v2
    ds_write_addtid_b32 v12 offset:8704
    v_smfmac_f32_16x16x64_bf16 v[56:59], v[84:87], a[232:239], v2
    v_smfmac_f32_16x16x64_bf16 v[56:59], v[88:91], a[240:247], v2
    v_smfmac_f32_16x16x64_bf16 v[56:59], v[92:95], a[248:255], v2
    s_waitcnt lgkmcnt(0)
    s_barrier
    ds_read_addtid_b32 v13 offset:8960
    ds_read_addtid_b32 v14 offset:8192
    v_smfmac_f32_16x16x64_bf16 v[60:63], v[72:75], a[200:207], v2
    ds_read_addtid_b32 v15 offset:8448
    ds_read_b128 v[40:43], v0 offset:11264
    v_smfmac_f32_16x16x64_bf16 v[60:63], v[76:79], a[216:223], v2
    ds_read_b128 v[48:51], v0 offset:8192
    ds_read_b128 v[52:55], v0 offset:9216
    v_add_f32 v56, v56, v58
    v_smfmac_f32_16x16x64_bf16 v[60:63], v[80:83], v[96:103], v2
    v_add_f32 v57, v57, v59
    v_smfmac_f32_16x16x64_bf16 v[60:63], v[84:87], v[104:111], v2
    v_cvt_pk_bf16_f32 v16, v56, v57
    v_smfmac_f32_16x16x64_bf16 v[60:63], v[88:91], v[112:119], v2
    s_waitcnt lgkmcnt(1)
    v_cvt_pk_bf16_f32 v20, v56, v57
    v_add_f32 v12, v12, v13
    v_add_f32 v14, v14, v15
    v_add_f32 v12, v12, v14
    v_pk_add_f32 v[44:45], v[44:45], v[40:41]
    v_pk_add_f32 v[46:47], v[46:47], v[42:43]
    v_pk_add_f32 v[44:45], v[44:45], v[48:49]
    v_pk_add_f32 v[46:47], v[46:47], v[50:51]
    s_waitcnt lgkmcnt(0)
    v_pk_add_f32 v[44:45], v[44:45], v[52:53]
    v_pk_add_f32 v[46:47], v[46:47], v[54:55]
    v_max3_f32 v40, v44, v45, v12
    v_max3_f32 v40, v40, v46, v47
    v_smfmac_f32_16x16x64_bf16 v[60:63], v[92:95], v[120:127], v2
    ds_read_b128 v[96:99], v1 offset:32768
    ds_read_b128 v[100:103], v1 offset:33792
    v_max_f32_dpp v40, v40, v40 quad_perm:[2,3,0,1] row_mask:0xf bank_mask:0xf
    v_mov_b32 v41, v40
    v_mov_b64 v[52:53], s[58:59]
    v_mov_b64 v[54:55], s[58:59]
    v_permlane16_swap_b32 v40, v41
    v_max_f32 v40, v40, v41
    v_mov_b32 v41, v40
    v_add_f32 v60, v60, v62
    v_add_f32 v61, v61, v63
    v_permlane32_swap_b32 v40, v41
    v_max_f32 v40, v40, v41
    v_sub_f32 v12, v12, v40
    v_pk_add_f32 v[44:45], v[44:45], v[40:41] op_sel_hi:[1,0] neg_lo:[0,1] neg_hi:[0,1]
    v_pk_add_f32 v[46:47], v[46:47], v[40:41] op_sel_hi:[1,0] neg_lo:[0,1] neg_hi:[0,1]
    v_exp_f32 v12, v12
    v_exp_f32 v44, v44
    v_exp_f32 v45, v45
    v_exp_f32 v46, v46
    v_exp_f32 v47, v47
    v_cvt_pk_bf16_f32 v12, v12, v12
    v_cvt_pk_bf16_f32 v49, v44, v45
    v_cvt_pk_bf16_f32 v51, v46, v47
    v_and_b32 v48, v12, v17
    v_and_b32 v50, v12, v21
    v_cvt_pk_bf16_f32 v24, v60, v61
    v_cvt_pk_bf16_f32 v28, v60, v61
    v_mfma_f32_16x16x32_bf16 v[40:43], v[48:51], v[52:55], 0
    v_mov_b64 v[64:65], 0
    v_mov_b64 v[66:67], 0
    v_smfmac_f32_16x16x64_bf16 v[32:35], v[48:51], v[16:23], v2 abid:1
    ds_read_b128 v[104:107], v1 offset:34816
    ds_read_b128 v[108:111], v1 offset:35840
    v_mov_b64 v[68:69], 0
    v_smfmac_f32_16x16x64_bf16 v[36:39], v[48:51], v[24:31], v2 abid:1
    v_add_f32 v40, v40, v42
    v_add_f32 v41, v41, v43
    v_rcp_f32 v40, v40
    v_rcp_f32 v41, v41
    v_pk_add_f32 v[32:33], v[32:33], v[34:35]
    v_pk_add_f32 v[36:37], v[36:37], v[38:39]
    v_pk_mul_f32 v[32:33], v[32:33], v[40:41]
    v_pk_mul_f32 v[36:37], v[36:37], v[40:41]
    v_cvt_pk_bf16_f32 v32, v32, v36
    v_cvt_pk_bf16_f32 v33, v33, v37
    v_mfma_f32_32x32x16_bf16 v[80:95], v[64:67], v[64:67], 0
    ds_write2_b32 v9, v32, v33 offset0:0 offset1:16
    ds_read_b128 v[40:43], v10 offset:5120
    v_mov_b64 v[70:71], 0
    v_mov_b64 v[72:73], 0
    v_mov_b64 v[74:75], 0
    v_mov_b64 v[76:77], 0
    v_mov_b64 v[78:79], 0
    s_waitcnt lgkmcnt(1)
    s_barrier
    ds_read_b128 v[44:47], v10 offset:5632
    s_waitcnt lgkmcnt(1)
    v_smfmac_f32_16x16x64_bf16 v[64:67], v[40:43], v[96:103], v2
    ds_read_b128 v[48:51], v10 offset:4096
    ds_read_b128 v[52:55], v10 offset:4608
    v_smfmac_f32_16x16x64_bf16 v[68:71], v[40:43], v[104:111], v2
    s_waitcnt lgkmcnt(2)
    v_smfmac_f32_16x16x64_bf16 v[64:67], v[44:47], v[128:135], v2
    ds_read_b128 v[112:115], v1 offset:28672
    s_waitcnt lgkmcnt(2)
    v_smfmac_f32_16x16x64_bf16 v[64:67], v[48:51], v[136:143], v2
    ds_read_b128 v[116:119], v1 offset:29696
    s_waitcnt lgkmcnt(2)
    v_smfmac_f32_16x16x64_bf16 v[64:67], v[52:55], v[144:151], v2
    ds_read_b128 v[120:123], v1 offset:30720
    v_smfmac_f32_16x16x64_bf16 v[68:71], v[44:47], v[152:159], v2
    ds_read_b128 v[124:127], v1 offset:31744
    v_smfmac_f32_16x16x64_bf16 v[68:71], v[48:51], v[160:167], v2
    ds_read_b128 v[96:99], v1 offset:24576
    v_cvt_pk_bf16_f32 v56, v64, v65
    v_or_b32 v56, 1, v56
    v_cvt_pk_bf16_f32 v57, v66, v67
    v_smfmac_f32_16x16x64_bf16 v[68:71], v[52:55], v[168:175], v2
    buffer_store_dwordx2 v[56:57], v3, s[8:11], s50 offen
    ds_read_b128 v[100:103], v1 offset:25600
    v_smfmac_f32_16x16x64_bf16 v[72:75], v[40:43], v[176:183], v2
    ds_read_b128 v[104:107], v1 offset:26624
    v_smfmac_f32_16x16x64_bf16 v[72:75], v[44:47], v[184:191], v2
    ds_read_b128 v[108:111], v1 offset:27648
    v_cvt_pk_bf16_f32 v58, v68, v69
    v_or_b32 v58, 1, v58
    v_cvt_pk_bf16_f32 v59, v70, v71
    v_smfmac_f32_16x16x64_bf16 v[72:75], v[48:51], v[192:199], v2
    buffer_store_dwordx2 v[58:59], v3, s[8:11], s51 offen
    v_smfmac_f32_16x16x64_bf16 v[72:75], v[52:55], v[200:207], v2
    s_waitcnt lgkmcnt(4)
    v_smfmac_f32_16x16x64_bf16 v[76:79], v[40:43], v[112:119], v2
    v_smfmac_f32_16x16x64_bf16 v[76:79], v[44:47], v[120:127], v2
    s_waitcnt lgkmcnt(0)
    v_cvt_pk_bf16_f32 v60, v72, v73
    v_or_b32 v60, 1, v60
    v_cvt_pk_bf16_f32 v61, v74, v75
    v_smfmac_f32_16x16x64_bf16 v[76:79], v[48:51], v[96:103], v2
    buffer_store_dwordx2 v[60:61], v3, s[8:11], s2 offen
    v_smfmac_f32_16x16x64_bf16 v[76:79], v[52:55], v[104:111], v2
    s_add_u32 s36, s36, 1
    s_cmp_lt_u32 s36, 62
    s_cselect_b32 s45, 0x80000, 0
    s_add_u32 s38, s38, s45
    s_mov_b32 s54, 0
    s_add_u32 s39, s39, 0x2000
    s_nop 1
    v_cvt_pk_bf16_f32 v62, v76, v77
    v_or_b32 v62, 1, v62
    v_cvt_pk_bf16_f32 v63, v78, v79
    s_nop 1
    buffer_store_dwordx2 v[62:63], v3, s[8:11], s99 offen
    s_cmp_eq_u32 s36, 63
    s_cbranch_scc1 L_chain_end
    ds_read_b128 v[96:99], v1 offset:0
    ds_read_b128 v[100:103], v1 offset:1024
    ds_read_b128 v[104:107], v1 offset:2048
    ds_read_b128 v[108:111], v1 offset:3072
    ds_read_b128 v[112:115], v1 offset:4096
    ds_read_b128 v[116:119], v1 offset:5120
    ds_read_b128 v[120:123], v1 offset:6144
    ds_read_b128 v[124:127], v1 offset:7168
    v_mov_b64 v[40:41], 0
    v_mov_b64 v[42:43], 0
    v_mov_b64 v[44:45], 0
    v_mov_b64 v[46:47], 0
    v_mov_b64 v[48:49], 0
    v_mov_b64 v[50:51], 0
    v_mov_b64 v[52:53], 0
    v_mov_b64 v[54:55], 0
    v_mov_b64 v[56:57], 0
    v_mov_b64 v[58:59], 0
    v_mov_b64 v[60:61], 0
    v_mov_b64 v[62:63], 0
    s_waitcnt vmcnt(4)
    v_mov_b64 v[32:33], v[240:241]
    v_mov_b64 v[34:35], v[242:243]
    v_mov_b64 v[36:37], v[244:245]
    v_mov_b64 v[38:39], v[246:247]
    v_mov_b64 v[18:19], v[248:249]
    v_mov_b64 v[22:23], v[250:251]
    v_mov_b64 v[26:27], v[252:253]
    v_mov_b64 v[30:31], v[254:255]
    s_waitcnt lgkmcnt(0)
L_step2_1:
    s_barrier
    ds_read_b128 v[64:67], v7 offset:0
    ds_read_b128 v[68:71], v7 offset:1024
    buffer_load_dwordx4 v29, s[8:11], s44 offen offset:2048 sc1 lds
    s_waitcnt lgkmcnt(1)
    v_smfmac_f32_16x16x64_bf16 v[40:43], v[64:67], v[96:103], v2
    v_smfmac_f32_16x16x64_bf16 v[44:47], v[64:67], v[104:111], v2
    ds_read_b128 v[96:99], v1 offset:8192
    v_smfmac_f32_16x16x64_bf16 v[48:51], v[64:67], v[112:119], v2
    ds_read_b128 v[100:103], v1 offset:9216
    v_smfmac_f32_16x16x64_bf16 v[52:55], v[64:67], v[120:127], v2
    ds_read_b128 v[104:107], v1 offset:10240
    s_waitcnt lgkmcnt(3)
    v_smfmac_f32_16x16x64_bf16 v[40:43], v[68:71], v[208:215], v2
    buffer_load_dwordx4 v[240:243], v0, s[8:11], s38 offen offset:0 sc1
    v_smfmac_f32_16x16x64_bf16 v[44:47], v[68:71], v[216:223], v2
    ds_read_b128 v[108:111], v1 offset:11264
    v_smfmac_f32_16x16x64_bf16 v[48:51], v[68:71], a[80:87], v2
    ds_read_b128 v[112:115], v1 offset:12288
    v_smfmac_f32_16x16x64_bf16 v[52:55], v[68:71], a[88:95], v2
    s_barrier
    ds_read_b128 v[72:75], v7 offset:2048
    v_smfmac_f32_16x16x64_bf16 v[56:59], v[64:67], a[160:167], v2
    ds_read_b128 v[76:79], v7 offset:3072
    v_smfmac_f32_16x16x64_bf16 v[56:59], v[68:71], a[176:183], v2
    ds_read_b128 v[116:119], v1 offset:13312
    v_smfmac_f32_16x16x64_bf16 v[60:63], v[64:67], a[168:175], v2
    buffer_load_dwordx4 v[244:247], v0, s[8:11], s38 offen offset:1024 sc1
    v_smfmac_f32_16x16x64_bf16 v[60:63], v[68:71], a[184:191], v2
    ds_read_b128 v[120:123], v1 offset:14336
    s_waitcnt lgkmcnt(3)
    v_smfmac_f32_16x16x64_bf16 v[40:43], v[72:75], v[224:231], v2
    ds_read_b128 v[124:127], v1 offset:15360
    v_smfmac_f32_16x16x64_bf16 v[44:47], v[72:75], v[232:239], v2
    v_bitop3_b32 v12, v64, v66, v68 bitop3:0x80
    v_smfmac_f32_16x16x64_bf16 v[48:51], v[72:75], a[96:103], v2
    s_waitcnt vmcnt(2)
    s_barrier
    ds_read_b128 v[80:83], v7 offset:4096
    v_bitop3_b32 v12, v12, v70, v72 bitop3:0x80
    v_smfmac_f32_16x16x64_bf16 v[52:55], v[72:75], a[104:111], v2
    ds_read_b128 v[84:87], v7 offset:5120
    s_waitcnt lgkmcnt(5)
    v_smfmac_f32_16x16x64_bf16 v[40:43], v[76:79], a[0:7], v2
    ds_read_b128 v[88:91], v7 offset:6144
    v_bitop3_b32 v12, v12, v74, v76 bitop3:0x80
    v_smfmac_f32_16x16x64_bf16 v[44:47], v[76:79], a[8:15], v2
    ds_read_b128 v[92:95], v7 offset:7168
    v_smfmac_f32_16x16x64_bf16 v[48:51], v[76:79], a[112:119], v2
    buffer_load_dwordx4 v[248:251], v0, s[8:11], s38 offen offset:2048 sc1
    v_smfmac_f32_16x16x64_bf16 v[52:55], v[76:79], a[120:127], v2
    s_waitcnt lgkmcnt(3)
    v_bitop3_b32 v12, v12, v78, v80 bitop3:0x80
    v_smfmac_f32_16x16x64_bf16 v[40:43], v[80:83], a[16:23], v2
    s_waitcnt lgkmcnt(2)
    v_bitop3_b32 v12, v12, v82, v84 bitop3:0x80
    v_smfmac_f32_16x16x64_bf16 v[40:43], v[84:87], a[32:39], v2
    s_waitcnt lgkmcnt(1)
    v_bitop3_b32 v12, v12, v86, v88 bitop3:0x80
    v_smfmac_f32_16x16x64_bf16 v[40:43], v[88:91], a[48:55], v2
    buffer_load_dwordx4 v[252:255], v0, s[8:11], s38 offen offset:3072 sc1
    s_waitcnt lgkmcnt(0)
    v_bitop3_b32 v12, v12, v90, v92 bitop3:0x80
    v_smfmac_f32_16x16x64_bf16 v[40:43], v[92:95], a[64:71], v2
    v_bitop3_b32 v12, v12, v94, 1 bitop3:0x80
    v_smfmac_f32_16x16x64_bf16 v[48:51], v[80:83], v[96:103], v2
    v_cmp_eq_u32 vcc, 0, v12
    v_smfmac_f32_16x16x64_bf16 v[48:51], v[84:87], v[104:111], v2
    v_add_f32 v40, v40, v42
    v_smfmac_f32_16x16x64_bf16 v[48:51], v[88:91], v[112:119], v2
    v_add_f32 v41, v41, v43
    v_smfmac_f32_16x16x64_bf16 v[48:51], v[92:95], v[120:127], v2
    ds_read_b128 v[96:99], v1 offset:16384
    v_mul_f32 v40, s48, v40
    v_smfmac_f32_16x16x64_bf16 v[44:47], v[80:83], a[24:31], v2
    ds_read_b128 v[100:103], v1 offset:17408
    v_mul_f32 v41, s48, v41
    v_smfmac_f32_16x16x64_bf16 v[44:47], v[84:87], a[40:47], v2
    ds_read_b128 v[104:107], v1 offset:18432
    v_cvt_pk_bf16_f32 v42, v40, v41
    v_smfmac_f32_16x16x64_bf16 v[44:47], v[88:91], a[56:63], v2
    ds_read_b128 v[108:111], v1 offset:19456
    v_add_f32 v48, v48, v50
    v_smfmac_f32_16x16x64_bf16 v[44:47], v[92:95], a[72:79], v2
    ds_read_b128 v[112:115], v1 offset:20480
    v_add_f32 v49, v49, v51
    v_smfmac_f32_16x16x64_bf16 v[52:55], v[80:83], a[128:135], v2
    ds_read_b128 v[116:119], v1 offset:21504
    v_cvt_pk_bf16_f32 v43, v48, v49
    v_smfmac_f32_16x16x64_bf16 v[52:55], v[84:87], a[136:143], v2
    ds_read_b128 v[120:123], v1 offset:22528
    v_add_f32 v44, v44, v46
    v_smfmac_f32_16x16x64_bf16 v[52:55], v[88:91], a[144:151], v2
    ds_read_b128 v[124:127], v1 offset:23552
    v_add_f32 v45, v45, v47
    v_smfmac_f32_16x16x64_bf16 v[52:55], v[92:95], a[152:159], v2
    s_cbranch_vccnz L_rec2_1
L_norec2_1:
    v_mul_f32 v44, s48, v44
    v_mfma_f32_16x16x16_bf16 v[48:51], v[42:43], v[4:5], 0
    v_mul_f32 v45, s48, v45
    v_cvt_pk_bf16_f32 v46, v44, v45
    s_nop 1
    v_add_f32 v52, v52, v54
    v_add_f32 v53, v53, v55
    v_cvt_pk_bf16_f32 v47, v52, v53
    s_mov_b64 vcc, s[56:57]
    v_cvt_pk_bf16_f32 v40, v48, v49
    v_mfma_f32_16x16x16_bf16 v[52:55], v[46:47], v[4:5], 0
    v_cvt_pk_bf16_f32 v41, v50, v51
    v_smfmac_f32_16x16x64_bf16 v[56:59], v[72:75], a[192:199], v2
    s_mov_b32 m0, 4096
    s_nop 2
    v_cvt_pk_bf16_f32 v42, v52, v53
    v_cvt_pk_bf16_f32 v43, v54, v55
    s_nop 1
    v_mfma_f32_16x16x32_bf16 v[44:47], v[32:35], v[40:43], 0
    v_mfma_f32_16x16x32_bf16 v[48:51], v[36:39], v[40:43], 0
    v_mov_b64 v[32:33], 0
    v_mov_b64 v[34:35], 0
    v_mfma_f32_16x16x32_bf16 v[52:55], v[40:43], v[40:43], 0
    v_mov_b64 v[36:37], 0
    v_mov_b64 v[38:39], 0
    s_nop 0
    v_cndmask_b32_dpp v44, v48, v44, vcc quad_perm:[0,1,0,1] row_mask:0xf bank_mask:0xf
    v_cndmask_b32_dpp v45, v49, v45, vcc quad_perm:[0,1,0,1] row_mask:0xf bank_mask:0xf
    v_cndmask_b32_dpp v46, v50, v46, vcc quad_perm:[0,1,0,1] row_mask:0xf bank_mask:0xf
    v_cndmask_b32_dpp v47, v51, v47, vcc quad_perm:[0,1,0,1] row_mask:0xf bank_mask:0xf
    v_cndmask_b32_dpp v12, v55, v54, vcc quad_perm:[0,1,0,1] row_mask:0xf bank_mask:0xf
    v_smfmac_f32_16x16x64_bf16 v[56:59], v[76:79], a[208:215], v2
    ds_write_b128 v0, v[44:47] offset:10240
    v_smfmac_f32_16x16x64_bf16 v[56:59], v[80:83], a[224:231], v2
    ds_write_addtid_b32 v12 offset:8704
    v_smfmac_f32_16x16x64_bf16 v[56:59], v[84:87], a[232:239], v2
    v_smfmac_f32_16x16x64_bf16 v[56:59], v[88:91], a[240:247], v2
    v_smfmac_f32_16x16x64_bf16 v[56:59], v[92:95], a[248:255], v2
    s_waitcnt lgkmcnt(0)
    s_barrier
    ds_read_addtid_b32 v13 offset:8960
    ds_read_addtid_b32 v14 offset:8192
    v_smfmac_f32_16x16x64_bf16 v[60:63], v[72:75], a[200:207], v2
    ds_read_addtid_b32 v15 offset:8448
    ds_read_b128 v[40:43], v0 offset:11264
    v_smfmac_f32_16x16x64_bf16 v[60:63], v[76:79], a[216:223], v2
    ds_read_b128 v[48:51], v0 offset:8192
    ds_read_b128 v[52:55], v0 offset:9216
    v_add_f32 v56, v56, v58
    v_smfmac_f32_16x16x64_bf16 v[60:63], v[80:83], v[96:103], v2
    v_add_f32 v57, v57, v59
    v_smfmac_f32_16x16x64_bf16 v[60:63], v[84:87], v[104:111], v2
    v_cvt_pk_bf16_f32 v16, v56, v57
    v_smfmac_f32_16x16x64_bf16 v[60:63], v[88:91], v[112:119], v2
    s_waitcnt lgkmcnt(1)
    v_cvt_pk_bf16_f32 v20, v56, v57
    v_add_f32 v12, v12, v13
    v_add_f32 v14, v14, v15
    v_add_f32 v12, v12, v14
    v_pk_add_f32 v[44:45], v[44:45], v[40:41]
    v_pk_add_f32 v[46:47], v[46:47], v[42:43]
    v_pk_add_f32 v[44:45], v[44:45], v[48:49]
    v_pk_add_f32 v[46:47], v[46:47], v[50:51]
    s_waitcnt lgkmcnt(0)
    v_pk_add_f32 v[44:45], v[44:45], v[52:53]
    v_pk_add_f32 v[46:47], v[46:47], v[54:55]
    v_max3_f32 v40, v44, v45, v12
    v_max3_f32 v40, v40, v46, v47
    v_smfmac_f32_16x16x64_bf16 v[60:63], v[92:95], v[120:127], v2
    ds_read_b128 v[96:99], v1 offset:32768
    ds_read_b128 v[100:103], v1 offset:33792
    v_max_f32_dpp v40, v40, v40 quad_perm:[2,3,0,1] row_mask:0xf bank_mask:0xf
    v_mov_b32 v41, v40
    v_mov_b64 v[52:53], s[58:59]
    v_mov_b64 v[54:55], s[58:59]
    v_permlane16_swap_b32 v40, v41
    v_max_f32 v40, v40, v41
    v_mov_b32 v41, v40
    v_add_f32 v60, v60, v62
    v_add_f32 v61, v61, v63
    v_permlane32_swap_b32 v40, v41
    v_max_f32 v40, v40, v41
    v_sub_f32 v12, v12, v40
    v_pk_add_f32 v[44:45], v[44:45], v[40:41] op_sel_hi:[1,0] neg_lo:[0,1] neg_hi:[0,1]
    v_pk_add_f32 v[46:47], v[46:47], v[40:41] op_sel_hi:[1,0] neg_lo:[0,1] neg_hi:[0,1]
    v_exp_f32 v12, v12
    v_exp_f32 v44, v44
    v_exp_f32 v45, v45
    v_exp_f32 v46, v46
    v_exp_f32 v47, v47
    v_cvt_pk_bf16_f32 v12, v12, v12
    v_cvt_pk_bf16_f32 v49, v44, v45
    v_cvt_pk_bf16_f32 v51, v46, v47
    v_and_b32 v48, v12, v17
    v_and_b32 v50, v12, v21
    v_cvt_pk_bf16_f32 v24, v60, v61
    v_cvt_pk_bf16_f32 v28, v60, v61
    v_mfma_f32_16x16x32_bf16 v[40:43], v[48:51], v[52:55], 0
    v_mov_b64 v[64:65], 0
    v_mov_b64 v[66:67], 0
    v_smfmac_f32_16x16x64_bf16 v[32:35], v[48:51], v[16:23], v2 abid:1
    ds_read_b128 v[104:107], v1 offset:34816
    ds_read_b128 v[108:111], v1 offset:35840
    v_mov_b64 v[68:69], 0
    v_smfmac_f32_16x16x64_bf16 v[36:39], v[48:51], v[24:31], v2 abid:1
    v_add_f32 v40, v40, v42
    v_add_f32 v41, v41, v43
    v_rcp_f32 v40, v40
    v_rcp_f32 v41, v41
    v_pk_add_f32 v[32:33], v[32:33], v[34:35]
    v_pk_add_f32 v[36:37], v[36:37], v[38:39]
    v_pk_mul_f32 v[32:33], v[32:33], v[40:41]
    v_pk_mul_f32 v[36:37], v[36:37], v[40:41]
    v_cvt_pk_bf16_f32 v32, v32, v36
    v_cvt_pk_bf16_f32 v33, v33, v37
    v_mfma_f32_32x32x16_bf16 v[80:95], v[64:67], v[64:67], 0
    ds_write2_b32 v9, v32, v33 offset0:0 offset1:16
    ds_read_b128 v[40:43], v10 offset:5120
    v_mov_b64 v[70:71], 0
    v_mov_b64 v[72:73], 0
    v_mov_b64 v[74:75], 0
    v_mov_b64 v[76:77], 0
    v_mov_b64 v[78:79], 0
    s_waitcnt lgkmcnt(1)
    s_barrier
    ds_read_b128 v[44:47], v10 offset:5632
    s_waitcnt lgkmcnt(1)
    v_smfmac_f32_16x16x64_bf16 v[64:67], v[40:43], v[96:103], v2
    ds_read_b128 v[48:51], v10 offset:4096
    ds_read_b128 v[52:55], v10 offset:4608
    v_smfmac_f32_16x16x64_bf16 v[68:71], v[40:43], v[104:111], v2
    s_waitcnt lgkmcnt(2)
    v_smfmac_f32_16x16x64_bf16 v[64:67], v[44:47], v[128:135], v2
    ds_read_b128 v[112:115], v1 offset:28672
    s_waitcnt lgkmcnt(2)
    v_smfmac_f32_16x16x64_bf16 v[64:67], v[48:51], v[136:143], v2
    ds_read_b128 v[116:119], v1 offset:29696
    s_waitcnt lgkmcnt(2)
    v_smfmac_f32_16x16x64_bf16 v[64:67], v[52:55], v[144:151], v2
    ds_read_b128 v[120:123], v1 offset:30720
    v_smfmac_f32_16x16x64_bf16 v[68:71], v[44:47], v[152:159], v2
    ds_read_b128 v[124:127], v1 offset:31744
    v_smfmac_f32_16x16x64_bf16 v[68:71], v[48:51], v[160:167], v2
    ds_read_b128 v[96:99], v1 offset:24576
    v_cvt_pk_bf16_f32 v56, v64, v65
    v_and_b32 v56, -2, v56
    v_cvt_pk_bf16_f32 v57, v66, v67
    v_smfmac_f32_16x16x64_bf16 v[68:71], v[52:55], v[168:175], v2
    buffer_store_dwordx2 v[56:57], v3, s[8:11], s50 offen
    ds_read_b128 v[100:103], v1 offset:25600
    v_smfmac_f32_16x16x64_bf16 v[72:75], v[40:43], v[176:183], v2
    ds_read_b128 v[104:107], v1 offset:26624
    v_smfmac_f32_16x16x64_bf16 v[72:75], v[44:47], v[184:191], v2
    ds_read_b128 v[108:111], v1 offset:27648
    v_cvt_pk_bf16_f32 v58, v68, v69
    v_and_b32 v58, -2, v58
    v_cvt_pk_bf16_f32 v59, v70, v71
    v_smfmac_f32_16x16x64_bf16 v[72:75], v[48:51], v[192:199], v2
    buffer_store_dwordx2 v[58:59], v3, s[8:11], s51 offen
    v_smfmac_f32_16x16x64_bf16 v[72:75], v[52:55], v[200:207], v2
    s_waitcnt lgkmcnt(4)
    v_smfmac_f32_16x16x64_bf16 v[76:79], v[40:43], v[112:119], v2
    v_smfmac_f32_16x16x64_bf16 v[76:79], v[44:47], v[120:127], v2
    s_waitcnt lgkmcnt(0)
    v_cvt_pk_bf16_f32 v60, v72, v73
    v_and_b32 v60, -2, v60
    v_cvt_pk_bf16_f32 v61, v74, v75
    v_smfmac_f32_16x16x64_bf16 v[76:79], v[48:51], v[96:103], v2
    buffer_store_dwordx2 v[60:61], v3, s[8:11], s2 offen
    v_smfmac_f32_16x16x64_bf16 v[76:79], v[52:55], v[104:111], v2
    s_add_u32 s36, s36, 1
    s_cmp_lt_u32 s36, 62
    s_cselect_b32 s45, 0x80000, 0
    s_add_u32 s38, s38, s45
    s_mov_b32 s54, 0
    s_add_u32 s39, s39, 0x2000
    s_nop 1
    v_cvt_pk_bf16_f32 v62, v76, v77
    v_and_b32 v62, -2, v62
    v_cvt_pk_bf16_f32 v63, v78, v79
    s_nop 1
    buffer_store_dwordx2 v[62:63], v3, s[8:11], s99 offen
    ds_read_b128 v[96:99], v1 offset:0
    ds_read_b128 v[100:103], v1 offset:1024
    ds_read_b128 v[104:107], v1 offset:2048
    ds_read_b128 v[108:111], v1 offset:3072
    ds_read_b128 v[112:115], v1 offset:4096
    ds_read_b128 v[116:119], v1 offset:5120
    ds_read_b128 v[120:123], v1 offset:6144
    ds_read_b128 v[124:127], v1 offset:7168
    v_mov_b64 v[40:41], 0
    v_mov_b64 v[42:43], 0
    v_mov_b64 v[44:45], 0
    v_mov_b64 v[46:47], 0
    v_mov_b64 v[48:49], 0
    v_mov_b64 v[50:51], 0
    v_mov_b64 v[52:53], 0
    v_mov_b64 v[54:55], 0
    v_mov_b64 v[56:57], 0
    v_mov_b64 v[58:59], 0
    v_mov_b64 v[60:61], 0
    v_mov_b64 v[62:63], 0
    s_waitcnt vmcnt(4)
    v_mov_b64 v[32:33], v[240:241]
    v_mov_b64 v[34:35], v[242:243]
    v_mov_b64 v[36:37], v[244:245]
    v_mov_b64 v[38:39], v[246:247]
    v_mov_b64 v[18:19], v[248:249]
    v_mov_b64 v[22:23], v[250:251]
    v_mov_b64 v[26:27], v[252:253]
    v_mov_b64 v[30:31], v[254:255]
    s_waitcnt lgkmcnt(0)
    s_branch L_step2_0
.p2align 6
L_step3_0:
    s_barrier
    ds_read_b128 v[64:67], v7 offset:0
    ds_read_b128 v[68:71], v7 offset:1024
    buffer_load_dwordx4 v29, s[8:11], s55 offen offset:3072 sc1 lds
    s_waitcnt lgkmcnt(1)
    v_smfmac_f32_16x16x64_bf16 v[40:43], v[64:67], v[96:103], v2
    v_smfmac_f32_16x16x64_bf16 v[44:47], v[64:67], v[104:111], v2
    buffer_load_dword v6, off, s[8:11], s52 sc1
    v_smfmac_f32_16x16x64_bf16 v[48:51], v[64:67], v[112:119], v2
    ds_read_b128 v[96:99], v1 offset:8192
    v_smfmac_f32_16x16x64_bf16 v[52:55], v[64:67], v[120:127], v2
    ds_read_b128 v[100:103], v1 offset:9216
    s_waitcnt lgkmcnt(2)
    v_smfmac_f32_16x16x64_bf16 v[40:43], v[68:71], v[208:215], v2
    ds_read_b128 v[104:107], v1 offset:10240
    v_smfmac_f32_16x16x64_bf16 v[44:47], v[68:71], v[216:223], v2
    buffer_load_dwordx4 v[240:243], v0, s[8:11], s38 offen offset:0 sc1
    v_smfmac_f32_16x16x64_bf16 v[48:51], v[68:71], a[80:87], v2
    ds_read_b128 v[108:111], v1 offset:11264
    v_smfmac_f32_16x16x64_bf16 v[52:55], v[68:71], a[88:95], v2
    s_barrier
    ds_read_b128 v[72:75], v7 offset:2048
    v_smfmac_f32_16x16x64_bf16 v[56:59], v[64:67], a[160:167], v2
    ds_read_b128 v[76:79], v7 offset:3072
    v_smfmac_f32_16x16x64_bf16 v[56:59], v[68:71], a[176:183], v2
    ds_read_b128 v[112:115], v1 offset:12288
    v_smfmac_f32_16x16x64_bf16 v[60:63], v[64:67], a[168:175], v2
    ds_read_b128 v[116:119], v1 offset:13312
    v_smfmac_f32_16x16x64_bf16 v[60:63], v[68:71], a[184:191], v2
    buffer_load_dwordx4 v[244:247], v0, s[8:11], s38 offen offset:1024 sc1
    s_waitcnt lgkmcnt(3)
    v_smfmac_f32_16x16x64_bf16 v[40:43], v[72:75], v[224:231], v2
    ds_read_b128 v[120:123], v1 offset:14336
    v_smfmac_f32_16x16x64_bf16 v[44:47], v[72:75], v[232:239], v2
    ds_read_b128 v[124:127], v1 offset:15360
    v_bitop3_b32 v12, v64, v66, v68 bitop3:0xfe
    v_smfmac_f32_16x16x64_bf16 v[48:51], v[72:75], a[96:103], v2
    s_waitcnt vmcnt(3)
    s_barrier
    ds_read_b128 v[80:83], v7 offset:4096
    v_bitop3_b32 v12, v12, v70, v72 bitop3:0xfe
    v_smfmac_f32_16x16x64_bf16 v[52:55], v[72:75], a[104:111], v2
    ds_read_b128 v[84:87], v7 offset:5120
    s_waitcnt lgkmcnt(6)
    v_smfmac_f32_16x16x64_bf16 v[40:43], v[76:79], a[0:7], v2
    ds_read_b128 v[88:91], v7 offset:6144
    v_bitop3_b32 v12, v12, v74, v76 bitop3:0xfe
    v_smfmac_f32_16x16x64_bf16 v[44:47], v[76:79], a[8:15], v2
    ds_read_b128 v[92:95], v7 offset:7168
    v_smfmac_f32_16x16x64_bf16 v[48:51], v[76:79], a[112:119], v2
    v_smfmac_f32_16x16x64_bf16 v[52:55], v[76:79], a[120:127], v2
    buffer_load_dwordx4 v[248:251], v0, s[8:11], s38 offen offset:2048 sc1
    s_waitcnt lgkmcnt(3)
    v_bitop3_b32 v12, v12, v78, v80 bitop3:0xfe
    v_smfmac_f32_16x16x64_bf16 v[40:43], v[80:83], a[16:23], v2
    s_waitcnt lgkmcnt(2)
    v_bitop3_b32 v12, v12, v82, v84 bitop3:0xfe
    v_smfmac_f32_16x16x64_bf16 v[40:43], v[84:87], a[32:39], v2
    s_waitcnt lgkmcnt(1)
    v_bitop3_b32 v12, v12, v86, v88 bitop3:0xfe
    v_smfmac_f32_16x16x64_bf16 v[40:43], v[88:91], a[48:55], v2
    s_waitcnt lgkmcnt(0)
    v_bitop3_b32 v12, v12, v90, v92 bitop3:0xfe
    v_smfmac_f32_16x16x64_bf16 v[40:43], v[92:95], a[64:71], v2
    buffer_load_dwordx4 v[252:255], v0, s[8:11], s38 offen offset:3072 sc1
    v_bitop3_b32 v12, v12, v94, 1 bitop3:0xa8
    v_smfmac_f32_16x16x64_bf16 v[48:51], v[80:83], v[96:103], v2
    v_cmp_ne_u32 vcc, 0, v12
    v_smfmac_f32_16x16x64_bf16 v[48:51], v[84:87], v[104:111], v2
    v_add_f32 v40, v40, v42
    v_smfmac_f32_16x16x64_bf16 v[48:51], v[88:91], v[112:119], v2
    v_add_f32 v41, v41, v43
    v_smfmac_f32_16x16x64_bf16 v[48:51], v[92:95], v[120:127], v2
    ds_read_b128 v[96:99], v1 offset:16384
    v_mul_f32 v40, s48, v40
    v_smfmac_f32_16x16x64_bf16 v[44:47], v[80:83], a[24:31], v2
    ds_read_b128 v[100:103], v1 offset:17408
    v_mul_f32 v41, s48, v41
    v_smfmac_f32_16x16x64_bf16 v[44:47], v[84:87], a[40:47], v2
    ds_read_b128 v[104:107], v1 offset:18432
    v_cvt_pk_bf16_f32 v42, v40, v41
    v_smfmac_f32_16x16x64_bf16 v[44:47], v[88:91], a[56:63], v2
    ds_read_b128 v[108:111], v1 offset:19456
    v_add_f32 v48, v48, v50
    v_smfmac_f32_16x16x64_bf16 v[44:47], v[92:95], a[72:79], v2
    ds_read_b128 v[112:115], v1 offset:20480
    v_add_f32 v49, v49, v51
    v_smfmac_f32_16x16x64_bf16 v[52:55], v[80:83], a[128:135], v2
    ds_read_b128 v[116:119], v1 offset:21504
    v_cvt_pk_bf16_f32 v43, v48, v49
    v_smfmac_f32_16x16x64_bf16 v[52:55], v[84:87], a[136:143], v2
    ds_read_b128 v[120:123], v1 offset:22528
    v_add_f32 v44, v44, v46
    v_smfmac_f32_16x16x64_bf16 v[52:55], v[88:91], a[144:151], v2
    ds_read_b128 v[124:127], v1 offset:23552
    v_add_f32 v45, v45, v47
    v_smfmac_f32_16x16x64_bf16 v[52:55], v[92:95], a[152:159], v2
    s_cbranch_vccnz L_rec3_0
L_norec3_0:
    v_mul_f32 v44, s48, v44
    v_mfma_f32_16x16x16_bf16 v[48:51], v[42:43], v[4:5], 0
    v_mul_f32 v45, s48, v45
    v_cvt_pk_bf16_f32 v46, v44, v45
    s_nop 1
    v_add_f32 v52, v52, v54
    v_add_f32 v53, v53, v55
    v_cvt_pk_bf16_f32 v47, v52, v53
    s_mov_b64 vcc, s[56:57]
    v_cvt_pk_bf16_f32 v40, v48, v49
    v_mfma_f32_16x16x16_bf16 v[52:55], v[46:47], v[4:5], 0
    v_cvt_pk_bf16_f32 v41, v50, v51
    v_smfmac_f32_16x16x64_bf16 v[56:59], v[72:75], a[192:199], v2
    s_mov_b32 m0, 4096
    s_nop 2
    v_cvt_pk_bf16_f32 v42, v52, v53
    v_cvt_pk_bf16_f32 v43, v54, v55
    s_nop 1
    v_mfma_f32_16x16x32_bf16 v[44:47], v[32:35], v[40:43], 0
    v_mfma_f32_16x16x32_bf16 v[48:51], v[36:39], v[40:43], 0
    v_mov_b64 v[32:33], 0
    v_mov_b64 v[34:35], 0
    v_mfma_f32_16x16x32_bf16 v[52:55], v[40:43], v[40:43], 0
    v_mov_b64 v[36:37], 0
    v_mov_b64 v[38:39], 0
    s_nop 0
    v_cndmask_b32_dpp v44, v48, v44, vcc quad_perm:[0,1,0,1] row_mask:0xf bank_mask:0xf
    v_cndmask_b32_dpp v45, v49, v45, vcc quad_perm:[0,1,0,1] row_mask:0xf bank_mask:0xf
    v_cndmask_b32_dpp v46, v50, v46, vcc quad_perm:[0,1,0,1] row_mask:0xf bank_mask:0xf
    v_cndmask_b32_dpp v47, v51, v47, vcc quad_perm:[0,1,0,1] row_mask:0xf bank_mask:0xf
    v_cndmask_b32_dpp v12, v55, v54, vcc quad_perm:[0,1,0,1] row_mask:0xf bank_mask:0xf
    v_smfmac_f32_16x16x64_bf16 v[56:59], v[76:79], a[208:215], v2
    ds_write_b128 v0, v[44:47] offset:11264
    v_smfmac_f32_16x16x64_bf16 v[56:59], v[80:83], a[224:231], v2
    ds_write_addtid_b32 v12 offset:8960
    v_smfmac_f32_16x16x64_bf16 v[56:59], v[84:87], a[232:239], v2
    v_smfmac_f32_16x16x64_bf16 v[56:59], v[88:91], a[240:247], v2
    v_smfmac_f32_16x16x64_bf16 v[56:59], v[92:95], a[248:255], v2
    s_waitcnt lgkmcnt(0)
    s_barrier
    ds_read_addtid_b32 v13 offset:8192
    ds_read_addtid_b32 v14 offset:8448
    v_smfmac_f32_16x16x64_bf16 v[60:63], v[72:75], a[200:207], v2
    ds_read_addtid_b32 v15 offset:8704
    ds_read_b128 v[40:43], v0 offset:8192
    v_smfmac_f32_16x16x64_bf16 v[60:63], v[76:79], a[216:223], v2
    ds_read_b128 v[48:51], v0 offset:9216
    ds_read_b128 v[52:55], v0 offset:10240
    v_add_f32 v56, v56, v58
    v_smfmac_f32_16x16x64_bf16 v[60:63], v[80:83], v[96:103], v2
    v_add_f32 v57, v57, v59
    v_smfmac_f32_16x16x64_bf16 v[60:63], v[84:87], v[104:111], v2
    v_cvt_pk_bf16_f32 v16, v56, v57
    v_smfmac_f32_16x16x64_bf16 v[60:63], v[88:91], v[112:119], v2
    s_waitcnt lgkmcnt(1)
    v_cvt_pk_bf16_f32 v20, v56, v57
    v_add_f32 v12, v12, v13
    v_add_f32 v14, v14, v15
    v_add_f32 v12, v12, v14
    v_pk_add_f32 v[44:45], v[44:45], v[40:41]
    v_pk_add_f32 v[46:47], v[46:47], v[42:43]
    v_pk_add_f32 v[44:45], v[44:45], v[48:49]
    v_pk_add_f32 v[46:47], v[46:47], v[50:51]
    s_waitcnt lgkmcnt(0)
    v_pk_add_f32 v[44:45], v[44:45], v[52:53]
    v_pk_add_f32 v[46:47], v[46:47], v[54:55]
    v_max3_f32 v40, v44, v45, v12
    v_max3_f32 v40, v40, v46, v47
    v_smfmac_f32_16x16x64_bf16 v[60:63], v[92:95], v[120:127], v2
    ds_read_b128 v[96:99], v1 offset:32768
    ds_read_b128 v[100:103], v1 offset:33792
    v_max_f32_dpp v40, v40, v40 quad_perm:[2,3,0,1] row_mask:0xf bank_mask:0xf
    v_mov_b32 v41, v40
    v_mov_b64 v[52:53], s[58:59]
    v_mov_b64 v[54:55], s[58:59]
    v_permlane16_swap_b32 v40, v41
    v_max_f32 v40, v40, v41
    v_mov_b32 v41, v40
    v_add_f32 v60, v60, v62
    v_add_f32 v61, v61, v63
    v_permlane32_swap_b32 v40, v41
    v_max_f32 v40, v40, v41
    v_sub_f32 v12, v12, v40
    v_pk_add_f32 v[44:45], v[44:45], v[40:41] op_sel_hi:[1,0] neg_lo:[0,1] neg_hi:[0,1]
    v_pk_add_f32 v[46:47], v[46:47], v[40:41] op_sel_hi:[1,0] neg_lo:[0,1] neg_hi:[0,1]
    v_exp_f32 v12, v12
    v_exp_f32 v44, v44
    v_exp_f32 v45, v45
    v_exp_f32 v46, v46
    v_exp_f32 v47, v47
    v_cvt_pk_bf16_f32 v12, v12, v12
    v_cvt_pk_bf16_f32 v49, v44, v45
    v_cvt_pk_bf16_f32 v51, v46, v47
    v_and_b32 v48, v12, v17
    v_and_b32 v50, v12, v21
    v_cvt_pk_bf16_f32 v24, v60, v61
    v_cvt_pk_bf16_f32 v28, v60, v61
    v_mfma_f32_16x16x32_bf16 v[40:43], v[48:51], v[52:55], 0
    v_mov_b64 v[64:65], 0
    v_mov_b64 v[66:67], 0
    v_smfmac_f32_16x16x64_bf16 v[32:35], v[48:51], v[16:23], v2 abid:1
    ds_read_b128 v[104:107], v1 offset:34816
    ds_read_b128 v[108:111], v1 offset:35840
    v_mov_b64 v[68:69], 0
    v_smfmac_f32_16x16x64_bf16 v[36:39], v[48:51], v[24:31], v2 abid:1
    v_add_f32 v40, v40, v42
    v_add_f32 v41, v41, v43
    v_rcp_f32 v40, v40
    v_rcp_f32 v41, v41
    v_pk_add_f32 v[32:33], v[32:33], v[34:35]
    v_pk_add_f32 v[36:37], v[36:37], v[38:39]
    v_pk_mul_f32 v[32:33], v[32:33], v[40:41]
    v_pk_mul_f32 v[36:37], v[36:37], v[40:41]
    v_cvt_pk_bf16_f32 v32, v32, v36
    v_cvt_pk_bf16_f32 v33, v33, v37
    v_mfma_f32_32x32x16_bf16 v[80:95], v[64:67], v[64:67], 0
    ds_write2_b32 v9, v32, v33 offset0:0 offset1:16
    ds_read_b128 v[40:43], v10 offset:5632
    v_mov_b64 v[70:71], 0
    v_mov_b64 v[72:73], 0
    v_mov_b64 v[74:75], 0
    v_mov_b64 v[76:77], 0
    v_mov_b64 v[78:79], 0
    s_waitcnt lgkmcnt(1)
    s_barrier
    ds_read_b128 v[44:47], v10 offset:4096
    s_waitcnt lgkmcnt(1)
    v_smfmac_f32_16x16x64_bf16 v[64:67], v[40:43], v[96:103], v2
    ds_read_b128 v[48:51], v10 offset:4608
    ds_read_b128 v[52:55], v10 offset:5120
    v_smfmac_f32_16x16x64_bf16 v[68:71], v[40:43], v[104:111], v2
    s_waitcnt lgkmcnt(2)
    v_smfmac_f32_16x16x64_bf16 v[64:67], v[44:47], v[128:135], v2
    ds_read_b128 v[112:115], v1 offset:28672
    s_waitcnt lgkmcnt(2)
    v_smfmac_f32_16x16x64_bf16 v[64:67], v[48:51], v[136:143], v2
    ds_read_b128 v[116:119], v1 offset:29696
    s_waitcnt lgkmcnt(2)
    v_smfmac_f32_16x16x64_bf16 v[64:67], v[52:55], v[144:151], v2
    ds_read_b128 v[120:123], v1 offset:30720
    v_smfmac_f32_16x16x64_bf16 v[68:71], v[44:47], v[152:159], v2
    ds_read_b128 v[124:127], v1 offset:31744
    v_smfmac_f32_16x16x64_bf16 v[68:71], v[48:51], v[160:167], v2
    ds_read_b128 v[96:99], v1 offset:24576
    v_cvt_pk_bf16_f32 v56, v64, v65
    v_or_b32 v56, 1, v56
    v_cvt_pk_bf16_f32 v57, v66, v67
    v_smfmac_f32_16x16x64_bf16 v[68:71], v[52:55], v[168:175], v2
    buffer_store_dwordx2 v[56:57], v3, s[8:11], s50 offen
    ds_read_b128 v[100:103], v1 offset:25600
    v_smfmac_f32_16x16x64_bf16 v[72:75], v[40:43], v[176:183], v2
    ds_read_b128 v[104:107], v1 offset:26624
    v_smfmac_f32_16x16x64_bf16 v[72:75], v[44:47], v[184:191], v2
    ds_read_b128 v[108:111], v1 offset:27648
    v_cvt_pk_bf16_f32 v58, v68, v69
    v_or_b32 v58, 1, v58
    v_cvt_pk_bf16_f32 v59, v70, v71
    v_smfmac_f32_16x16x64_bf16 v[72:75], v[48:51], v[192:199], v2
    buffer_store_dwordx2 v[58:59], v3, s[8:11], s51 offen
    v_smfmac_f32_16x16x64_bf16 v[72:75], v[52:55], v[200:207], v2
    s_waitcnt lgkmcnt(4)
    v_smfmac_f32_16x16x64_bf16 v[76:79], v[40:43], v[112:119], v2
    v_smfmac_f32_16x16x64_bf16 v[76:79], v[44:47], v[120:127], v2
    s_waitcnt lgkmcnt(0)
    v_cvt_pk_bf16_f32 v60, v72, v73
    v_or_b32 v60, 1, v60
    v_cvt_pk_bf16_f32 v61, v74, v75
    v_smfmac_f32_16x16x64_bf16 v[76:79], v[48:51], v[96:103], v2
    buffer_store_dwordx2 v[60:61], v3, s[8:11], s2 offen
    v_smfmac_f32_16x16x64_bf16 v[76:79], v[52:55], v[104:111], v2
    s_add_u32 s36, s36, 1
    s_cmp_lt_u32 s36, 62
    s_cselect_b32 s45, 0x80000, 0
    s_add_u32 s38, s38, s45
    s_mov_b32 s54, 0
    s_add_u32 s39, s39, 0x2000
    s_nop 1
    v_cvt_pk_bf16_f32 v62, v76, v77
    v_or_b32 v62, 1, v62
    v_cvt_pk_bf16_f32 v63, v78, v79
    s_nop 1
    buffer_store_dwordx2 v[62:63], v3, s[8:11], s99 offen
    s_cmp_eq_u32 s36, 63
    s_cbranch_scc1 L_chain_end
    ds_read_b128 v[96:99], v1 offset:0
    ds_read_b128 v[100:103], v1 offset:1024
    ds_read_b128 v[104:107], v1 offset:2048
    ds_read_b128 v[108:111], v1 offset:3072
    ds_read_b128 v[112:115], v1 offset:4096
    ds_read_b128 v[116:119], v1 offset:5120
    ds_read_b128 v[120:123], v1 offset:6144
    ds_read_b128 v[124:127], v1 offset:7168
    v_mov_b64 v[40:41], 0
    v_mov_b64 v[42:43], 0
    v_mov_b64 v[44:45], 0
    v_mov_b64 v[46:47], 0
    v_mov_b64 v[48:49], 0
    v_mov_b64 v[50:51], 0
    v_mov_b64 v[52:53], 0
    v_mov_b64 v[54:55], 0
    v_mov_b64 v[56:57], 0
    v_mov_b64 v[58:59], 0
    v_mov_b64 v[60:61], 0
    v_mov_b64 v[62:63], 0
    s_waitcnt vmcnt(4)
    v_mov_b64 v[32:33], v[240:241]
    v_mov_b64 v[34:35], v[242:243]
    v_mov_b64 v[36:37], v[244:245]
    v_mov_b64 v[38:39], v[246:247]
    v_mov_b64 v[18:19], v[248:249]
    v_mov_b64 v[22:23], v[250:251]
    v_mov_b64 v[26:27], v[252:253]
    v_mov_b64 v[30:31], v[254:255]
    v_cmp_ge_u32 vcc, s53, v6
    s_cbranch_vccnz L_kvw3_0
L_kvok3_0:
    s_add_u32 s45, s36, 2
    s_min_u32 s45, s45, 62
    s_lshr_b32 s53, s45, 2
    s_and_b32 s45, s45, 3
    s_lshl_b32 s45, s45, 7
    s_add_u32 s52, s37, s45
    s_waitcnt lgkmcnt(0)
L_step3_1:
    s_barrier
    ds_read_b128 v[64:67], v7 offset:0
    ds_read_b128 v[68:71], v7 offset:1024
    buffer_load_dwordx4 v29, s[8:11], s55 offen offset:3072 sc1 lds
    s_waitcnt lgkmcnt(1)
    v_smfmac_f32_16x16x64_bf16 v[40:43], v[64:67], v[96:103], v2
    v_smfmac_f32_16x16x64_bf16 v[44:47], v[64:67], v[104:111], v2
    buffer_load_dword v6, off, s[8:11], s52 sc1
    v_smfmac_f32_16x16x64_bf16 v[48:51], v[64:67], v[112:119], v2
    ds_read_b128 v[96:99], v1 offset:8192
    v_smfmac_f32_16x16x64_bf16 v[52:55], v[64:67], v[120:127], v2
    ds_read_b128 v[100:103], v1 offset:9216
    s_waitcnt lgkmcnt(2)
    v_smfmac_f32_16x16x64_bf16 v[40:43], v[68:71], v[208:215], v2
    ds_read_b128 v[104:107], v1 offset:10240
    v_smfmac_f32_16x16x64_bf16 v[44:47], v[68:71], v[216:223], v2
    buffer_load_dwordx4 v[240:243], v0, s[8:11], s38 offen offset:0 sc1
    v_smfmac_f32_16x16x64_bf16 v[48:51], v[68:71], a[80:87], v2
    ds_read_b128 v[108:111], v1 offset:11264
    v_smfmac_f32_16x16x64_bf16 v[52:55], v[68:71], a[88:95], v2
    s_barrier
    ds_read_b128 v[72:75], v7 offset:2048
    v_smfmac_f32_16x16x64_bf16 v[56:59], v[64:67], a[160:167], v2
    ds_read_b128 v[76:79], v7 offset:3072
    v_smfmac_f32_16x16x64_bf16 v[56:59], v[68:71], a[176:183], v2
    ds_read_b128 v[112:115], v1 offset:12288
    v_smfmac_f32_16x16x64_bf16 v[60:63], v[64:67], a[168:175], v2
    ds_read_b128 v[116:119], v1 offset:13312
    v_smfmac_f32_16x16x64_bf16 v[60:63], v[68:71], a[184:191], v2
    buffer_load_dwordx4 v[244:247], v0, s[8:11], s38 offen offset:1024 sc1
    s_waitcnt lgkmcnt(3)
    v_smfmac_f32_16x16x64_bf16 v[40:43], v[72:75], v[224:231], v2
    ds_read_b128 v[120:123], v1 offset:14336
    v_smfmac_f32_16x16x64_bf16 v[44:47], v[72:75], v[232:239], v2
    ds_read_b128 v[124:127], v1 offset:15360
    v_bitop3_b32 v12, v64, v66, v68 bitop3:0x80
    v_smfmac_f32_16x16x64_bf16 v[48:51], v[72:75], a[96:103], v2
    s_waitcnt vmcnt(3)
    s_barrier
    ds_read_b128 v[80:83], v7 offset:4096
    v_bitop3_b32 v12, v12, v70, v72 bitop3:0x80
    v_smfmac_f32_16x16x64_bf16 v[52:55], v[72:75], a[104:111], v2
    ds_read_b128 v[84:87], v7 offset:5120
    s_waitcnt lgkmcnt(6)
    v_smfmac_f32_16x16x64_bf16 v[40:43], v[76:79], a[0:7], v2
    ds_read_b128 v[88:91], v7 offset:6144
    v_bitop3_b32 v12, v12, v74, v76 bitop3:0x80
    v_smfmac_f32_16x16x64_bf16 v[44:47], v[76:79], a[8:15], v2
    ds_read_b128 v[92:95], v7 offset:7168
    v_smfmac_f32_16x16x64_bf16 v[48:51], v[76:79], a[112:119], v2
    v_smfmac_f32_16x16x64_bf16 v[52:55], v[76:79], a[120:127], v2
    buffer_load_dwordx4 v[248:251], v0, s[8:11], s38 offen offset:2048 sc1
    s_waitcnt lgkmcnt(3)
    v_bitop3_b32 v12, v12, v78, v80 bitop3:0x80
    v_smfmac_f32_16x16x64_bf16 v[40:43], v[80:83], a[16:23], v2
    s_waitcnt lgkmcnt(2)
    v_bitop3_b32 v12, v12, v82, v84 bitop3:0x80
    v_smfmac_f32_16x16x64_bf16 v[40:43], v[84:87], a[32:39], v2
    s_waitcnt lgkmcnt(1)
    v_bitop3_b32 v12, v12, v86, v88 bitop3:0x80
    v_smfmac_f32_16x16x64_bf16 v[40:43], v[88:91], a[48:55], v2
    s_waitcnt lgkmcnt(0)
    v_bitop3_b32 v12, v12, v90, v92 bitop3:0x80
    v_smfmac_f32_16x16x64_bf16 v[40:43], v[92:95], a[64:71], v2
    buffer_load_dwordx4 v[252:255], v0, s[8:11], s38 offen offset:3072 sc1
    v_bitop3_b32 v12, v12, v94, 1 bitop3:0x80
    v_smfmac_f32_16x16x64_bf16 v[48:51], v[80:83], v[96:103], v2
    v_cmp_eq_u32 vcc, 0, v12
    v_smfmac_f32_16x16x64_bf16 v[48:51], v[84:87], v[104:111], v2
    v_add_f32 v40, v40, v42
    v_smfmac_f32_16x16x64_bf16 v[48:51], v[88:91], v[112:119], v2
    v_add_f32 v41, v41, v43
    v_smfmac_f32_16x16x64_bf16 v[48:51], v[92:95], v[120:127], v2
    ds_read_b128 v[96:99], v1 offset:16384
    v_mul_f32 v40, s48, v40
    v_smfmac_f32_16x16x64_bf16 v[44:47], v[80:83], a[24:31], v2
    ds_read_b128 v[100:103], v1 offset:17408
    v_mul_f32 v41, s48, v41
    v_smfmac_f32_16x16x64_bf16 v[44:47], v[84:87], a[40:47], v2
    ds_read_b128 v[104:107], v1 offset:18432
    v_cvt_pk_bf16_f32 v42, v40, v41
    v_smfmac_f32_16x16x64_bf16 v[44:47], v[88:91], a[56:63], v2
    ds_read_b128 v[108:111], v1 offset:19456
    v_add_f32 v48, v48, v50
    v_smfmac_f32_16x16x64_bf16 v[44:47], v[92:95], a[72:79], v2
    ds_read_b128 v[112:115], v1 offset:20480
    v_add_f32 v49, v49, v51
    v_smfmac_f32_16x16x64_bf16 v[52:55], v[80:83], a[128:135], v2
    ds_read_b128 v[116:119], v1 offset:21504
    v_cvt_pk_bf16_f32 v43, v48, v49
    v_smfmac_f32_16x16x64_bf16 v[52:55], v[84:87], a[136:143], v2
    ds_read_b128 v[120:123], v1 offset:22528
    v_add_f32 v44, v44, v46
    v_smfmac_f32_16x16x64_bf16 v[52:55], v[88:91], a[144:151], v2
    ds_read_b128 v[124:127], v1 offset:23552
    v_add_f32 v45, v45, v47
    v_smfmac_f32_16x16x64_bf16 v[52:55], v[92:95], a[152:159], v2
    s_cbranch_vccnz L_rec3_1
L_norec3_1:
    v_mul_f32 v44, s48, v44
    v_mfma_f32_16x16x16_bf16 v[48:51], v[42:43], v[4:5], 0
    v_mul_f32 v45, s48, v45
    v_cvt_pk_bf16_f32 v46, v44, v45
    s_nop 1
    v_add_f32 v52, v52, v54
    v_add_f32 v53, v53, v55
    v_cvt_pk_bf16_f32 v47, v52, v53
    s_mov_b64 vcc, s[56:57]
    v_cvt_pk_bf16_f32 v40, v48, v49
    v_mfma_f32_16x16x16_bf16 v[52:55], v[46:47], v[4:5], 0
    v_cvt_pk_bf16_f32 v41, v50, v51
    v_smfmac_f32_16x16x64_bf16 v[56:59], v[72:75], a[192:199], v2
    s_mov_b32 m0, 4096
    s_nop 2
    v_cvt_pk_bf16_f32 v42, v52, v53
    v_cvt_pk_bf16_f32 v43, v54, v55
    s_nop 1
    v_mfma_f32_16x16x32_bf16 v[44:47], v[32:35], v[40:43], 0
    v_mfma_f32_16x16x32_bf16 v[48:51], v[36:39], v[40:43], 0
    v_mov_b64 v[32:33], 0
    v_mov_b64 v[34:35], 0
    v_mfma_f32_16x16x32_bf16 v[52:55], v[40:43], v[40:43], 0
    v_mov_b64 v[36:37], 0
    v_mov_b64 v[38:39], 0
    s_nop 0
    v_cndmask_b32_dpp v44, v48, v44, vcc quad_perm:[0,1,0,1] row_mask:0xf bank_mask:0xf
    v_cndmask_b32_dpp v45, v49, v45, vcc quad_perm:[0,1,0,1] row_mask:0xf bank_mask:0xf
    v_cndmask_b32_dpp v46, v50, v46, vcc quad_perm:[0,1,0,1] row_mask:0xf bank_mask:0xf
    v_cndmask_b32_dpp v47, v51, v47, vcc quad_perm:[0,1,0,1] row_mask:0xf bank_mask:0xf
    v_cndmask_b32_dpp v12, v55, v54, vcc quad_perm:[0,1,0,1] row_mask:0xf bank_mask:0xf
    v_smfmac_f32_16x16x64_bf16 v[56:59], v[76:79], a[208:215], v2
    ds_write_b128 v0, v[44:47] offset:11264
    v_smfmac_f32_16x16x64_bf16 v[56:59], v[80:83], a[224:231], v2
    ds_write_addtid_b32 v12 offset:8960
    v_smfmac_f32_16x16x64_bf16 v[56:59], v[84:87], a[232:239], v2
    v_smfmac_f32_16x16x64_bf16 v[56:59], v[88:91], a[240:247], v2
    v_smfmac_f32_16x16x64_bf16 v[56:59], v[92:95], a[248:255], v2
    s_waitcnt lgkmcnt(0)
    s_barrier
    ds_read_addtid_b32 v13 offset:8192
    ds_read_addtid_b32 v14 offset:8448
    v_smfmac_f32_16x16x64_bf16 v[60:63], v[72:75], a[200:207], v2
    ds_read_addtid_b32 v15 offset:8704
    ds_read_b128 v[40:43], v0 offset:8192
    v_smfmac_f32_16x16x64_bf16 v[60:63], v[76:79], a[216:223], v2
    ds_read_b128 v[48:51], v0 offset:9216
    ds_read_b128 v[52:55], v0 offset:10240
    v_add_f32 v56, v56, v58
    v_smfmac_f32_16x16x64_bf16 v[60:63], v[80:83], v[96:103], v2
    v_add_f32 v57, v57, v59
    v_smfmac_f32_16x16x64_bf16 v[60:63], v[84:87], v[104:111], v2
    v_cvt_pk_bf16_f32 v16, v56, v57
    v_smfmac_f32_16x16x64_bf16 v[60:63], v[88:91], v[112:119], v2
    s_waitcnt lgkmcnt(1)
    v_cvt_pk_bf16_f32 v20, v56, v57
    v_add_f32 v12, v12, v13
    v_add_f32 v14, v14, v15
    v_add_f32 v12, v12, v14
    v_pk_add_f32 v[44:45], v[44:45], v[40:41]
    v_pk_add_f32 v[46:47], v[46:47], v[42:43]
    v_pk_add_f32 v[44:45], v[44:45], v[48:49]
    v_pk_add_f32 v[46:47], v[46:47], v[50:51]
    s_waitcnt lgkmcnt(0)
    v_pk_add_f32 v[44:45], v[44:45], v[52:53]
    v_pk_add_f32 v[46:47], v[46:47], v[54:55]
    v_max3_f32 v40, v44, v45, v12
    v_max3_f32 v40, v40, v46, v47
    v_smfmac_f32_16x16x64_bf16 v[60:63], v[92:95], v[120:127], v2
    ds_read_b128 v[96:99], v1 offset:32768
    ds_read_b128 v[100:103], v1 offset:33792
    v_max_f32_dpp v40, v40, v40 quad_perm:[2,3,0,1] row_mask:0xf bank_mask:0xf
    v_mov_b32 v41, v40
    v_mov_b64 v[52:53], s[58:59]
    v_mov_b64 v[54:55], s[58:59]
    v_permlane16_swap_b32 v40, v41
    v_max_f32 v40, v40, v41
    v_mov_b32 v41, v40
    v_add_f32 v60, v60, v62
    v_add_f32 v61, v61, v63
    v_permlane32_swap_b32 v40, v41
    v_max_f32 v40, v40, v41
    v_sub_f32 v12, v12, v40
    v_pk_add_f32 v[44:45], v[44:45], v[40:41] op_sel_hi:[1,0] neg_lo:[0,1] neg_hi:[0,1]
    v_pk_add_f32 v[46:47], v[46:47], v[40:41] op_sel_hi:[1,0] neg_lo:[0,1] neg_hi:[0,1]
    v_exp_f32 v12, v12
    v_exp_f32 v44, v44
    v_exp_f32 v45, v45
    v_exp_f32 v46, v46
    v_exp_f32 v47, v47
    v_cvt_pk_bf16_f32 v12, v12, v12
    v_cvt_pk_bf16_f32 v49, v44, v45
    v_cvt_pk_bf16_f32 v51, v46, v47
    v_and_b32 v48, v12, v17
    v_and_b32 v50, v12, v21
    v_cvt_pk_bf16_f32 v24, v60, v61
    v_cvt_pk_bf16_f32 v28, v60, v61
    v_mfma_f32_16x16x32_bf16 v[40:43], v[48:51], v[52:55], 0
    v_mov_b64 v[64:65], 0
    v_mov_b64 v[66:67], 0
    v_smfmac_f32_16x16x64_bf16 v[32:35], v[48:51], v[16:23], v2 abid:1
    ds_read_b128 v[104:107], v1 offset:34816
    ds_read_b128 v[108:111], v1 offset:35840
    v_mov_b64 v[68:69], 0
    v_smfmac_f32_16x16x64_bf16 v[36:39], v[48:51], v[24:31], v2 abid:1
    v_add_f32 v40, v40, v42
    v_add_f32 v41, v41, v43
    v_rcp_f32 v40, v40
    v_rcp_f32 v41, v41
    v_pk_add_f32 v[32:33], v[32:33], v[34:35]
    v_pk_add_f32 v[36:37], v[36:37], v[38:39]
    v_pk_mul_f32 v[32:33], v[32:33], v[40:41]
    v_pk_mul_f32 v[36:37], v[36:37], v[40:41]
    v_cvt_pk_bf16_f32 v32, v32, v36
    v_cvt_pk_bf16_f32 v33, v33, v37
    v_mfma_f32_32x32x16_bf16 v[80:95], v[64:67], v[64:67], 0
    ds_write2_b32 v9, v32, v33 offset0:0 offset1:16
    ds_read_b128 v[40:43], v10 offset:5632
    v_mov_b64 v[70:71], 0
    v_mov_b64 v[72:73], 0
    v_mov_b64 v[74:75], 0
    v_mov_b64 v[76:77], 0
    v_mov_b64 v[78:79], 0
    s_waitcnt lgkmcnt(1)
    s_barrier
    ds_read_b128 v[44:47], v10 offset:4096
    s_waitcnt lgkmcnt(1)
    v_smfmac_f32_16x16x64_bf16 v[64:67], v[40:43], v[96:103], v2
    ds_read_b128 v[48:51], v10 offset:4608
    ds_read_b128 v[52:55], v10 offset:5120
    v_smfmac_f32_16x16x64_bf16 v[68:71], v[40:43], v[104:111], v2
    s_waitcnt lgkmcnt(2)
    v_smfmac_f32_16x16x64_bf16 v[64:67], v[44:47], v[128:135], v2
    ds_read_b128 v[112:115], v1 offset:28672
    s_waitcnt lgkmcnt(2)
    v_smfmac_f32_16x16x64_bf16 v[64:67], v[48:51], v[136:143], v2
    ds_read_b128 v[116:119], v1 offset:29696
    s_waitcnt lgkmcnt(2)
    v_smfmac_f32_16x16x64_bf16 v[64:67], v[52:55], v[144:151], v2
    ds_read_b128 v[120:123], v1 offset:30720
    v_smfmac_f32_16x16x64_bf16 v[68:71], v[44:47], v[152:159], v2
    ds_read_b128 v[124:127], v1 offset:31744
    v_smfmac_f32_16x16x64_bf16 v[68:71], v[48:51], v[160:167], v2
    ds_read_b128 v[96:99], v1 offset:24576
    v_cvt_pk_bf16_f32 v56, v64, v65
    v_and_b32 v56, -2, v56
    v_cvt_pk_bf16_f32 v57, v66, v67
    v_smfmac_f32_16x16x64_bf16 v[68:71], v[52:55], v[168:175], v2
    buffer_store_dwordx2 v[56:57], v3, s[8:11], s50 offen
    ds_read_b128 v[100:103], v1 offset:25600
    v_smfmac_f32_16x16x64_bf16 v[72:75], v[40:43], v[176:183], v2
    ds_read_b128 v[104:107], v1 offset:26624
    v_smfmac_f32_16x16x64_bf16 v[72:75], v[44:47], v[184:191], v2
    ds_read_b128 v[108:111], v1 offset:27648
    v_cvt_pk_bf16_f32 v58, v68, v69
    v_and_b32 v58, -2, v58
    v_cvt_pk_bf16_f32 v59, v70, v71
    v_smfmac_f32_16x16x64_bf16 v[72:75], v[48:51], v[192:199], v2
    buffer_store_dwordx2 v[58:59], v3, s[8:11], s51 offen
    v_smfmac_f32_16x16x64_bf16 v[72:75], v[52:55], v[200:207], v2
    s_waitcnt lgkmcnt(4)
    v_smfmac_f32_16x16x64_bf16 v[76:79], v[40:43], v[112:119], v2
    v_smfmac_f32_16x16x64_bf16 v[76:79], v[44:47], v[120:127], v2
    s_waitcnt lgkmcnt(0)
    v_cvt_pk_bf16_f32 v60, v72, v73
    v_and_b32 v60, -2, v60
    v_cvt_pk_bf16_f32 v61, v74, v75
    v_smfmac_f32_16x16x64_bf16 v[76:79], v[48:51], v[96:103], v2
    buffer_store_dwordx2 v[60:61], v3, s[8:11], s2 offen
    v_smfmac_f32_16x16x64_bf16 v[76:79], v[52:55], v[104:111], v2
    s_add_u32 s36, s36, 1
    s_cmp_lt_u32 s36, 62
    s_cselect_b32 s45, 0x80000, 0
    s_add_u32 s38, s38, s45
    s_mov_b32 s54, 0
    s_add_u32 s39, s39, 0x2000
    s_nop 1
    v_cvt_pk_bf16_f32 v62, v76, v77
    v_and_b32 v62, -2, v62
    v_cvt_pk_bf16_f32 v63, v78, v79
    s_nop 1
    buffer_store_dwordx2 v[62:63], v3, s[8:11], s99 offen
    ds_read_b128 v[96:99], v1 offset:0
    ds_read_b128 v[100:103], v1 offset:1024
    ds_read_b128 v[104:107], v1 offset:2048
    ds_read_b128 v[108:111], v1 offset:3072
    ds_read_b128 v[112:115], v1 offset:4096
    ds_read_b128 v[116:119], v1 offset:5120
    ds_read_b128 v[120:123], v1 offset:6144
    ds_read_b128 v[124:127], v1 offset:7168
    v_mov_b64 v[40:41], 0
    v_mov_b64 v[42:43], 0
    v_mov_b64 v[44:45], 0
    v_mov_b64 v[46:47], 0
    v_mov_b64 v[48:49], 0
    v_mov_b64 v[50:51], 0
    v_mov_b64 v[52:53], 0
    v_mov_b64 v[54:55], 0
    v_mov_b64 v[56:57], 0
    v_mov_b64 v[58:59], 0
    v_mov_b64 v[60:61], 0
    v_mov_b64 v[62:63], 0
    s_waitcnt vmcnt(4)
    v_mov_b64 v[32:33], v[240:241]
    v_mov_b64 v[34:35], v[242:243]
    v_mov_b64 v[36:37], v[244:245]
    v_mov_b64 v[38:39], v[246:247]
    v_mov_b64 v[18:19], v[248:249]
    v_mov_b64 v[22:23], v[250:251]
    v_mov_b64 v[26:27], v[252:253]
    v_mov_b64 v[30:31], v[254:255]
    v_cmp_ge_u32 vcc, s53, v6
    s_cbranch_vccnz L_kvw3_1
L_kvok3_1:
    s_add_u32 s45, s36, 2
    s_min_u32 s45, s45, 62
    s_lshr_b32 s53, s45, 2
    s_and_b32 s45, s45, 3
    s_lshl_b32 s45, s45, 7
    s_add_u32 s52, s37, s45
    s_waitcnt lgkmcnt(0)
    s_branch L_step3_0
L_cold:
L_rec0_0:
    s_cmp_eq_u32 s36, 0
    s_cbranch_scc1 L_norec0_0
    s_waitcnt lgkmcnt(0)
    s_mov_b32 s54, 0
    s_nop 7
    ds_read_b128 v[96:99], v1 offset:0
    ds_read_b128 v[100:103], v1 offset:1024
    ds_read_b128 v[104:107], v1 offset:2048
    ds_read_b128 v[108:111], v1 offset:3072
    ds_read_b128 v[112:115], v1 offset:4096
    ds_read_b128 v[116:119], v1 offset:5120
    ds_read_b128 v[120:123], v1 offset:6144
    ds_read_b128 v[124:127], v1 offset:7168
    v_mov_b64 v[40:41], 0
    v_mov_b64 v[42:43], 0
    v_mov_b64 v[44:45], 0
    v_mov_b64 v[46:47], 0
    v_mov_b64 v[48:49], 0
    v_mov_b64 v[50:51], 0
    v_mov_b64 v[52:53], 0
    v_mov_b64 v[54:55], 0
    v_mov_b64 v[56:57], 0
    v_mov_b64 v[58:59], 0
    v_mov_b64 v[60:61], 0
    v_mov_b64 v[62:63], 0
    s_waitcnt lgkmcnt(4)
    ds_read_b128 v[64:67], v7 offset:0
    ds_read_b128 v[68:71], v7 offset:1024
    ds_read_b128 v[72:75], v7 offset:2048
    ds_read_b128 v[76:79], v7 offset:3072
    ds_read_b128 v[80:83], v7 offset:4096
    ds_read_b128 v[84:87], v7 offset:5120
    ds_read_b128 v[88:91], v7 offset:6144
    ds_read_b128 v[92:95], v7 offset:7168
    s_waitcnt lgkmcnt(0)
    v_bitop3_b32 v12, v64, v66, v68 bitop3:0xfe
    v_bitop3_b32 v12, v12, v70, v72 bitop3:0xfe
    v_bitop3_b32 v12, v12, v74, v76 bitop3:0xfe
    v_bitop3_b32 v12, v12, v78, v80 bitop3:0xfe
    v_bitop3_b32 v12, v12, v82, v84 bitop3:0xfe
    v_bitop3_b32 v12, v12, v86, v88 bitop3:0xfe
    v_bitop3_b32 v12, v12, v90, v92 bitop3:0xfe
    v_bitop3_b32 v12, v12, v94, 1 bitop3:0xa8
    v_cmp_ne_u32 vcc, 0, v12
    s_cbranch_vccz L_recok0_0
L_recl0_0:
    v_and_b32 v12, 0xffffff80, v7
    v_add_u32 v12, v12, v7
    s_mov_b32 s46, 0x8000
    buffer_load_dwordx4 v[64:67], v12, s[8:11], s46 offen sc1
    s_mov_b32 s46, 0x8800
    buffer_load_dwordx4 v[68:71], v12, s[8:11], s46 offen sc1
    s_mov_b32 s46, 0x9000
    buffer_load_dwordx4 v[72:75], v12, s[8:11], s46 offen sc1
    s_mov_b32 s46, 0x9800
    buffer_load_dwordx4 v[76:79], v12, s[8:11], s46 offen sc1
    s_mov_b32 s46, 0x8080
    buffer_load_dwordx4 v[80:83], v12, s[8:11], s46 offen sc1
    s_mov_b32 s46, 0x8880
    buffer_load_dwordx4 v[84:87], v12, s[8:11], s46 offen sc1
    s_mov_b32 s46, 0x9080
    buffer_load_dwordx4 v[88:91], v12, s[8:11], s46 offen sc1
    s_mov_b32 s46, 0x9880
    buffer_load_dwordx4 v[92:95], v12, s[8:11], s46 offen sc1
    s_waitcnt vmcnt(0)
    v_bitop3_b32 v12, v64, v66, v68 bitop3:0xfe
    v_bitop3_b32 v12, v12, v70, v72 bitop3:0xfe
    v_bitop3_b32 v12, v12, v74, v76 bitop3:0xfe
    v_bitop3_b32 v12, v12, v78, v80 bitop3:0xfe
    v_bitop3_b32 v12, v12, v82, v84 bitop3:0xfe
    v_bitop3_b32 v12, v12, v86, v88 bitop3:0xfe
    v_bitop3_b32 v12, v12, v90, v92 bitop3:0xfe
    v_bitop3_b32 v12, v12, v94, 1 bitop3:0xa8
    v_cmp_ne_u32 vcc, 0, v12
    s_cbranch_vccz L_recok0_0
    s_add_u32 s54, s54, 1
    s_and_b32 s45, s54, 63
    s_cbranch_scc1 L_recl0_0
    buffer_wbl2 sc1
    s_waitcnt vmcnt(0)
    buffer_inv sc1
    s_waitcnt vmcnt(0)
    s_cmp_lt_u32 s54, 0x40000
    s_cbranch_scc1 L_recl0_0
    s_endpgm
L_recok0_0:
    v_smfmac_f32_16x16x64_bf16 v[40:43], v[64:67], v[96:103], v2
    v_smfmac_f32_16x16x64_bf16 v[44:47], v[64:67], v[104:111], v2
    v_smfmac_f32_16x16x64_bf16 v[48:51], v[64:67], v[112:119], v2
    v_smfmac_f32_16x16x64_bf16 v[52:55], v[64:67], v[120:127], v2
    v_smfmac_f32_16x16x64_bf16 v[40:43], v[68:71], v[208:215], v2
    v_smfmac_f32_16x16x64_bf16 v[44:47], v[68:71], v[216:223], v2
    v_smfmac_f32_16x16x64_bf16 v[48:51], v[68:71], a[80:87], v2
    v_smfmac_f32_16x16x64_bf16 v[52:55], v[68:71], a[88:95], v2
    ds_read_b128 v[96:99], v1 offset:8192
    ds_read_b128 v[100:103], v1 offset:9216
    ds_read_b128 v[104:107], v1 offset:10240
    ds_read_b128 v[108:111], v1 offset:11264
    ds_read_b128 v[112:115], v1 offset:12288
    ds_read_b128 v[116:119], v1 offset:13312
    ds_read_b128 v[120:123], v1 offset:14336
    ds_read_b128 v[124:127], v1 offset:15360
    s_waitcnt lgkmcnt(0)
    v_smfmac_f32_16x16x64_bf16 v[56:59], v[64:67], a[160:167], v2
    v_smfmac_f32_16x16x64_bf16 v[56:59], v[68:71], a[176:183], v2
    v_smfmac_f32_16x16x64_bf16 v[60:63], v[64:67], a[168:175], v2
    v_smfmac_f32_16x16x64_bf16 v[60:63], v[68:71], a[184:191], v2
    v_smfmac_f32_16x16x64_bf16 v[40:43], v[72:75], v[224:231], v2
    v_smfmac_f32_16x16x64_bf16 v[44:47], v[72:75], v[232:239], v2
    v_smfmac_f32_16x16x64_bf16 v[48:51], v[72:75], a[96:103], v2
    v_smfmac_f32_16x16x64_bf16 v[52:55], v[72:75], a[104:111], v2
    v_smfmac_f32_16x16x64_bf16 v[40:43], v[76:79], a[0:7], v2
    v_smfmac_f32_16x16x64_bf16 v[44:47], v[76:79], a[8:15], v2
    v_smfmac_f32_16x16x64_bf16 v[48:51], v[76:79], a[112:119], v2
    v_smfmac_f32_16x16x64_bf16 v[52:55], v[76:79], a[120:127], v2
    v_smfmac_f32_16x16x64_bf16 v[40:43], v[80:83], a[16:23], v2
    v_smfmac_f32_16x16x64_bf16 v[40:43], v[84:87], a[32:39], v2
    v_smfmac_f32_16x16x64_bf16 v[40:43], v[88:91], a[48:55], v2
    v_smfmac_f32_16x16x64_bf16 v[40:43], v[92:95], a[64:71], v2
    v_smfmac_f32_16x16x64_bf16 v[48:51], v[80:83], v[96:103], v2
    v_smfmac_f32_16x16x64_bf16 v[48:51], v[84:87], v[104:111], v2
    v_smfmac_f32_16x16x64_bf16 v[48:51], v[88:91], v[112:119], v2
    v_smfmac_f32_16x16x64_bf16 v[48:51], v[92:95], v[120:127], v2
    v_smfmac_f32_16x16x64_bf16 v[44:47], v[80:83], a[24:31], v2
    v_smfmac_f32_16x16x64_bf16 v[44:47], v[84:87], a[40:47], v2
    v_smfmac_f32_16x16x64_bf16 v[44:47], v[88:91], a[56:63], v2
    v_smfmac_f32_16x16x64_bf16 v[44:47], v[92:95], a[72:79], v2
    v_smfmac_f32_16x16x64_bf16 v[52:55], v[80:83], a[128:135], v2
    v_smfmac_f32_16x16x64_bf16 v[52:55], v[84:87], a[136:143], v2
    v_smfmac_f32_16x16x64_bf16 v[52:55], v[88:91], a[144:151], v2
    v_smfmac_f32_16x16x64_bf16 v[52:55], v[92:95], a[152:159], v2
    ds_read_b128 v[96:99], v1 offset:16384
    ds_read_b128 v[100:103], v1 offset:17408
    ds_read_b128 v[104:107], v1 offset:18432
    ds_read_b128 v[108:111], v1 offset:19456
    ds_read_b128 v[112:115], v1 offset:20480
    ds_read_b128 v[116:119], v1 offset:21504
    ds_read_b128 v[120:123], v1 offset:22528
    ds_read_b128 v[124:127], v1 offset:23552
    v_add_f32 v40, v40, v42
    v_add_f32 v41, v41, v43
    v_mul_f32 v40, s48, v40
    v_mul_f32 v41, s48, v41
    v_cvt_pk_bf16_f32 v42, v40, v41
    v_add_f32 v48, v48, v50
    v_add_f32 v49, v49, v51
    v_cvt_pk_bf16_f32 v43, v48, v49
    v_add_f32 v44, v44, v46
    v_add_f32 v45, v45, v47
    s_branch L_norec0_0
L_p2d0_0:
    buffer_load_dword v16, v25, s[8:11], s42 offen sc1
    buffer_load_dwordx4 v29, s[8:11], s6 offen offset:0 sc1 lds
    buffer_load_dwordx4 v29, s[8:11], s43 offen offset:1024 sc1 lds
    s_waitcnt vmcnt(0)
    v_and_b32 v16, 1, v16
    v_cmp_ne_u32 vcc, 1, v16
    s_cbranch_vccz L_p2f0_0
    s_add_u32 s54, s54, 1
    s_and_b32 s45, s54, 63
    s_cbranch_scc1 L_p2d0_0
    buffer_wbl2 sc1
    s_waitcnt vmcnt(0)
    buffer_inv sc1
    s_waitcnt vmcnt(0)
    s_cmp_lt_u32 s54, 0x40000
    s_cbranch_scc1 L_p2d0_0
    s_endpgm
L_rec0_1:
    s_waitcnt lgkmcnt(0)
    s_mov_b32 s54, 0
    s_nop 7
    ds_read_b128 v[96:99], v1 offset:0
    ds_read_b128 v[100:103], v1 offset:1024
    ds_read_b128 v[104:107], v1 offset:2048
    ds_read_b128 v[108:111], v1 offset:3072
    ds_read_b128 v[112:115], v1 offset:4096
    ds_read_b128 v[116:119], v1 offset:5120
    ds_read_b128 v[120:123], v1 offset:6144
    ds_read_b128 v[124:127], v1 offset:7168
    v_mov_b64 v[40:41], 0
    v_mov_b64 v[42:43], 0
    v_mov_b64 v[44:45], 0
    v_mov_b64 v[46:47], 0
    v_mov_b64 v[48:49], 0
    v_mov_b64 v[50:51], 0
    v_mov_b64 v[52:53], 0
    v_mov_b64 v[54:55], 0
    v_mov_b64 v[56:57], 0
    v_mov_b64 v[58:59], 0
    v_mov_b64 v[60:61], 0
    v_mov_b64 v[62:63], 0
    s_waitcnt lgkmcnt(4)
    ds_read_b128 v[64:67], v7 offset:0
    ds_read_b128 v[68:71], v7 offset:1024
    ds_read_b128 v[72:75], v7 offset:2048
    ds_read_b128 v[76:79], v7 offset:3072
    ds_read_b128 v[80:83], v7 offset:4096
    ds_read_b128 v[84:87], v7 offset:5120
    ds_read_b128 v[88:91], v7 offset:6144
    ds_read_b128 v[92:95], v7 offset:7168
    s_waitcnt lgkmcnt(0)
    v_bitop3_b32 v12, v64, v66, v68 bitop3:0x80
    v_bitop3_b32 v12, v12, v70, v72 bitop3:0x80
    v_bitop3_b32 v12, v12, v74, v76 bitop3:0x80
    v_bitop3_b32 v12, v12, v78, v80 bitop3:0x80
    v_bitop3_b32 v12, v12, v82, v84 bitop3:0x80
    v_bitop3_b32 v12, v12, v86, v88 bitop3:0x80
    v_bitop3_b32 v12, v12, v90, v92 bitop3:0x80
    v_bitop3_b32 v12, v12, v94, 1 bitop3:0x80
    v_cmp_eq_u32 vcc, 0, v12
    s_cbranch_vccz L_recok0_1
L_recl0_1:
    v_and_b32 v12, 0xffffff80, v7
    v_add_u32 v12, v12, v7
    s_mov_b32 s46, 0x8000
    buffer_load_dwordx4 v[64:67], v12, s[8:11], s46 offen sc1
    s_mov_b32 s46, 0x8800
    buffer_load_dwordx4 v[68:71], v12, s[8:11], s46 offen sc1
    s_mov_b32 s46, 0x9000
    buffer_load_dwordx4 v[72:75], v12, s[8:11], s46 offen sc1
    s_mov_b32 s46, 0x9800
    buffer_load_dwordx4 v[76:79], v12, s[8:11], s46 offen sc1
    s_mov_b32 s46, 0x8080
    buffer_load_dwordx4 v[80:83], v12, s[8:11], s46 offen sc1
    s_mov_b32 s46, 0x8880
    buffer_load_dwordx4 v[84:87], v12, s[8:11], s46 offen sc1
    s_mov_b32 s46, 0x9080
    buffer_load_dwordx4 v[88:91], v12, s[8:11], s46 offen sc1
    s_mov_b32 s46, 0x9880
    buffer_load_dwordx4 v[92:95], v12, s[8:11], s46 offen sc1
    s_waitcnt vmcnt(0)
    v_bitop3_b32 v12, v64, v66, v68 bitop3:0x80
    v_bitop3_b32 v12, v12, v70, v72 bitop3:0x80
    v_bitop3_b32 v12, v12, v74, v76 bitop3:0x80
    v_bitop3_b32 v12, v12, v78, v80 bitop3:0x80
    v_bitop3_b32 v12, v12, v82, v84 bitop3:0x80
    v_bitop3_b32 v12, v12, v86, v88 bitop3:0x80
    v_bitop3_b32 v12, v12, v90, v92 bitop3:0x80
    v_bitop3_b32 v12, v12, v94, 1 bitop3:0x80
    v_cmp_eq_u32 vcc, 0, v12
    s_cbranch_vccz L_recok0_1
    s_add_u32 s54, s54, 1
    s_and_b32 s45, s54, 63
    s_cbranch_scc1 L_recl0_1
    buffer_wbl2 sc1
    s_waitcnt vmcnt(0)
    buffer_inv sc1
    s_waitcnt vmcnt(0)
    s_cmp_lt_u32 s54, 0x40000
    s_cbranch_scc1 L_recl0_1
    s_endpgm
L_recok0_1:
    v_smfmac_f32_16x16x64_bf16 v[40:43], v[64:67], v[96:103], v2
    v_smfmac_f32_16x16x64_bf16 v[44:47], v[64:67], v[104:111], v2
    v_smfmac_f32_16x16x64_bf16 v[48:51], v[64:67], v[112:119], v2
    v_smfmac_f32_16x16x64_bf16 v[52:55], v[64:67], v[120:127], v2
    v_smfmac_f32_16x16x64_bf16 v[40:43], v[68:71], v[208:215], v2
    v_smfmac_f32_16x16x64_bf16 v[44:47], v[68:71], v[216:223], v2
    v_smfmac_f32_16x16x64_bf16 v[48:51], v[68:71], a[80:87], v2
    v_smfmac_f32_16x16x64_bf16 v[52:55], v[68:71], a[88:95], v2
    ds_read_b128 v[96:99], v1 offset:8192
    ds_read_b128 v[100:103], v1 offset:9216
    ds_read_b128 v[104:107], v1 offset:10240
    ds_read_b128 v[108:111], v1 offset:11264
    ds_read_b128 v[112:115], v1 offset:12288
    ds_read_b128 v[116:119], v1 offset:13312
    ds_read_b128 v[120:123], v1 offset:14336
    ds_read_b128 v[124:127], v1 offset:15360
    s_waitcnt lgkmcnt(0)
    v_smfmac_f32_16x16x64_bf16 v[56:59], v[64:67], a[160:167], v2
    v_smfmac_f32_16x16x64_bf16 v[56:59], v[68:71], a[176:183], v2
    v_smfmac_f32_16x16x64_bf16 v[60:63], v[64:67], a[168:175], v2
    v_smfmac_f32_16x16x64_bf16 v[60:63], v[68:71], a[184:191], v2
    v_smfmac_f32_16x16x64_bf16 v[40:43], v[72:75], v[224:231], v2
    v_smfmac_f32_16x16x64_bf16 v[44:47], v[72:75], v[232:239], v2
    v_smfmac_f32_16x16x64_bf16 v[48:51], v[72:75], a[96:103], v2
    v_smfmac_f32_16x16x64_bf16 v[52:55], v[72:75], a[104:111], v2
    v_smfmac_f32_16x16x64_bf16 v[40:43], v[76:79], a[0:7], v2
    v_smfmac_f32_16x16x64_bf16 v[44:47], v[76:79], a[8:15], v2
    v_smfmac_f32_16x16x64_bf16 v[48:51], v[76:79], a[112:119], v2
    v_smfmac_f32_16x16x64_bf16 v[52:55], v[76:79], a[120:127], v2
    v_smfmac_f32_16x16x64_bf16 v[40:43], v[80:83], a[16:23], v2
    v_smfmac_f32_16x16x64_bf16 v[40:43], v[84:87], a[32:39], v2
    v_smfmac_f32_16x16x64_bf16 v[40:43], v[88:91], a[48:55], v2
    v_smfmac_f32_16x16x64_bf16 v[40:43], v[92:95], a[64:71], v2
    v_smfmac_f32_16x16x64_bf16 v[48:51], v[80:83], v[96:103], v2
    v_smfmac_f32_16x16x64_bf16 v[48:51], v[84:87], v[104:111], v2
    v_smfmac_f32_16x16x64_bf16 v[48:51], v[88:91], v[112:119], v2
    v_smfmac_f32_16x16x64_bf16 v[48:51], v[92:95], v[120:127], v2
    v_smfmac_f32_16x16x64_bf16 v[44:47], v[80:83], a[24:31], v2
    v_smfmac_f32_16x16x64_bf16 v[44:47], v[84:87], a[40:47], v2
    v_smfmac_f32_16x16x64_bf16 v[44:47], v[88:91], a[56:63], v2
    v_smfmac_f32_16x16x64_bf16 v[44:47], v[92:95], a[72:79], v2
    v_smfmac_f32_16x16x64_bf16 v[52:55], v[80:83], a[128:135], v2
    v_smfmac_f32_16x16x64_bf16 v[52:55], v[84:87], a[136:143], v2
    v_smfmac_f32_16x16x64_bf16 v[52:55], v[88:91], a[144:151], v2
    v_smfmac_f32_16x16x64_bf16 v[52:55], v[92:95], a[152:159], v2
    ds_read_b128 v[96:99], v1 offset:16384
    ds_read_b128 v[100:103], v1 offset:17408
    ds_read_b128 v[104:107], v1 offset:18432
    ds_read_b128 v[108:111], v1 offset:19456
    ds_read_b128 v[112:115], v1 offset:20480
    ds_read_b128 v[116:119], v1 offset:21504
    ds_read_b128 v[120:123], v1 offset:22528
    ds_read_b128 v[124:127], v1 offset:23552
    v_add_f32 v40, v40, v42
    v_add_f32 v41, v41, v43
    v_mul_f32 v40, s48, v40
    v_mul_f32 v41, s48, v41
    v_cvt_pk_bf16_f32 v42, v40, v41
    v_add_f32 v48, v48, v50
    v_add_f32 v49, v49, v51
    v_cvt_pk_bf16_f32 v43, v48, v49
    v_add_f32 v44, v44, v46
    v_add_f32 v45, v45, v47
    s_branch L_norec0_1
L_p2d0_1:
    buffer_load_dword v16, v25, s[8:11], s42 offen sc1
    buffer_load_dwordx4 v29, s[8:11], s6 offen offset:0 sc1 lds
    buffer_load_dwordx4 v29, s[8:11], s43 offen offset:1024 sc1 lds
    s_waitcnt vmcnt(0)
    v_and_b32 v16, 1, v16
    v_cmp_ne_u32 vcc, 0, v16
    s_cbranch_vccz L_p2f0_1
    s_add_u32 s54, s54, 1
    s_and_b32 s45, s54, 63
    s_cbranch_scc1 L_p2d0_1
    buffer_wbl2 sc1
    s_waitcnt vmcnt(0)
    buffer_inv sc1
    s_waitcnt vmcnt(0)
    s_cmp_lt_u32 s54, 0x40000
    s_cbranch_scc1 L_p2d0_1
    s_endpgm
L_rec1_0:
    s_cmp_eq_u32 s36, 0
    s_cbranch_scc1 L_norec1_0
    s_waitcnt lgkmcnt(0)
    s_mov_b32 s54, 0
    s_nop 7
    ds_read_b128 v[96:99], v1 offset:0
    ds_read_b128 v[100:103], v1 offset:1024
    ds_read_b128 v[104:107], v1 offset:2048
    ds_read_b128 v[108:111], v1 offset:3072
    ds_read_b128 v[112:115], v1 offset:4096
    ds_read_b128 v[116:119], v1 offset:5120
    ds_read_b128 v[120:123], v1 offset:6144
    ds_read_b128 v[124:127], v1 offset:7168
    v_mov_b64 v[40:41], 0
    v_mov_b64 v[42:43], 0
    v_mov_b64 v[44:45], 0
    v_mov_b64 v[46:47], 0
    v_mov_b64 v[48:49], 0
    v_mov_b64 v[50:51], 0
    v_mov_b64 v[52:53], 0
    v_mov_b64 v[54:55], 0
    v_mov_b64 v[56:57], 0
    v_mov_b64 v[58:59], 0
    v_mov_b64 v[60:61], 0
    v_mov_b64 v[62:63], 0
    s_waitcnt lgkmcnt(4)
    ds_read_b128 v[64:67], v7 offset:0
    ds_read_b128 v[68:71], v7 offset:1024
    ds_read_b128 v[72:75], v7 offset:2048
    ds_read_b128 v[76:79], v7 offset:3072
    ds_read_b128 v[80:83], v7 offset:4096
    ds_read_b128 v[84:87], v7 offset:5120
    ds_read_b128 v[88:91], v7 offset:6144
    ds_read_b128 v[92:95], v7 offset:7168
    s_waitcnt lgkmcnt(0)
    v_bitop3_b32 v12, v64, v66, v68 bitop3:0xfe
    v_bitop3_b32 v12, v12, v70, v72 bitop3:0xfe
    v_bitop3_b32 v12, v12, v74, v76 bitop3:0xfe
    v_bitop3_b32 v12, v12, v78, v80 bitop3:0xfe
    v_bitop3_b32 v12, v12, v82, v84 bitop3:0xfe
    v_bitop3_b32 v12, v12, v86, v88 bitop3:0xfe
    v_bitop3_b32 v12, v12, v90, v92 bitop3:0xfe
    v_bitop3_b32 v12, v12, v94, 1 bitop3:0xa8
    v_cmp_ne_u32 vcc, 0, v12
    s_cbranch_vccz L_recok1_0
L_recl1_0:
    v_and_b32 v12, 0xffffff80, v7
    v_add_u32 v12, v12, v7
    s_mov_b32 s46, 0x8000
    buffer_load_dwordx4 v[64:67], v12, s[8:11], s46 offen sc1
    s_mov_b32 s46, 0x8800
    buffer_load_dwordx4 v[68:71], v12, s[8:11], s46 offen sc1
    s_mov_b32 s46, 0x9000
    buffer_load_dwordx4 v[72:75], v12, s[8:11], s46 offen sc1
    s_mov_b32 s46, 0x9800
    buffer_load_dwordx4 v[76:79], v12, s[8:11], s46 offen sc1
    s_mov_b32 s46, 0x8080
    buffer_load_dwordx4 v[80:83], v12, s[8:11], s46 offen sc1
    s_mov_b32 s46, 0x8880
    buffer_load_dwordx4 v[84:87], v12, s[8:11], s46 offen sc1
    s_mov_b32 s46, 0x9080
    buffer_load_dwordx4 v[88:91], v12, s[8:11], s46 offen sc1
    s_mov_b32 s46, 0x9880
    buffer_load_dwordx4 v[92:95], v12, s[8:11], s46 offen sc1
    s_waitcnt vmcnt(0)
    v_bitop3_b32 v12, v64, v66, v68 bitop3:0xfe
    v_bitop3_b32 v12, v12, v70, v72 bitop3:0xfe
    v_bitop3_b32 v12, v12, v74, v76 bitop3:0xfe
    v_bitop3_b32 v12, v12, v78, v80 bitop3:0xfe
    v_bitop3_b32 v12, v12, v82, v84 bitop3:0xfe
    v_bitop3_b32 v12, v12, v86, v88 bitop3:0xfe
    v_bitop3_b32 v12, v12, v90, v92 bitop3:0xfe
    v_bitop3_b32 v12, v12, v94, 1 bitop3:0xa8
    v_cmp_ne_u32 vcc, 0, v12
    s_cbranch_vccz L_recok1_0
    s_add_u32 s54, s54, 1
    s_and_b32 s45, s54, 63
    s_cbranch_scc1 L_recl1_0
    buffer_wbl2 sc1
    s_waitcnt vmcnt(0)
    buffer_inv sc1
    s_waitcnt vmcnt(0)
    s_cmp_lt_u32 s54, 0x40000
    s_cbranch_scc1 L_recl1_0
    s_endpgm
L_recok1_0:
    v_smfmac_f32_16x16x64_bf16 v[40:43], v[64:67], v[96:103], v2
    v_smfmac_f32_16x16x64_bf16 v[44:47], v[64:67], v[104:111], v2
    v_smfmac_f32_16x16x64_bf16 v[48:51], v[64:67], v[112:119], v2
    v_smfmac_f32_16x16x64_bf16 v[52:55], v[64:67], v[120:127], v2
    v_smfmac_f32_16x16x64_bf16 v[40:43], v[68:71], v[208:215], v2
    v_smfmac_f32_16x16x64_bf16 v[44:47], v[68:71], v[216:223], v2
    v_smfmac_f32_16x16x64_bf16 v[48:51], v[68:71], a[80:87], v2
    v_smfmac_f32_16x16x64_bf16 v[52:55], v[68:71], a[88:95], v2
    ds_read_b128 v[96:99], v1 offset:8192
    ds_read_b128 v[100:103], v1 offset:9216
    ds_read_b128 v[104:107], v1 offset:10240
    ds_read_b128 v[108:111], v1 offset:11264
    ds_read_b128 v[112:115], v1 offset:12288
    ds_read_b128 v[116:119], v1 offset:13312
    ds_read_b128 v[120:123], v1 offset:14336
    ds_read_b128 v[124:127], v1 offset:15360
    s_waitcnt lgkmcnt(0)
    v_smfmac_f32_16x16x64_bf16 v[56:59], v[64:67], a[160:167], v2
    v_smfmac_f32_16x16x64_bf16 v[56:59], v[68:71], a[176:183], v2
    v_smfmac_f32_16x16x64_bf16 v[60:63], v[64:67], a[168:175], v2
    v_smfmac_f32_16x16x64_bf16 v[60:63], v[68:71], a[184:191], v2
    v_smfmac_f32_16x16x64_bf16 v[40:43], v[72:75], v[224:231], v2
    v_smfmac_f32_16x16x64_bf16 v[44:47], v[72:75], v[232:239], v2
    v_smfmac_f32_16x16x64_bf16 v[48:51], v[72:75], a[96:103], v2
    v_smfmac_f32_16x16x64_bf16 v[52:55], v[72:75], a[104:111], v2
    v_smfmac_f32_16x16x64_bf16 v[40:43], v[76:79], a[0:7], v2
    v_smfmac_f32_16x16x64_bf16 v[44:47], v[76:79], a[8:15], v2
    v_smfmac_f32_16x16x64_bf16 v[48:51], v[76:79], a[112:119], v2
    v_smfmac_f32_16x16x64_bf16 v[52:55], v[76:79], a[120:127], v2
    v_smfmac_f32_16x16x64_bf16 v[40:43], v[80:83], a[16:23], v2
    v_smfmac_f32_16x16x64_bf16 v[40:43], v[84:87], a[32:39], v2
    v_smfmac_f32_16x16x64_bf16 v[40:43], v[88:91], a[48:55], v2
    v_smfmac_f32_16x16x64_bf16 v[40:43], v[92:95], a[64:71], v2
    v_smfmac_f32_16x16x64_bf16 v[48:51], v[80:83], v[96:103], v2
    v_smfmac_f32_16x16x64_bf16 v[48:51], v[84:87], v[104:111], v2
    v_smfmac_f32_16x16x64_bf16 v[48:51], v[88:91], v[112:119], v2
    v_smfmac_f32_16x16x64_bf16 v[48:51], v[92:95], v[120:127], v2
    v_smfmac_f32_16x16x64_bf16 v[44:47], v[80:83], a[24:31], v2
    v_smfmac_f32_16x16x64_bf16 v[44:47], v[84:87], a[40:47], v2
    v_smfmac_f32_16x16x64_bf16 v[44:47], v[88:91], a[56:63], v2
    v_smfmac_f32_16x16x64_bf16 v[44:47], v[92:95], a[72:79], v2
    v_smfmac_f32_16x16x64_bf16 v[52:55], v[80:83], a[128:135], v2
    v_smfmac_f32_16x16x64_bf16 v[52:55], v[84:87], a[136:143], v2
    v_smfmac_f32_16x16x64_bf16 v[52:55], v[88:91], a[144:151], v2
    v_smfmac_f32_16x16x64_bf16 v[52:55], v[92:95], a[152:159], v2
    ds_read_b128 v[96:99], v1 offset:16384
    ds_read_b128 v[100:103], v1 offset:17408
    ds_read_b128 v[104:107], v1 offset:18432
    ds_read_b128 v[108:111], v1 offset:19456
    ds_read_b128 v[112:115], v1 offset:20480
    ds_read_b128 v[116:119], v1 offset:21504
    ds_read_b128 v[120:123], v1 offset:22528
    ds_read_b128 v[124:127], v1 offset:23552
    v_add_f32 v40, v40, v42
    v_add_f32 v41, v41, v43
    v_mul_f32 v40, s48, v40
    v_mul_f32 v41, s48, v41
    v_cvt_pk_bf16_f32 v42, v40, v41
    v_add_f32 v48, v48, v50
    v_add_f32 v49, v49, v51
    v_cvt_pk_bf16_f32 v43, v48, v49
    v_add_f32 v44, v44, v46
    v_add_f32 v45, v45, v47
    s_branch L_norec1_0
L_rec1_1:
    s_waitcnt lgkmcnt(0)
    s_mov_b32 s54, 0
    s_nop 7
    ds_read_b128 v[96:99], v1 offset:0
    ds_read_b128 v[100:103], v1 offset:1024
    ds_read_b128 v[104:107], v1 offset:2048
    ds_read_b128 v[108:111], v1 offset:3072
    ds_read_b128 v[112:115], v1 offset:4096
    ds_read_b128 v[116:119], v1 offset:5120
    ds_read_b128 v[120:123], v1 offset:6144
    ds_read_b128 v[124:127], v1 offset:7168
    v_mov_b64 v[40:41], 0
    v_mov_b64 v[42:43], 0
    v_mov_b64 v[44:45], 0
    v_mov_b64 v[46:47], 0
    v_mov_b64 v[48:49], 0
    v_mov_b64 v[50:51], 0
    v_mov_b64 v[52:53], 0
    v_mov_b64 v[54:55], 0
    v_mov_b64 v[56:57], 0
    v_mov_b64 v[58:59], 0
    v_mov_b64 v[60:61], 0
    v_mov_b64 v[62:63], 0
    s_waitcnt lgkmcnt(4)
    ds_read_b128 v[64:67], v7 offset:0
    ds_read_b128 v[68:71], v7 offset:1024
    ds_read_b128 v[72:75], v7 offset:2048
    ds_read_b128 v[76:79], v7 offset:3072
    ds_read_b128 v[80:83], v7 offset:4096
    ds_read_b128 v[84:87], v7 offset:5120
    ds_read_b128 v[88:91], v7 offset:6144
    ds_read_b128 v[92:95], v7 offset:7168
    s_waitcnt lgkmcnt(0)
    v_bitop3_b32 v12, v64, v66, v68 bitop3:0x80
    v_bitop3_b32 v12, v12, v70, v72 bitop3:0x80
    v_bitop3_b32 v12, v12, v74, v76 bitop3:0x80
    v_bitop3_b32 v12, v12, v78, v80 bitop3:0x80
    v_bitop3_b32 v12, v12, v82, v84 bitop3:0x80
    v_bitop3_b32 v12, v12, v86, v88 bitop3:0x80
    v_bitop3_b32 v12, v12, v90, v92 bitop3:0x80
    v_bitop3_b32 v12, v12, v94, 1 bitop3:0x80
    v_cmp_eq_u32 vcc, 0, v12
    s_cbranch_vccz L_recok1_1
L_recl1_1:
    v_and_b32 v12, 0xffffff80, v7
    v_add_u32 v12, v12, v7
    s_mov_b32 s46, 0x8000
    buffer_load_dwordx4 v[64:67], v12, s[8:11], s46 offen sc1
    s_mov_b32 s46, 0x8800
    buffer_load_dwordx4 v[68:71], v12, s[8:11], s46 offen sc1
    s_mov_b32 s46, 0x9000
    buffer_load_dwordx4 v[72:75], v12, s[8:11], s46 offen sc1
    s_mov_b32 s46, 0x9800
    buffer_load_dwordx4 v[76:79], v12, s[8:11], s46 offen sc1
    s_mov_b32 s46, 0x8080
    buffer_load_dwordx4 v[80:83], v12, s[8:11], s46 offen sc1
    s_mov_b32 s46, 0x8880
    buffer_load_dwordx4 v[84:87], v12, s[8:11], s46 offen sc1
    s_mov_b32 s46, 0x9080
    buffer_load_dwordx4 v[88:91], v12, s[8:11], s46 offen sc1
    s_mov_b32 s46, 0x9880
    buffer_load_dwordx4 v[92:95], v12, s[8:11], s46 offen sc1
    s_waitcnt vmcnt(0)
    v_bitop3_b32 v12, v64, v66, v68 bitop3:0x80
    v_bitop3_b32 v12, v12, v70, v72 bitop3:0x80
    v_bitop3_b32 v12, v12, v74, v76 bitop3:0x80
    v_bitop3_b32 v12, v12, v78, v80 bitop3:0x80
    v_bitop3_b32 v12, v12, v82, v84 bitop3:0x80
    v_bitop3_b32 v12, v12, v86, v88 bitop3:0x80
    v_bitop3_b32 v12, v12, v90, v92 bitop3:0x80
    v_bitop3_b32 v12, v12, v94, 1 bitop3:0x80
    v_cmp_eq_u32 vcc, 0, v12
    s_cbranch_vccz L_recok1_1
    s_add_u32 s54, s54, 1
    s_and_b32 s45, s54, 63
    s_cbranch_scc1 L_recl1_1
    buffer_wbl2 sc1
    s_waitcnt vmcnt(0)
    buffer_inv sc1
    s_waitcnt vmcnt(0)
    s_cmp_lt_u32 s54, 0x40000
    s_cbranch_scc1 L_recl1_1
    s_endpgm
L_recok1_1:
    v_smfmac_f32_16x16x64_bf16 v[40:43], v[64:67], v[96:103], v2
    v_smfmac_f32_16x16x64_bf16 v[44:47], v[64:67], v[104:111], v2
    v_smfmac_f32_16x16x64_bf16 v[48:51], v[64:67], v[112:119], v2
    v_smfmac_f32_16x16x64_bf16 v[52:55], v[64:67], v[120:127], v2
    v_smfmac_f32_16x16x64_bf16 v[40:43], v[68:71], v[208:215], v2
    v_smfmac_f32_16x16x64_bf16 v[44:47], v[68:71], v[216:223], v2
    v_smfmac_f32_16x16x64_bf16 v[48:51], v[68:71], a[80:87], v2
    v_smfmac_f32_16x16x64_bf16 v[52:55], v[68:71], a[88:95], v2
    ds_read_b128 v[96:99], v1 offset:8192
    ds_read_b128 v[100:103], v1 offset:9216
    ds_read_b128 v[104:107], v1 offset:10240
    ds_read_b128 v[108:111], v1 offset:11264
    ds_read_b128 v[112:115], v1 offset:12288
    ds_read_b128 v[116:119], v1 offset:13312
    ds_read_b128 v[120:123], v1 offset:14336
    ds_read_b128 v[124:127], v1 offset:15360
    s_waitcnt lgkmcnt(0)
    v_smfmac_f32_16x16x64_bf16 v[56:59], v[64:67], a[160:167], v2
    v_smfmac_f32_16x16x64_bf16 v[56:59], v[68:71], a[176:183], v2
    v_smfmac_f32_16x16x64_bf16 v[60:63], v[64:67], a[168:175], v2
    v_smfmac_f32_16x16x64_bf16 v[60:63], v[68:71], a[184:191], v2
    v_smfmac_f32_16x16x64_bf16 v[40:43], v[72:75], v[224:231], v2
    v_smfmac_f32_16x16x64_bf16 v[44:47], v[72:75], v[232:239], v2
    v_smfmac_f32_16x16x64_bf16 v[48:51], v[72:75], a[96:103], v2
    v_smfmac_f32_16x16x64_bf16 v[52:55], v[72:75], a[104:111], v2
    v_smfmac_f32_16x16x64_bf16 v[40:43], v[76:79], a[0:7], v2
    v_smfmac_f32_16x16x64_bf16 v[44:47], v[76:79], a[8:15], v2
    v_smfmac_f32_16x16x64_bf16 v[48:51], v[76:79], a[112:119], v2
    v_smfmac_f32_16x16x64_bf16 v[52:55], v[76:79], a[120:127], v2
    v_smfmac_f32_16x16x64_bf16 v[40:43], v[80:83], a[16:23], v2
    v_smfmac_f32_16x16x64_bf16 v[40:43], v[84:87], a[32:39], v2
    v_smfmac_f32_16x16x64_bf16 v[40:43], v[88:91], a[48:55], v2
    v_smfmac_f32_16x16x64_bf16 v[40:43], v[92:95], a[64:71], v2
    v_smfmac_f32_16x16x64_bf16 v[48:51], v[80:83], v[96:103], v2
    v_smfmac_f32_16x16x64_bf16 v[48:51], v[84:87], v[104:111], v2
    v_smfmac_f32_16x16x64_bf16 v[48:51], v[88:91], v[112:119], v2
    v_smfmac_f32_16x16x64_bf16 v[48:51], v[92:95], v[120:127], v2
    v_smfmac_f32_16x16x64_bf16 v[44:47], v[80:83], a[24:31], v2
    v_smfmac_f32_16x16x64_bf16 v[44:47], v[84:87], a[40:47], v2
    v_smfmac_f32_16x16x64_bf16 v[44:47], v[88:91], a[56:63], v2
    v_smfmac_f32_16x16x64_bf16 v[44:47], v[92:95], a[72:79], v2
    v_smfmac_f32_16x16x64_bf16 v[52:55], v[80:83], a[128:135], v2
    v_smfmac_f32_16x16x64_bf16 v[52:55], v[84:87], a[136:143], v2
    v_smfmac_f32_16x16x64_bf16 v[52:55], v[88:91], a[144:151], v2
    v_smfmac_f32_16x16x64_bf16 v[52:55], v[92:95], a[152:159], v2
    ds_read_b128 v[96:99], v1 offset:16384
    ds_read_b128 v[100:103], v1 offset:17408
    ds_read_b128 v[104:107], v1 offset:18432
    ds_read_b128 v[108:111], v1 offset:19456
    ds_read_b128 v[112:115], v1 offset:20480
    ds_read_b128 v[116:119], v1 offset:21504
    ds_read_b128 v[120:123], v1 offset:22528
    ds_read_b128 v[124:127], v1 offset:23552
    v_add_f32 v40, v40, v42
    v_add_f32 v41, v41, v43
    v_mul_f32 v40, s48, v40
    v_mul_f32 v41, s48, v41
    v_cvt_pk_bf16_f32 v42, v40, v41
    v_add_f32 v48, v48, v50
    v_add_f32 v49, v49, v51
    v_cvt_pk_bf16_f32 v43, v48, v49
    v_add_f32 v44, v44, v46
    v_add_f32 v45, v45, v47
    s_branch L_norec1_1
L_rec2_0:
    s_cmp_eq_u32 s36, 0
    s_cbranch_scc1 L_norec2_0
    s_waitcnt lgkmcnt(0)
    s_mov_b32 s54, 0
    s_nop 7
    ds_read_b128 v[96:99], v1 offset:0
    ds_read_b128 v[100:103], v1 offset:1024
    ds_read_b128 v[104:107], v1 offset:2048
    ds_read_b128 v[108:111], v1 offset:3072
    ds_read_b128 v[112:115], v1 offset:4096
    ds_read_b128 v[116:119], v1 offset:5120
    ds_read_b128 v[120:123], v1 offset:6144
    ds_read_b128 v[124:127], v1 offset:7168
    v_mov_b64 v[40:41], 0
    v_mov_b64 v[42:43], 0
    v_mov_b64 v[44:45], 0
    v_mov_b64 v[46:47], 0
    v_mov_b64 v[48:49], 0
    v_mov_b64 v[50:51], 0
    v_mov_b64 v[52:53], 0
    v_mov_b64 v[54:55], 0
    v_mov_b64 v[56:57], 0
    v_mov_b64 v[58:59], 0
    v_mov_b64 v[60:61], 0
    v_mov_b64 v[62:63], 0
    s_waitcnt lgkmcnt(4)
    ds_read_b128 v[64:67], v7 offset:0
    ds_read_b128 v[68:71], v7 offset:1024
    ds_read_b128 v[72:75], v7 offset:2048
    ds_read_b128 v[76:79], v7 offset:3072
    ds_read_b128 v[80:83], v7 offset:4096
    ds_read_b128 v[84:87], v7 offset:5120
    ds_read_b128 v[88:91], v7 offset:6144
    ds_read_b128 v[92:95], v7 offset:7168
    s_waitcnt lgkmcnt(0)
    v_bitop3_b32 v12, v64, v66, v68 bitop3:0xfe
    v_bitop3_b32 v12, v12, v70, v72 bitop3:0xfe
    v_bitop3_b32 v12, v12, v74, v76 bitop3:0xfe
    v_bitop3_b32 v12, v12, v78, v80 bitop3:0xfe
    v_bitop3_b32 v12, v12, v82, v84 bitop3:0xfe
    v_bitop3_b32 v12, v12, v86, v88 bitop3:0xfe
    v_bitop3_b32 v12, v12, v90, v92 bitop3:0xfe
    v_bitop3_b32 v12, v12, v94, 1 bitop3:0xa8
    v_cmp_ne_u32 vcc, 0, v12
    s_cbranch_vccz L_recok2_0
L_recl2_0:
    v_and_b32 v12, 0xffffff80, v7
    v_add_u32 v12, v12, v7
    s_mov_b32 s46, 0x8000
    buffer_load_dwordx4 v[64:67], v12, s[8:11], s46 offen sc1
    s_mov_b32 s46, 0x8800
    buffer_load_dwordx4 v[68:71], v12, s[8:11], s46 offen sc1
    s_mov_b32 s46, 0x9000
    buffer_load_dwordx4 v[72:75], v12, s[8:11], s46 offen sc1
    s_mov_b32 s46, 0x9800
    buffer_load_dwordx4 v[76:79], v12, s[8:11], s46 offen sc1
    s_mov_b32 s46, 0x8080
    buffer_load_dwordx4 v[80:83], v12, s[8:11], s46 offen sc1
    s_mov_b32 s46, 0x8880
    buffer_load_dwordx4 v[84:87], v12, s[8:11], s46 offen sc1
    s_mov_b32 s46, 0x9080
    buffer_load_dwordx4 v[88:91], v12, s[8:11], s46 offen sc1
    s_mov_b32 s46, 0x9880
    buffer_load_dwordx4 v[92:95], v12, s[8:11], s46 offen sc1
    s_waitcnt vmcnt(0)
    v_bitop3_b32 v12, v64, v66, v68 bitop3:0xfe
    v_bitop3_b32 v12, v12, v70, v72 bitop3:0xfe
    v_bitop3_b32 v12, v12, v74, v76 bitop3:0xfe
    v_bitop3_b32 v12, v12, v78, v80 bitop3:0xfe
    v_bitop3_b32 v12, v12, v82, v84 bitop3:0xfe
    v_bitop3_b32 v12, v12, v86, v88 bitop3:0xfe
    v_bitop3_b32 v12, v12, v90, v92 bitop3:0xfe
    v_bitop3_b32 v12, v12, v94, 1 bitop3:0xa8
    v_cmp_ne_u32 vcc, 0, v12
    s_cbranch_vccz L_recok2_0
    s_add_u32 s54, s54, 1
    s_and_b32 s45, s54, 63
    s_cbranch_scc1 L_recl2_0
    buffer_wbl2 sc1
    s_waitcnt vmcnt(0)
    buffer_inv sc1
    s_waitcnt vmcnt(0)
    s_cmp_lt_u32 s54, 0x40000
    s_cbranch_scc1 L_recl2_0
    s_endpgm
L_recok2_0:
    v_smfmac_f32_16x16x64_bf16 v[40:43], v[64:67], v[96:103], v2
    v_smfmac_f32_16x16x64_bf16 v[44:47], v[64:67], v[104:111], v2
    v_smfmac_f32_16x16x64_bf16 v[48:51], v[64:67], v[112:119], v2
    v_smfmac_f32_16x16x64_bf16 v[52:55], v[64:67], v[120:127], v2
    v_smfmac_f32_16x16x64_bf16 v[40:43], v[68:71], v[208:215], v2
    v_smfmac_f32_16x16x64_bf16 v[44:47], v[68:71], v[216:223], v2
    v_smfmac_f32_16x16x64_bf16 v[48:51], v[68:71], a[80:87], v2
    v_smfmac_f32_16x16x64_bf16 v[52:55], v[68:71], a[88:95], v2
    ds_read_b128 v[96:99], v1 offset:8192
    ds_read_b128 v[100:103], v1 offset:9216
    ds_read_b128 v[104:107], v1 offset:10240
    ds_read_b128 v[108:111], v1 offset:11264
    ds_read_b128 v[112:115], v1 offset:12288
    ds_read_b128 v[116:119], v1 offset:13312
    ds_read_b128 v[120:123], v1 offset:14336
    ds_read_b128 v[124:127], v1 offset:15360
    s_waitcnt lgkmcnt(0)
    v_smfmac_f32_16x16x64_bf16 v[56:59], v[64:67], a[160:167], v2
    v_smfmac_f32_16x16x64_bf16 v[56:59], v[68:71], a[176:183], v2
    v_smfmac_f32_16x16x64_bf16 v[60:63], v[64:67], a[168:175], v2
    v_smfmac_f32_16x16x64_bf16 v[60:63], v[68:71], a[184:191], v2
    v_smfmac_f32_16x16x64_bf16 v[40:43], v[72:75], v[224:231], v2
    v_smfmac_f32_16x16x64_bf16 v[44:47], v[72:75], v[232:239], v2
    v_smfmac_f32_16x16x64_bf16 v[48:51], v[72:75], a[96:103], v2
    v_smfmac_f32_16x16x64_bf16 v[52:55], v[72:75], a[104:111], v2
    v_smfmac_f32_16x16x64_bf16 v[40:43], v[76:79], a[0:7], v2
    v_smfmac_f32_16x16x64_bf16 v[44:47], v[76:79], a[8:15], v2
    v_smfmac_f32_16x16x64_bf16 v[48:51], v[76:79], a[112:119], v2
    v_smfmac_f32_16x16x64_bf16 v[52:55], v[76:79], a[120:127], v2
    v_smfmac_f32_16x16x64_bf16 v[40:43], v[80:83], a[16:23], v2
    v_smfmac_f32_16x16x64_bf16 v[40:43], v[84:87], a[32:39], v2
    v_smfmac_f32_16x16x64_bf16 v[40:43], v[88:91], a[48:55], v2
    v_smfmac_f32_16x16x64_bf16 v[40:43], v[92:95], a[64:71], v2
    v_smfmac_f32_16x16x64_bf16 v[48:51], v[80:83], v[96:103], v2
    v_smfmac_f32_16x16x64_bf16 v[48:51], v[84:87], v[104:111], v2
    v_smfmac_f32_16x16x64_bf16 v[48:51], v[88:91], v[112:119], v2
    v_smfmac_f32_16x16x64_bf16 v[48:51], v[92:95], v[120:127], v2
    v_smfmac_f32_16x16x64_bf16 v[44:47], v[80:83], a[24:31], v2
    v_smfmac_f32_16x16x64_bf16 v[44:47], v[84:87], a[40:47], v2
    v_smfmac_f32_16x16x64_bf16 v[44:47], v[88:91], a[56:63], v2
    v_smfmac_f32_16x16x64_bf16 v[44:47], v[92:95], a[72:79], v2
    v_smfmac_f32_16x16x64_bf16 v[52:55], v[80:83], a[128:135], v2
    v_smfmac_f32_16x16x64_bf16 v[52:55], v[84:87], a[136:143], v2
    v_smfmac_f32_16x16x64_bf16 v[52:55], v[88:91], a[144:151], v2
    v_smfmac_f32_16x16x64_bf16 v[52:55], v[92:95], a[152:159], v2
    ds_read_b128 v[96:99], v1 offset:16384
    ds_read_b128 v[100:103], v1 offset:17408
    ds_read_b128 v[104:107], v1 offset:18432
    ds_read_b128 v[108:111], v1 offset:19456
    ds_read_b128 v[112:115], v1 offset:20480
    ds_read_b128 v[116:119], v1 offset:21504
    ds_read_b128 v[120:123], v1 offset:22528
    ds_read_b128 v[124:127], v1 offset:23552
    v_add_f32 v40, v40, v42
    v_add_f32 v41, v41, v43
    v_mul_f32 v40, s48, v40
    v_mul_f32 v41, s48, v41
    v_cvt_pk_bf16_f32 v42, v40, v41
    v_add_f32 v48, v48, v50
    v_add_f32 v49, v49, v51
    v_cvt_pk_bf16_f32 v43, v48, v49
    v_add_f32 v44, v44, v46
    v_add_f32 v45, v45, v47
    s_branch L_norec2_0
L_rec2_1:
    s_waitcnt lgkmcnt(0)
    s_mov_b32 s54, 0
    s_nop 7
    ds_read_b128 v[96:99], v1 offset:0
    ds_read_b128 v[100:103], v1 offset:1024
    ds_read_b128 v[104:107], v1 offset:2048
    ds_read_b128 v[108:111], v1 offset:3072
    ds_read_b128 v[112:115], v1 offset:4096
    ds_read_b128 v[116:119], v1 offset:5120
    ds_read_b128 v[120:123], v1 offset:6144
    ds_read_b128 v[124:127], v1 offset:7168
    v_mov_b64 v[40:41], 0
    v_mov_b64 v[42:43], 0
    v_mov_b64 v[44:45], 0
    v_mov_b64 v[46:47], 0
    v_mov_b64 v[48:49], 0
    v_mov_b64 v[50:51], 0
    v_mov_b64 v[52:53], 0
    v_mov_b64 v[54:55], 0
    v_mov_b64 v[56:57], 0
    v_mov_b64 v[58:59], 0
    v_mov_b64 v[60:61], 0
    v_mov_b64 v[62:63], 0
    s_waitcnt lgkmcnt(4)
    ds_read_b128 v[64:67], v7 offset:0
    ds_read_b128 v[68:71], v7 offset:1024
    ds_read_b128 v[72:75], v7 offset:2048
    ds_read_b128 v[76:79], v7 offset:3072
    ds_read_b128 v[80:83], v7 offset:4096
    ds_read_b128 v[84:87], v7 offset:5120
    ds_read_b128 v[88:91], v7 offset:6144
    ds_read_b128 v[92:95], v7 offset:7168
    s_waitcnt lgkmcnt(0)
    v_bitop3_b32 v12, v64, v66, v68 bitop3:0x80
    v_bitop3_b32 v12, v12, v70, v72 bitop3:0x80
    v_bitop3_b32 v12, v12, v74, v76 bitop3:0x80
    v_bitop3_b32 v12, v12, v78, v80 bitop3:0x80
    v_bitop3_b32 v12, v12, v82, v84 bitop3:0x80
    v_bitop3_b32 v12, v12, v86, v88 bitop3:0x80
    v_bitop3_b32 v12, v12, v90, v92 bitop3:0x80
    v_bitop3_b32 v12, v12, v94, 1 bitop3:0x80
    v_cmp_eq_u32 vcc, 0, v12
    s_cbranch_vccz L_recok2_1
L_recl2_1:
    v_and_b32 v12, 0xffffff80, v7
    v_add_u32 v12, v12, v7
    s_mov_b32 s46, 0x8000
    buffer_load_dwordx4 v[64:67], v12, s[8:11], s46 offen sc1
    s_mov_b32 s46, 0x8800
    buffer_load_dwordx4 v[68:71], v12, s[8:11], s46 offen sc1
    s_mov_b32 s46, 0x9000
    buffer_load_dwordx4 v[72:75], v12, s[8:11], s46 offen sc1
    s_mov_b32 s46, 0x9800
    buffer_load_dwordx4 v[76:79], v12, s[8:11], s46 offen sc1
    s_mov_b32 s46, 0x8080
    buffer_load_dwordx4 v[80:83], v12, s[8:11], s46 offen sc1
    s_mov_b32 s46, 0x8880
    buffer_load_dwordx4 v[84:87], v12, s[8:11], s46 offen sc1
    s_mov_b32 s46, 0x9080
    buffer_load_dwordx4 v[88:91], v12, s[8:11], s46 offen sc1
    s_mov_b32 s46, 0x9880
    buffer_load_dwordx4 v[92:95], v12, s[8:11], s46 offen sc1
    s_waitcnt vmcnt(0)
    v_bitop3_b32 v12, v64, v66, v68 bitop3:0x80
    v_bitop3_b32 v12, v12, v70, v72 bitop3:0x80
    v_bitop3_b32 v12, v12, v74, v76 bitop3:0x80
    v_bitop3_b32 v12, v12, v78, v80 bitop3:0x80
    v_bitop3_b32 v12, v12, v82, v84 bitop3:0x80
    v_bitop3_b32 v12, v12, v86, v88 bitop3:0x80
    v_bitop3_b32 v12, v12, v90, v92 bitop3:0x80
    v_bitop3_b32 v12, v12, v94, 1 bitop3:0x80
    v_cmp_eq_u32 vcc, 0, v12
    s_cbranch_vccz L_recok2_1
    s_add_u32 s54, s54, 1
    s_and_b32 s45, s54, 63
    s_cbranch_scc1 L_recl2_1
    buffer_wbl2 sc1
    s_waitcnt vmcnt(0)
    buffer_inv sc1
    s_waitcnt vmcnt(0)
    s_cmp_lt_u32 s54, 0x40000
    s_cbranch_scc1 L_recl2_1
    s_endpgm
L_recok2_1:
    v_smfmac_f32_16x16x64_bf16 v[40:43], v[64:67], v[96:103], v2
    v_smfmac_f32_16x16x64_bf16 v[44:47], v[64:67], v[104:111], v2
    v_smfmac_f32_16x16x64_bf16 v[48:51], v[64:67], v[112:119], v2
    v_smfmac_f32_16x16x64_bf16 v[52:55], v[64:67], v[120:127], v2
    v_smfmac_f32_16x16x64_bf16 v[40:43], v[68:71], v[208:215], v2
    v_smfmac_f32_16x16x64_bf16 v[44:47], v[68:71], v[216:223], v2
    v_smfmac_f32_16x16x64_bf16 v[48:51], v[68:71], a[80:87], v2
    v_smfmac_f32_16x16x64_bf16 v[52:55], v[68:71], a[88:95], v2
    ds_read_b128 v[96:99], v1 offset:8192
    ds_read_b128 v[100:103], v1 offset:9216
    ds_read_b128 v[104:107], v1 offset:10240
    ds_read_b128 v[108:111], v1 offset:11264
    ds_read_b128 v[112:115], v1 offset:12288
    ds_read_b128 v[116:119], v1 offset:13312
    ds_read_b128 v[120:123], v1 offset:14336
    ds_read_b128 v[124:127], v1 offset:15360
    s_waitcnt lgkmcnt(0)
    v_smfmac_f32_16x16x64_bf16 v[56:59], v[64:67], a[160:167], v2
    v_smfmac_f32_16x16x64_bf16 v[56:59], v[68:71], a[176:183], v2
    v_smfmac_f32_16x16x64_bf16 v[60:63], v[64:67], a[168:175], v2
    v_smfmac_f32_16x16x64_bf16 v[60:63], v[68:71], a[184:191], v2
    v_smfmac_f32_16x16x64_bf16 v[40:43], v[72:75], v[224:231], v2
    v_smfmac_f32_16x16x64_bf16 v[44:47], v[72:75], v[232:239], v2
    v_smfmac_f32_16x16x64_bf16 v[48:51], v[72:75], a[96:103], v2
    v_smfmac_f32_16x16x64_bf16 v[52:55], v[72:75], a[104:111], v2
    v_smfmac_f32_16x16x64_bf16 v[40:43], v[76:79], a[0:7], v2
    v_smfmac_f32_16x16x64_bf16 v[44:47], v[76:79], a[8:15], v2
    v_smfmac_f32_16x16x64_bf16 v[48:51], v[76:79], a[112:119], v2
    v_smfmac_f32_16x16x64_bf16 v[52:55], v[76:79], a[120:127], v2
    v_smfmac_f32_16x16x64_bf16 v[40:43], v[80:83], a[16:23], v2
    v_smfmac_f32_16x16x64_bf16 v[40:43], v[84:87], a[32:39], v2
    v_smfmac_f32_16x16x64_bf16 v[40:43], v[88:91], a[48:55], v2
    v_smfmac_f32_16x16x64_bf16 v[40:43], v[92:95], a[64:71], v2
    v_smfmac_f32_16x16x64_bf16 v[48:51], v[80:83], v[96:103], v2
    v_smfmac_f32_16x16x64_bf16 v[48:51], v[84:87], v[104:111], v2
    v_smfmac_f32_16x16x64_bf16 v[48:51], v[88:91], v[112:119], v2
    v_smfmac_f32_16x16x64_bf16 v[48:51], v[92:95], v[120:127], v2
    v_smfmac_f32_16x16x64_bf16 v[44:47], v[80:83], a[24:31], v2
    v_smfmac_f32_16x16x64_bf16 v[44:47], v[84:87], a[40:47], v2
    v_smfmac_f32_16x16x64_bf16 v[44:47], v[88:91], a[56:63], v2
    v_smfmac_f32_16x16x64_bf16 v[44:47], v[92:95], a[72:79], v2
    v_smfmac_f32_16x16x64_bf16 v[52:55], v[80:83], a[128:135], v2
    v_smfmac_f32_16x16x64_bf16 v[52:55], v[84:87], a[136:143], v2
    v_smfmac_f32_16x16x64_bf16 v[52:55], v[88:91], a[144:151], v2
    v_smfmac_f32_16x16x64_bf16 v[52:55], v[92:95], a[152:159], v2
    ds_read_b128 v[96:99], v1 offset:16384
    ds_read_b128 v[100:103], v1 offset:17408
    ds_read_b128 v[104:107], v1 offset:18432
    ds_read_b128 v[108:111], v1 offset:19456
    ds_read_b128 v[112:115], v1 offset:20480
    ds_read_b128 v[116:119], v1 offset:21504
    ds_read_b128 v[120:123], v1 offset:22528
    ds_read_b128 v[124:127], v1 offset:23552
    v_add_f32 v40, v40, v42
    v_add_f32 v41, v41, v43
    v_mul_f32 v40, s48, v40
    v_mul_f32 v41, s48, v41
    v_cvt_pk_bf16_f32 v42, v40, v41
    v_add_f32 v48, v48, v50
    v_add_f32 v49, v49, v51
    v_cvt_pk_bf16_f32 v43, v48, v49
    v_add_f32 v44, v44, v46
    v_add_f32 v45, v45, v47
    s_branch L_norec2_1
L_rec3_0:
    s_cmp_eq_u32 s36, 0
    s_cbranch_scc1 L_norec3_0
    s_waitcnt lgkmcnt(0)
    s_mov_b32 s54, 0
    s_nop 7
    ds_read_b128 v[96:99], v1 offset:0
    ds_read_b128 v[100:103], v1 offset:1024
    ds_read_b128 v[104:107], v1 offset:2048
    ds_read_b128 v[108:111], v1 offset:3072
    ds_read_b128 v[112:115], v1 offset:4096
    ds_read_b128 v[116:119], v1 offset:5120
    ds_read_b128 v[120:123], v1 offset:6144
    ds_read_b128 v[124:127], v1 offset:7168
    v_mov_b64 v[40:41], 0
    v_mov_b64 v[42:43], 0
    v_mov_b64 v[44:45], 0
    v_mov_b64 v[46:47], 0
    v_mov_b64 v[48:49], 0
    v_mov_b64 v[50:51], 0
    v_mov_b64 v[52:53], 0
    v_mov_b64 v[54:55], 0
    v_mov_b64 v[56:57], 0
    v_mov_b64 v[58:59], 0
    v_mov_b64 v[60:61], 0
    v_mov_b64 v[62:63], 0
    s_waitcnt lgkmcnt(4)
    ds_read_b128 v[64:67], v7 offset:0
    ds_read_b128 v[68:71], v7 offset:1024
    ds_read_b128 v[72:75], v7 offset:2048
    ds_read_b128 v[76:79], v7 offset:3072
    ds_read_b128 v[80:83], v7 offset:4096
    ds_read_b128 v[84:87], v7 offset:5120
    ds_read_b128 v[88:91], v7 offset:6144
    ds_read_b128 v[92:95], v7 offset:7168
    s_waitcnt lgkmcnt(0)
    v_bitop3_b32 v12, v64, v66, v68 bitop3:0xfe
    v_bitop3_b32 v12, v12, v70, v72 bitop3:0xfe
    v_bitop3_b32 v12, v12, v74, v76 bitop3:0xfe
    v_bitop3_b32 v12, v12, v78, v80 bitop3:0xfe
    v_bitop3_b32 v12, v12, v82, v84 bitop3:0xfe
    v_bitop3_b32 v12, v12, v86, v88 bitop3:0xfe
    v_bitop3_b32 v12, v12, v90, v92 bitop3:0xfe
    v_bitop3_b32 v12, v12, v94, 1 bitop3:0xa8
    v_cmp_ne_u32 vcc, 0, v12
    s_cbranch_vccz L_recok3_0
L_recl3_0:
    v_and_b32 v12, 0xffffff80, v7
    v_add_u32 v12, v12, v7
    s_mov_b32 s46, 0x8000
    buffer_load_dwordx4 v[64:67], v12, s[8:11], s46 offen sc1
    s_mov_b32 s46, 0x8800
    buffer_load_dwordx4 v[68:71], v12, s[8:11], s46 offen sc1
    s_mov_b32 s46, 0x9000
    buffer_load_dwordx4 v[72:75], v12, s[8:11], s46 offen sc1
    s_mov_b32 s46, 0x9800
    buffer_load_dwordx4 v[76:79], v12, s[8:11], s46 offen sc1
    s_mov_b32 s46, 0x8080
    buffer_load_dwordx4 v[80:83], v12, s[8:11], s46 offen sc1
    s_mov_b32 s46, 0x8880
    buffer_load_dwordx4 v[84:87], v12, s[8:11], s46 offen sc1
    s_mov_b32 s46, 0x9080
    buffer_load_dwordx4 v[88:91], v12, s[8:11], s46 offen sc1
    s_mov_b32 s46, 0x9880
    buffer_load_dwordx4 v[92:95], v12, s[8:11], s46 offen sc1
    s_waitcnt vmcnt(0)
    v_bitop3_b32 v12, v64, v66, v68 bitop3:0xfe
    v_bitop3_b32 v12, v12, v70, v72 bitop3:0xfe
    v_bitop3_b32 v12, v12, v74, v76 bitop3:0xfe
    v_bitop3_b32 v12, v12, v78, v80 bitop3:0xfe
    v_bitop3_b32 v12, v12, v82, v84 bitop3:0xfe
    v_bitop3_b32 v12, v12, v86, v88 bitop3:0xfe
    v_bitop3_b32 v12, v12, v90, v92 bitop3:0xfe
    v_bitop3_b32 v12, v12, v94, 1 bitop3:0xa8
    v_cmp_ne_u32 vcc, 0, v12
    s_cbranch_vccz L_recok3_0
    s_add_u32 s54, s54, 1
    s_and_b32 s45, s54, 63
    s_cbranch_scc1 L_recl3_0
    buffer_wbl2 sc1
    s_waitcnt vmcnt(0)
    buffer_inv sc1
    s_waitcnt vmcnt(0)
    s_cmp_lt_u32 s54, 0x40000
    s_cbranch_scc1 L_recl3_0
    s_endpgm
L_recok3_0:
    v_smfmac_f32_16x16x64_bf16 v[40:43], v[64:67], v[96:103], v2
    v_smfmac_f32_16x16x64_bf16 v[44:47], v[64:67], v[104:111], v2
    v_smfmac_f32_16x16x64_bf16 v[48:51], v[64:67], v[112:119], v2
    v_smfmac_f32_16x16x64_bf16 v[52:55], v[64:67], v[120:127], v2
    v_smfmac_f32_16x16x64_bf16 v[40:43], v[68:71], v[208:215], v2
    v_smfmac_f32_16x16x64_bf16 v[44:47], v[68:71], v[216:223], v2
    v_smfmac_f32_16x16x64_bf16 v[48:51], v[68:71], a[80:87], v2
    v_smfmac_f32_16x16x64_bf16 v[52:55], v[68:71], a[88:95], v2
    ds_read_b128 v[96:99], v1 offset:8192
    ds_read_b128 v[100:103], v1 offset:9216
    ds_read_b128 v[104:107], v1 offset:10240
    ds_read_b128 v[108:111], v1 offset:11264
    ds_read_b128 v[112:115], v1 offset:12288
    ds_read_b128 v[116:119], v1 offset:13312
    ds_read_b128 v[120:123], v1 offset:14336
    ds_read_b128 v[124:127], v1 offset:15360
    s_waitcnt lgkmcnt(0)
    v_smfmac_f32_16x16x64_bf16 v[56:59], v[64:67], a[160:167], v2
    v_smfmac_f32_16x16x64_bf16 v[56:59], v[68:71], a[176:183], v2
    v_smfmac_f32_16x16x64_bf16 v[60:63], v[64:67], a[168:175], v2
    v_smfmac_f32_16x16x64_bf16 v[60:63], v[68:71], a[184:191], v2
    v_smfmac_f32_16x16x64_bf16 v[40:43], v[72:75], v[224:231], v2
    v_smfmac_f32_16x16x64_bf16 v[44:47], v[72:75], v[232:239], v2
    v_smfmac_f32_16x16x64_bf16 v[48:51], v[72:75], a[96:103], v2
    v_smfmac_f32_16x16x64_bf16 v[52:55], v[72:75], a[104:111], v2
    v_smfmac_f32_16x16x64_bf16 v[40:43], v[76:79], a[0:7], v2
    v_smfmac_f32_16x16x64_bf16 v[44:47], v[76:79], a[8:15], v2
    v_smfmac_f32_16x16x64_bf16 v[48:51], v[76:79], a[112:119], v2
    v_smfmac_f32_16x16x64_bf16 v[52:55], v[76:79], a[120:127], v2
    v_smfmac_f32_16x16x64_bf16 v[40:43], v[80:83], a[16:23], v2
    v_smfmac_f32_16x16x64_bf16 v[40:43], v[84:87], a[32:39], v2
    v_smfmac_f32_16x16x64_bf16 v[40:43], v[88:91], a[48:55], v2
    v_smfmac_f32_16x16x64_bf16 v[40:43], v[92:95], a[64:71], v2
    v_smfmac_f32_16x16x64_bf16 v[48:51], v[80:83], v[96:103], v2
    v_smfmac_f32_16x16x64_bf16 v[48:51], v[84:87], v[104:111], v2
    v_smfmac_f32_16x16x64_bf16 v[48:51], v[88:91], v[112:119], v2
    v_smfmac_f32_16x16x64_bf16 v[48:51], v[92:95], v[120:127], v2
    v_smfmac_f32_16x16x64_bf16 v[44:47], v[80:83], a[24:31], v2
    v_smfmac_f32_16x16x64_bf16 v[44:47], v[84:87], a[40:47], v2
    v_smfmac_f32_16x16x64_bf16 v[44:47], v[88:91], a[56:63], v2
    v_smfmac_f32_16x16x64_bf16 v[44:47], v[92:95], a[72:79], v2
    v_smfmac_f32_16x16x64_bf16 v[52:55], v[80:83], a[128:135], v2
    v_smfmac_f32_16x16x64_bf16 v[52:55], v[84:87], a[136:143], v2
    v_smfmac_f32_16x16x64_bf16 v[52:55], v[88:91], a[144:151], v2
    v_smfmac_f32_16x16x64_bf16 v[52:55], v[92:95], a[152:159], v2
    ds_read_b128 v[96:99], v1 offset:16384
    ds_read_b128 v[100:103], v1 offset:17408
    ds_read_b128 v[104:107], v1 offset:18432
    ds_read_b128 v[108:111], v1 offset:19456
    ds_read_b128 v[112:115], v1 offset:20480
    ds_read_b128 v[116:119], v1 offset:21504
    ds_read_b128 v[120:123], v1 offset:22528
    ds_read_b128 v[124:127], v1 offset:23552
    v_add_f32 v40, v40, v42
    v_add_f32 v41, v41, v43
    v_mul_f32 v40, s48, v40
    v_mul_f32 v41, s48, v41
    v_cvt_pk_bf16_f32 v42, v40, v41
    v_add_f32 v48, v48, v50
    v_add_f32 v49, v49, v51
    v_cvt_pk_bf16_f32 v43, v48, v49
    v_add_f32 v44, v44, v46
    v_add_f32 v45, v45, v47
    s_branch L_norec3_0
L_kvw3_0:
    s_mov_b32 s54, 0
L_kvs3_0:
    buffer_load_dword v6, off, s[8:11], s52 sc1
    s_waitcnt vmcnt(0)
    v_cmp_ge_u32 vcc, s53, v6
    s_cbranch_vccz L_kvs3_0_ok
    s_sleep 2
    s_add_u32 s54, s54, 1
    s_cmp_lt_u32 s54, 0x40000
    s_cbranch_scc1 L_kvs3_0
    s_endpgm
L_kvs3_0_ok:
    s_branch L_kvok3_0
L_rec3_1:
    s_waitcnt lgkmcnt(0)
    s_mov_b32 s54, 0
    s_nop 7
    ds_read_b128 v[96:99], v1 offset:0
    ds_read_b128 v[100:103], v1 offset:1024
    ds_read_b128 v[104:107], v1 offset:2048
    ds_read_b128 v[108:111], v1 offset:3072
    ds_read_b128 v[112:115], v1 offset:4096
    ds_read_b128 v[116:119], v1 offset:5120
    ds_read_b128 v[120:123], v1 offset:6144
    ds_read_b128 v[124:127], v1 offset:7168
    v_mov_b64 v[40:41], 0
    v_mov_b64 v[42:43], 0
    v_mov_b64 v[44:45], 0
    v_mov_b64 v[46:47], 0
    v_mov_b64 v[48:49], 0
    v_mov_b64 v[50:51], 0
    v_mov_b64 v[52:53], 0
    v_mov_b64 v[54:55], 0
    v_mov_b64 v[56:57], 0
    v_mov_b64 v[58:59], 0
    v_mov_b64 v[60:61], 0
    v_mov_b64 v[62:63], 0
    s_waitcnt lgkmcnt(4)
    ds_read_b128 v[64:67], v7 offset:0
    ds_read_b128 v[68:71], v7 offset:1024
    ds_read_b128 v[72:75], v7 offset:2048
    ds_read_b128 v[76:79], v7 offset:3072
    ds_read_b128 v[80:83], v7 offset:4096
    ds_read_b128 v[84:87], v7 offset:5120
    ds_read_b128 v[88:91], v7 offset:6144
    ds_read_b128 v[92:95], v7 offset:7168
    s_waitcnt lgkmcnt(0)
    v_bitop3_b32 v12, v64, v66, v68 bitop3:0x80
    v_bitop3_b32 v12, v12, v70, v72 bitop3:0x80
    v_bitop3_b32 v12, v12, v74, v76 bitop3:0x80
    v_bitop3_b32 v12, v12, v78, v80 bitop3:0x80
    v_bitop3_b32 v12, v12, v82, v84 bitop3:0x80
    v_bitop3_b32 v12, v12, v86, v88 bitop3:0x80
    v_bitop3_b32 v12, v12, v90, v92 bitop3:0x80
    v_bitop3_b32 v12, v12, v94, 1 bitop3:0x80
    v_cmp_eq_u32 vcc, 0, v12
    s_cbranch_vccz L_recok3_1
L_recl3_1:
    v_and_b32 v12, 0xffffff80, v7
    v_add_u32 v12, v12, v7
    s_mov_b32 s46, 0x8000
    buffer_load_dwordx4 v[64:67], v12, s[8:11], s46 offen sc1
    s_mov_b32 s46, 0x8800
    buffer_load_dwordx4 v[68:71], v12, s[8:11], s46 offen sc1
    s_mov_b32 s46, 0x9000
    buffer_load_dwordx4 v[72:75], v12, s[8:11], s46 offen sc1
    s_mov_b32 s46, 0x9800
    buffer_load_dwordx4 v[76:79], v12, s[8:11], s46 offen sc1
    s_mov_b32 s46, 0x8080
    buffer_load_dwordx4 v[80:83], v12, s[8:11], s46 offen sc1
    s_mov_b32 s46, 0x8880
    buffer_load_dwordx4 v[84:87], v12, s[8:11], s46 offen sc1
    s_mov_b32 s46, 0x9080
    buffer_load_dwordx4 v[88:91], v12, s[8:11], s46 offen sc1
    s_mov_b32 s46, 0x9880
    buffer_load_dwordx4 v[92:95], v12, s[8:11], s46 offen sc1
    s_waitcnt vmcnt(0)
    v_bitop3_b32 v12, v64, v66, v68 bitop3:0x80
    v_bitop3_b32 v12, v12, v70, v72 bitop3:0x80
    v_bitop3_b32 v12, v12, v74, v76 bitop3:0x80
    v_bitop3_b32 v12, v12, v78, v80 bitop3:0x80
    v_bitop3_b32 v12, v12, v82, v84 bitop3:0x80
    v_bitop3_b32 v12, v12, v86, v88 bitop3:0x80
    v_bitop3_b32 v12, v12, v90, v92 bitop3:0x80
    v_bitop3_b32 v12, v12, v94, 1 bitop3:0x80
    v_cmp_eq_u32 vcc, 0, v12
    s_cbranch_vccz L_recok3_1
    s_add_u32 s54, s54, 1
    s_and_b32 s45, s54, 63
    s_cbranch_scc1 L_recl3_1
    buffer_wbl2 sc1
    s_waitcnt vmcnt(0)
    buffer_inv sc1
    s_waitcnt vmcnt(0)
    s_cmp_lt_u32 s54, 0x40000
    s_cbranch_scc1 L_recl3_1
    s_endpgm
L_recok3_1:
    v_smfmac_f32_16x16x64_bf16 v[40:43], v[64:67], v[96:103], v2
    v_smfmac_f32_16x16x64_bf16 v[44:47], v[64:67], v[104:111], v2
    v_smfmac_f32_16x16x64_bf16 v[48:51], v[64:67], v[112:119], v2
    v_smfmac_f32_16x16x64_bf16 v[52:55], v[64:67], v[120:127], v2
    v_smfmac_f32_16x16x64_bf16 v[40:43], v[68:71], v[208:215], v2
    v_smfmac_f32_16x16x64_bf16 v[44:47], v[68:71], v[216:223], v2
    v_smfmac_f32_16x16x64_bf16 v[48:51], v[68:71], a[80:87], v2
    v_smfmac_f32_16x16x64_bf16 v[52:55], v[68:71], a[88:95], v2
    ds_read_b128 v[96:99], v1 offset:8192
    ds_read_b128 v[100:103], v1 offset:9216
    ds_read_b128 v[104:107], v1 offset:10240
    ds_read_b128 v[108:111], v1 offset:11264
    ds_read_b128 v[112:115], v1 offset:12288
    ds_read_b128 v[116:119], v1 offset:13312
    ds_read_b128 v[120:123], v1 offset:14336
    ds_read_b128 v[124:127], v1 offset:15360
    s_waitcnt lgkmcnt(0)
    v_smfmac_f32_16x16x64_bf16 v[56:59], v[64:67], a[160:167], v2
    v_smfmac_f32_16x16x64_bf16 v[56:59], v[68:71], a[176:183], v2
    v_smfmac_f32_16x16x64_bf16 v[60:63], v[64:67], a[168:175], v2
    v_smfmac_f32_16x16x64_bf16 v[60:63], v[68:71], a[184:191], v2
    v_smfmac_f32_16x16x64_bf16 v[40:43], v[72:75], v[224:231], v2
    v_smfmac_f32_16x16x64_bf16 v[44:47], v[72:75], v[232:239], v2
    v_smfmac_f32_16x16x64_bf16 v[48:51], v[72:75], a[96:103], v2
    v_smfmac_f32_16x16x64_bf16 v[52:55], v[72:75], a[104:111], v2
    v_smfmac_f32_16x16x64_bf16 v[40:43], v[76:79], a[0:7], v2
    v_smfmac_f32_16x16x64_bf16 v[44:47], v[76:79], a[8:15], v2
    v_smfmac_f32_16x16x64_bf16 v[48:51], v[76:79], a[112:119], v2
    v_smfmac_f32_16x16x64_bf16 v[52:55], v[76:79], a[120:127], v2
    v_smfmac_f32_16x16x64_bf16 v[40:43], v[80:83], a[16:23], v2
    v_smfmac_f32_16x16x64_bf16 v[40:43], v[84:87], a[32:39], v2
    v_smfmac_f32_16x16x64_bf16 v[40:43], v[88:91], a[48:55], v2
    v_smfmac_f32_16x16x64_bf16 v[40:43], v[92:95], a[64:71], v2
    v_smfmac_f32_16x16x64_bf16 v[48:51], v[80:83], v[96:103], v2
    v_smfmac_f32_16x16x64_bf16 v[48:51], v[84:87], v[104:111], v2
    v_smfmac_f32_16x16x64_bf16 v[48:51], v[88:91], v[112:119], v2
    v_smfmac_f32_16x16x64_bf16 v[48:51], v[92:95], v[120:127], v2
    v_smfmac_f32_16x16x64_bf16 v[44:47], v[80:83], a[24:31], v2
    v_smfmac_f32_16x16x64_bf16 v[44:47], v[84:87], a[40:47], v2
    v_smfmac_f32_16x16x64_bf16 v[44:47], v[88:91], a[56:63], v2
    v_smfmac_f32_16x16x64_bf16 v[44:47], v[92:95], a[72:79], v2
    v_smfmac_f32_16x16x64_bf16 v[52:55], v[80:83], a[128:135], v2
    v_smfmac_f32_16x16x64_bf16 v[52:55], v[84:87], a[136:143], v2
    v_smfmac_f32_16x16x64_bf16 v[52:55], v[88:91], a[144:151], v2
    v_smfmac_f32_16x16x64_bf16 v[52:55], v[92:95], a[152:159], v2
    ds_read_b128 v[96:99], v1 offset:16384
    ds_read_b128 v[100:103], v1 offset:17408
    ds_read_b128 v[104:107], v1 offset:18432
    ds_read_b128 v[108:111], v1 offset:19456
    ds_read_b128 v[112:115], v1 offset:20480
    ds_read_b128 v[116:119], v1 offset:21504
    ds_read_b128 v[120:123], v1 offset:22528
    ds_read_b128 v[124:127], v1 offset:23552
    v_add_f32 v40, v40, v42
    v_add_f32 v41, v41, v43
    v_mul_f32 v40, s48, v40
    v_mul_f32 v41, s48, v41
    v_cvt_pk_bf16_f32 v42, v40, v41
    v_add_f32 v48, v48, v50
    v_add_f32 v49, v49, v51
    v_cvt_pk_bf16_f32 v43, v48, v49
    v_add_f32 v44, v44, v46
    v_add_f32 v45, v45, v47
    s_branch L_norec3_1
L_kvw3_1:
    s_mov_b32 s54, 0
L_kvs3_1:
    buffer_load_dword v6, off, s[8:11], s52 sc1
    s_waitcnt vmcnt(0)
    v_cmp_ge_u32 vcc, s53, v6
    s_cbranch_vccz L_kvs3_1_ok
    s_sleep 2
    s_add_u32 s54, s54, 1
    s_cmp_lt_u32 s54, 0x40000
    s_cbranch_scc1 L_kvs3_1
    s_endpgm
L_kvs3_1_ok:
    s_branch L_kvok3_1
L_chain_fin:
    buffer_store_dwordx2 v[14:15], v8, s[8:11], s39 offen sc1
L_chain_end:
    s_waitcnt vmcnt(0)
    s_barrier
    buffer_store_dwordx2 v[56:57], v3, s[8:11], s50 offen sc1
    buffer_store_dwordx2 v[58:59], v3, s[8:11], s51 offen sc1
    buffer_store_dwordx2 v[60:61], v3, s[8:11], s2 offen sc1
    buffer_store_dwordx2 v[62:63], v3, s[8:11], s99 offen sc1
    s_endpgm
.p2align 6
L_other:
    s_waitcnt lgkmcnt(0)
    s_mov_b32 s10, 0x10000000
    s_mov_b32 s11, 0x20000
    s_mov_b32 s14, 0x100
    s_mov_b32 s15, 0x20000
    v_lshlrev_b32 v6, 3, v0
    s_mov_b32 s96, 0x804c4000
    s_mov_b32 s97, 0xd8ccc08c
    s_lshl_b32 s7, s4, 3
    s_lshr_b64 s[96:97], s[96:97], s7
    s_and_b32 s96, s96, 255
    s_add_u32 s7, s96, 4
    s_cmp_eq_u32 s3, 0
    s_cbranch_scc0 L_o_nc
    s_lshl_b32 s97, 1, s5
    v_mov_b32 v126, s97
    s_mov_b64 exec, 1
    buffer_atomic_or v126, off, s[12:15], s96 sc0
    s_mov_b64 exec, -1
L_o_nc:
    s_lshr_b32 s96, s2, 2
    s_and_b32 s96, s96, 1
    s_xor_b32 s96, s96, 1
    v_mov_b32 v4, s96
    v_mov_b32 v5, s96
    s_lshl_b32 s96, s2, 11
    s_add_u32 s96, s96, 0x100000
    buffer_store_dwordx2 v[4:5], v6, s[8:11], s96 offen sc1
L_dispatch:
    s_cmp_eq_u32 s4, 0
    s_cbranch_scc1 L_chain
    s_cmp_lt_u32 s4, 5
    s_cbranch_scc1 L_r1
    s_cmp_lt_u32 s4, 7
    s_cbranch_scc1 L_r3
    s_branch L_r4
L_r1:
    s_load_dwordx2 s[16:17], s[0:1], 88
    s_load_dwordx2 s[20:21], s[0:1], 96
    s_load_dwordx2 s[24:25], s[0:1], 104
    s_load_dwordx2 s[28:29], s[0:1], 0
    s_load_dwordx2 s[32:33], s[0:1], 80
    s_sub_u32 s36, s4, 1
    s_lshl_b32 s36, s36, 3
    s_lshr_b32 s40, s5, 2
    s_add_u32 s36, s36, s40
    s_and_b32 s37, s5, 3
    s_and_b32 s47, s5, 1
    s_lshl_b32 s46, s4, 5
    s_add_u32 s46, s46, s5
    s_lshl_b32 s46, s46, 7
    s_lshl_b32 s39, s37, 15
    s_lshl_b32 s40, s3, 13
    s_add_u32 s39, s39, s40
    s_lshl_b32 s43, s37, 19
    s_lshl_b32 s40, s36, 14
    s_add_u32 s43, s43, s40
    s_lshl_b32 s40, s3, 12
    s_add_u32 s43, s43, s40
    s_add_u32 s43, s43, 0x1000000
    s_lshl_b32 s44, s37, 18
    s_and_b32 s40, s3, 1
    s_lshl_b32 s40, s40, 17
    s_add_u32 s44, s44, s40
    s_lshl_b32 s40, s36, 12
    s_add_u32 s44, s44, s40
    s_lshr_b32 s40, s3, 1
    s_lshl_b32 s40, s40, 11
    s_add_u32 s44, s44, s40
    s_add_u32 s44, s44, 0x4000000
    s_lshl_b32 s45, s37, 13
    s_lshl_b32 s40, s3, 11
    s_add_u32 s45, s45, s40
    s_add_u32 s45, s45, 0x100000
    s_mov_b32 s48, 0x3e0293ee
    v_lshrrev_b32 v70, 1, v0
    v_lshlrev_b32 v70, 13, v70
    v_and_b32 v71, 1, v0
    v_lshl_add_u32 v70, v71, 7, v70
    v_and_b32 v64, 63, v0
    v_and_b32 v65, 15, v64
    v_lshrrev_b32 v66, 4, v64
    v_lshlrev_b32 v0, 4, v64
    v_mul_u32_u24 v67, 1040, v65
    v_lshl_add_u32 v1, v66, 8, v67
    v_and_b32 v67, 7, v65
    v_mul_u32_u24 v67, 1040, v67
    v_lshl_add_u32 v67, v66, 8, v67
    v_add_u32 v3, 115712, v67
    v_and_b32 v67, 6, v65
    v_and_b32 v68, 1, v65
    v_lshl_add_u32 v67, v67, 1, v68
    v_lshl_add_u32 v67, v66, 4, v67
    v_lshlrev_b32 v67, 4, v67
    v_lshrrev_b32 v68, 3, v65
    v_lshl_add_u32 v7, v68, 10, v67
    s_mul_i32 s40, s3, 2080
    s_add_u32 s40, s40, 115712
    v_and_b32 v67, 0x380, v0
    v_and_b32 v68, 3, v64
    v_lshl_add_u32 v67, v68, 5, v67
    v_and_b32 v68, 4, v64
    v_lshl_add_u32 v67, v68, 1, v67
    v_add_u32 v9, s40, v67
    v_add_u32 v11, 124032, v0
    s_lshl_b32 s40, s3, 10
    v_add_u32 v10, s40, v11
    v_lshlrev_b32 v67, 3, v64
    v_add_u32 v67, 128128, v67
    v_add_u32 v12, s40, v67
    s_lshr_b32 s40, s3, 1
    s_lshl_b32 s40, s40, 11
    v_add_u32 v13, s40, v67
    s_and_b32 s40, s3, 1
    s_lshl_b32 s40, s40, 4
    v_add_u32 v67, s40, v65
    v_lshlrev_b32 v68, 2, v66
    v_sub_u32 v67, v67, v68
    v_mov_b32 v69, 0xf149f2ca
    v_cmp_gt_i32 vcc, 0, v67
    s_nop 1
    v_cndmask_b32 v16, 0, v69, vcc
    v_cmp_gt_i32 vcc, 1, v67
    s_nop 1
    v_cndmask_b32 v17, 0, v69, vcc
    v_cmp_gt_i32 vcc, 2, v67
    s_nop 1
    v_cndmask_b32 v18, 0, v69, vcc
    v_cmp_gt_i32 vcc, 3, v67
    s_nop 1
    v_cndmask_b32 v19, 0, v69, vcc
    v_cmp_gt_i32 vcc, 16, v67
    s_nop 1
    v_cndmask_b32 v20, 0, v69, vcc
    v_cmp_gt_i32 vcc, 17, v67
    s_nop 1
    v_cndmask_b32 v21, 0, v69, vcc
    v_cmp_gt_i32 vcc, 18, v67
    s_nop 1
    v_cndmask_b32 v22, 0, v69, vcc
    v_cmp_gt_i32 vcc, 19, v67
    s_nop 1
    v_cndmask_b32 v23, 0, v69, vcc
    v_cmp_lt_u32 vcc, 1, v66
    s_nop 1
    v_cndmask_b32 v24, 0, v69, vcc
    v_cndmask_b32 v25, 0, v69, vcc
    v_cndmask_b32 v26, 0, v69, vcc
    v_cndmask_b32 v27, 0, v69, vcc
    v_lshlrev_b32 v67, 20, v66
    v_lshrrev_b32 v68, 2, v65
    v_lshl_add_u32 v67, v68, 13, v67
    v_and_b32 v68, 3, v65
    v_lshl_add_u32 v67, v68, 4, v67
    s_lshl_b32 s40, s36, 8
    s_lshl_b32 s41, s3, 6
    s_add_u32 s40, s40, s41
    v_add_u32 v31, s40, v67
    v_lshlrev_b32 v68, 3, v68
    v_sub_u32 v30, v10, v68
    s_waitcnt lgkmcnt(0)
    s_mov_b32 s18, 0x400000
    s_mov_b32 s19, 0x20000
    s_mov_b32 s22, 0x400000
    s_mov_b32 s23, 0x20000
    s_mov_b32 s26, 0x400000
    s_mov_b32 s27, 0x20000
    s_mov_b32 s30, 0x200000
    s_mov_b32 s31, 0x20000
    s_mov_b32 s34, 0x2000
    s_mov_b32 s35, 0x20000
    s_mov_b32 s42, 0
    s_mul_i32 s40, s3, 8320
    s_add_u32 m0, s40, s42
    s_mov_b32 s41, s39
    buffer_load_dwordx4 v0, s[28:31], s41 offen lds
    s_add_u32 m0, m0, 1040
    s_add_u32 s41, s41, 1024
    buffer_load_dwordx4 v0, s[28:31], s41 offen lds
    s_add_u32 m0, m0, 1040
    s_add_u32 s41, s41, 1024
    buffer_load_dwordx4 v0, s[28:31], s41 offen lds
    s_add_u32 m0, m0, 1040
    s_add_u32 s41, s41, 1024
    buffer_load_dwordx4 v0, s[28:31], s41 offen lds
    s_add_u32 m0, m0, 1040
    s_add_u32 s41, s41, 1024
    buffer_load_dwordx4 v0, s[28:31], s41 offen lds
    s_add_u32 m0, m0, 1040
    s_add_u32 s41, s41, 1024
    buffer_load_dwordx4 v0, s[28:31], s41 offen lds
    s_add_u32 m0, m0, 1040
    s_add_u32 s41, s41, 1024
    buffer_load_dwordx4 v0, s[28:31], s41 offen lds
    s_add_u32 m0, m0, 1040
    s_add_u32 s41, s41, 1024
    buffer_load_dwordx4 v0, s[28:31], s41 offen lds
    s_add_u32 s39, s39, 0x20000
    s_lshl_b32 s42, s37, 20
    s_lshl_b32 s41, s36, 8
    s_add_u32 s42, s42, s41
    v_mov_b32 v28, v70
    s_mov_b32 s40, 0x0
    buffer_load_dwordx4 v[32:35], v31, s[20:23], s40 offen
    s_mov_b32 s40, 0x8000
    buffer_load_dwordx4 v[36:39], v31, s[20:23], s40 offen
    s_mov_b32 s40, 0x10000
    buffer_load_dwordx4 v[40:43], v31, s[20:23], s40 offen
    s_mov_b32 s40, 0x18000
    buffer_load_dwordx4 v[44:47], v31, s[20:23], s40 offen
    s_mov_b32 s40, 0x20000
    buffer_load_dwordx4 v[48:51], v31, s[20:23], s40 offen
    s_mov_b32 s40, 0x28000
    buffer_load_dwordx4 v[52:55], v31, s[20:23], s40 offen
    s_mov_b32 s40, 0x30000
    buffer_load_dwordx4 v[56:59], v31, s[20:23], s40 offen
    s_mov_b32 s40, 0x38000
    buffer_load_dwordx4 v[60:63], v31, s[20:23], s40 offen
    s_mov_b32 s40, 0x40000
    buffer_load_dwordx4 v[64:67], v31, s[20:23], s40 offen
    s_mov_b32 s40, 0x48000
    buffer_load_dwordx4 v[68:71], v31, s[20:23], s40 offen
    s_mov_b32 s40, 0x50000
    buffer_load_dwordx4 v[72:75], v31, s[20:23], s40 offen
    s_mov_b32 s40, 0x58000
    buffer_load_dwordx4 v[76:79], v31, s[20:23], s40 offen
    s_mov_b32 s40, 0x60000
    buffer_load_dwordx4 v[80:83], v31, s[20:23], s40 offen
    s_mov_b32 s40, 0x68000
    buffer_load_dwordx4 v[84:87], v31, s[20:23], s40 offen
    s_mov_b32 s40, 0x70000
    buffer_load_dwordx4 v[88:91], v31, s[20:23], s40 offen
    s_mov_b32 s40, 0x78000
    buffer_load_dwordx4 v[92:95], v31, s[20:23], s40 offen
    s_mov_b32 s40, 0x80000
    buffer_load_dwordx4 v[96:99], v31, s[20:23], s40 offen
    s_mov_b32 s40, 0x88000
    buffer_load_dwordx4 v[100:103], v31, s[20:23], s40 offen
    s_mov_b32 s40, 0x90000
    buffer_load_dwordx4 v[104:107], v31, s[20:23], s40 offen
    s_mov_b32 s40, 0x98000
    buffer_load_dwordx4 v[108:111], v31, s[20:23], s40 offen
    s_mov_b32 s40, 0xa0000
    buffer_load_dwordx4 v[112:115], v31, s[20:23], s40 offen
    s_mov_b32 s40, 0xa8000
    buffer_load_dwordx4 v[116:119], v31, s[20:23], s40 offen
    s_mov_b32 s40, 0xb0000
    buffer_load_dwordx4 v[120:123], v31, s[20:23], s40 offen
    s_lshl_b32 s96, s4, 5
    s_add_u32 s96, s96, s5
    s_cmp_eq_u32 s98, 1
    s_cbranch_scc1 L_r1_cf_ok
    v_mov_b32 v125, 163836
    s_cmp_eq_u32 s3, 0
    s_cbranch_scc0 L_r1_cf_b
    s_waitcnt vmcnt(32)
    v_readfirstlane_b32 s97, v126
    v_mov_b32 v124, s96
    s_nop 2
    s_bitcmp1_b32 s97, s5
    s_cbranch_scc1 L_lost
    ds_write_b32 v125, v124
    s_waitcnt lgkmcnt(0)
L_r1_cf_b:
    s_barrier
    ds_read_b32 v124, v125
    s_waitcnt lgkmcnt(0)
    v_readfirstlane_b32 s97, v124
    s_barrier
    s_cmp_eq_u32 s97, s96
    s_cbranch_scc0 L_restart
L_r1_cf_ok:
    s_lshl_b32 s96, s96, 7
    s_lshl_b32 s97, s3, 3
    s_add_u32 s96, s96, s97
    v_mov_b64 v[124:125], 0
    buffer_store_dwordx2 v[124:125], off, s[8:11], s96 sc1
    s_waitcnt vmcnt(23)
    ds_write_b128 v10, v[32:35] offset:0
    ds_read_b64_tr_b16 a[128:129], v30 offset:0
    ds_read_b64_tr_b16 a[136:137], v30 offset:32
    s_mov_b32 s40, 0xb8000
    buffer_load_dwordx4 v[124:127], v31, s[20:23], s40 offen
    s_waitcnt vmcnt(23)
    ds_write_b128 v10, v[36:39] offset:0
    ds_read_b64_tr_b16 a[130:131], v30 offset:0
    ds_read_b64_tr_b16 a[138:139], v30 offset:32
    s_waitcnt lgkmcnt(5)
    s_barrier
    s_mov_b32 s40, 0xc0000
    buffer_load_dwordx4 v[32:35], v31, s[20:23], s40 offen
    s_waitcnt vmcnt(23)
    ds_write_b128 v10, v[40:43] offset:0
    ds_read_b64_tr_b16 a[132:133], v30 offset:0
    ds_read_b64_tr_b16 a[140:141], v30 offset:32
    s_mov_b32 s40, 0xc8000
    buffer_load_dwordx4 v[36:39], v31, s[20:23], s40 offen
    s_waitcnt vmcnt(23)
    ds_write_b128 v10, v[44:47] offset:0
    ds_read_b64_tr_b16 a[134:135], v30 offset:0
    ds_read_b64_tr_b16 a[142:143], v30 offset:32
    s_waitcnt lgkmcnt(5)
    s_barrier
    s_mov_b32 s40, 0xd0000
    buffer_load_dwordx4 v[40:43], v31, s[20:23], s40 offen
    s_waitcnt vmcnt(23)
    ds_write_b128 v10, v[48:51] offset:0
    ds_read_b64_tr_b16 a[144:145], v30 offset:0
    ds_read_b64_tr_b16 a[152:153], v30 offset:32
    s_mov_b32 s40, 0xd8000
    buffer_load_dwordx4 v[44:47], v31, s[20:23], s40 offen
    s_waitcnt vmcnt(23)
    ds_write_b128 v10, v[52:55] offset:0
    ds_read_b64_tr_b16 a[146:147], v30 offset:0
    ds_read_b64_tr_b16 a[154:155], v30 offset:32
    s_waitcnt lgkmcnt(5)
    s_barrier
    s_mov_b32 s40, 0xe0000
    buffer_load_dwordx4 v[48:51], v31, s[20:23], s40 offen
    s_waitcnt vmcnt(23)
    ds_write_b128 v10, v[56:59] offset:0
    ds_read_b64_tr_b16 a[148:149], v30 offset:0
    ds_read_b64_tr_b16 a[156:157], v30 offset:32
    s_mov_b32 s40, 0xe8000
    buffer_load_dwordx4 v[52:55], v31, s[20:23], s40 offen
    s_waitcnt vmcnt(23)
    ds_write_b128 v10, v[60:63] offset:0
    ds_read_b64_tr_b16 a[150:151], v30 offset:0
    ds_read_b64_tr_b16 a[158:159], v30 offset:32
    s_waitcnt lgkmcnt(5)
    s_barrier
    s_mov_b32 s40, 0xf0000
    buffer_load_dwordx4 v[56:59], v31, s[20:23], s40 offen
    s_waitcnt vmcnt(23)
    ds_write_b128 v10, v[64:67] offset:0
    ds_read_b64_tr_b16 a[160:161], v30 offset:0
    ds_read_b64_tr_b16 a[168:169], v30 offset:32
    s_mov_b32 s40, 0xf8000
    buffer_load_dwordx4 v[60:63], v31, s[20:23], s40 offen
    s_waitcnt vmcnt(23)
    ds_write_b128 v10, v[68:71] offset:0
    ds_read_b64_tr_b16 a[162:163], v30 offset:0
    ds_read_b64_tr_b16 a[170:171], v30 offset:32
    s_waitcnt lgkmcnt(5)
    s_barrier
    s_mov_b32 s40, 0x0
    buffer_load_dwordx4 v[64:67], v31, s[24:27], s40 offen
    s_waitcnt vmcnt(23)
    ds_write_b128 v10, v[72:75] offset:0
    ds_read_b64_tr_b16 a[164:165], v30 offset:0
    ds_read_b64_tr_b16 a[172:173], v30 offset:32
    s_mov_b32 s40, 0x8000
    buffer_load_dwordx4 v[68:71], v31, s[24:27], s40 offen
    s_waitcnt vmcnt(23)
    ds_write_b128 v10, v[76:79] offset:0
    ds_read_b64_tr_b16 a[166:167], v30 offset:0
    ds_read_b64_tr_b16 a[174:175], v30 offset:32
    s_waitcnt lgkmcnt(5)
    s_barrier
    s_mov_b32 s40, 0x10000
    buffer_load_dwordx4 v[72:75], v31, s[24:27], s40 offen
    s_waitcnt vmcnt(23)
    ds_write_b128 v10, v[80:83] offset:0
    ds_read_b64_tr_b16 a[176:177], v30 offset:0
    ds_read_b64_tr_b16 a[184:185], v30 offset:32
    s_mov_b32 s40, 0x18000
    buffer_load_dwordx4 v[76:79], v31, s[24:27], s40 offen
    s_waitcnt vmcnt(23)
    ds_write_b128 v10, v[84:87] offset:0
    ds_read_b64_tr_b16 a[178:179], v30 offset:0
    ds_read_b64_tr_b16 a[186:187], v30 offset:32
    s_waitcnt lgkmcnt(5)
    s_barrier
    s_mov_b32 s40, 0x20000
    buffer_load_dwordx4 v[80:83], v31, s[24:27], s40 offen
    s_waitcnt vmcnt(23)
    ds_write_b128 v10, v[88:91] offset:0
    ds_read_b64_tr_b16 a[180:181], v30 offset:0
    ds_read_b64_tr_b16 a[188:189], v30 offset:32
    s_mov_b32 s40, 0x28000
    buffer_load_dwordx4 v[84:87], v31, s[24:27], s40 offen
    s_waitcnt vmcnt(23)
    ds_write_b128 v10, v[92:95] offset:0
    ds_read_b64_tr_b16 a[182:183], v30 offset:0
    ds_read_b64_tr_b16 a[190:191], v30 offset:32
    s_waitcnt lgkmcnt(5)
    s_barrier
    s_mov_b32 s40, 0x30000
    buffer_load_dwordx4 v[88:91], v31, s[24:27], s40 offen
    s_waitcnt vmcnt(23)
    ds_write_b128 v10, v[96:99] offset:0
    ds_read_b64_tr_b16 a[192:193], v30 offset:0
    ds_read_b64_tr_b16 a[200:201], v30 offset:32
    s_mov_b32 s40, 0x38000
    buffer_load_dwordx4 v[92:95], v31, s[24:27], s40 offen
    s_waitcnt vmcnt(23)
    ds_write_b128 v10, v[100:103] offset:0
    ds_read_b64_tr_b16 a[194:195], v30 offset:0
    ds_read_b64_tr_b16 a[202:203], v30 offset:32
    s_waitcnt lgkmcnt(5)
    s_barrier
    s_mov_b32 s40, 0x40000
    buffer_load_dwordx4 v[96:99], v31, s[24:27], s40 offen
    s_waitcnt vmcnt(23)
    ds_write_b128 v10, v[104:107] offset:0
    ds_read_b64_tr_b16 a[196:197], v30 offset:0
    ds_read_b64_tr_b16 a[204:205], v30 offset:32
    s_mov_b32 s40, 0x48000
    buffer_load_dwordx4 v[100:103], v31, s[24:27], s40 offen
    s_waitcnt vmcnt(23)
    ds_write_b128 v10, v[108:111] offset:0
    ds_read_b64_tr_b16 a[198:199], v30 offset:0
    ds_read_b64_tr_b16 a[206:207], v30 offset:32
    s_waitcnt lgkmcnt(5)
    s_barrier
    s_mov_b32 s40, 0x50000
    buffer_load_dwordx4 v[104:107], v31, s[24:27], s40 offen
    s_waitcnt vmcnt(23)
    ds_write_b128 v10, v[112:115] offset:0
    ds_read_b64_tr_b16 a[208:209], v30 offset:0
    ds_read_b64_tr_b16 a[216:217], v30 offset:32
    s_mov_b32 s40, 0x58000
    buffer_load_dwordx4 v[108:111], v31, s[24:27], s40 offen
    s_waitcnt vmcnt(23)
    ds_write_b128 v10, v[116:119] offset:0
    ds_read_b64_tr_b16 a[210:211], v30 offset:0
    ds_read_b64_tr_b16 a[218:219], v30 offset:32
    s_waitcnt lgkmcnt(5)
    s_barrier
    s_mov_b32 s40, 0x60000
    buffer_load_dwordx4 v[112:115], v31, s[24:27], s40 offen
    s_waitcnt vmcnt(23)
    ds_write_b128 v10, v[120:123] offset:0
    ds_read_b64_tr_b16 a[212:213], v30 offset:0
    ds_read_b64_tr_b16 a[220:221], v30 offset:32
    s_mov_b32 s40, 0x68000
    buffer_load_dwordx4 v[116:119], v31, s[24:27], s40 offen
    s_waitcnt vmcnt(22)
    s_barrier
    s_cmp_eq_u32 s3, 0
    s_cbranch_scc0 L_r1_id
    v_mov_b32 v29, 1
    s_mov_b64 exec, 1
    buffer_atomic_add v29, off, s[12:15], s7
    s_mov_b64 exec, -1
L_r1_id:
    ds_write_b128 v10, v[124:127] offset:0
    ds_read_b64_tr_b16 a[214:215], v30 offset:0
    ds_read_b64_tr_b16 a[222:223], v30 offset:32
    s_waitcnt lgkmcnt(5)
    s_barrier
    s_mov_b32 s40, 0x70000
    buffer_load_dwordx4 v[120:123], v31, s[24:27], s40 offen
    s_waitcnt vmcnt(22)
    ds_write_b128 v10, v[32:35] offset:0
    ds_read_b64_tr_b16 a[224:225], v30 offset:0
    ds_read_b64_tr_b16 a[232:233], v30 offset:32
    s_mov_b32 s40, 0x78000
    buffer_load_dwordx4 v[124:127], v31, s[24:27], s40 offen
    s_waitcnt vmcnt(22)
    ds_write_b128 v10, v[36:39] offset:0
    ds_read_b64_tr_b16 a[226:227], v30 offset:0
    ds_read_b64_tr_b16 a[234:235], v30 offset:32
    s_waitcnt lgkmcnt(5)
    s_barrier
    s_mov_b32 s40, 0x80000
    buffer_load_dwordx4 v[32:35], v31, s[24:27], s40 offen
    s_waitcnt vmcnt(22)
    ds_write_b128 v10, v[40:43] offset:0
    ds_read_b64_tr_b16 a[228:229], v30 offset:0
    ds_read_b64_tr_b16 a[236:237], v30 offset:32
    s_mov_b32 s40, 0x88000
    buffer_load_dwordx4 v[36:39], v31, s[24:27], s40 offen
    s_waitcnt vmcnt(22)
    ds_write_b128 v10, v[44:47] offset:0
    ds_read_b64_tr_b16 a[230:231], v30 offset:0
    ds_read_b64_tr_b16 a[238:239], v30 offset:32
    s_waitcnt lgkmcnt(5)
    s_barrier
    s_mov_b32 s40, 0x90000
    buffer_load_dwordx4 v[40:43], v31, s[24:27], s40 offen
    s_waitcnt vmcnt(22)
    ds_write_b128 v10, v[48:51] offset:0
    ds_read_b64_tr_b16 a[240:241], v30 offset:0
    ds_read_b64_tr_b16 a[248:249], v30 offset:32
    s_mov_b32 s40, 0x98000
    buffer_load_dwordx4 v[44:47], v31, s[24:27], s40 offen
    s_waitcnt vmcnt(22)
    ds_write_b128 v10, v[52:55] offset:0
    ds_read_b64_tr_b16 a[242:243], v30 offset:0
    ds_read_b64_tr_b16 a[250:251], v30 offset:32
    s_waitcnt lgkmcnt(5)
    s_barrier
    s_mov_b32 s40, 0xa0000
    buffer_load_dwordx4 v[48:51], v31, s[24:27], s40 offen
    s_waitcnt vmcnt(22)
    ds_write_b128 v10, v[56:59] offset:0
    ds_read_b64_tr_b16 a[244:245], v30 offset:0
    ds_read_b64_tr_b16 a[252:253], v30 offset:32
    s_mov_b32 s40, 0xa8000
    buffer_load_dwordx4 v[52:55], v31, s[24:27], s40 offen
    s_waitcnt vmcnt(22)
    ds_write_b128 v10, v[60:63] offset:0
    ds_read_b64_tr_b16 a[246:247], v30 offset:0
    ds_read_b64_tr_b16 a[254:255], v30 offset:32
    s_waitcnt lgkmcnt(5)
    s_barrier
    s_mov_b32 s40, 0xb0000
    buffer_load_dwordx4 v[56:59], v31, s[24:27], s40 offen
    s_waitcnt vmcnt(22)
    ds_write_b128 v10, v[64:67] offset:0
    ds_read_b64_tr_b16 v[128:129], v30 offset:0
    ds_read_b64_tr_b16 v[136:137], v30 offset:32
    s_mov_b32 s40, 0xb8000
    buffer_load_dwordx4 v[60:63], v31, s[24:27], s40 offen
    s_waitcnt vmcnt(22)
    ds_write_b128 v10, v[68:71] offset:0
    ds_read_b64_tr_b16 v[130:131], v30 offset:0
    ds_read_b64_tr_b16 v[138:139], v30 offset:32
    s_waitcnt lgkmcnt(5)
    s_barrier
    s_mov_b32 s40, 0xc0000
    buffer_load_dwordx4 v[64:67], v31, s[24:27], s40 offen
    s_waitcnt vmcnt(22)
    ds_write_b128 v10, v[72:75] offset:0
    ds_read_b64_tr_b16 v[132:133], v30 offset:0
    ds_read_b64_tr_b16 v[140:141], v30 offset:32
    s_mov_b32 s40, 0xc8000
    buffer_load_dwordx4 v[68:71], v31, s[24:27], s40 offen
    s_waitcnt vmcnt(22)
    ds_write_b128 v10, v[76:79] offset:0
    ds_read_b64_tr_b16 v[134:135], v30 offset:0
    ds_read_b64_tr_b16 v[142:143], v30 offset:32
    s_waitcnt lgkmcnt(5)
    s_barrier
    s_mov_b32 s40, 0xd0000
    buffer_load_dwordx4 v[72:75], v31, s[24:27], s40 offen
    s_waitcnt vmcnt(22)
    ds_write_b128 v10, v[80:83] offset:0
    ds_read_b64_tr_b16 v[144:145], v30 offset:0
    ds_read_b64_tr_b16 v[152:153], v30 offset:32
    s_mov_b32 s40, 0xd8000
    buffer_load_dwordx4 v[76:79], v31, s[24:27], s40 offen
    s_waitcnt vmcnt(22)
    ds_write_b128 v10, v[84:87] offset:0
    ds_read_b64_tr_b16 v[146:147], v30 offset:0
    ds_read_b64_tr_b16 v[154:155], v30 offset:32
    s_waitcnt lgkmcnt(5)
    s_barrier
    s_mov_b32 s40, 0xe0000
    buffer_load_dwordx4 v[80:83], v31, s[24:27], s40 offen
    s_waitcnt vmcnt(22)
    ds_write_b128 v10, v[88:91] offset:0
    ds_read_b64_tr_b16 v[148:149], v30 offset:0
    ds_read_b64_tr_b16 v[156:157], v30 offset:32
    s_mov_b32 s40, 0xe8000
    buffer_load_dwordx4 v[84:87], v31, s[24:27], s40 offen
    s_waitcnt vmcnt(22)
    ds_write_b128 v10, v[92:95] offset:0
    ds_read_b64_tr_b16 v[150:151], v30 offset:0
    ds_read_b64_tr_b16 v[158:159], v30 offset:32
    s_waitcnt lgkmcnt(5)
    s_barrier
    s_mov_b32 s40, 0xf0000
    buffer_load_dwordx4 v[88:91], v31, s[24:27], s40 offen
    s_waitcnt vmcnt(22)
    ds_write_b128 v10, v[96:99] offset:0
    ds_read_b64_tr_b16 v[160:161], v30 offset:0
    ds_read_b64_tr_b16 v[168:169], v30 offset:32
    s_mov_b32 s40, 0xf8000
    buffer_load_dwordx4 v[92:95], v31, s[24:27], s40 offen
    s_waitcnt vmcnt(22)
    ds_write_b128 v10, v[100:103] offset:0
    ds_read_b64_tr_b16 v[162:163], v30 offset:0
    ds_read_b64_tr_b16 v[170:171], v30 offset:32
    s_waitcnt lgkmcnt(5)
    s_barrier
    s_waitcnt vmcnt(21)
    ds_write_b128 v10, v[104:107] offset:0
    ds_read_b64_tr_b16 v[164:165], v30 offset:0
    ds_read_b64_tr_b16 v[172:173], v30 offset:32
    s_waitcnt vmcnt(20)
    ds_write_b128 v10, v[108:111] offset:0
    ds_read_b64_tr_b16 v[166:167], v30 offset:0
    ds_read_b64_tr_b16 v[174:175], v30 offset:32
    s_waitcnt lgkmcnt(5)
    s_barrier
    s_waitcnt vmcnt(19)
    ds_write_b128 v10, v[112:115] offset:0
    ds_read_b64_tr_b16 v[176:177], v30 offset:0
    ds_read_b64_tr_b16 v[184:185], v30 offset:32
    s_waitcnt vmcnt(18)
    ds_write_b128 v10, v[116:119] offset:0
    ds_read_b64_tr_b16 v[178:179], v30 offset:0
    ds_read_b64_tr_b16 v[186:187], v30 offset:32
    s_waitcnt lgkmcnt(5)
    s_barrier
    s_waitcnt vmcnt(17)
    ds_write_b128 v10, v[120:123] offset:0
    ds_read_b64_tr_b16 v[180:181], v30 offset:0
    ds_read_b64_tr_b16 v[188:189], v30 offset:32
    s_waitcnt vmcnt(16)
    ds_write_b128 v10, v[124:127] offset:0
    ds_read_b64_tr_b16 v[182:183], v30 offset:0
    ds_read_b64_tr_b16 v[190:191], v30 offset:32
    s_waitcnt lgkmcnt(5)
    s_barrier
    s_waitcnt vmcnt(15)
    ds_write_b128 v10, v[32:35] offset:0
    ds_read_b64_tr_b16 v[192:193], v30 offset:0
    ds_read_b64_tr_b16 v[200:201], v30 offset:32
    s_waitcnt vmcnt(14)
    ds_write_b128 v10, v[36:39] offset:0
    ds_read_b64_tr_b16 v[194:195], v30 offset:0
    ds_read_b64_tr_b16 v[202:203], v30 offset:32
    s_waitcnt lgkmcnt(5)
    s_barrier
    s_waitcnt vmcnt(13)
    ds_write_b128 v10, v[40:43] offset:0
    ds_read_b64_tr_b16 v[196:197], v30 offset:0
    ds_read_b64_tr_b16 v[204:205], v30 offset:32
    s_waitcnt vmcnt(12)
    ds_write_b128 v10, v[44:47] offset:0
    ds_read_b64_tr_b16 v[198:199], v30 offset:0
    ds_read_b64_tr_b16 v[206:207], v30 offset:32
    s_waitcnt lgkmcnt(5)
    s_barrier
    s_waitcnt vmcnt(11)
    ds_write_b128 v10, v[48:51] offset:0
    ds_read_b64_tr_b16 v[208:209], v30 offset:0
    ds_read_b64_tr_b16 v[216:217], v30 offset:32
    s_waitcnt vmcnt(10)
    ds_write_b128 v10, v[52:55] offset:0
    ds_read_b64_tr_b16 v[210:211], v30 offset:0
    ds_read_b64_tr_b16 v[218:219], v30 offset:32
    s_waitcnt lgkmcnt(5)
    s_barrier
    s_waitcnt vmcnt(9)
    ds_write_b128 v10, v[56:59] offset:0
    ds_read_b64_tr_b16 v[212:213], v30 offset:0
    ds_read_b64_tr_b16 v[220:221], v30 offset:32
    s_waitcnt vmcnt(8)
    ds_write_b128 v10, v[60:63] offset:0
    ds_read_b64_tr_b16 v[214:215], v30 offset:0
    ds_read_b64_tr_b16 v[222:223], v30 offset:32
    s_waitcnt lgkmcnt(5)
    s_barrier
    s_waitcnt vmcnt(7)
    ds_write_b128 v10, v[64:67] offset:0
    ds_read_b64_tr_b16 v[224:225], v30 offset:0
    ds_read_b64_tr_b16 v[232:233], v30 offset:32
    s_waitcnt vmcnt(6)
    ds_write_b128 v10, v[68:71] offset:0
    ds_read_b64_tr_b16 v[226:227], v30 offset:0
    ds_read_b64_tr_b16 v[234:235], v30 offset:32
    s_waitcnt lgkmcnt(5)
    s_barrier
    s_waitcnt vmcnt(5)
    ds_write_b128 v10, v[72:75] offset:0
    ds_read_b64_tr_b16 v[228:229], v30 offset:0
    ds_read_b64_tr_b16 v[236:237], v30 offset:32
    s_waitcnt vmcnt(4)
    ds_write_b128 v10, v[76:79] offset:0
    ds_read_b64_tr_b16 v[230:231], v30 offset:0
    ds_read_b64_tr_b16 v[238:239], v30 offset:32
    s_waitcnt lgkmcnt(5)
    s_barrier
    s_waitcnt vmcnt(3)
    ds_write_b128 v10, v[80:83] offset:0
    ds_read_b64_tr_b16 v[240:241], v30 offset:0
    ds_read_b64_tr_b16 v[248:249], v30 offset:32
    s_waitcnt vmcnt(2)
    ds_write_b128 v10, v[84:87] offset:0
    ds_read_b64_tr_b16 v[242:243], v30 offset:0
    ds_read_b64_tr_b16 v[250:251], v30 offset:32
    s_waitcnt lgkmcnt(5)
    s_barrier
    s_waitcnt vmcnt(1)
    ds_write_b128 v10, v[88:91] offset:0
    ds_read_b64_tr_b16 v[244:245], v30 offset:0
    ds_read_b64_tr_b16 v[252:253], v30 offset:32
    s_waitcnt vmcnt(0)
    ds_write_b128 v10, v[92:95] offset:0
    ds_read_b64_tr_b16 v[246:247], v30 offset:0
    ds_read_b64_tr_b16 v[254:255], v30 offset:32
    s_waitcnt lgkmcnt(5)
    s_barrier
    s_waitcnt lgkmcnt(0)
    s_barrier
    v_and_b32 v15, 0, v0
    v_add_u32 v15, v15, v0
    s_mov_b32 s38, -1
L_r1_loop:
    s_cmp_eq_u32 s38, 15
    s_cbranch_scc1 L_r1_att
    s_add_u32 s50, s38, 1
    s_and_b32 s40, s50, 1
    s_mul_i32 s41, s40, 33280
    v_add_u32 v2, s41, v1
    s_sub_u32 s42, 33280, s41
    s_mul_i32 s40, s40, 24576
    s_lshl_b32 s41, s3, 11
    s_add_u32 s40, s40, s41
    s_add_u32 s40, s40, 66560
    v_add_u32 v4, s40, v0
    v_add_u32 v8, s40, v7
    ds_read_b128 v[80:83], v2 offset:0
    ds_read_b128 v[84:87], v2 offset:16640
    s_cmp_eq_u32 s50, 15
    s_cbranch_scc1 L_r1_nodma
    s_mul_i32 s40, s3, 8320
    s_add_u32 m0, s40, s42
    s_mov_b32 s41, s39
    buffer_load_dwordx4 v0, s[28:31], s41 offen lds
    s_add_u32 m0, m0, 1040
    s_add_u32 s41, s41, 1024
    buffer_load_dwordx4 v0, s[28:31], s41 offen lds
    s_add_u32 m0, m0, 1040
    s_add_u32 s41, s41, 1024
    buffer_load_dwordx4 v0, s[28:31], s41 offen lds
    s_add_u32 m0, m0, 1040
    s_add_u32 s41, s41, 1024
    buffer_load_dwordx4 v0, s[28:31], s41 offen lds
    s_add_u32 m0, m0, 1040
    s_add_u32 s41, s41, 1024
    buffer_load_dwordx4 v0, s[28:31], s41 offen lds
    s_add_u32 m0, m0, 1040
    s_add_u32 s41, s41, 1024
    buffer_load_dwordx4 v0, s[28:31], s41 offen lds
    s_add_u32 m0, m0, 1040
    s_add_u32 s41, s41, 1024
    buffer_load_dwordx4 v0, s[28:31], s41 offen lds
    s_add_u32 m0, m0, 1040
    s_add_u32 s41, s41, 1024
    buffer_load_dwordx4 v0, s[28:31], s41 offen lds
    s_add_u32 s39, s39, 0x20000
    s_branch L_r1_go
L_r1_nodma:
    s_add_u32 s40, s44, 0x100000
    v_mov_b64 v[96:97], 0
    v_mov_b64 v[98:99], 0
    buffer_store_dwordx4 v[96:99], v15, s[8:11], s40 offen offset:0 sc1
    buffer_store_dwordx4 v[96:99], v15, s[8:11], s40 offen offset:1024 sc1
L_r1_go:
    s_waitcnt lgkmcnt(0)
    v_mfma_f32_16x16x32_bf16 v[48:51], a[128:131], v[80:83], 0
    ds_read_b128 v[88:91], v2 offset:16
    ds_read_b128 v[92:95], v2 offset:16656
    v_mfma_f32_16x16x32_bf16 v[52:55], a[128:131], v[84:87], 0
    v_mfma_f32_16x16x32_bf16 v[56:59], a[136:139], v[80:83], 0
    v_mfma_f32_16x16x32_bf16 v[60:63], a[136:139], v[84:87], 0
    v_mfma_f32_16x16x32_bf16 v[64:67], v[80:83], v[128:131], 0
    v_mfma_f32_16x16x32_bf16 v[68:71], v[84:87], v[128:131], 0
    v_mfma_f32_16x16x32_bf16 v[72:75], v[80:83], v[136:139], 0
    v_mfma_f32_16x16x32_bf16 v[76:79], v[84:87], v[136:139], 0
    s_waitcnt lgkmcnt(0)
    v_mfma_f32_16x16x32_bf16 v[48:51], a[132:135], v[88:91], v[48:51]
    ds_read_b128 v[80:83], v2 offset:32
    ds_read_b128 v[84:87], v2 offset:16672
    v_mfma_f32_16x16x32_bf16 v[52:55], a[132:135], v[92:95], v[52:55]
    v_mfma_f32_16x16x32_bf16 v[56:59], a[140:143], v[88:91], v[56:59]
    v_mfma_f32_16x16x32_bf16 v[60:63], a[140:143], v[92:95], v[60:63]
    v_mfma_f32_16x16x32_bf16 v[64:67], v[88:91], v[132:135], v[64:67]
    v_mfma_f32_16x16x32_bf16 v[68:71], v[92:95], v[132:135], v[68:71]
    v_mfma_f32_16x16x32_bf16 v[72:75], v[88:91], v[140:143], v[72:75]
    v_mfma_f32_16x16x32_bf16 v[76:79], v[92:95], v[140:143], v[76:79]
    s_waitcnt lgkmcnt(0)
    v_mfma_f32_16x16x32_bf16 v[48:51], a[144:147], v[80:83], v[48:51]
    ds_read_b128 v[88:91], v2 offset:48
    ds_read_b128 v[92:95], v2 offset:16688
    v_mfma_f32_16x16x32_bf16 v[52:55], a[144:147], v[84:87], v[52:55]
    v_mfma_f32_16x16x32_bf16 v[56:59], a[152:155], v[80:83], v[56:59]
    v_mfma_f32_16x16x32_bf16 v[60:63], a[152:155], v[84:87], v[60:63]
    v_mfma_f32_16x16x32_bf16 v[64:67], v[80:83], v[144:147], v[64:67]
    v_mfma_f32_16x16x32_bf16 v[68:71], v[84:87], v[144:147], v[68:71]
    v_mfma_f32_16x16x32_bf16 v[72:75], v[80:83], v[152:155], v[72:75]
    v_mfma_f32_16x16x32_bf16 v[76:79], v[84:87], v[152:155], v[76:79]
    s_waitcnt lgkmcnt(0)
    v_mfma_f32_16x16x32_bf16 v[48:51], a[148:151], v[88:91], v[48:51]
    ds_read_b128 v[80:83], v2 offset:64
    ds_read_b128 v[84:87], v2 offset:16704
    v_mfma_f32_16x16x32_bf16 v[52:55], a[148:151], v[92:95], v[52:55]
    v_mfma_f32_16x16x32_bf16 v[56:59], a[156:159], v[88:91], v[56:59]
    v_mfma_f32_16x16x32_bf16 v[60:63], a[156:159], v[92:95], v[60:63]
    v_mfma_f32_16x16x32_bf16 v[64:67], v[88:91], v[148:151], v[64:67]
    v_mfma_f32_16x16x32_bf16 v[68:71], v[92:95], v[148:151], v[68:71]
    v_mfma_f32_16x16x32_bf16 v[72:75], v[88:91], v[156:159], v[72:75]
    v_mfma_f32_16x16x32_bf16 v[76:79], v[92:95], v[156:159], v[76:79]
    s_waitcnt lgkmcnt(0)
    v_mfma_f32_16x16x32_bf16 v[48:51], a[160:163], v[80:83], v[48:51]
    ds_read_b128 v[88:91], v2 offset:80
    ds_read_b128 v[92:95], v2 offset:16720
    v_mfma_f32_16x16x32_bf16 v[52:55], a[160:163], v[84:87], v[52:55]
    v_mfma_f32_16x16x32_bf16 v[56:59], a[168:171], v[80:83], v[56:59]
    v_mfma_f32_16x16x32_bf16 v[60:63], a[168:171], v[84:87], v[60:63]
    v_mfma_f32_16x16x32_bf16 v[64:67], v[80:83], v[160:163], v[64:67]
    v_mfma_f32_16x16x32_bf16 v[68:71], v[84:87], v[160:163], v[68:71]
    v_mfma_f32_16x16x32_bf16 v[72:75], v[80:83], v[168:171], v[72:75]
    v_mfma_f32_16x16x32_bf16 v[76:79], v[84:87], v[168:171], v[76:79]
    s_waitcnt lgkmcnt(0)
    v_mfma_f32_16x16x32_bf16 v[48:51], a[164:167], v[88:91], v[48:51]
    ds_read_b128 v[80:83], v2 offset:96
    ds_read_b128 v[84:87], v2 offset:16736
    v_mfma_f32_16x16x32_bf16 v[52:55], a[164:167], v[92:95], v[52:55]
    v_mfma_f32_16x16x32_bf16 v[56:59], a[172:175], v[88:91], v[56:59]
    v_mfma_f32_16x16x32_bf16 v[60:63], a[172:175], v[92:95], v[60:63]
    v_mfma_f32_16x16x32_bf16 v[64:67], v[88:91], v[164:167], v[64:67]
    v_mfma_f32_16x16x32_bf16 v[68:71], v[92:95], v[164:167], v[68:71]
    v_mfma_f32_16x16x32_bf16 v[72:75], v[88:91], v[172:175], v[72:75]
    v_mfma_f32_16x16x32_bf16 v[76:79], v[92:95], v[172:175], v[76:79]
    s_waitcnt lgkmcnt(0)
    v_mfma_f32_16x16x32_bf16 v[48:51], a[176:179], v[80:83], v[48:51]
    ds_read_b128 v[88:91], v2 offset:112
    ds_read_b128 v[92:95], v2 offset:16752
    v_mfma_f32_16x16x32_bf16 v[52:55], a[176:179], v[84:87], v[52:55]
    v_mfma_f32_16x16x32_bf16 v[56:59], a[184:187], v[80:83], v[56:59]
    v_mfma_f32_16x16x32_bf16 v[60:63], a[184:187], v[84:87], v[60:63]
    v_mfma_f32_16x16x32_bf16 v[64:67], v[80:83], v[176:179], v[64:67]
    v_mfma_f32_16x16x32_bf16 v[68:71], v[84:87], v[176:179], v[68:71]
    v_mfma_f32_16x16x32_bf16 v[72:75], v[80:83], v[184:187], v[72:75]
    v_mfma_f32_16x16x32_bf16 v[76:79], v[84:87], v[184:187], v[76:79]
    s_waitcnt lgkmcnt(0)
    v_mfma_f32_16x16x32_bf16 v[48:51], a[180:183], v[88:91], v[48:51]
    ds_read_b128 v[80:83], v2 offset:128
    ds_read_b128 v[84:87], v2 offset:16768
    v_mfma_f32_16x16x32_bf16 v[52:55], a[180:183], v[92:95], v[52:55]
    v_mfma_f32_16x16x32_bf16 v[56:59], a[188:191], v[88:91], v[56:59]
    v_mfma_f32_16x16x32_bf16 v[60:63], a[188:191], v[92:95], v[60:63]
    v_mfma_f32_16x16x32_bf16 v[64:67], v[88:91], v[180:183], v[64:67]
    v_mfma_f32_16x16x32_bf16 v[68:71], v[92:95], v[180:183], v[68:71]
    v_mfma_f32_16x16x32_bf16 v[72:75], v[88:91], v[188:191], v[72:75]
    v_mfma_f32_16x16x32_bf16 v[76:79], v[92:95], v[188:191], v[76:79]
    s_waitcnt lgkmcnt(0)
    v_mfma_f32_16x16x32_bf16 v[48:51], a[192:195], v[80:83], v[48:51]
    ds_read_b128 v[88:91], v2 offset:144
    ds_read_b128 v[92:95], v2 offset:16784
    v_mfma_f32_16x16x32_bf16 v[52:55], a[192:195], v[84:87], v[52:55]
    v_mfma_f32_16x16x32_bf16 v[56:59], a[200:203], v[80:83], v[56:59]
    v_mfma_f32_16x16x32_bf16 v[60:63], a[200:203], v[84:87], v[60:63]
    v_mfma_f32_16x16x32_bf16 v[64:67], v[80:83], v[192:195], v[64:67]
    v_mfma_f32_16x16x32_bf16 v[68:71], v[84:87], v[192:195], v[68:71]
    v_mfma_f32_16x16x32_bf16 v[72:75], v[80:83], v[200:203], v[72:75]
    v_mfma_f32_16x16x32_bf16 v[76:79], v[84:87], v[200:203], v[76:79]
    s_waitcnt lgkmcnt(0)
    v_mfma_f32_16x16x32_bf16 v[48:51], a[196:199], v[88:91], v[48:51]
    ds_read_b128 v[80:83], v2 offset:160
    ds_read_b128 v[84:87], v2 offset:16800
    v_mfma_f32_16x16x32_bf16 v[52:55], a[196:199], v[92:95], v[52:55]
    v_mfma_f32_16x16x32_bf16 v[56:59], a[204:207], v[88:91], v[56:59]
    v_mfma_f32_16x16x32_bf16 v[60:63], a[204:207], v[92:95], v[60:63]
    v_mfma_f32_16x16x32_bf16 v[64:67], v[88:91], v[196:199], v[64:67]
    v_mfma_f32_16x16x32_bf16 v[68:71], v[92:95], v[196:199], v[68:71]
    v_mfma_f32_16x16x32_bf16 v[72:75], v[88:91], v[204:207], v[72:75]
    v_mfma_f32_16x16x32_bf16 v[76:79], v[92:95], v[204:207], v[76:79]
    s_waitcnt lgkmcnt(0)
    v_mfma_f32_16x16x32_bf16 v[48:51], a[208:211], v[80:83], v[48:51]
    ds_read_b128 v[88:91], v2 offset:176
    ds_read_b128 v[92:95], v2 offset:16816
    v_mfma_f32_16x16x32_bf16 v[52:55], a[208:211], v[84:87], v[52:55]
    v_mfma_f32_16x16x32_bf16 v[56:59], a[216:219], v[80:83], v[56:59]
    v_mfma_f32_16x16x32_bf16 v[60:63], a[216:219], v[84:87], v[60:63]
    v_mfma_f32_16x16x32_bf16 v[64:67], v[80:83], v[208:211], v[64:67]
    v_mfma_f32_16x16x32_bf16 v[68:71], v[84:87], v[208:211], v[68:71]
    v_mfma_f32_16x16x32_bf16 v[72:75], v[80:83], v[216:219], v[72:75]
    v_mfma_f32_16x16x32_bf16 v[76:79], v[84:87], v[216:219], v[76:79]
    s_waitcnt lgkmcnt(0)
    v_mfma_f32_16x16x32_bf16 v[48:51], a[212:215], v[88:91], v[48:51]
    ds_read_b128 v[80:83], v2 offset:192
    ds_read_b128 v[84:87], v2 offset:16832
    v_mfma_f32_16x16x32_bf16 v[52:55], a[212:215], v[92:95], v[52:55]
    v_mfma_f32_16x16x32_bf16 v[56:59], a[220:223], v[88:91], v[56:59]
    v_mfma_f32_16x16x32_bf16 v[60:63], a[220:223], v[92:95], v[60:63]
    v_mfma_f32_16x16x32_bf16 v[64:67], v[88:91], v[212:215], v[64:67]
    v_mfma_f32_16x16x32_bf16 v[68:71], v[92:95], v[212:215], v[68:71]
    v_mfma_f32_16x16x32_bf16 v[72:75], v[88:91], v[220:223], v[72:75]
    v_mfma_f32_16x16x32_bf16 v[76:79], v[92:95], v[220:223], v[76:79]
    s_waitcnt lgkmcnt(0)
    v_mfma_f32_16x16x32_bf16 v[48:51], a[224:227], v[80:83], v[48:51]
    ds_read_b128 v[88:91], v2 offset:208
    ds_read_b128 v[92:95], v2 offset:16848
    v_mfma_f32_16x16x32_bf16 v[52:55], a[224:227], v[84:87], v[52:55]
    v_mfma_f32_16x16x32_bf16 v[56:59], a[232:235], v[80:83], v[56:59]
    v_mfma_f32_16x16x32_bf16 v[60:63], a[232:235], v[84:87], v[60:63]
    v_mfma_f32_16x16x32_bf16 v[64:67], v[80:83], v[224:227], v[64:67]
    v_mfma_f32_16x16x32_bf16 v[68:71], v[84:87], v[224:227], v[68:71]
    v_mfma_f32_16x16x32_bf16 v[72:75], v[80:83], v[232:235], v[72:75]
    v_mfma_f32_16x16x32_bf16 v[76:79], v[84:87], v[232:235], v[76:79]
    s_waitcnt lgkmcnt(0)
    v_mfma_f32_16x16x32_bf16 v[48:51], a[228:231], v[88:91], v[48:51]
    ds_read_b128 v[80:83], v2 offset:224
    ds_read_b128 v[84:87], v2 offset:16864
    v_mfma_f32_16x16x32_bf16 v[52:55], a[228:231], v[92:95], v[52:55]
    v_mfma_f32_16x16x32_bf16 v[56:59], a[236:239], v[88:91], v[56:59]
    v_mfma_f32_16x16x32_bf16 v[60:63], a[236:239], v[92:95], v[60:63]
    v_mfma_f32_16x16x32_bf16 v[64:67], v[88:91], v[228:231], v[64:67]
    v_mfma_f32_16x16x32_bf16 v[68:71], v[92:95], v[228:231], v[68:71]
    v_mfma_f32_16x16x32_bf16 v[72:75], v[88:91], v[236:239], v[72:75]
    v_mfma_f32_16x16x32_bf16 v[76:79], v[92:95], v[236:239], v[76:79]
    s_waitcnt lgkmcnt(0)
    v_mfma_f32_16x16x32_bf16 v[48:51], a[240:243], v[80:83], v[48:51]
    ds_read_b128 v[88:91], v2 offset:240
    ds_read_b128 v[92:95], v2 offset:16880
    v_mfma_f32_16x16x32_bf16 v[52:55], a[240:243], v[84:87], v[52:55]
    v_mfma_f32_16x16x32_bf16 v[56:59], a[248:251], v[80:83], v[56:59]
    v_mfma_f32_16x16x32_bf16 v[60:63], a[248:251], v[84:87], v[60:63]
    v_mfma_f32_16x16x32_bf16 v[64:67], v[80:83], v[240:243], v[64:67]
    v_mfma_f32_16x16x32_bf16 v[68:71], v[84:87], v[240:243], v[68:71]
    v_mfma_f32_16x16x32_bf16 v[72:75], v[80:83], v[248:251], v[72:75]
    v_mfma_f32_16x16x32_bf16 v[76:79], v[84:87], v[248:251], v[76:79]
    s_waitcnt lgkmcnt(0)
    v_mfma_f32_16x16x32_bf16 v[48:51], a[244:247], v[88:91], v[48:51]
    v_mfma_f32_16x16x32_bf16 v[52:55], a[244:247], v[92:95], v[52:55]
    v_mfma_f32_16x16x32_bf16 v[56:59], a[252:255], v[88:91], v[56:59]
    v_mfma_f32_16x16x32_bf16 v[60:63], a[252:255], v[92:95], v[60:63]
    v_mfma_f32_16x16x32_bf16 v[64:67], v[88:91], v[244:247], v[64:67]
    v_mfma_f32_16x16x32_bf16 v[68:71], v[92:95], v[244:247], v[68:71]
    v_mfma_f32_16x16x32_bf16 v[72:75], v[88:91], v[252:255], v[72:75]
    v_mfma_f32_16x16x32_bf16 v[76:79], v[92:95], v[252:255], v[76:79]
    v_cvt_pk_bf16_f32 v96, v48, v49
    v_cvt_pk_bf16_f32 v97, v50, v51
    v_cvt_pk_bf16_f32 v98, v56, v57
    v_cvt_pk_bf16_f32 v99, v58, v59
    ds_write_b128 v4, v[96:99] offset:8192
    v_cvt_pk_bf16_f32 v100, v52, v53
    v_cvt_pk_bf16_f32 v101, v54, v55
    v_cvt_pk_bf16_f32 v102, v60, v61
    v_cvt_pk_bf16_f32 v103, v62, v63
    ds_write_b128 v4, v[100:103] offset:9216
    ds_read_b128 v[112:115], v8 offset:8192
    ds_read_b128 v[116:119], v8 offset:8224
    v_cvt_pk_bf16_f32 v104, v64, v65
    v_cvt_pk_bf16_f32 v105, v66, v67
    v_cvt_pk_bf16_f32 v106, v68, v69
    v_cvt_pk_bf16_f32 v107, v70, v71
    buffer_store_dwordx4 v[104:107], v0, s[8:11], s43 offen offset:2048 sc1
    v_cvt_pk_bf16_f32 v108, v72, v73
    v_cvt_pk_bf16_f32 v109, v74, v75
    v_cvt_pk_bf16_f32 v110, v76, v77
    v_cvt_pk_bf16_f32 v111, v78, v79
    buffer_store_dwordx4 v[108:111], v0, s[8:11], s43 offen offset:3072 sc1
    ds_write_b128 v4, v[104:107] offset:16384
    ds_write_b128 v4, v[108:111] offset:17408
    s_waitcnt lgkmcnt(2)
    buffer_store_dwordx4 v[112:115], v0, s[8:11], s43 offen offset:0 sc1
    buffer_store_dwordx4 v[116:119], v0, s[8:11], s43 offen offset:1024 sc1
    s_add_u32 s43, s43, 0x200000
    s_add_u32 s50, s50, 1
    s_cmp_eq_u32 s38, -1
    s_cbranch_scc0 L_r1_q
    s_waitcnt vmcnt(0) lgkmcnt(0)
    s_barrier
    s_cmp_eq_u32 s3, 0
    s_cbranch_scc0 L_r1_f0
    v_mov_b32 v64, s50
    s_mov_b64 exec, 1
    buffer_store_dword v64, off, s[8:11], s46 offset:0 sc1
    s_mov_b64 exec, -1
L_r1_f0:
    s_mov_b32 s40, 0x0
    buffer_load_dwordx4 v[32:35], v31, s[16:19], s40 offen
    s_mov_b32 s40, 0x8000
    buffer_load_dwordx4 v[36:39], v31, s[16:19], s40 offen
    s_mov_b32 s40, 0x10000
    buffer_load_dwordx4 v[40:43], v31, s[16:19], s40 offen
    s_mov_b32 s40, 0x18000
    buffer_load_dwordx4 v[44:47], v31, s[16:19], s40 offen
    s_mov_b32 s40, 0x20000
    buffer_load_dwordx4 v[48:51], v31, s[16:19], s40 offen
    s_mov_b32 s40, 0x28000
    buffer_load_dwordx4 v[52:55], v31, s[16:19], s40 offen
    s_mov_b32 s40, 0x30000
    buffer_load_dwordx4 v[56:59], v31, s[16:19], s40 offen
    s_mov_b32 s40, 0x38000
    buffer_load_dwordx4 v[60:63], v31, s[16:19], s40 offen
    s_mov_b32 s40, 0x40000
    buffer_load_dwordx4 v[64:67], v31, s[16:19], s40 offen
    s_mov_b32 s40, 0x48000
    buffer_load_dwordx4 v[68:71], v31, s[16:19], s40 offen
    s_mov_b32 s40, 0x50000
    buffer_load_dwordx4 v[72:75], v31, s[16:19], s40 offen
    s_mov_b32 s40, 0x58000
    buffer_load_dwordx4 v[76:79], v31, s[16:19], s40 offen
    s_mov_b32 s40, 0x60000
    buffer_load_dwordx4 v[80:83], v31, s[16:19], s40 offen
    s_mov_b32 s40, 0x68000
    buffer_load_dwordx4 v[84:87], v31, s[16:19], s40 offen
    s_mov_b32 s40, 0x70000
    buffer_load_dwordx4 v[88:91], v31, s[16:19], s40 offen
    s_mov_b32 s40, 0x78000
    buffer_load_dwordx4 v[92:95], v31, s[16:19], s40 offen
    s_mov_b32 s40, 0x80000
    buffer_load_dwordx4 v[96:99], v31, s[16:19], s40 offen
    s_mov_b32 s40, 0x88000
    buffer_load_dwordx4 v[100:103], v31, s[16:19], s40 offen
    s_mov_b32 s40, 0x90000
    buffer_load_dwordx4 v[104:107], v31, s[16:19], s40 offen
    s_mov_b32 s40, 0x98000
    buffer_load_dwordx4 v[108:111], v31, s[16:19], s40 offen
    s_mov_b32 s40, 0xa0000
    buffer_load_dwordx4 v[112:115], v31, s[16:19], s40 offen
    s_mov_b32 s40, 0xa8000
    buffer_load_dwordx4 v[116:119], v31, s[16:19], s40 offen
    s_mov_b32 s40, 0xb0000
    buffer_load_dwordx4 v[120:123], v31, s[16:19], s40 offen
    s_waitcnt vmcnt(22)
    ds_write_b128 v10, v[32:35] offset:0
    ds_read_b64_tr_b16 a[0:1], v30 offset:0
    ds_read_b64_tr_b16 a[8:9], v30 offset:32
    s_mov_b32 s40, 0xb8000
    buffer_load_dwordx4 v[124:127], v31, s[16:19], s40 offen
    s_waitcnt vmcnt(22)
    ds_write_b128 v10, v[36:39] offset:0
    ds_read_b64_tr_b16 a[2:3], v30 offset:0
    ds_read_b64_tr_b16 a[10:11], v30 offset:32
    s_waitcnt lgkmcnt(5)
    s_barrier
    s_mov_b32 s40, 0xc0000
    buffer_load_dwordx4 v[32:35], v31, s[16:19], s40 offen
    s_waitcnt vmcnt(22)
    ds_write_b128 v10, v[40:43] offset:0
    ds_read_b64_tr_b16 a[4:5], v30 offset:0
    ds_read_b64_tr_b16 a[12:13], v30 offset:32
    s_mov_b32 s40, 0xc8000
    buffer_load_dwordx4 v[36:39], v31, s[16:19], s40 offen
    s_waitcnt vmcnt(22)
    ds_write_b128 v10, v[44:47] offset:0
    ds_read_b64_tr_b16 a[6:7], v30 offset:0
    ds_read_b64_tr_b16 a[14:15], v30 offset:32
    s_waitcnt lgkmcnt(5)
    s_barrier
    s_mov_b32 s40, 0xd0000
    buffer_load_dwordx4 v[40:43], v31, s[16:19], s40 offen
    s_waitcnt vmcnt(22)
    ds_write_b128 v10, v[48:51] offset:0
    ds_read_b64_tr_b16 a[16:17], v30 offset:0
    ds_read_b64_tr_b16 a[24:25], v30 offset:32
    s_mov_b32 s40, 0xd8000
    buffer_load_dwordx4 v[44:47], v31, s[16:19], s40 offen
    s_waitcnt vmcnt(22)
    ds_write_b128 v10, v[52:55] offset:0
    ds_read_b64_tr_b16 a[18:19], v30 offset:0
    ds_read_b64_tr_b16 a[26:27], v30 offset:32
    s_waitcnt lgkmcnt(5)
    s_barrier
    s_mov_b32 s40, 0xe0000
    buffer_load_dwordx4 v[48:51], v31, s[16:19], s40 offen
    s_waitcnt vmcnt(22)
    ds_write_b128 v10, v[56:59] offset:0
    ds_read_b64_tr_b16 a[20:21], v30 offset:0
    ds_read_b64_tr_b16 a[28:29], v30 offset:32
    s_mov_b32 s40, 0xe8000
    buffer_load_dwordx4 v[52:55], v31, s[16:19], s40 offen
    s_waitcnt vmcnt(22)
    ds_write_b128 v10, v[60:63] offset:0
    ds_read_b64_tr_b16 a[22:23], v30 offset:0
    ds_read_b64_tr_b16 a[30:31], v30 offset:32
    s_waitcnt lgkmcnt(5)
    s_barrier
    s_mov_b32 s40, 0xf0000
    buffer_load_dwordx4 v[56:59], v31, s[16:19], s40 offen
    s_waitcnt vmcnt(22)
    ds_write_b128 v10, v[64:67] offset:0
    ds_read_b64_tr_b16 a[32:33], v30 offset:0
    ds_read_b64_tr_b16 a[40:41], v30 offset:32
    s_mov_b32 s40, 0xf8000
    buffer_load_dwordx4 v[60:63], v31, s[16:19], s40 offen
    s_waitcnt vmcnt(22)
    ds_write_b128 v10, v[68:71] offset:0
    ds_read_b64_tr_b16 a[34:35], v30 offset:0
    ds_read_b64_tr_b16 a[42:43], v30 offset:32
    s_waitcnt lgkmcnt(5)
    s_barrier
    s_waitcnt vmcnt(21)
    ds_write_b128 v10, v[72:75] offset:0
    ds_read_b64_tr_b16 a[36:37], v30 offset:0
    ds_read_b64_tr_b16 a[44:45], v30 offset:32
    s_waitcnt vmcnt(20)
    ds_write_b128 v10, v[76:79] offset:0
    ds_read_b64_tr_b16 a[38:39], v30 offset:0
    ds_read_b64_tr_b16 a[46:47], v30 offset:32
    s_waitcnt lgkmcnt(5)
    s_barrier
    s_waitcnt vmcnt(19)
    ds_write_b128 v10, v[80:83] offset:0
    ds_read_b64_tr_b16 a[48:49], v30 offset:0
    ds_read_b64_tr_b16 a[56:57], v30 offset:32
    s_waitcnt vmcnt(18)
    ds_write_b128 v10, v[84:87] offset:0
    ds_read_b64_tr_b16 a[50:51], v30 offset:0
    ds_read_b64_tr_b16 a[58:59], v30 offset:32
    s_waitcnt lgkmcnt(5)
    s_barrier
    s_waitcnt vmcnt(17)
    ds_write_b128 v10, v[88:91] offset:0
    ds_read_b64_tr_b16 a[52:53], v30 offset:0
    ds_read_b64_tr_b16 a[60:61], v30 offset:32
    s_waitcnt vmcnt(16)
    ds_write_b128 v10, v[92:95] offset:0
    ds_read_b64_tr_b16 a[54:55], v30 offset:0
    ds_read_b64_tr_b16 a[62:63], v30 offset:32
    s_waitcnt lgkmcnt(5)
    s_barrier
    s_waitcnt vmcnt(15)
    ds_write_b128 v10, v[96:99] offset:0
    ds_read_b64_tr_b16 a[64:65], v30 offset:0
    ds_read_b64_tr_b16 a[72:73], v30 offset:32
    s_waitcnt vmcnt(14)
    ds_write_b128 v10, v[100:103] offset:0
    ds_read_b64_tr_b16 a[66:67], v30 offset:0
    ds_read_b64_tr_b16 a[74:75], v30 offset:32
    s_waitcnt lgkmcnt(5)
    s_barrier
    s_waitcnt vmcnt(13)
    ds_write_b128 v10, v[104:107] offset:0
    ds_read_b64_tr_b16 a[68:69], v30 offset:0
    ds_read_b64_tr_b16 a[76:77], v30 offset:32
    s_waitcnt vmcnt(12)
    ds_write_b128 v10, v[108:111] offset:0
    ds_read_b64_tr_b16 a[70:71], v30 offset:0
    ds_read_b64_tr_b16 a[78:79], v30 offset:32
    s_waitcnt lgkmcnt(5)
    s_barrier
    s_waitcnt vmcnt(11)
    ds_write_b128 v10, v[112:115] offset:0
    ds_read_b64_tr_b16 a[80:81], v30 offset:0
    ds_read_b64_tr_b16 a[88:89], v30 offset:32
    s_waitcnt vmcnt(10)
    ds_write_b128 v10, v[116:119] offset:0
    ds_read_b64_tr_b16 a[82:83], v30 offset:0
    ds_read_b64_tr_b16 a[90:91], v30 offset:32
    s_waitcnt lgkmcnt(5)
    s_barrier
    s_waitcnt vmcnt(9)
    ds_write_b128 v10, v[120:123] offset:0
    ds_read_b64_tr_b16 a[84:85], v30 offset:0
    ds_read_b64_tr_b16 a[92:93], v30 offset:32
    s_waitcnt vmcnt(8)
    ds_write_b128 v10, v[124:127] offset:0
    ds_read_b64_tr_b16 a[86:87], v30 offset:0
    ds_read_b64_tr_b16 a[94:95], v30 offset:32
    s_waitcnt lgkmcnt(5)
    s_barrier
    s_waitcnt vmcnt(7)
    ds_write_b128 v10, v[32:35] offset:0
    ds_read_b64_tr_b16 a[96:97], v30 offset:0
    ds_read_b64_tr_b16 a[104:105], v30 offset:32
    s_waitcnt vmcnt(6)
    ds_write_b128 v10, v[36:39] offset:0
    ds_read_b64_tr_b16 a[98:99], v30 offset:0
    ds_read_b64_tr_b16 a[106:107], v30 offset:32
    s_waitcnt lgkmcnt(5)
    s_barrier
    s_waitcnt vmcnt(5)
    ds_write_b128 v10, v[40:43] offset:0
    ds_read_b64_tr_b16 a[100:101], v30 offset:0
    ds_read_b64_tr_b16 a[108:109], v30 offset:32
    s_waitcnt vmcnt(4)
    ds_write_b128 v10, v[44:47] offset:0
    ds_read_b64_tr_b16 a[102:103], v30 offset:0
    ds_read_b64_tr_b16 a[110:111], v30 offset:32
    s_waitcnt lgkmcnt(5)
    s_barrier
    s_waitcnt vmcnt(3)
    ds_write_b128 v10, v[48:51] offset:0
    ds_read_b64_tr_b16 a[112:113], v30 offset:0
    ds_read_b64_tr_b16 a[120:121], v30 offset:32
    s_waitcnt vmcnt(2)
    ds_write_b128 v10, v[52:55] offset:0
    ds_read_b64_tr_b16 a[114:115], v30 offset:0
    ds_read_b64_tr_b16 a[122:123], v30 offset:32
    s_waitcnt lgkmcnt(5)
    s_barrier
    s_waitcnt vmcnt(1)
    ds_write_b128 v10, v[56:59] offset:0
    ds_read_b64_tr_b16 a[116:117], v30 offset:0
    ds_read_b64_tr_b16 a[124:125], v30 offset:32
    s_waitcnt vmcnt(0)
    ds_write_b128 v10, v[60:63] offset:0
    ds_read_b64_tr_b16 a[118:119], v30 offset:0
    ds_read_b64_tr_b16 a[126:127], v30 offset:32
    s_waitcnt lgkmcnt(5)
    s_barrier
    v_lshrrev_b32 v65, 2, v0
    s_mov_b32 s49, 0
L_r1_wi:
    buffer_load_dword v64, v65, s[12:15], 0 offen sc1
    s_waitcnt vmcnt(0)
    v_cmp_ne_u32 vcc, 32, v64
    s_nop 3
    s_and_b32 vcc_lo, vcc_lo, 0x120002
    s_and_b32 vcc_hi, vcc_hi, 0x920012
    s_or_b64 vcc, vcc, vcc
    s_cbranch_vccz L_r1_wi_ok
    s_sleep 8
    s_add_u32 s49, s49, 1
    s_cmp_lt_u32 s49, 0x40000
    s_cbranch_scc1 L_r1_wi
    s_endpgm
L_r1_wi_ok:
L_r1_q:
    ds_read_b128 v[80:83], v2 offset:0
    ds_read_b128 v[84:87], v2 offset:16640
    s_waitcnt lgkmcnt(0)
    v_mfma_f32_16x16x32_bf16 v[32:35], a[0:3], v[80:83], 0
    ds_read_b128 v[88:91], v2 offset:16
    ds_read_b128 v[92:95], v2 offset:16656
    v_mfma_f32_16x16x32_bf16 v[36:39], a[0:3], v[84:87], 0
    v_mfma_f32_16x16x32_bf16 v[40:43], a[8:11], v[80:83], 0
    v_mfma_f32_16x16x32_bf16 v[44:47], a[8:11], v[84:87], 0
    s_waitcnt lgkmcnt(0)
    v_mfma_f32_16x16x32_bf16 v[32:35], a[4:7], v[88:91], v[32:35]
    ds_read_b128 v[80:83], v2 offset:32
    ds_read_b128 v[84:87], v2 offset:16672
    v_mfma_f32_16x16x32_bf16 v[36:39], a[4:7], v[92:95], v[36:39]
    v_mfma_f32_16x16x32_bf16 v[40:43], a[12:15], v[88:91], v[40:43]
    v_mfma_f32_16x16x32_bf16 v[44:47], a[12:15], v[92:95], v[44:47]
    s_waitcnt lgkmcnt(0)
    v_mfma_f32_16x16x32_bf16 v[32:35], a[16:19], v[80:83], v[32:35]
    ds_read_b128 v[88:91], v2 offset:48
    ds_read_b128 v[92:95], v2 offset:16688
    v_mfma_f32_16x16x32_bf16 v[36:39], a[16:19], v[84:87], v[36:39]
    v_mfma_f32_16x16x32_bf16 v[40:43], a[24:27], v[80:83], v[40:43]
    v_mfma_f32_16x16x32_bf16 v[44:47], a[24:27], v[84:87], v[44:47]
    s_waitcnt lgkmcnt(0)
    v_mfma_f32_16x16x32_bf16 v[32:35], a[20:23], v[88:91], v[32:35]
    ds_read_b128 v[80:83], v2 offset:64
    ds_read_b128 v[84:87], v2 offset:16704
    v_mfma_f32_16x16x32_bf16 v[36:39], a[20:23], v[92:95], v[36:39]
    v_mfma_f32_16x16x32_bf16 v[40:43], a[28:31], v[88:91], v[40:43]
    v_mfma_f32_16x16x32_bf16 v[44:47], a[28:31], v[92:95], v[44:47]
    s_waitcnt lgkmcnt(0)
    v_mfma_f32_16x16x32_bf16 v[32:35], a[32:35], v[80:83], v[32:35]
    ds_read_b128 v[88:91], v2 offset:80
    ds_read_b128 v[92:95], v2 offset:16720
    v_mfma_f32_16x16x32_bf16 v[36:39], a[32:35], v[84:87], v[36:39]
    v_mfma_f32_16x16x32_bf16 v[40:43], a[40:43], v[80:83], v[40:43]
    v_mfma_f32_16x16x32_bf16 v[44:47], a[40:43], v[84:87], v[44:47]
    s_waitcnt lgkmcnt(0)
    v_mfma_f32_16x16x32_bf16 v[32:35], a[36:39], v[88:91], v[32:35]
    ds_read_b128 v[80:83], v2 offset:96
    ds_read_b128 v[84:87], v2 offset:16736
    v_mfma_f32_16x16x32_bf16 v[36:39], a[36:39], v[92:95], v[36:39]
    v_mfma_f32_16x16x32_bf16 v[40:43], a[44:47], v[88:91], v[40:43]
    v_mfma_f32_16x16x32_bf16 v[44:47], a[44:47], v[92:95], v[44:47]
    s_waitcnt lgkmcnt(0)
    v_mfma_f32_16x16x32_bf16 v[32:35], a[48:51], v[80:83], v[32:35]
    ds_read_b128 v[88:91], v2 offset:112
    ds_read_b128 v[92:95], v2 offset:16752
    v_mfma_f32_16x16x32_bf16 v[36:39], a[48:51], v[84:87], v[36:39]
    v_mfma_f32_16x16x32_bf16 v[40:43], a[56:59], v[80:83], v[40:43]
    v_mfma_f32_16x16x32_bf16 v[44:47], a[56:59], v[84:87], v[44:47]
    s_waitcnt lgkmcnt(0)
    v_mfma_f32_16x16x32_bf16 v[32:35], a[52:55], v[88:91], v[32:35]
    ds_read_b128 v[80:83], v2 offset:128
    ds_read_b128 v[84:87], v2 offset:16768
    v_mfma_f32_16x16x32_bf16 v[36:39], a[52:55], v[92:95], v[36:39]
    v_mfma_f32_16x16x32_bf16 v[40:43], a[60:63], v[88:91], v[40:43]
    v_mfma_f32_16x16x32_bf16 v[44:47], a[60:63], v[92:95], v[44:47]
    s_waitcnt lgkmcnt(0)
    v_mfma_f32_16x16x32_bf16 v[32:35], a[64:67], v[80:83], v[32:35]
    ds_read_b128 v[88:91], v2 offset:144
    ds_read_b128 v[92:95], v2 offset:16784
    v_mfma_f32_16x16x32_bf16 v[36:39], a[64:67], v[84:87], v[36:39]
    v_mfma_f32_16x16x32_bf16 v[40:43], a[72:75], v[80:83], v[40:43]
    v_mfma_f32_16x16x32_bf16 v[44:47], a[72:75], v[84:87], v[44:47]
    s_waitcnt lgkmcnt(0)
    v_mfma_f32_16x16x32_bf16 v[32:35], a[68:71], v[88:91], v[32:35]
    ds_read_b128 v[80:83], v2 offset:160
    ds_read_b128 v[84:87], v2 offset:16800
    v_mfma_f32_16x16x32_bf16 v[36:39], a[68:71], v[92:95], v[36:39]
    v_mfma_f32_16x16x32_bf16 v[40:43], a[76:79], v[88:91], v[40:43]
    v_mfma_f32_16x16x32_bf16 v[44:47], a[76:79], v[92:95], v[44:47]
    s_waitcnt lgkmcnt(0)
    v_mfma_f32_16x16x32_bf16 v[32:35], a[80:83], v[80:83], v[32:35]
    ds_read_b128 v[88:91], v2 offset:176
    ds_read_b128 v[92:95], v2 offset:16816
    v_mfma_f32_16x16x32_bf16 v[36:39], a[80:83], v[84:87], v[36:39]
    v_mfma_f32_16x16x32_bf16 v[40:43], a[88:91], v[80:83], v[40:43]
    v_mfma_f32_16x16x32_bf16 v[44:47], a[88:91], v[84:87], v[44:47]
    s_waitcnt lgkmcnt(0)
    v_mfma_f32_16x16x32_bf16 v[32:35], a[84:87], v[88:91], v[32:35]
    ds_read_b128 v[80:83], v2 offset:192
    ds_read_b128 v[84:87], v2 offset:16832
    v_mfma_f32_16x16x32_bf16 v[36:39], a[84:87], v[92:95], v[36:39]
    v_mfma_f32_16x16x32_bf16 v[40:43], a[92:95], v[88:91], v[40:43]
    v_mfma_f32_16x16x32_bf16 v[44:47], a[92:95], v[92:95], v[44:47]
    s_waitcnt lgkmcnt(0)
    v_mfma_f32_16x16x32_bf16 v[32:35], a[96:99], v[80:83], v[32:35]
    ds_read_b128 v[88:91], v2 offset:208
    ds_read_b128 v[92:95], v2 offset:16848
    v_mfma_f32_16x16x32_bf16 v[36:39], a[96:99], v[84:87], v[36:39]
    v_mfma_f32_16x16x32_bf16 v[40:43], a[104:107], v[80:83], v[40:43]
    v_mfma_f32_16x16x32_bf16 v[44:47], a[104:107], v[84:87], v[44:47]
    s_waitcnt lgkmcnt(0)
    v_mfma_f32_16x16x32_bf16 v[32:35], a[100:103], v[88:91], v[32:35]
    ds_read_b128 v[80:83], v2 offset:224
    ds_read_b128 v[84:87], v2 offset:16864
    v_mfma_f32_16x16x32_bf16 v[36:39], a[100:103], v[92:95], v[36:39]
    v_mfma_f32_16x16x32_bf16 v[40:43], a[108:111], v[88:91], v[40:43]
    v_mfma_f32_16x16x32_bf16 v[44:47], a[108:111], v[92:95], v[44:47]
    s_waitcnt lgkmcnt(0)
    v_mfma_f32_16x16x32_bf16 v[32:35], a[112:115], v[80:83], v[32:35]
    ds_read_b128 v[88:91], v2 offset:240
    ds_read_b128 v[92:95], v2 offset:16880
    v_mfma_f32_16x16x32_bf16 v[36:39], a[112:115], v[84:87], v[36:39]
    v_mfma_f32_16x16x32_bf16 v[40:43], a[120:123], v[80:83], v[40:43]
    v_mfma_f32_16x16x32_bf16 v[44:47], a[120:123], v[84:87], v[44:47]
    s_waitcnt lgkmcnt(0)
    v_mfma_f32_16x16x32_bf16 v[32:35], a[116:119], v[88:91], v[32:35]
    v_mfma_f32_16x16x32_bf16 v[36:39], a[116:119], v[92:95], v[36:39]
    v_mfma_f32_16x16x32_bf16 v[40:43], a[124:127], v[88:91], v[40:43]
    v_mfma_f32_16x16x32_bf16 v[44:47], a[124:127], v[92:95], v[44:47]
    s_nop 3
    v_mul_f32 v32, s48, v32
    v_mul_f32 v33, s48, v33
    v_mul_f32 v34, s48, v34
    v_mul_f32 v35, s48, v35
    v_cvt_pk_bf16_f32 v120, v32, v33
    v_cvt_pk_bf16_f32 v121, v34, v35
    v_mul_f32 v40, s48, v40
    v_mul_f32 v41, s48, v41
    v_mul_f32 v42, s48, v42
    v_mul_f32 v43, s48, v43
    v_cvt_pk_bf16_f32 v122, v40, v41
    v_cvt_pk_bf16_f32 v123, v42, v43
    ds_write_b128 v4, v[120:123] offset:0
    v_mul_f32 v36, s48, v36
    v_mul_f32 v37, s48, v37
    v_mul_f32 v38, s48, v38
    v_mul_f32 v39, s48, v39
    v_cvt_pk_bf16_f32 v124, v36, v37
    v_cvt_pk_bf16_f32 v125, v38, v39
    v_mul_f32 v44, s48, v44
    v_mul_f32 v45, s48, v45
    v_mul_f32 v46, s48, v46
    v_mul_f32 v47, s48, v47
    v_cvt_pk_bf16_f32 v126, v44, v45
    v_cvt_pk_bf16_f32 v127, v46, v47
    ds_write_b128 v4, v[124:127] offset:1024
    s_waitcnt vmcnt(0) lgkmcnt(0)
    s_barrier
    s_cmp_eq_u32 s3, 0
    s_cbranch_scc0 L_r1_f1
    v_mov_b32 v64, s50
    s_mov_b64 exec, 1
    buffer_store_dword v64, off, s[8:11], s46 offset:0 sc1
    s_mov_b64 exec, -1
L_r1_f1:
    s_cmp_eq_u32 s38, -1
    s_cbranch_scc1 L_r1_next
L_r1_att:
    s_and_b32 s40, s38, 1
    s_mul_i32 s40, s40, 24576
    s_add_u32 s40, s40, 66560
    v_add_u32 v5, s40, v0
    s_and_b32 s40, s3, 1
    s_lshl_b32 s40, s40, 10
    v_add_u32 v6, s40, v5
    s_lshr_b32 s40, s3, 1
    s_lshl_b32 s40, s40, 12
    v_add_u32 v14, s40, v5
    ds_read_b128 v[32:35], v6 offset:0
    ds_read_b128 v[48:51], v5 offset:8192
    ds_read_b128 v[52:55], v5 offset:9216
    ds_read_b128 v[36:39], v6 offset:2048
    ds_read_b128 v[56:59], v5 offset:10240
    ds_read_b128 v[60:63], v5 offset:11264
    ds_read_b128 v[40:43], v6 offset:4096
    ds_read_b128 v[64:67], v5 offset:12288
    ds_read_b128 v[68:71], v5 offset:13312
    ds_read_b128 v[44:47], v6 offset:6144
    ds_read_b128 v[72:75], v5 offset:14336
    ds_read_b128 v[76:79], v5 offset:15360
    s_waitcnt lgkmcnt(9)
    v_mfma_f32_16x16x32_bf16 v[80:83], v[48:51], v[32:35], v[16:19]
    v_mfma_f32_16x16x32_bf16 v[84:87], v[52:55], v[32:35], v[20:23]
    s_waitcnt lgkmcnt(6)
    v_mfma_f32_16x16x32_bf16 v[80:83], v[56:59], v[36:39], v[80:83]
    v_mfma_f32_16x16x32_bf16 v[84:87], v[60:63], v[36:39], v[84:87]
    s_waitcnt lgkmcnt(3)
    v_mfma_f32_16x16x32_bf16 v[80:83], v[64:67], v[40:43], v[80:83]
    v_mfma_f32_16x16x32_bf16 v[84:87], v[68:71], v[40:43], v[84:87]
    s_waitcnt lgkmcnt(0)
    v_mfma_f32_16x16x32_bf16 v[80:83], v[72:75], v[44:47], v[80:83]
    v_mfma_f32_16x16x32_bf16 v[84:87], v[76:79], v[44:47], v[84:87]
    s_nop 3
    ds_read_b128 v[64:67], v14 offset:16384
    ds_read_b128 v[68:71], v14 offset:17408
    ds_read_b128 v[72:75], v14 offset:18432
    ds_read_b128 v[76:79], v14 offset:19456
    v_max3_f32 v92, v80, v81, v82
    v_max3_f32 v92, v92, v83, v84
    v_max3_f32 v92, v92, v85, v86
    v_max_f32 v92, v92, v87
    s_add_u32 s40, s38, s37
    s_cmp_eq_u32 s40, 0
    s_cbranch_scc0 L_r1_mpoll
    s_lshl_b32 s40, s3, 11
    buffer_load_dwordx4 v[48:51], v0, s[32:35], s40 offen
    buffer_load_dwordx4 v[52:55], v0, s[32:35], s40 offen offset:1024
    s_mul_i32 s40, s3, 2080
    s_add_u32 s40, s40, 115712
    v_add_u32 v94, s40, v0
    s_waitcnt vmcnt(0)
    ds_write_b128 v94, v[48:51]
    ds_write_b128 v94, v[52:55] offset:1040
    s_branch L_r1_mpok
L_r1_mpoll:
    s_mov_b32 s49, 0
    buffer_load_dwordx4 v[48:51], v0, s[8:11], s45 offen offset:0 sc1
    buffer_load_dwordx4 v[52:55], v0, s[8:11], s45 offen offset:1024 sc1
    s_sleep 1
L_r1_mp:
    buffer_load_dwordx4 v[56:59], v0, s[8:11], s45 offen offset:0 sc1
    buffer_load_dwordx4 v[60:63], v0, s[8:11], s45 offen offset:1024 sc1
    s_waitcnt vmcnt(2)
    v_bitop3_b32 v94, v48, v50, s47 bitop3:0x7e
    v_bitop3_b32 v95, v52, v54, s47 bitop3:0x7e
    v_bitop3_b32 v94, v94, v95, 1 bitop3:0xa8
    v_cmp_ne_u32 vcc, 0, v94
    s_cbranch_vccz L_r1_mp0
    s_sleep 1
    buffer_load_dwordx4 v[48:51], v0, s[8:11], s45 offen offset:0 sc1
    buffer_load_dwordx4 v[52:55], v0, s[8:11], s45 offen offset:1024 sc1
    s_waitcnt vmcnt(2)
    v_bitop3_b32 v94, v56, v58, s47 bitop3:0x7e
    v_bitop3_b32 v95, v60, v62, s47 bitop3:0x7e
    v_bitop3_b32 v94, v94, v95, 1 bitop3:0xa8
    v_cmp_ne_u32 vcc, 0, v94
    s_cbranch_vccz L_r1_mp1
    s_sleep 1
    s_add_u32 s49, s49, 1
    s_cmp_lt_u32 s49, 0x40000
    s_cbranch_scc1 L_r1_mp
    s_endpgm
L_r1_mp1:
    ds_write2_b64 v9, v[56:57], v[58:59] offset0:0 offset1:2
    ds_write2_b64 v9, v[60:61], v[62:63] offset0:130 offset1:132
    s_branch L_r1_mpok
L_r1_mp0:
    ds_write2_b64 v9, v[48:49], v[50:51] offset0:0 offset1:2
    ds_write2_b64 v9, v[52:53], v[54:55] offset0:130 offset1:132
L_r1_mpok:
    s_add_u32 s45, s45, 0x8000
    s_waitcnt lgkmcnt(0)
    s_barrier
    ds_read_b128 v[112:115], v3 offset:0
    ds_read_b128 v[116:119], v3 offset:16
    ds_read_b128 v[120:123], v3 offset:32
    s_waitcnt lgkmcnt(2)
    v_mfma_f32_16x16x32_bf16 v[96:99], a[128:131], v[112:115], 0
    ds_read_b128 v[124:127], v3 offset:48
    v_mfma_f32_16x16x32_bf16 v[100:103], a[136:139], v[112:115], 0
    s_waitcnt lgkmcnt(2)
    v_mfma_f32_16x16x32_bf16 v[96:99], a[132:135], v[116:119], v[96:99]
    ds_read_b128 v[112:115], v3 offset:64
    v_mfma_f32_16x16x32_bf16 v[100:103], a[140:143], v[116:119], v[100:103]
    s_waitcnt lgkmcnt(2)
    v_mfma_f32_16x16x32_bf16 v[96:99], a[144:147], v[120:123], v[96:99]
    ds_read_b128 v[116:119], v3 offset:80
    v_mfma_f32_16x16x32_bf16 v[100:103], a[152:155], v[120:123], v[100:103]
    s_waitcnt lgkmcnt(2)
    v_mfma_f32_16x16x32_bf16 v[96:99], a[148:151], v[124:127], v[96:99]
    ds_read_b128 v[120:123], v3 offset:96
    v_mfma_f32_16x16x32_bf16 v[100:103], a[156:159], v[124:127], v[100:103]
    s_waitcnt lgkmcnt(2)
    v_mfma_f32_16x16x32_bf16 v[96:99], a[160:163], v[112:115], v[96:99]
    ds_read_b128 v[124:127], v3 offset:112
    v_mfma_f32_16x16x32_bf16 v[100:103], a[168:171], v[112:115], v[100:103]
    s_waitcnt lgkmcnt(2)
    v_mfma_f32_16x16x32_bf16 v[96:99], a[164:167], v[116:119], v[96:99]
    ds_read_b128 v[112:115], v3 offset:128
    v_mfma_f32_16x16x32_bf16 v[100:103], a[172:175], v[116:119], v[100:103]
    s_waitcnt lgkmcnt(2)
    v_mfma_f32_16x16x32_bf16 v[96:99], a[176:179], v[120:123], v[96:99]
    ds_read_b128 v[116:119], v3 offset:144
    v_mfma_f32_16x16x32_bf16 v[100:103], a[184:187], v[120:123], v[100:103]
    s_waitcnt lgkmcnt(2)
    v_mfma_f32_16x16x32_bf16 v[96:99], a[180:183], v[124:127], v[96:99]
    ds_read_b128 v[120:123], v3 offset:160
    v_mfma_f32_16x16x32_bf16 v[100:103], a[188:191], v[124:127], v[100:103]
    s_waitcnt lgkmcnt(2)
    v_mfma_f32_16x16x32_bf16 v[96:99], a[192:195], v[112:115], v[96:99]
    ds_read_b128 v[124:127], v3 offset:176
    v_mfma_f32_16x16x32_bf16 v[100:103], a[200:203], v[112:115], v[100:103]
    s_waitcnt lgkmcnt(2)
    v_mfma_f32_16x16x32_bf16 v[96:99], a[196:199], v[116:119], v[96:99]
    ds_read_b128 v[112:115], v3 offset:192
    v_mfma_f32_16x16x32_bf16 v[100:103], a[204:207], v[116:119], v[100:103]
    s_waitcnt lgkmcnt(2)
    v_mfma_f32_16x16x32_bf16 v[96:99], a[208:211], v[120:123], v[96:99]
    ds_read_b128 v[116:119], v3 offset:208
    v_mfma_f32_16x16x32_bf16 v[100:103], a[216:219], v[120:123], v[100:103]
    s_waitcnt lgkmcnt(2)
    v_mfma_f32_16x16x32_bf16 v[96:99], a[212:215], v[124:127], v[96:99]
    ds_read_b128 v[120:123], v3 offset:224
    v_mfma_f32_16x16x32_bf16 v[100:103], a[220:223], v[124:127], v[100:103]
    s_waitcnt lgkmcnt(2)
    v_mfma_f32_16x16x32_bf16 v[96:99], a[224:227], v[112:115], v[96:99]
    ds_read_b128 v[124:127], v3 offset:240
    v_mfma_f32_16x16x32_bf16 v[100:103], a[232:235], v[112:115], v[100:103]
    s_waitcnt lgkmcnt(2)
    v_mfma_f32_16x16x32_bf16 v[96:99], a[228:231], v[116:119], v[96:99]
    ds_read_b128 v[112:115], v3 offset:0
    v_mfma_f32_16x16x32_bf16 v[100:103], a[236:239], v[116:119], v[100:103]
    s_waitcnt lgkmcnt(2)
    v_mfma_f32_16x16x32_bf16 v[96:99], a[240:243], v[120:123], v[96:99]
    ds_read_b128 v[116:119], v3 offset:16
    v_mfma_f32_16x16x32_bf16 v[100:103], a[248:251], v[120:123], v[100:103]
    s_waitcnt lgkmcnt(2)
    v_mfma_f32_16x16x32_bf16 v[96:99], a[244:247], v[124:127], v[96:99]
    ds_read_b128 v[120:123], v3 offset:32
    v_mfma_f32_16x16x32_bf16 v[100:103], a[252:255], v[124:127], v[100:103]
    s_waitcnt vmcnt(0)
    s_waitcnt lgkmcnt(2)
    v_mfma_f32_16x16x32_bf16 v[104:107], v[112:115], v[128:131], 0
    ds_read_b128 v[124:127], v3 offset:48
    v_mfma_f32_16x16x32_bf16 v[108:111], v[112:115], v[136:139], 0
    s_waitcnt lgkmcnt(2)
    v_mfma_f32_16x16x32_bf16 v[104:107], v[116:119], v[132:135], v[104:107]
    ds_read_b128 v[112:115], v3 offset:64
    v_cvt_pk_bf16_f32 v28, v96, v97
    v_cvt_pk_bf16_f32 v29, v98, v99
    v_mfma_f32_16x16x32_bf16 v[108:111], v[116:119], v[140:143], v[108:111]
    v_cvt_pk_bf16_f32 v30, v100, v101
    v_cvt_pk_bf16_f32 v31, v102, v103
    ds_write_b128 v10, v[28:31]
    s_waitcnt lgkmcnt(3)
    v_mfma_f32_16x16x32_bf16 v[104:107], v[120:123], v[144:147], v[104:107]
    ds_read_b128 v[116:119], v3 offset:80
    v_mfma_f32_16x16x32_bf16 v[108:111], v[120:123], v[152:155], v[108:111]
    s_waitcnt lgkmcnt(3)
    v_mfma_f32_16x16x32_bf16 v[104:107], v[124:127], v[148:151], v[104:107]
    ds_read_b128 v[120:123], v3 offset:96
    v_mfma_f32_16x16x32_bf16 v[108:111], v[124:127], v[156:159], v[108:111]
    s_waitcnt lgkmcnt(2)
    s_barrier
    ds_read_b128 v[48:51], v11 offset:0
    ds_read_b128 v[52:55], v11 offset:1024
    ds_read_b128 v[56:59], v11 offset:2048
    ds_read_b128 v[60:63], v11 offset:3072
    s_waitcnt lgkmcnt(7)
    v_mfma_f32_16x16x32_bf16 v[104:107], v[112:115], v[160:163], v[104:107]
    ds_read_b128 v[124:127], v3 offset:112
    v_mfma_f32_16x16x32_bf16 v[108:111], v[112:115], v[168:171], v[108:111]
    s_waitcnt lgkmcnt(6)
    v_mfma_f32_16x16x32_bf16 v[104:107], v[116:119], v[164:167], v[104:107]
    ds_read_b128 v[112:115], v3 offset:128
    v_mfma_f32_16x16x32_bf16 v[108:111], v[116:119], v[172:175], v[108:111]
    s_waitcnt lgkmcnt(6)
    v_mfma_f32_16x16x32_bf16 v[104:107], v[120:123], v[176:179], v[104:107]
    ds_read_b128 v[116:119], v3 offset:144
    v_mfma_f32_16x16x32_bf16 v[108:111], v[120:123], v[184:187], v[108:111]
    s_waitcnt lgkmcnt(3)
    v_mfma_f32_16x16x32_bf16 v[88:91], v[48:51], v[32:35], v[24:27]
    v_mfma_f32_16x16x32_bf16 v[88:91], v[52:55], v[36:39], v[88:91]
    v_mfma_f32_16x16x32_bf16 v[88:91], v[56:59], v[40:43], v[88:91]
    v_mfma_f32_16x16x32_bf16 v[88:91], v[60:63], v[44:47], v[88:91]
    s_waitcnt lgkmcnt(2)
    v_mfma_f32_16x16x32_bf16 v[104:107], v[124:127], v[180:183], v[104:107]
    ds_read_b128 v[120:123], v3 offset:160
    v_mfma_f32_16x16x32_bf16 v[108:111], v[124:127], v[188:191], v[108:111]
    s_waitcnt lgkmcnt(2)
    v_mfma_f32_16x16x32_bf16 v[104:107], v[112:115], v[192:195], v[104:107]
    ds_read_b128 v[124:127], v3 offset:176
    v_max3_f32 v92, v92, v88, v89
    v_max3_f32 v92, v92, v90, v91
    v_mfma_f32_16x16x32_bf16 v[108:111], v[112:115], v[200:203], v[108:111]
    v_mov_b32 v93, v92
    s_waitcnt lgkmcnt(2)
    v_mfma_f32_16x16x32_bf16 v[104:107], v[116:119], v[196:199], v[104:107]
    ds_read_b128 v[112:115], v3 offset:192
    v_permlane16_swap_b32 v92, v93
    v_max_f32 v92, v92, v93
    v_mfma_f32_16x16x32_bf16 v[108:111], v[116:119], v[204:207], v[108:111]
    v_mov_b32 v93, v92
    s_waitcnt lgkmcnt(2)
    v_mfma_f32_16x16x32_bf16 v[104:107], v[120:123], v[208:211], v[104:107]
    ds_read_b128 v[116:119], v3 offset:208
    v_permlane32_swap_b32 v92, v93
    v_max_f32 v92, v92, v93
    v_mfma_f32_16x16x32_bf16 v[108:111], v[120:123], v[216:219], v[108:111]
    v_sub_f32 v80, v80, v92
    v_sub_f32 v81, v81, v92
    s_waitcnt lgkmcnt(2)
    v_mfma_f32_16x16x32_bf16 v[104:107], v[124:127], v[212:215], v[104:107]
    ds_read_b128 v[120:123], v3 offset:224
    v_sub_f32 v82, v82, v92
    v_sub_f32 v83, v83, v92
    v_mfma_f32_16x16x32_bf16 v[108:111], v[124:127], v[220:223], v[108:111]
    v_sub_f32 v84, v84, v92
    v_sub_f32 v85, v85, v92
    s_waitcnt lgkmcnt(2)
    v_mfma_f32_16x16x32_bf16 v[104:107], v[112:115], v[224:227], v[104:107]
    ds_read_b128 v[124:127], v3 offset:240
    v_sub_f32 v86, v86, v92
    v_sub_f32 v87, v87, v92
    v_mfma_f32_16x16x32_bf16 v[108:111], v[112:115], v[232:235], v[108:111]
    v_sub_f32 v88, v88, v92
    v_sub_f32 v89, v89, v92
    s_waitcnt lgkmcnt(2)
    v_mfma_f32_16x16x32_bf16 v[104:107], v[116:119], v[228:231], v[104:107]
    v_sub_f32 v90, v90, v92
    v_sub_f32 v91, v91, v92
    v_mfma_f32_16x16x32_bf16 v[108:111], v[116:119], v[236:239], v[108:111]
    v_exp_f32 v80, v80
    s_waitcnt lgkmcnt(1)
    v_mfma_f32_16x16x32_bf16 v[104:107], v[120:123], v[240:243], v[104:107]
    v_exp_f32 v81, v81
    v_mfma_f32_16x16x32_bf16 v[108:111], v[120:123], v[248:251], v[108:111]
    v_exp_f32 v82, v82
    s_waitcnt lgkmcnt(0)
    v_mfma_f32_16x16x32_bf16 v[104:107], v[124:127], v[244:247], v[104:107]
    v_exp_f32 v83, v83
    v_mfma_f32_16x16x32_bf16 v[108:111], v[124:127], v[252:255], v[108:111]
    v_exp_f32 v84, v84
    v_exp_f32 v85, v85
    v_exp_f32 v86, v86
    v_exp_f32 v87, v87
    v_exp_f32 v88, v88
    v_cvt_pk_bf16_f32 v28, v104, v105
    v_cvt_pk_bf16_f32 v29, v106, v107
    v_cvt_pk_bf16_f32 v30, v108, v109
    v_cvt_pk_bf16_f32 v31, v110, v111
    ds_write_b64 v12, v[28:29] offset:0
    ds_write_b64 v12, v[30:31] offset:512
    v_exp_f32 v89, v89
    v_exp_f32 v90, v90
    v_exp_f32 v91, v91
    v_cvt_pk_bf16_f32 v32, v80, v81
    v_cvt_pk_bf16_f32 v33, v82, v83
    v_cvt_pk_bf16_f32 v34, v84, v85
    v_cvt_pk_bf16_f32 v35, v86, v87
    v_cvt_pk_bf16_f32 v36, v88, v89
    v_cvt_pk_bf16_f32 v37, v90, v91
    s_waitcnt lgkmcnt(0)
    s_barrier
    ds_read_b64 v[112:113], v13 offset:0
    ds_read_b64 v[114:115], v13 offset:512
    ds_read_b64 v[116:117], v13 offset:1024
    ds_read_b64 v[118:119], v13 offset:1536
    v_add_f32 v92, v80, v81
    v_mfma_f32_16x16x32_bf16 v[96:99], v[64:67], v[32:35], 0
    v_add_f32 v92, v92, v82
    v_add_f32 v92, v92, v83
    v_mfma_f32_16x16x32_bf16 v[100:103], v[68:71], v[32:35], 0
    v_add_f32 v92, v92, v84
    v_add_f32 v92, v92, v85
    v_mfma_f32_16x16x32_bf16 v[104:107], v[72:75], v[32:35], 0
    v_add_f32 v92, v92, v86
    v_add_f32 v92, v92, v87
    v_mfma_f32_16x16x32_bf16 v[108:111], v[76:79], v[32:35], 0
    v_add_f32 v92, v92, v88
    v_add_f32 v92, v92, v89
    s_waitcnt lgkmcnt(0)
    v_mfma_f32_16x16x16_bf16 v[96:99], v[112:113], v[36:37], v[96:99]
    v_add_f32 v92, v92, v90
    v_add_f32 v92, v92, v91
    v_mov_b32 v93, v92
    s_nop 1
    v_mfma_f32_16x16x16_bf16 v[100:103], v[114:115], v[36:37], v[100:103]
    v_permlane16_swap_b32 v92, v93
    v_add_f32 v92, v92, v93
    v_mov_b32 v93, v92
    v_mfma_f32_16x16x16_bf16 v[104:107], v[116:117], v[36:37], v[104:107]
    s_nop 1
    v_permlane32_swap_b32 v92, v93
    v_add_f32 v92, v92, v93
    v_mfma_f32_16x16x16_bf16 v[108:111], v[118:119], v[36:37], v[108:111]
    s_cmp_eq_u32 s38, 15
    v_rcp_f32 v92, v92
    s_cselect_b32 s41, 1, 0
    v_mul_f32 v96, v96, v92
    v_mul_f32 v97, v97, v92
    v_mul_f32 v98, v98, v92
    v_mul_f32 v99, v99, v92
    v_mul_f32 v100, v100, v92
    v_mul_f32 v101, v101, v92
    v_mul_f32 v102, v102, v92
    v_mul_f32 v103, v103, v92
    v_cvt_pk_bf16_f32 v80, v96, v100
    v_cvt_pk_bf16_f32 v81, v97, v101
    v_cvt_pk_bf16_f32 v82, v98, v102
    v_cvt_pk_bf16_f32 v83, v99, v103
    v_or_b32 v80, s41, v80
    buffer_store_dwordx4 v[80:83], v15, s[8:11], s44 offen offset:0 sc1
    v_pk_mul_f32 v[104:105], v[104:105], v[92:93] op_sel_hi:[1,0]
    v_pk_mul_f32 v[106:107], v[106:107], v[92:93] op_sel_hi:[1,0]
    v_pk_mul_f32 v[108:109], v[108:109], v[92:93] op_sel_hi:[1,0]
    v_pk_mul_f32 v[110:111], v[110:111], v[92:93] op_sel_hi:[1,0]
    v_cvt_pk_bf16_f32 v84, v104, v108
    v_cvt_pk_bf16_f32 v85, v105, v109
    v_cvt_pk_bf16_f32 v86, v106, v110
    v_cvt_pk_bf16_f32 v87, v107, v111
    v_or_b32 v84, s41, v84
    buffer_store_dwordx4 v[84:87], v15, s[8:11], s44 offen offset:1024 sc1
    s_add_u32 s44, s44, 0x100000
    s_add_u32 s50, s38, 1
    s_lshl_b32 s40, s3, 2
    s_add_u32 s40, s40, s46
    v_mov_b32 v64, s50
    s_mov_b64 exec, 1
    s_cmp_eq_u32 s38, 15
    s_cbranch_scc1 L_r1_hint
    s_waitcnt vmcnt(0)
L_r1_hint:
    buffer_store_dword v64, off, s[8:11], s40 offset:16 sc1
    s_mov_b64 exec, -1
    s_barrier
L_r1_next:
    s_add_u32 s38, s38, 1
    s_cmp_lt_u32 s38, 16
    s_cbranch_scc1 L_r1_loop
    s_endpgm
L_r3:
    s_getpc_b64 s[72:73]
L_r3_pc:
    s_mov_b32 s74, L_r4-L_r3_pc
    s_mov_b32 s75, 0x20000
    v_lshlrev_b32 v64, 7, v0
    s_mov_b32 s76, 0
    buffer_load_dword v127, v64, s[72:75], s76 offen
    v_lshlrev_b32 v64, 7, v0
    s_load_dwordx2 s[16:17], s[0:1], 24
    s_load_dwordx2 s[20:21], s[0:1], 32
    s_load_dwordx2 s[24:25], s[0:1], 8
    s_load_dwordx2 s[28:29], s[0:1], 0
    s_load_dwordx2 s[32:33], s[0:1], 16
    s_load_dwordx2 s[52:53], s[0:1], 56
    s_lshl_b32 s41, s4, 5
    s_add_u32 s41, s41, s5
    s_lshl_b32 s41, s41, 7
    s_sub_u32 s37, s4, 5
    s_lshl_b32 s37, s37, 2
    s_and_b32 s36, s5, 3
    s_add_u32 s36, s36, s37
    s_lshl_b32 s37, s36, 2
    s_add_u32 s39, s37, s3
    s_lshl_b32 s39, s39, 16
    s_and_b32 s45, s5, 28
    s_add_u32 s45, s45, s3
    s_lshl_b32 s40, s36, 19
    s_lshl_b32 s38, s45, 10
    s_add_u32 s40, s40, s38
    s_add_u32 s40, s40, 0x400000
    s_lshl_b32 s44, s45, 12
    s_add_u32 s44, s44, 0x180000
    v_and_b32 v64, 63, v0
    v_and_b32 v65, 15, v64
    v_lshrrev_b32 v66, 4, v64
    v_add_u32 v16, s37, v66
    v_lshlrev_b32 v0, 4, v64
    v_mul_u32_u24 v67, 1040, v65
    v_lshl_add_u32 v1, v66, 8, v67
    v_add_u32 v2, 49920, v1
    v_add_u32 v3, 99840, v1
    s_mul_i32 s36, s3, 33280
    v_add_u32 v31, s36, v1
    s_mul_i32 s36, s3, 4352
    s_add_u32 s36, s36, 133120
    v_mul_u32_u24 v67, 1088, v66
    v_lshrrev_b32 v68, 2, v65
    v_mul_u32_u24 v68, 272, v68
    v_and_b32 v69, 3, v65
    v_lshl_add_u32 v68, v69, 2, v68
    v_add3_u32 v4, v67, v68, s36
    v_mul_u32_u24 v67, 272, v66
    v_lshl_add_u32 v67, v65, 4, v67
    v_add_u32 v5, s36, v67
    v_lshlrev_b32 v6, 3, v65
    s_lshl_b32 s36, s45, 5
    v_lshl_add_u32 v30, v65, 1, s36
    s_lshl_b32 s45, s45, 14
    s_waitcnt lgkmcnt(0)
    s_mov_b32 s18, 0x80000
    s_mov_b32 s19, 0x20000
    s_mov_b32 s22, 0x80000
    s_mov_b32 s23, 0x20000
    s_mov_b32 s26, 0x400
    s_mov_b32 s27, 0x20000
    s_mov_b32 s30, 0x200000
    s_mov_b32 s31, 0x20000
    s_mov_b32 s34, 0x400
    s_mov_b32 s35, 0x20000
    s_mov_b32 s54, 0x400
    s_mov_b32 s55, 0x20000
    buffer_load_ushort v18, v30, s[24:27], 0 offen
    buffer_load_ushort v19, v30, s[32:35], 0 offen
    buffer_load_ushort v20, v30, s[52:55], 0 offen
    s_mul_i32 s36, s3, 33280
    s_add_u32 m0, s36, 0
    s_add_u32 s37, s45, 0
    buffer_load_dwordx4 v0, s[16:19], s37 offen offset:0 lds
    s_add_u32 m0, m0, 16
    s_nop 0
    buffer_load_dwordx4 v0, s[16:19], s37 offen offset:1024 lds
    s_add_u32 m0, m0, 16
    s_nop 0
    buffer_load_dwordx4 v0, s[16:19], s37 offen offset:2048 lds
    s_add_u32 m0, m0, 16
    s_nop 0
    buffer_load_dwordx4 v0, s[16:19], s37 offen offset:3072 lds
    s_add_u32 m0, s36, 4160
    s_add_u32 s37, s45, 4096
    buffer_load_dwordx4 v0, s[16:19], s37 offen offset:0 lds
    s_add_u32 m0, m0, 16
    s_nop 0
    buffer_load_dwordx4 v0, s[16:19], s37 offen offset:1024 lds
    s_add_u32 m0, m0, 16
    s_nop 0
    buffer_load_dwordx4 v0, s[16:19], s37 offen offset:2048 lds
    s_add_u32 m0, m0, 16
    s_nop 0
    buffer_load_dwordx4 v0, s[16:19], s37 offen offset:3072 lds
    s_add_u32 m0, s36, 8320
    s_add_u32 s37, s45, 8192
    buffer_load_dwordx4 v0, s[16:19], s37 offen offset:0 lds
    s_add_u32 m0, m0, 16
    s_nop 0
    buffer_load_dwordx4 v0, s[16:19], s37 offen offset:1024 lds
    s_add_u32 m0, m0, 16
    s_nop 0
    buffer_load_dwordx4 v0, s[16:19], s37 offen offset:2048 lds
    s_add_u32 m0, m0, 16
    s_nop 0
    buffer_load_dwordx4 v0, s[16:19], s37 offen offset:3072 lds
    s_add_u32 m0, s36, 12480
    s_add_u32 s37, s45, 12288
    buffer_load_dwordx4 v0, s[16:19], s37 offen offset:0 lds
    s_add_u32 m0, m0, 16
    s_nop 0
    buffer_load_dwordx4 v0, s[16:19], s37 offen offset:1024 lds
    s_add_u32 m0, m0, 16
    s_nop 0
    buffer_load_dwordx4 v0, s[16:19], s37 offen offset:2048 lds
    s_add_u32 m0, m0, 16
    s_nop 0
    buffer_load_dwordx4 v0, s[16:19], s37 offen offset:3072 lds
    s_add_u32 m0, s36, 16640
    s_add_u32 s37, s45, 0
    buffer_load_dwordx4 v0, s[20:23], s37 offen offset:0 lds
    s_add_u32 m0, m0, 16
    s_nop 0
    buffer_load_dwordx4 v0, s[20:23], s37 offen offset:1024 lds
    s_add_u32 m0, m0, 16
    s_nop 0
    buffer_load_dwordx4 v0, s[20:23], s37 offen offset:2048 lds
    s_add_u32 m0, m0, 16
    s_nop 0
    buffer_load_dwordx4 v0, s[20:23], s37 offen offset:3072 lds
    s_add_u32 m0, s36, 20800
    s_add_u32 s37, s45, 4096
    buffer_load_dwordx4 v0, s[20:23], s37 offen offset:0 lds
    s_add_u32 m0, m0, 16
    s_nop 0
    buffer_load_dwordx4 v0, s[20:23], s37 offen offset:1024 lds
    s_add_u32 m0, m0, 16
    s_nop 0
    buffer_load_dwordx4 v0, s[20:23], s37 offen offset:2048 lds
    s_add_u32 m0, m0, 16
    s_nop 0
    buffer_load_dwordx4 v0, s[20:23], s37 offen offset:3072 lds
    s_add_u32 m0, s36, 24960
    s_add_u32 s37, s45, 8192
    buffer_load_dwordx4 v0, s[20:23], s37 offen offset:0 lds
    s_add_u32 m0, m0, 16
    s_nop 0
    buffer_load_dwordx4 v0, s[20:23], s37 offen offset:1024 lds
    s_add_u32 m0, m0, 16
    s_nop 0
    buffer_load_dwordx4 v0, s[20:23], s37 offen offset:2048 lds
    s_add_u32 m0, m0, 16
    s_nop 0
    buffer_load_dwordx4 v0, s[20:23], s37 offen offset:3072 lds
    s_add_u32 m0, s36, 29120
    s_add_u32 s37, s45, 12288
    buffer_load_dwordx4 v0, s[20:23], s37 offen offset:0 lds
    s_add_u32 m0, m0, 16
    s_nop 0
    buffer_load_dwordx4 v0, s[20:23], s37 offen offset:1024 lds
    s_add_u32 m0, m0, 16
    s_nop 0
    buffer_load_dwordx4 v0, s[20:23], s37 offen offset:2048 lds
    s_add_u32 m0, m0, 16
    s_nop 0
    buffer_load_dwordx4 v0, s[20:23], s37 offen offset:3072 lds
    s_lshl_b32 s96, s4, 5
    s_add_u32 s96, s96, s5
    s_cmp_eq_u32 s98, 1
    s_cbranch_scc1 L_r3_cf_ok
    v_mov_b32 v125, 163836
    s_cmp_eq_u32 s3, 0
    s_cbranch_scc0 L_r3_cf_b
    s_waitcnt vmcnt(37)
    v_readfirstlane_b32 s97, v126
    v_mov_b32 v124, s96
    s_nop 2
    s_bitcmp1_b32 s97, s5
    s_cbranch_scc1 L_lost
    ds_write_b32 v125, v124
    s_waitcnt lgkmcnt(0)
L_r3_cf_b:
    s_barrier
    ds_read_b32 v124, v125
    s_waitcnt lgkmcnt(0)
    v_readfirstlane_b32 s97, v124
    s_barrier
    s_cmp_eq_u32 s97, s96
    s_cbranch_scc0 L_restart
L_r3_cf_ok:
    s_lshl_b32 s96, s96, 7
    s_lshl_b32 s97, s3, 3
    s_add_u32 s96, s96, s97
    v_mov_b64 v[124:125], 0
    buffer_store_dwordx2 v[124:125], off, s[8:11], s96 sc1
    s_waitcnt vmcnt(0)
    ds_read_b128 v[128:131], v31 offset:0
    ds_read_b128 v[132:135], v31 offset:16
    ds_read_b128 v[136:139], v31 offset:32
    ds_read_b128 v[140:143], v31 offset:48
    ds_read_b128 v[144:147], v31 offset:64
    ds_read_b128 v[148:151], v31 offset:80
    ds_read_b128 v[152:155], v31 offset:96
    ds_read_b128 v[156:159], v31 offset:112
    s_waitcnt lgkmcnt(4)
    ds_read_b128 v[160:163], v31 offset:128
    ds_read_b128 v[164:167], v31 offset:144
    ds_read_b128 v[168:171], v31 offset:160
    ds_read_b128 v[172:175], v31 offset:176
    ds_read_b128 v[176:179], v31 offset:192
    ds_read_b128 v[180:183], v31 offset:208
    ds_read_b128 v[184:187], v31 offset:224
    ds_read_b128 v[188:191], v31 offset:240
    s_waitcnt lgkmcnt(4)
    ds_read_b128 v[192:195], v31 offset:16640
    ds_read_b128 v[196:199], v31 offset:16656
    ds_read_b128 v[200:203], v31 offset:16672
    ds_read_b128 v[204:207], v31 offset:16688
    ds_read_b128 v[208:211], v31 offset:16704
    ds_read_b128 v[212:215], v31 offset:16720
    ds_read_b128 v[216:219], v31 offset:16736
    ds_read_b128 v[220:223], v31 offset:16752
    s_waitcnt lgkmcnt(4)
    ds_read_b128 v[224:227], v31 offset:16768
    ds_read_b128 v[228:231], v31 offset:16784
    ds_read_b128 v[232:235], v31 offset:16800
    ds_read_b128 v[236:239], v31 offset:16816
    ds_read_b128 v[240:243], v31 offset:16832
    ds_read_b128 v[244:247], v31 offset:16848
    ds_read_b128 v[248:251], v31 offset:16864
    ds_read_b128 v[252:255], v31 offset:16880
    s_waitcnt lgkmcnt(4)
    s_waitcnt lgkmcnt(0)
    s_barrier
    s_cmp_eq_u32 s3, 0
    s_cbranch_scc0 L_r3_id
    v_mov_b32 v64, 1
    s_mov_b64 exec, 1
    buffer_atomic_add v64, off, s[12:15], s7
    s_mov_b64 exec, -1
L_r3_id:
    s_mul_i32 s38, s3, 4160
    s_add_u32 m0, s38, 0
    s_add_u32 s37, s39, 0
    buffer_load_dwordx4 v0, s[28:31], s37 offen offset:0 lds
    s_add_u32 m0, m0, 16
    s_nop 0
    buffer_load_dwordx4 v0, s[28:31], s37 offen offset:1024 lds
    s_add_u32 m0, m0, 16
    s_nop 0
    buffer_load_dwordx4 v0, s[28:31], s37 offen offset:2048 lds
    s_add_u32 m0, m0, 16
    s_nop 0
    buffer_load_dwordx4 v0, s[28:31], s37 offen offset:3072 lds
    s_add_u32 m0, s38, 16640
    s_add_u32 s37, s39, 4096
    buffer_load_dwordx4 v0, s[28:31], s37 offen offset:0 lds
    s_add_u32 m0, m0, 16
    s_nop 0
    buffer_load_dwordx4 v0, s[28:31], s37 offen offset:1024 lds
    s_add_u32 m0, m0, 16
    s_nop 0
    buffer_load_dwordx4 v0, s[28:31], s37 offen offset:2048 lds
    s_add_u32 m0, m0, 16
    s_nop 0
    buffer_load_dwordx4 v0, s[28:31], s37 offen offset:3072 lds
    s_add_u32 m0, s38, 33280
    s_add_u32 s37, s39, 8192
    buffer_load_dwordx4 v0, s[28:31], s37 offen offset:0 lds
    s_add_u32 m0, m0, 16
    s_nop 0
    buffer_load_dwordx4 v0, s[28:31], s37 offen offset:1024 lds
    s_add_u32 m0, m0, 16
    s_nop 0
    buffer_load_dwordx4 v0, s[28:31], s37 offen offset:2048 lds
    s_add_u32 m0, m0, 16
    s_nop 0
    buffer_load_dwordx4 v0, s[28:31], s37 offen offset:3072 lds
    s_add_u32 m0, s38, 49920
    s_add_u32 s37, s39, 12288
    buffer_load_dwordx4 v0, s[28:31], s37 offen offset:0 lds
    s_add_u32 m0, m0, 16
    s_nop 0
    buffer_load_dwordx4 v0, s[28:31], s37 offen offset:1024 lds
    s_add_u32 m0, m0, 16
    s_nop 0
    buffer_load_dwordx4 v0, s[28:31], s37 offen offset:2048 lds
    s_add_u32 m0, m0, 16
    s_nop 0
    buffer_load_dwordx4 v0, s[28:31], s37 offen offset:3072 lds
    s_add_u32 m0, s38, 66560
    s_add_u32 s37, s39, 16384
    buffer_load_dwordx4 v0, s[28:31], s37 offen offset:0 lds
    s_add_u32 m0, m0, 16
    s_nop 0
    buffer_load_dwordx4 v0, s[28:31], s37 offen offset:1024 lds
    s_add_u32 m0, m0, 16
    s_nop 0
    buffer_load_dwordx4 v0, s[28:31], s37 offen offset:2048 lds
    s_add_u32 m0, m0, 16
    s_nop 0
    buffer_load_dwordx4 v0, s[28:31], s37 offen offset:3072 lds
    s_add_u32 m0, s38, 83200
    s_add_u32 s37, s39, 20480
    buffer_load_dwordx4 v0, s[28:31], s37 offen offset:0 lds
    s_add_u32 m0, m0, 16
    s_nop 0
    buffer_load_dwordx4 v0, s[28:31], s37 offen offset:1024 lds
    s_add_u32 m0, m0, 16
    s_nop 0
    buffer_load_dwordx4 v0, s[28:31], s37 offen offset:2048 lds
    s_add_u32 m0, m0, 16
    s_nop 0
    buffer_load_dwordx4 v0, s[28:31], s37 offen offset:3072 lds
    v_lshlrev_b32 v18, 16, v18
    v_lshlrev_b32 v19, 16, v19
    v_lshlrev_b32 v20, 16, v20
    v_mul_f32 v20, 0x3fb8aa3b, v20
    v_exp_f32 v20, v20
    s_nop 0
    v_cvt_pk_bf16_f32 v20, v20, v20
    v_and_b32 v20, 0xffff0000, v20
    v_mul_f32 v21, v20, v18
    v_mul_f32 v22, v20, v19
    v_mul_f32 v21, 0x3fb8aa3b, v21
    v_exp_f32 v21, v21
    v_mul_f32 v22, 0.15915494, v22
    v_rndne_f32 v23, v22
    v_sub_f32 v22, v22, v23
    v_cos_f32 v23, v22
    v_sin_f32 v24, v22
    v_mul_f32 v8, v21, v23
    v_mul_f32 v9, v21, v24
    v_mul_f32 v21, v18, v18
    v_fmac_f32 v21, v19, v19
    v_rcp_f32 v21, v21
    v_subrev_f32 v22, 1.0, v8
    v_mul_f32 v23, v22, v18
    v_fmac_f32 v23, v9, v19
    v_mul_f32 v24, v9, v18
    v_fma_f32 v24, -v22, v19, v24
    v_add_f32 v21, v21, v21
    v_mul_f32 v12, v23, v21
    v_mul_f32 v13, v24, v21
    v_mov_b32 v10, v8
    v_mov_b32 v11, v9
    v_mov_b32 v14, 0
    v_mov_b32 v15, 0
    v_mul_f32 v18, v11, v11
    v_mul_f32 v19, v10, v11
    v_fma_f32 v10, v10, v10, -v18
    v_add_f32 v11, v19, v19
    v_mul_f32 v18, v11, v11
    v_mul_f32 v19, v10, v11
    v_fma_f32 v10, v10, v10, -v18
    v_add_f32 v11, v19, v19
    v_mul_f32 v18, v11, v11
    v_mul_f32 v19, v10, v11
    v_fma_f32 v10, v10, v10, -v18
    v_add_f32 v11, v19, v19
    v_mul_f32 v18, v11, v11
    v_mul_f32 v19, v10, v11
    v_fma_f32 v10, v10, v10, -v18
    v_add_f32 v11, v19, v19
    v_mul_f32 v18, v11, v11
    v_mul_f32 v19, v10, v11
    v_fma_f32 v10, v10, v10, -v18
    v_add_f32 v11, v19, v19
    v_mul_f32 v18, v11, v11
    v_mul_f32 v19, v10, v11
    v_fma_f32 v10, v10, v10, -v18
    v_add_f32 v11, v19, v19
    s_waitcnt vmcnt(20)
    s_barrier
    ds_read_b128 v[32:35], v1 offset:0
    ds_read_b128 v[36:39], v1 offset:16
    ds_read_b128 v[40:43], v1 offset:32
    ds_read_b128 v[44:47], v1 offset:48
    ds_read_b128 v[48:51], v1 offset:64
    ds_read_b128 v[52:55], v1 offset:80
    ds_read_b128 v[56:59], v1 offset:96
    s_waitcnt lgkmcnt(6)
    v_mfma_f32_16x16x32_bf16 a[0:3], v[32:35], v[128:131], 0
    ds_read_b128 v[60:63], v1 offset:112
    v_mfma_f32_16x16x32_bf16 a[4:7], v[32:35], v[192:195], 0
    s_waitcnt lgkmcnt(6)
    v_mfma_f32_16x16x32_bf16 a[0:3], v[36:39], v[132:135], a[0:3]
    ds_read_b128 v[32:35], v1 offset:128
    v_mfma_f32_16x16x32_bf16 a[4:7], v[36:39], v[196:199], a[4:7]
    s_waitcnt lgkmcnt(6)
    v_mfma_f32_16x16x32_bf16 a[0:3], v[40:43], v[136:139], a[0:3]
    ds_read_b128 v[36:39], v1 offset:144
    v_mfma_f32_16x16x32_bf16 a[4:7], v[40:43], v[200:203], a[4:7]
    s_waitcnt lgkmcnt(6)
    v_mfma_f32_16x16x32_bf16 a[0:3], v[44:47], v[140:143], a[0:3]
    ds_read_b128 v[40:43], v1 offset:160
    v_mfma_f32_16x16x32_bf16 a[4:7], v[44:47], v[204:207], a[4:7]
    s_waitcnt lgkmcnt(6)
    v_mfma_f32_16x16x32_bf16 a[0:3], v[48:51], v[144:147], a[0:3]
    ds_read_b128 v[44:47], v1 offset:176
    v_mfma_f32_16x16x32_bf16 a[4:7], v[48:51], v[208:211], a[4:7]
    s_waitcnt lgkmcnt(6)
    v_mfma_f32_16x16x32_bf16 a[0:3], v[52:55], v[148:151], a[0:3]
    ds_read_b128 v[48:51], v1 offset:192
    v_mfma_f32_16x16x32_bf16 a[4:7], v[52:55], v[212:215], a[4:7]
    s_waitcnt lgkmcnt(6)
    v_mfma_f32_16x16x32_bf16 a[0:3], v[56:59], v[152:155], a[0:3]
    ds_read_b128 v[52:55], v1 offset:208
    v_mfma_f32_16x16x32_bf16 a[4:7], v[56:59], v[216:219], a[4:7]
    s_waitcnt lgkmcnt(6)
    v_mfma_f32_16x16x32_bf16 a[0:3], v[60:63], v[156:159], a[0:3]
    ds_read_b128 v[56:59], v1 offset:224
    v_mfma_f32_16x16x32_bf16 a[4:7], v[60:63], v[220:223], a[4:7]
    s_waitcnt lgkmcnt(6)
    v_mfma_f32_16x16x32_bf16 a[0:3], v[32:35], v[160:163], a[0:3]
    ds_read_b128 v[60:63], v1 offset:240
    v_mfma_f32_16x16x32_bf16 a[4:7], v[32:35], v[224:227], a[4:7]
    s_add_u32 m0, s38, 99840
    s_add_u32 s37, s39, 24576
    buffer_load_dwordx4 v0, s[28:31], s37 offen offset:0 lds
    s_add_u32 m0, m0, 16
    s_nop 0
    buffer_load_dwordx4 v0, s[28:31], s37 offen offset:1024 lds
    s_add_u32 m0, m0, 16
    s_nop 0
    buffer_load_dwordx4 v0, s[28:31], s37 offen offset:2048 lds
    s_add_u32 m0, m0, 16
    s_nop 0
    buffer_load_dwordx4 v0, s[28:31], s37 offen offset:3072 lds
    s_waitcnt vmcnt(20)
    s_barrier
    s_waitcnt lgkmcnt(6)
    v_mfma_f32_16x16x32_bf16 a[0:3], v[36:39], v[164:167], a[0:3]
    ds_read_b128 v[32:35], v1 offset:16640
    v_mfma_f32_16x16x32_bf16 a[4:7], v[36:39], v[228:231], a[4:7]
    s_waitcnt lgkmcnt(6)
    v_mfma_f32_16x16x32_bf16 a[0:3], v[40:43], v[168:171], a[0:3]
    ds_read_b128 v[36:39], v1 offset:16656
    v_mfma_f32_16x16x32_bf16 a[4:7], v[40:43], v[232:235], a[4:7]
    s_waitcnt lgkmcnt(6)
    v_mfma_f32_16x16x32_bf16 a[0:3], v[44:47], v[172:175], a[0:3]
    ds_read_b128 v[40:43], v1 offset:16672
    v_mfma_f32_16x16x32_bf16 a[4:7], v[44:47], v[236:239], a[4:7]
    s_waitcnt lgkmcnt(6)
    v_mfma_f32_16x16x32_bf16 a[0:3], v[48:51], v[176:179], a[0:3]
    ds_read_b128 v[44:47], v1 offset:16688
    v_mfma_f32_16x16x32_bf16 a[4:7], v[48:51], v[240:243], a[4:7]
    s_waitcnt lgkmcnt(6)
    v_mfma_f32_16x16x32_bf16 a[0:3], v[52:55], v[180:183], a[0:3]
    ds_read_b128 v[48:51], v1 offset:16704
    v_mfma_f32_16x16x32_bf16 a[4:7], v[52:55], v[244:247], a[4:7]
    s_waitcnt lgkmcnt(6)
    v_mfma_f32_16x16x32_bf16 a[0:3], v[56:59], v[184:187], a[0:3]
    ds_read_b128 v[52:55], v1 offset:16720
    v_mfma_f32_16x16x32_bf16 a[4:7], v[56:59], v[248:251], a[4:7]
    s_waitcnt lgkmcnt(6)
    v_mfma_f32_16x16x32_bf16 a[0:3], v[60:63], v[188:191], a[0:3]
    ds_read_b128 v[56:59], v1 offset:16736
    v_mfma_f32_16x16x32_bf16 a[4:7], v[60:63], v[252:255], a[4:7]
    s_waitcnt lgkmcnt(6)
    v_mfma_f32_16x16x32_bf16 a[8:11], v[32:35], v[128:131], 0
    ds_read_b128 v[60:63], v1 offset:16752
    v_mfma_f32_16x16x32_bf16 a[12:15], v[32:35], v[192:195], 0
    s_waitcnt lgkmcnt(6)
    v_mfma_f32_16x16x32_bf16 a[8:11], v[36:39], v[132:135], a[8:11]
    ds_read_b128 v[32:35], v1 offset:16768
    v_accvgpr_read_b32 v24, a0
    v_accvgpr_read_b32 v25, a4
    v_mfma_f32_16x16x32_bf16 a[12:15], v[36:39], v[196:199], a[12:15]
    v_mul_f32 v26, v12, v24
    v_mul_f32 v27, v12, v25
    s_waitcnt lgkmcnt(6)
    v_mfma_f32_16x16x32_bf16 a[8:11], v[40:43], v[136:139], a[8:11]
    ds_read_b128 v[36:39], v1 offset:16784
    v_fma_f32 v26, -v13, v25, v26
    v_mfma_f32_16x16x32_bf16 a[12:15], v[40:43], v[200:203], a[12:15]
    v_fma_f32 v27, v13, v24, v27
    v_accvgpr_write_b32 a0, v26
    s_waitcnt lgkmcnt(6)
    v_mfma_f32_16x16x32_bf16 a[8:11], v[44:47], v[140:143], a[8:11]
    ds_read_b128 v[40:43], v1 offset:16800
    v_accvgpr_write_b32 a4, v27
    v_fma_f32 v18, v8, v14, v26
    v_mfma_f32_16x16x32_bf16 a[12:15], v[44:47], v[204:207], a[12:15]
    v_fma_f32 v19, v8, v15, v27
    v_fma_f32 v20, -v9, v15, v18
    s_waitcnt lgkmcnt(6)
    v_mfma_f32_16x16x32_bf16 a[8:11], v[48:51], v[144:147], a[8:11]
    ds_read_b128 v[44:47], v1 offset:16816
    v_fma_f32 v21, v9, v14, v19
    v_mfma_f32_16x16x32_bf16 a[12:15], v[48:51], v[208:211], a[12:15]
    v_accvgpr_read_b32 v24, a1
    v_accvgpr_read_b32 v25, a5
    s_waitcnt lgkmcnt(6)
    v_mfma_f32_16x16x32_bf16 a[8:11], v[52:55], v[148:151], a[8:11]
    ds_read_b128 v[48:51], v1 offset:16832
    v_mul_f32 v26, v12, v24
    v_mul_f32 v27, v12, v25
    v_mfma_f32_16x16x32_bf16 a[12:15], v[52:55], v[212:215], a[12:15]
    v_fma_f32 v26, -v13, v25, v26
    v_fma_f32 v27, v13, v24, v27
    s_waitcnt lgkmcnt(6)
    v_mfma_f32_16x16x32_bf16 a[8:11], v[56:59], v[152:155], a[8:11]
    ds_read_b128 v[52:55], v1 offset:16848
    v_accvgpr_write_b32 a1, v26
    v_mfma_f32_16x16x32_bf16 a[12:15], v[56:59], v[216:219], a[12:15]
    v_accvgpr_write_b32 a5, v27
    v_fma_f32 v18, v8, v20, v26
    s_waitcnt lgkmcnt(6)
    v_mfma_f32_16x16x32_bf16 a[8:11], v[60:63], v[156:159], a[8:11]
    ds_read_b128 v[56:59], v1 offset:16864
    v_fma_f32 v19, v8, v21, v27
    v_fma_f32 v22, -v9, v21, v18
    v_mfma_f32_16x16x32_bf16 a[12:15], v[60:63], v[220:223], a[12:15]
    v_fma_f32 v23, v9, v20, v19
    v_accvgpr_read_b32 v24, a2
    s_waitcnt lgkmcnt(6)
    v_mfma_f32_16x16x32_bf16 a[8:11], v[32:35], v[160:163], a[8:11]
    ds_read_b128 v[60:63], v1 offset:16880
    v_accvgpr_read_b32 v25, a6
    v_mfma_f32_16x16x32_bf16 a[12:15], v[32:35], v[224:227], a[12:15]
    v_mul_f32 v26, v12, v24
    v_mul_f32 v27, v12, v25
    s_add_u32 m0, s38, 116480
    s_add_u32 s37, s39, 28672
    buffer_load_dwordx4 v0, s[28:31], s37 offen offset:0 lds
    s_add_u32 m0, m0, 16
    s_nop 0
    buffer_load_dwordx4 v0, s[28:31], s37 offen offset:1024 lds
    s_add_u32 m0, m0, 16
    s_nop 0
    buffer_load_dwordx4 v0, s[28:31], s37 offen offset:2048 lds
    s_add_u32 m0, m0, 16
    s_nop 0
    buffer_load_dwordx4 v0, s[28:31], s37 offen offset:3072 lds
    s_waitcnt vmcnt(20)
    s_barrier
    s_waitcnt lgkmcnt(6)
    v_mfma_f32_16x16x32_bf16 a[8:11], v[36:39], v[164:167], a[8:11]
    ds_read_b128 v[32:35], v1 offset:33280
    v_fma_f32 v26, -v13, v25, v26
    v_fma_f32 v27, v13, v24, v27
    v_mfma_f32_16x16x32_bf16 a[12:15], v[36:39], v[228:231], a[12:15]
    v_accvgpr_write_b32 a2, v26
    v_accvgpr_write_b32 a6, v27
    s_waitcnt lgkmcnt(6)
    v_mfma_f32_16x16x32_bf16 a[8:11], v[40:43], v[168:171], a[8:11]
    ds_read_b128 v[36:39], v1 offset:33296
    v_fma_f32 v18, v8, v22, v26
    v_mfma_f32_16x16x32_bf16 a[12:15], v[40:43], v[232:235], a[12:15]
    v_fma_f32 v19, v8, v23, v27
    v_fma_f32 v20, -v9, v23, v18
    s_waitcnt lgkmcnt(6)
    v_mfma_f32_16x16x32_bf16 a[8:11], v[44:47], v[172:175], a[8:11]
    ds_read_b128 v[40:43], v1 offset:33312
    v_fma_f32 v21, v9, v22, v19
    v_accvgpr_read_b32 v24, a3
    v_mfma_f32_16x16x32_bf16 a[12:15], v[44:47], v[236:239], a[12:15]
    v_accvgpr_read_b32 v25, a7
    v_mul_f32 v26, v12, v24
    s_waitcnt lgkmcnt(6)
    v_mfma_f32_16x16x32_bf16 a[8:11], v[48:51], v[176:179], a[8:11]
    ds_read_b128 v[44:47], v1 offset:33328
    v_mul_f32 v27, v12, v25
    v_mfma_f32_16x16x32_bf16 a[12:15], v[48:51], v[240:243], a[12:15]
    v_fma_f32 v26, -v13, v25, v26
    v_fma_f32 v27, v13, v24, v27
    s_waitcnt lgkmcnt(6)
    v_mfma_f32_16x16x32_bf16 a[8:11], v[52:55], v[180:183], a[8:11]
    ds_read_b128 v[48:51], v1 offset:33344
    v_accvgpr_write_b32 a3, v26
    v_accvgpr_write_b32 a7, v27
    v_mfma_f32_16x16x32_bf16 a[12:15], v[52:55], v[244:247], a[12:15]
    v_fma_f32 v18, v8, v20, v26
    v_fma_f32 v19, v8, v21, v27
    s_waitcnt lgkmcnt(6)
    v_mfma_f32_16x16x32_bf16 a[8:11], v[56:59], v[184:187], a[8:11]
    ds_read_b128 v[52:55], v1 offset:33360
    v_fma_f32 v22, -v9, v21, v18
    v_mfma_f32_16x16x32_bf16 a[12:15], v[56:59], v[248:251], a[12:15]
    v_fma_f32 v23, v9, v20, v19
    s_waitcnt lgkmcnt(6)
    v_mfma_f32_16x16x32_bf16 a[8:11], v[60:63], v[188:191], a[8:11]
    ds_read_b128 v[56:59], v1 offset:33376
    v_mfma_f32_16x16x32_bf16 a[12:15], v[60:63], v[252:255], a[12:15]
    s_waitcnt lgkmcnt(6)
    v_mfma_f32_16x16x32_bf16 a[16:19], v[32:35], v[128:131], 0
    ds_read_b128 v[60:63], v1 offset:33392
    v_mfma_f32_16x16x32_bf16 a[20:23], v[32:35], v[192:195], 0
    s_waitcnt lgkmcnt(6)
    v_mfma_f32_16x16x32_bf16 a[16:19], v[36:39], v[132:135], a[16:19]
    ds_read_b128 v[32:35], v1 offset:33408
    v_accvgpr_read_b32 v24, a8
    v_accvgpr_read_b32 v25, a12
    v_mfma_f32_16x16x32_bf16 a[20:23], v[36:39], v[196:199], a[20:23]
    v_mul_f32 v26, v12, v24
    v_mul_f32 v27, v12, v25
    s_waitcnt lgkmcnt(6)
    v_mfma_f32_16x16x32_bf16 a[16:19], v[40:43], v[136:139], a[16:19]
    ds_read_b128 v[36:39], v1 offset:33424
    v_fma_f32 v26, -v13, v25, v26
    v_mfma_f32_16x16x32_bf16 a[20:23], v[40:43], v[200:203], a[20:23]
    v_fma_f32 v27, v13, v24, v27
    v_accvgpr_write_b32 a8, v26
    s_waitcnt lgkmcnt(6)
    v_mfma_f32_16x16x32_bf16 a[16:19], v[44:47], v[140:143], a[16:19]
    ds_read_b128 v[40:43], v1 offset:33440
    v_accvgpr_write_b32 a12, v27
    v_fma_f32 v18, v8, v22, v26
    v_mfma_f32_16x16x32_bf16 a[20:23], v[44:47], v[204:207], a[20:23]
    v_fma_f32 v19, v8, v23, v27
    v_fma_f32 v20, -v9, v23, v18
    s_waitcnt lgkmcnt(6)
    v_mfma_f32_16x16x32_bf16 a[16:19], v[48:51], v[144:147], a[16:19]
    ds_read_b128 v[44:47], v1 offset:33456
    v_fma_f32 v21, v9, v22, v19
    v_mfma_f32_16x16x32_bf16 a[20:23], v[48:51], v[208:211], a[20:23]
    v_accvgpr_read_b32 v24, a9
    v_accvgpr_read_b32 v25, a13
    s_waitcnt lgkmcnt(6)
    v_mfma_f32_16x16x32_bf16 a[16:19], v[52:55], v[148:151], a[16:19]
    ds_read_b128 v[48:51], v1 offset:33472
    v_mul_f32 v26, v12, v24
    v_mul_f32 v27, v12, v25
    v_mfma_f32_16x16x32_bf16 a[20:23], v[52:55], v[212:215], a[20:23]
    v_fma_f32 v26, -v13, v25, v26
    v_fma_f32 v27, v13, v24, v27
    s_waitcnt lgkmcnt(6)
    v_mfma_f32_16x16x32_bf16 a[16:19], v[56:59], v[152:155], a[16:19]
    ds_read_b128 v[52:55], v1 offset:33488
    v_accvgpr_write_b32 a9, v26
    v_mfma_f32_16x16x32_bf16 a[20:23], v[56:59], v[216:219], a[20:23]
    v_accvgpr_write_b32 a13, v27
    v_fma_f32 v18, v8, v20, v26
    s_waitcnt lgkmcnt(6)
    v_mfma_f32_16x16x32_bf16 a[16:19], v[60:63], v[156:159], a[16:19]
    ds_read_b128 v[56:59], v1 offset:33504
    v_fma_f32 v19, v8, v21, v27
    v_fma_f32 v22, -v9, v21, v18
    v_mfma_f32_16x16x32_bf16 a[20:23], v[60:63], v[220:223], a[20:23]
    v_fma_f32 v23, v9, v20, v19
    v_accvgpr_read_b32 v24, a10
    s_waitcnt lgkmcnt(6)
    v_mfma_f32_16x16x32_bf16 a[16:19], v[32:35], v[160:163], a[16:19]
    ds_read_b128 v[60:63], v1 offset:33520
    v_accvgpr_read_b32 v25, a14
    v_mfma_f32_16x16x32_bf16 a[20:23], v[32:35], v[224:227], a[20:23]
    v_mul_f32 v26, v12, v24
    v_mul_f32 v27, v12, v25
    s_add_u32 m0, s38, 0
    s_add_u32 s37, s39, 32768
    buffer_load_dwordx4 v0, s[28:31], s37 offen offset:0 lds
    s_add_u32 m0, m0, 16
    s_nop 0
    buffer_load_dwordx4 v0, s[28:31], s37 offen offset:1024 lds
    s_add_u32 m0, m0, 16
    s_nop 0
    buffer_load_dwordx4 v0, s[28:31], s37 offen offset:2048 lds
    s_add_u32 m0, m0, 16
    s_nop 0
    buffer_load_dwordx4 v0, s[28:31], s37 offen offset:3072 lds
    s_waitcnt vmcnt(20)
    s_barrier
    s_waitcnt lgkmcnt(6)
    v_mfma_f32_16x16x32_bf16 a[16:19], v[36:39], v[164:167], a[16:19]
    ds_read_b128 v[32:35], v2 offset:0
    v_fma_f32 v26, -v13, v25, v26
    v_fma_f32 v27, v13, v24, v27
    v_mfma_f32_16x16x32_bf16 a[20:23], v[36:39], v[228:231], a[20:23]
    v_accvgpr_write_b32 a10, v26
    v_accvgpr_write_b32 a14, v27
    s_waitcnt lgkmcnt(6)
    v_mfma_f32_16x16x32_bf16 a[16:19], v[40:43], v[168:171], a[16:19]
    ds_read_b128 v[36:39], v2 offset:16
    v_fma_f32 v18, v8, v22, v26
    v_mfma_f32_16x16x32_bf16 a[20:23], v[40:43], v[232:235], a[20:23]
    v_fma_f32 v19, v8, v23, v27
    v_fma_f32 v20, -v9, v23, v18
    s_waitcnt lgkmcnt(6)
    v_mfma_f32_16x16x32_bf16 a[16:19], v[44:47], v[172:175], a[16:19]
    ds_read_b128 v[40:43], v2 offset:32
    v_fma_f32 v21, v9, v22, v19
    v_accvgpr_read_b32 v24, a11
    v_mfma_f32_16x16x32_bf16 a[20:23], v[44:47], v[236:239], a[20:23]
    v_accvgpr_read_b32 v25, a15
    v_mul_f32 v26, v12, v24
    s_waitcnt lgkmcnt(6)
    v_mfma_f32_16x16x32_bf16 a[16:19], v[48:51], v[176:179], a[16:19]
    ds_read_b128 v[44:47], v2 offset:48
    v_mul_f32 v27, v12, v25
    v_mfma_f32_16x16x32_bf16 a[20:23], v[48:51], v[240:243], a[20:23]
    v_fma_f32 v26, -v13, v25, v26
    v_fma_f32 v27, v13, v24, v27
    s_waitcnt lgkmcnt(6)
    v_mfma_f32_16x16x32_bf16 a[16:19], v[52:55], v[180:183], a[16:19]
    ds_read_b128 v[48:51], v2 offset:64
    v_accvgpr_write_b32 a11, v26
    v_accvgpr_write_b32 a15, v27
    v_mfma_f32_16x16x32_bf16 a[20:23], v[52:55], v[244:247], a[20:23]
    v_fma_f32 v18, v8, v20, v26
    v_fma_f32 v19, v8, v21, v27
    s_waitcnt lgkmcnt(6)
    v_mfma_f32_16x16x32_bf16 a[16:19], v[56:59], v[184:187], a[16:19]
    ds_read_b128 v[52:55], v2 offset:80
    v_fma_f32 v22, -v9, v21, v18
    v_mfma_f32_16x16x32_bf16 a[20:23], v[56:59], v[248:251], a[20:23]
    v_fma_f32 v23, v9, v20, v19
    s_waitcnt lgkmcnt(6)
    v_mfma_f32_16x16x32_bf16 a[16:19], v[60:63], v[188:191], a[16:19]
    ds_read_b128 v[56:59], v2 offset:96
    v_mfma_f32_16x16x32_bf16 a[20:23], v[60:63], v[252:255], a[20:23]
    s_waitcnt lgkmcnt(6)
    v_mfma_f32_16x16x32_bf16 a[24:27], v[32:35], v[128:131], 0
    ds_read_b128 v[60:63], v2 offset:112
    v_mfma_f32_16x16x32_bf16 a[28:31], v[32:35], v[192:195], 0
    s_waitcnt lgkmcnt(6)
    v_mfma_f32_16x16x32_bf16 a[24:27], v[36:39], v[132:135], a[24:27]
    ds_read_b128 v[32:35], v2 offset:128
    v_accvgpr_read_b32 v24, a16
    v_accvgpr_read_b32 v25, a20
    v_mfma_f32_16x16x32_bf16 a[28:31], v[36:39], v[196:199], a[28:31]
    v_mul_f32 v26, v12, v24
    v_mul_f32 v27, v12, v25
    s_waitcnt lgkmcnt(6)
    v_mfma_f32_16x16x32_bf16 a[24:27], v[40:43], v[136:139], a[24:27]
    ds_read_b128 v[36:39], v2 offset:144
    v_fma_f32 v26, -v13, v25, v26
    v_mfma_f32_16x16x32_bf16 a[28:31], v[40:43], v[200:203], a[28:31]
    v_fma_f32 v27, v13, v24, v27
    v_accvgpr_write_b32 a16, v26
    s_waitcnt lgkmcnt(6)
    v_mfma_f32_16x16x32_bf16 a[24:27], v[44:47], v[140:143], a[24:27]
    ds_read_b128 v[40:43], v2 offset:160
    v_accvgpr_write_b32 a20, v27
    v_fma_f32 v18, v8, v22, v26
    v_mfma_f32_16x16x32_bf16 a[28:31], v[44:47], v[204:207], a[28:31]
    v_fma_f32 v19, v8, v23, v27
    v_fma_f32 v20, -v9, v23, v18
    s_waitcnt lgkmcnt(6)
    v_mfma_f32_16x16x32_bf16 a[24:27], v[48:51], v[144:147], a[24:27]
    ds_read_b128 v[44:47], v2 offset:176
    v_fma_f32 v21, v9, v22, v19
    v_mfma_f32_16x16x32_bf16 a[28:31], v[48:51], v[208:211], a[28:31]
    v_accvgpr_read_b32 v24, a17
    v_accvgpr_read_b32 v25, a21
    s_waitcnt lgkmcnt(6)
    v_mfma_f32_16x16x32_bf16 a[24:27], v[52:55], v[148:151], a[24:27]
    ds_read_b128 v[48:51], v2 offset:192
    v_mul_f32 v26, v12, v24
    v_mul_f32 v27, v12, v25
    v_mfma_f32_16x16x32_bf16 a[28:31], v[52:55], v[212:215], a[28:31]
    v_fma_f32 v26, -v13, v25, v26
    v_fma_f32 v27, v13, v24, v27
    s_waitcnt lgkmcnt(6)
    v_mfma_f32_16x16x32_bf16 a[24:27], v[56:59], v[152:155], a[24:27]
    ds_read_b128 v[52:55], v2 offset:208
    v_accvgpr_write_b32 a17, v26
    v_mfma_f32_16x16x32_bf16 a[28:31], v[56:59], v[216:219], a[28:31]
    v_accvgpr_write_b32 a21, v27
    v_fma_f32 v18, v8, v20, v26
    s_waitcnt lgkmcnt(6)
    v_mfma_f32_16x16x32_bf16 a[24:27], v[60:63], v[156:159], a[24:27]
    ds_read_b128 v[56:59], v2 offset:224
    v_fma_f32 v19, v8, v21, v27
    v_fma_f32 v22, -v9, v21, v18
    v_mfma_f32_16x16x32_bf16 a[28:31], v[60:63], v[220:223], a[28:31]
    v_fma_f32 v23, v9, v20, v19
    v_accvgpr_read_b32 v24, a18
    s_waitcnt lgkmcnt(6)
    v_mfma_f32_16x16x32_bf16 a[24:27], v[32:35], v[160:163], a[24:27]
    ds_read_b128 v[60:63], v2 offset:240
    v_accvgpr_read_b32 v25, a22
    v_mfma_f32_16x16x32_bf16 a[28:31], v[32:35], v[224:227], a[28:31]
    v_mul_f32 v26, v12, v24
    v_mul_f32 v27, v12, v25
    s_add_u32 m0, s38, 16640
    s_add_u32 s37, s39, 36864
    buffer_load_dwordx4 v0, s[28:31], s37 offen offset:0 lds
    s_add_u32 m0, m0, 16
    s_nop 0
    buffer_load_dwordx4 v0, s[28:31], s37 offen offset:1024 lds
    s_add_u32 m0, m0, 16
    s_nop 0
    buffer_load_dwordx4 v0, s[28:31], s37 offen offset:2048 lds
    s_add_u32 m0, m0, 16
    s_nop 0
    buffer_load_dwordx4 v0, s[28:31], s37 offen offset:3072 lds
    s_waitcnt vmcnt(20)
    s_barrier
    s_waitcnt lgkmcnt(6)
    v_mfma_f32_16x16x32_bf16 a[24:27], v[36:39], v[164:167], a[24:27]
    ds_read_b128 v[32:35], v2 offset:16640
    v_fma_f32 v26, -v13, v25, v26
    v_fma_f32 v27, v13, v24, v27
    v_mfma_f32_16x16x32_bf16 a[28:31], v[36:39], v[228:231], a[28:31]
    v_accvgpr_write_b32 a18, v26
    v_accvgpr_write_b32 a22, v27
    s_waitcnt lgkmcnt(6)
    v_mfma_f32_16x16x32_bf16 a[24:27], v[40:43], v[168:171], a[24:27]
    ds_read_b128 v[36:39], v2 offset:16656
    v_fma_f32 v18, v8, v22, v26
    v_mfma_f32_16x16x32_bf16 a[28:31], v[40:43], v[232:235], a[28:31]
    v_fma_f32 v19, v8, v23, v27
    v_fma_f32 v20, -v9, v23, v18
    s_waitcnt lgkmcnt(6)
    v_mfma_f32_16x16x32_bf16 a[24:27], v[44:47], v[172:175], a[24:27]
    ds_read_b128 v[40:43], v2 offset:16672
    v_fma_f32 v21, v9, v22, v19
    v_accvgpr_read_b32 v24, a19
    v_mfma_f32_16x16x32_bf16 a[28:31], v[44:47], v[236:239], a[28:31]
    v_accvgpr_read_b32 v25, a23
    v_mul_f32 v26, v12, v24
    s_waitcnt lgkmcnt(6)
    v_mfma_f32_16x16x32_bf16 a[24:27], v[48:51], v[176:179], a[24:27]
    ds_read_b128 v[44:47], v2 offset:16688
    v_mul_f32 v27, v12, v25
    v_mfma_f32_16x16x32_bf16 a[28:31], v[48:51], v[240:243], a[28:31]
    v_fma_f32 v26, -v13, v25, v26
    v_fma_f32 v27, v13, v24, v27
    s_waitcnt lgkmcnt(6)
    v_mfma_f32_16x16x32_bf16 a[24:27], v[52:55], v[180:183], a[24:27]
    ds_read_b128 v[48:51], v2 offset:16704
    v_accvgpr_write_b32 a19, v26
    v_accvgpr_write_b32 a23, v27
    v_mfma_f32_16x16x32_bf16 a[28:31], v[52:55], v[244:247], a[28:31]
    v_fma_f32 v18, v8, v20, v26
    v_fma_f32 v19, v8, v21, v27
    s_waitcnt lgkmcnt(6)
    v_mfma_f32_16x16x32_bf16 a[24:27], v[56:59], v[184:187], a[24:27]
    ds_read_b128 v[52:55], v2 offset:16720
    v_fma_f32 v22, -v9, v21, v18
    v_mfma_f32_16x16x32_bf16 a[28:31], v[56:59], v[248:251], a[28:31]
    v_fma_f32 v23, v9, v20, v19
    s_waitcnt lgkmcnt(6)
    v_mfma_f32_16x16x32_bf16 a[24:27], v[60:63], v[188:191], a[24:27]
    ds_read_b128 v[56:59], v2 offset:16736
    v_mfma_f32_16x16x32_bf16 a[28:31], v[60:63], v[252:255], a[28:31]
    s_waitcnt lgkmcnt(6)
    v_mfma_f32_16x16x32_bf16 a[32:35], v[32:35], v[128:131], 0
    ds_read_b128 v[60:63], v2 offset:16752
    v_mfma_f32_16x16x32_bf16 a[36:39], v[32:35], v[192:195], 0
    s_waitcnt lgkmcnt(6)
    v_mfma_f32_16x16x32_bf16 a[32:35], v[36:39], v[132:135], a[32:35]
    ds_read_b128 v[32:35], v2 offset:16768
    v_accvgpr_read_b32 v24, a24
    v_accvgpr_read_b32 v25, a28
    v_mfma_f32_16x16x32_bf16 a[36:39], v[36:39], v[196:199], a[36:39]
    v_mul_f32 v26, v12, v24
    v_mul_f32 v27, v12, v25
    s_waitcnt lgkmcnt(6)
    v_mfma_f32_16x16x32_bf16 a[32:35], v[40:43], v[136:139], a[32:35]
    ds_read_b128 v[36:39], v2 offset:16784
    v_fma_f32 v26, -v13, v25, v26
    v_mfma_f32_16x16x32_bf16 a[36:39], v[40:43], v[200:203], a[36:39]
    v_fma_f32 v27, v13, v24, v27
    v_accvgpr_write_b32 a24, v26
    s_waitcnt lgkmcnt(6)
    v_mfma_f32_16x16x32_bf16 a[32:35], v[44:47], v[140:143], a[32:35]
    ds_read_b128 v[40:43], v2 offset:16800
    v_accvgpr_write_b32 a28, v27
    v_fma_f32 v18, v8, v22, v26
    v_mfma_f32_16x16x32_bf16 a[36:39], v[44:47], v[204:207], a[36:39]
    v_fma_f32 v19, v8, v23, v27
    v_fma_f32 v20, -v9, v23, v18
    s_waitcnt lgkmcnt(6)
    v_mfma_f32_16x16x32_bf16 a[32:35], v[48:51], v[144:147], a[32:35]
    ds_read_b128 v[44:47], v2 offset:16816
    v_fma_f32 v21, v9, v22, v19
    v_mfma_f32_16x16x32_bf16 a[36:39], v[48:51], v[208:211], a[36:39]
    v_accvgpr_read_b32 v24, a25
    v_accvgpr_read_b32 v25, a29
    s_waitcnt lgkmcnt(6)
    v_mfma_f32_16x16x32_bf16 a[32:35], v[52:55], v[148:151], a[32:35]
    ds_read_b128 v[48:51], v2 offset:16832
    v_mul_f32 v26, v12, v24
    v_mul_f32 v27, v12, v25
    v_mfma_f32_16x16x32_bf16 a[36:39], v[52:55], v[212:215], a[36:39]
    v_fma_f32 v26, -v13, v25, v26
    v_fma_f32 v27, v13, v24, v27
    s_waitcnt lgkmcnt(6)
    v_mfma_f32_16x16x32_bf16 a[32:35], v[56:59], v[152:155], a[32:35]
    ds_read_b128 v[52:55], v2 offset:16848
    v_accvgpr_write_b32 a25, v26
    v_mfma_f32_16x16x32_bf16 a[36:39], v[56:59], v[216:219], a[36:39]
    v_accvgpr_write_b32 a29, v27
    v_fma_f32 v18, v8, v20, v26
    s_waitcnt lgkmcnt(6)
    v_mfma_f32_16x16x32_bf16 a[32:35], v[60:63], v[156:159], a[32:35]
    ds_read_b128 v[56:59], v2 offset:16864
    v_fma_f32 v19, v8, v21, v27
    v_fma_f32 v22, -v9, v21, v18
    v_mfma_f32_16x16x32_bf16 a[36:39], v[60:63], v[220:223], a[36:39]
    v_fma_f32 v23, v9, v20, v19
    v_accvgpr_read_b32 v24, a26
    s_waitcnt lgkmcnt(6)
    v_mfma_f32_16x16x32_bf16 a[32:35], v[32:35], v[160:163], a[32:35]
    ds_read_b128 v[60:63], v2 offset:16880
    v_accvgpr_read_b32 v25, a30
    v_mfma_f32_16x16x32_bf16 a[36:39], v[32:35], v[224:227], a[36:39]
    v_mul_f32 v26, v12, v24
    v_mul_f32 v27, v12, v25
    s_add_u32 m0, s38, 33280
    s_add_u32 s37, s39, 40960
    buffer_load_dwordx4 v0, s[28:31], s37 offen offset:0 lds
    s_add_u32 m0, m0, 16
    s_nop 0
    buffer_load_dwordx4 v0, s[28:31], s37 offen offset:1024 lds
    s_add_u32 m0, m0, 16
    s_nop 0
    buffer_load_dwordx4 v0, s[28:31], s37 offen offset:2048 lds
    s_add_u32 m0, m0, 16
    s_nop 0
    buffer_load_dwordx4 v0, s[28:31], s37 offen offset:3072 lds
    s_waitcnt vmcnt(20)
    s_barrier
    s_waitcnt lgkmcnt(6)
    v_mfma_f32_16x16x32_bf16 a[32:35], v[36:39], v[164:167], a[32:35]
    ds_read_b128 v[32:35], v2 offset:33280
    v_fma_f32 v26, -v13, v25, v26
    v_fma_f32 v27, v13, v24, v27
    v_mfma_f32_16x16x32_bf16 a[36:39], v[36:39], v[228:231], a[36:39]
    v_accvgpr_write_b32 a26, v26
    v_accvgpr_write_b32 a30, v27
    s_waitcnt lgkmcnt(6)
    v_mfma_f32_16x16x32_bf16 a[32:35], v[40:43], v[168:171], a[32:35]
    ds_read_b128 v[36:39], v2 offset:33296
    v_fma_f32 v18, v8, v22, v26
    v_mfma_f32_16x16x32_bf16 a[36:39], v[40:43], v[232:235], a[36:39]
    v_fma_f32 v19, v8, v23, v27
    v_fma_f32 v20, -v9, v23, v18
    s_waitcnt lgkmcnt(6)
    v_mfma_f32_16x16x32_bf16 a[32:35], v[44:47], v[172:175], a[32:35]
    ds_read_b128 v[40:43], v2 offset:33312
    v_fma_f32 v21, v9, v22, v19
    v_accvgpr_read_b32 v24, a27
    v_mfma_f32_16x16x32_bf16 a[36:39], v[44:47], v[236:239], a[36:39]
    v_accvgpr_read_b32 v25, a31
    v_mul_f32 v26, v12, v24
    s_waitcnt lgkmcnt(6)
    v_mfma_f32_16x16x32_bf16 a[32:35], v[48:51], v[176:179], a[32:35]
    ds_read_b128 v[44:47], v2 offset:33328
    v_mul_f32 v27, v12, v25
    v_mfma_f32_16x16x32_bf16 a[36:39], v[48:51], v[240:243], a[36:39]
    v_fma_f32 v26, -v13, v25, v26
    v_fma_f32 v27, v13, v24, v27
    s_waitcnt lgkmcnt(6)
    v_mfma_f32_16x16x32_bf16 a[32:35], v[52:55], v[180:183], a[32:35]
    ds_read_b128 v[48:51], v2 offset:33344
    v_accvgpr_write_b32 a27, v26
    v_accvgpr_write_b32 a31, v27
    v_mfma_f32_16x16x32_bf16 a[36:39], v[52:55], v[244:247], a[36:39]
    v_fma_f32 v18, v8, v20, v26
    v_fma_f32 v19, v8, v21, v27
    s_waitcnt lgkmcnt(6)
    v_mfma_f32_16x16x32_bf16 a[32:35], v[56:59], v[184:187], a[32:35]
    ds_read_b128 v[52:55], v2 offset:33360
    v_fma_f32 v22, -v9, v21, v18
    v_mfma_f32_16x16x32_bf16 a[36:39], v[56:59], v[248:251], a[36:39]
    v_fma_f32 v23, v9, v20, v19
    s_waitcnt lgkmcnt(6)
    v_mfma_f32_16x16x32_bf16 a[32:35], v[60:63], v[188:191], a[32:35]
    ds_read_b128 v[56:59], v2 offset:33376
    v_mfma_f32_16x16x32_bf16 a[36:39], v[60:63], v[252:255], a[36:39]
    s_waitcnt lgkmcnt(6)
    v_mfma_f32_16x16x32_bf16 a[40:43], v[32:35], v[128:131], 0
    ds_read_b128 v[60:63], v2 offset:33392
    v_mfma_f32_16x16x32_bf16 a[44:47], v[32:35], v[192:195], 0
    s_waitcnt lgkmcnt(6)
    v_mfma_f32_16x16x32_bf16 a[40:43], v[36:39], v[132:135], a[40:43]
    ds_read_b128 v[32:35], v2 offset:33408
    v_accvgpr_read_b32 v24, a32
    v_accvgpr_read_b32 v25, a36
    v_mfma_f32_16x16x32_bf16 a[44:47], v[36:39], v[196:199], a[44:47]
    v_mul_f32 v26, v12, v24
    v_mul_f32 v27, v12, v25
    s_waitcnt lgkmcnt(6)
    v_mfma_f32_16x16x32_bf16 a[40:43], v[40:43], v[136:139], a[40:43]
    ds_read_b128 v[36:39], v2 offset:33424
    v_fma_f32 v26, -v13, v25, v26
    v_mfma_f32_16x16x32_bf16 a[44:47], v[40:43], v[200:203], a[44:47]
    v_fma_f32 v27, v13, v24, v27
    v_accvgpr_write_b32 a32, v26
    s_waitcnt lgkmcnt(6)
    v_mfma_f32_16x16x32_bf16 a[40:43], v[44:47], v[140:143], a[40:43]
    ds_read_b128 v[40:43], v2 offset:33440
    v_accvgpr_write_b32 a36, v27
    v_fma_f32 v18, v8, v22, v26
    v_mfma_f32_16x16x32_bf16 a[44:47], v[44:47], v[204:207], a[44:47]
    v_fma_f32 v19, v8, v23, v27
    v_fma_f32 v20, -v9, v23, v18
    s_waitcnt lgkmcnt(6)
    v_mfma_f32_16x16x32_bf16 a[40:43], v[48:51], v[144:147], a[40:43]
    ds_read_b128 v[44:47], v2 offset:33456
    v_fma_f32 v21, v9, v22, v19
    v_mfma_f32_16x16x32_bf16 a[44:47], v[48:51], v[208:211], a[44:47]
    v_accvgpr_read_b32 v24, a33
    v_accvgpr_read_b32 v25, a37
    s_waitcnt lgkmcnt(6)
    v_mfma_f32_16x16x32_bf16 a[40:43], v[52:55], v[148:151], a[40:43]
    ds_read_b128 v[48:51], v2 offset:33472
    v_mul_f32 v26, v12, v24
    v_mul_f32 v27, v12, v25
    v_mfma_f32_16x16x32_bf16 a[44:47], v[52:55], v[212:215], a[44:47]
    v_fma_f32 v26, -v13, v25, v26
    v_fma_f32 v27, v13, v24, v27
    s_waitcnt lgkmcnt(6)
    v_mfma_f32_16x16x32_bf16 a[40:43], v[56:59], v[152:155], a[40:43]
    ds_read_b128 v[52:55], v2 offset:33488
    v_accvgpr_write_b32 a33, v26
    v_mfma_f32_16x16x32_bf16 a[44:47], v[56:59], v[216:219], a[44:47]
    v_accvgpr_write_b32 a37, v27
    v_fma_f32 v18, v8, v20, v26
    s_waitcnt lgkmcnt(6)
    v_mfma_f32_16x16x32_bf16 a[40:43], v[60:63], v[156:159], a[40:43]
    ds_read_b128 v[56:59], v2 offset:33504
    v_fma_f32 v19, v8, v21, v27
    v_fma_f32 v22, -v9, v21, v18
    v_mfma_f32_16x16x32_bf16 a[44:47], v[60:63], v[220:223], a[44:47]
    v_fma_f32 v23, v9, v20, v19
    v_accvgpr_read_b32 v24, a34
    s_waitcnt lgkmcnt(6)
    v_mfma_f32_16x16x32_bf16 a[40:43], v[32:35], v[160:163], a[40:43]
    ds_read_b128 v[60:63], v2 offset:33520
    v_accvgpr_read_b32 v25, a38
    v_mfma_f32_16x16x32_bf16 a[44:47], v[32:35], v[224:227], a[44:47]
    v_mul_f32 v26, v12, v24
    v_mul_f32 v27, v12, v25
    s_add_u32 m0, s38, 49920
    s_add_u32 s37, s39, 45056
    buffer_load_dwordx4 v0, s[28:31], s37 offen offset:0 lds
    s_add_u32 m0, m0, 16
    s_nop 0
    buffer_load_dwordx4 v0, s[28:31], s37 offen offset:1024 lds
    s_add_u32 m0, m0, 16
    s_nop 0
    buffer_load_dwordx4 v0, s[28:31], s37 offen offset:2048 lds
    s_add_u32 m0, m0, 16
    s_nop 0
    buffer_load_dwordx4 v0, s[28:31], s37 offen offset:3072 lds
    s_waitcnt vmcnt(20)
    s_barrier
    s_waitcnt lgkmcnt(6)
    v_mfma_f32_16x16x32_bf16 a[40:43], v[36:39], v[164:167], a[40:43]
    ds_read_b128 v[32:35], v3 offset:0
    v_fma_f32 v26, -v13, v25, v26
    v_fma_f32 v27, v13, v24, v27
    v_mfma_f32_16x16x32_bf16 a[44:47], v[36:39], v[228:231], a[44:47]
    v_accvgpr_write_b32 a34, v26
    v_accvgpr_write_b32 a38, v27
    s_waitcnt lgkmcnt(6)
    v_mfma_f32_16x16x32_bf16 a[40:43], v[40:43], v[168:171], a[40:43]
    ds_read_b128 v[36:39], v3 offset:16
    v_fma_f32 v18, v8, v22, v26
    v_mfma_f32_16x16x32_bf16 a[44:47], v[40:43], v[232:235], a[44:47]
    v_fma_f32 v19, v8, v23, v27
    v_fma_f32 v20, -v9, v23, v18
    s_waitcnt lgkmcnt(6)
    v_mfma_f32_16x16x32_bf16 a[40:43], v[44:47], v[172:175], a[40:43]
    ds_read_b128 v[40:43], v3 offset:32
    v_fma_f32 v21, v9, v22, v19
    v_accvgpr_read_b32 v24, a35
    v_mfma_f32_16x16x32_bf16 a[44:47], v[44:47], v[236:239], a[44:47]
    v_accvgpr_read_b32 v25, a39
    v_mul_f32 v26, v12, v24
    s_waitcnt lgkmcnt(6)
    v_mfma_f32_16x16x32_bf16 a[40:43], v[48:51], v[176:179], a[40:43]
    ds_read_b128 v[44:47], v3 offset:48
    v_mul_f32 v27, v12, v25
    v_mfma_f32_16x16x32_bf16 a[44:47], v[48:51], v[240:243], a[44:47]
    v_fma_f32 v26, -v13, v25, v26
    v_fma_f32 v27, v13, v24, v27
    s_waitcnt lgkmcnt(6)
    v_mfma_f32_16x16x32_bf16 a[40:43], v[52:55], v[180:183], a[40:43]
    ds_read_b128 v[48:51], v3 offset:64
    v_accvgpr_write_b32 a35, v26
    v_accvgpr_write_b32 a39, v27
    v_mfma_f32_16x16x32_bf16 a[44:47], v[52:55], v[244:247], a[44:47]
    v_fma_f32 v18, v8, v20, v26
    v_fma_f32 v19, v8, v21, v27
    s_waitcnt lgkmcnt(6)
    v_mfma_f32_16x16x32_bf16 a[40:43], v[56:59], v[184:187], a[40:43]
    ds_read_b128 v[52:55], v3 offset:80
    v_fma_f32 v22, -v9, v21, v18
    v_mfma_f32_16x16x32_bf16 a[44:47], v[56:59], v[248:251], a[44:47]
    v_fma_f32 v23, v9, v20, v19
    s_waitcnt lgkmcnt(6)
    v_mfma_f32_16x16x32_bf16 a[40:43], v[60:63], v[188:191], a[40:43]
    ds_read_b128 v[56:59], v3 offset:96
    v_mfma_f32_16x16x32_bf16 a[44:47], v[60:63], v[252:255], a[44:47]
    s_waitcnt lgkmcnt(6)
    v_mfma_f32_16x16x32_bf16 a[48:51], v[32:35], v[128:131], 0
    ds_read_b128 v[60:63], v3 offset:112
    v_mfma_f32_16x16x32_bf16 a[52:55], v[32:35], v[192:195], 0
    s_waitcnt lgkmcnt(6)
    v_mfma_f32_16x16x32_bf16 a[48:51], v[36:39], v[132:135], a[48:51]
    ds_read_b128 v[32:35], v3 offset:128
    v_accvgpr_read_b32 v24, a40
    v_accvgpr_read_b32 v25, a44
    v_mfma_f32_16x16x32_bf16 a[52:55], v[36:39], v[196:199], a[52:55]
    v_mul_f32 v26, v12, v24
    v_mul_f32 v27, v12, v25
    s_waitcnt lgkmcnt(6)
    v_mfma_f32_16x16x32_bf16 a[48:51], v[40:43], v[136:139], a[48:51]
    ds_read_b128 v[36:39], v3 offset:144
    v_fma_f32 v26, -v13, v25, v26
    v_mfma_f32_16x16x32_bf16 a[52:55], v[40:43], v[200:203], a[52:55]
    v_fma_f32 v27, v13, v24, v27
    v_accvgpr_write_b32 a40, v26
    s_waitcnt lgkmcnt(6)
    v_mfma_f32_16x16x32_bf16 a[48:51], v[44:47], v[140:143], a[48:51]
    ds_read_b128 v[40:43], v3 offset:160
    v_accvgpr_write_b32 a44, v27
    v_fma_f32 v18, v8, v22, v26
    v_mfma_f32_16x16x32_bf16 a[52:55], v[44:47], v[204:207], a[52:55]
    v_fma_f32 v19, v8, v23, v27
    v_fma_f32 v20, -v9, v23, v18
    s_waitcnt lgkmcnt(6)
    v_mfma_f32_16x16x32_bf16 a[48:51], v[48:51], v[144:147], a[48:51]
    ds_read_b128 v[44:47], v3 offset:176
    v_fma_f32 v21, v9, v22, v19
    v_mfma_f32_16x16x32_bf16 a[52:55], v[48:51], v[208:211], a[52:55]
    v_accvgpr_read_b32 v24, a41
    v_accvgpr_read_b32 v25, a45
    s_waitcnt lgkmcnt(6)
    v_mfma_f32_16x16x32_bf16 a[48:51], v[52:55], v[148:151], a[48:51]
    ds_read_b128 v[48:51], v3 offset:192
    v_mul_f32 v26, v12, v24
    v_mul_f32 v27, v12, v25
    v_mfma_f32_16x16x32_bf16 a[52:55], v[52:55], v[212:215], a[52:55]
    v_fma_f32 v26, -v13, v25, v26
    v_fma_f32 v27, v13, v24, v27
    s_waitcnt lgkmcnt(6)
    v_mfma_f32_16x16x32_bf16 a[48:51], v[56:59], v[152:155], a[48:51]
    ds_read_b128 v[52:55], v3 offset:208
    v_accvgpr_write_b32 a41, v26
    v_mfma_f32_16x16x32_bf16 a[52:55], v[56:59], v[216:219], a[52:55]
    v_accvgpr_write_b32 a45, v27
    v_fma_f32 v18, v8, v20, v26
    s_waitcnt lgkmcnt(6)
    v_mfma_f32_16x16x32_bf16 a[48:51], v[60:63], v[156:159], a[48:51]
    ds_read_b128 v[56:59], v3 offset:224
    v_fma_f32 v19, v8, v21, v27
    v_fma_f32 v22, -v9, v21, v18
    v_mfma_f32_16x16x32_bf16 a[52:55], v[60:63], v[220:223], a[52:55]
    v_fma_f32 v23, v9, v20, v19
    v_accvgpr_read_b32 v24, a42
    s_waitcnt lgkmcnt(6)
    v_mfma_f32_16x16x32_bf16 a[48:51], v[32:35], v[160:163], a[48:51]
    ds_read_b128 v[60:63], v3 offset:240
    v_accvgpr_read_b32 v25, a46
    v_mfma_f32_16x16x32_bf16 a[52:55], v[32:35], v[224:227], a[52:55]
    v_mul_f32 v26, v12, v24
    v_mul_f32 v27, v12, v25
    s_add_u32 m0, s38, 66560
    s_add_u32 s37, s39, 49152
    buffer_load_dwordx4 v0, s[28:31], s37 offen offset:0 lds
    s_add_u32 m0, m0, 16
    s_nop 0
    buffer_load_dwordx4 v0, s[28:31], s37 offen offset:1024 lds
    s_add_u32 m0, m0, 16
    s_nop 0
    buffer_load_dwordx4 v0, s[28:31], s37 offen offset:2048 lds
    s_add_u32 m0, m0, 16
    s_nop 0
    buffer_load_dwordx4 v0, s[28:31], s37 offen offset:3072 lds
    s_waitcnt vmcnt(20)
    s_barrier
    s_waitcnt lgkmcnt(6)
    v_mfma_f32_16x16x32_bf16 a[48:51], v[36:39], v[164:167], a[48:51]
    ds_read_b128 v[32:35], v3 offset:16640
    v_fma_f32 v26, -v13, v25, v26
    v_fma_f32 v27, v13, v24, v27
    v_mfma_f32_16x16x32_bf16 a[52:55], v[36:39], v[228:231], a[52:55]
    v_accvgpr_write_b32 a42, v26
    v_accvgpr_write_b32 a46, v27
    s_waitcnt lgkmcnt(6)
    v_mfma_f32_16x16x32_bf16 a[48:51], v[40:43], v[168:171], a[48:51]
    ds_read_b128 v[36:39], v3 offset:16656
    v_fma_f32 v18, v8, v22, v26
    v_mfma_f32_16x16x32_bf16 a[52:55], v[40:43], v[232:235], a[52:55]
    v_fma_f32 v19, v8, v23, v27
    v_fma_f32 v20, -v9, v23, v18
    s_waitcnt lgkmcnt(6)
    v_mfma_f32_16x16x32_bf16 a[48:51], v[44:47], v[172:175], a[48:51]
    ds_read_b128 v[40:43], v3 offset:16672
    v_fma_f32 v21, v9, v22, v19
    v_accvgpr_read_b32 v24, a43
    v_mfma_f32_16x16x32_bf16 a[52:55], v[44:47], v[236:239], a[52:55]
    v_accvgpr_read_b32 v25, a47
    v_mul_f32 v26, v12, v24
    s_waitcnt lgkmcnt(6)
    v_mfma_f32_16x16x32_bf16 a[48:51], v[48:51], v[176:179], a[48:51]
    ds_read_b128 v[44:47], v3 offset:16688
    v_mul_f32 v27, v12, v25
    v_mfma_f32_16x16x32_bf16 a[52:55], v[48:51], v[240:243], a[52:55]
    v_fma_f32 v26, -v13, v25, v26
    v_fma_f32 v27, v13, v24, v27
    s_waitcnt lgkmcnt(6)
    v_mfma_f32_16x16x32_bf16 a[48:51], v[52:55], v[180:183], a[48:51]
    ds_read_b128 v[48:51], v3 offset:16704
    v_accvgpr_write_b32 a43, v26
    v_accvgpr_write_b32 a47, v27
    v_mfma_f32_16x16x32_bf16 a[52:55], v[52:55], v[244:247], a[52:55]
    v_fma_f32 v18, v8, v20, v26
    v_fma_f32 v19, v8, v21, v27
    s_waitcnt lgkmcnt(6)
    v_mfma_f32_16x16x32_bf16 a[48:51], v[56:59], v[184:187], a[48:51]
    ds_read_b128 v[52:55], v3 offset:16720
    v_fma_f32 v22, -v9, v21, v18
    v_mfma_f32_16x16x32_bf16 a[52:55], v[56:59], v[248:251], a[52:55]
    v_fma_f32 v23, v9, v20, v19
    s_waitcnt lgkmcnt(6)
    v_mfma_f32_16x16x32_bf16 a[48:51], v[60:63], v[188:191], a[48:51]
    ds_read_b128 v[56:59], v3 offset:16736
    v_mfma_f32_16x16x32_bf16 a[52:55], v[60:63], v[252:255], a[52:55]
    s_waitcnt lgkmcnt(6)
    v_mfma_f32_16x16x32_bf16 a[56:59], v[32:35], v[128:131], 0
    ds_read_b128 v[60:63], v3 offset:16752
    v_mfma_f32_16x16x32_bf16 a[60:63], v[32:35], v[192:195], 0
    s_waitcnt lgkmcnt(6)
    v_mfma_f32_16x16x32_bf16 a[56:59], v[36:39], v[132:135], a[56:59]
    ds_read_b128 v[32:35], v3 offset:16768
    v_accvgpr_read_b32 v24, a48
    v_accvgpr_read_b32 v25, a52
    v_mfma_f32_16x16x32_bf16 a[60:63], v[36:39], v[196:199], a[60:63]
    v_mul_f32 v26, v12, v24
    v_mul_f32 v27, v12, v25
    s_waitcnt lgkmcnt(6)
    v_mfma_f32_16x16x32_bf16 a[56:59], v[40:43], v[136:139], a[56:59]
    ds_read_b128 v[36:39], v3 offset:16784
    v_fma_f32 v26, -v13, v25, v26
    v_mfma_f32_16x16x32_bf16 a[60:63], v[40:43], v[200:203], a[60:63]
    v_fma_f32 v27, v13, v24, v27
    v_accvgpr_write_b32 a48, v26
    s_waitcnt lgkmcnt(6)
    v_mfma_f32_16x16x32_bf16 a[56:59], v[44:47], v[140:143], a[56:59]
    ds_read_b128 v[40:43], v3 offset:16800
    v_accvgpr_write_b32 a52, v27
    v_fma_f32 v18, v8, v22, v26
    v_mfma_f32_16x16x32_bf16 a[60:63], v[44:47], v[204:207], a[60:63]
    v_fma_f32 v19, v8, v23, v27
    v_fma_f32 v20, -v9, v23, v18
    s_waitcnt lgkmcnt(6)
    v_mfma_f32_16x16x32_bf16 a[56:59], v[48:51], v[144:147], a[56:59]
    ds_read_b128 v[44:47], v3 offset:16816
    v_fma_f32 v21, v9, v22, v19
    v_mfma_f32_16x16x32_bf16 a[60:63], v[48:51], v[208:211], a[60:63]
    v_accvgpr_read_b32 v24, a49
    v_accvgpr_read_b32 v25, a53
    s_waitcnt lgkmcnt(6)
    v_mfma_f32_16x16x32_bf16 a[56:59], v[52:55], v[148:151], a[56:59]
    ds_read_b128 v[48:51], v3 offset:16832
    v_mul_f32 v26, v12, v24
    v_mul_f32 v27, v12, v25
    v_mfma_f32_16x16x32_bf16 a[60:63], v[52:55], v[212:215], a[60:63]
    v_fma_f32 v26, -v13, v25, v26
    v_fma_f32 v27, v13, v24, v27
    s_waitcnt lgkmcnt(6)
    v_mfma_f32_16x16x32_bf16 a[56:59], v[56:59], v[152:155], a[56:59]
    ds_read_b128 v[52:55], v3 offset:16848
    v_accvgpr_write_b32 a49, v26
    v_mfma_f32_16x16x32_bf16 a[60:63], v[56:59], v[216:219], a[60:63]
    v_accvgpr_write_b32 a53, v27
    v_fma_f32 v18, v8, v20, v26
    s_waitcnt lgkmcnt(6)
    v_mfma_f32_16x16x32_bf16 a[56:59], v[60:63], v[156:159], a[56:59]
    ds_read_b128 v[56:59], v3 offset:16864
    v_fma_f32 v19, v8, v21, v27
    v_fma_f32 v22, -v9, v21, v18
    v_mfma_f32_16x16x32_bf16 a[60:63], v[60:63], v[220:223], a[60:63]
    v_fma_f32 v23, v9, v20, v19
    v_accvgpr_read_b32 v24, a50
    s_waitcnt lgkmcnt(6)
    v_mfma_f32_16x16x32_bf16 a[56:59], v[32:35], v[160:163], a[56:59]
    ds_read_b128 v[60:63], v3 offset:16880
    v_accvgpr_read_b32 v25, a54
    v_mfma_f32_16x16x32_bf16 a[60:63], v[32:35], v[224:227], a[60:63]
    v_mul_f32 v26, v12, v24
    v_mul_f32 v27, v12, v25
    s_add_u32 m0, s38, 83200
    s_add_u32 s37, s39, 53248
    buffer_load_dwordx4 v0, s[28:31], s37 offen offset:0 lds
    s_add_u32 m0, m0, 16
    s_nop 0
    buffer_load_dwordx4 v0, s[28:31], s37 offen offset:1024 lds
    s_add_u32 m0, m0, 16
    s_nop 0
    buffer_load_dwordx4 v0, s[28:31], s37 offen offset:2048 lds
    s_add_u32 m0, m0, 16
    s_nop 0
    buffer_load_dwordx4 v0, s[28:31], s37 offen offset:3072 lds
    s_waitcnt vmcnt(20)
    s_barrier
    s_waitcnt lgkmcnt(6)
    v_mfma_f32_16x16x32_bf16 a[56:59], v[36:39], v[164:167], a[56:59]
    ds_read_b128 v[32:35], v1 offset:0
    v_fma_f32 v26, -v13, v25, v26
    v_fma_f32 v27, v13, v24, v27
    v_mfma_f32_16x16x32_bf16 a[60:63], v[36:39], v[228:231], a[60:63]
    v_accvgpr_write_b32 a50, v26
    v_accvgpr_write_b32 a54, v27
    s_waitcnt lgkmcnt(6)
    v_mfma_f32_16x16x32_bf16 a[56:59], v[40:43], v[168:171], a[56:59]
    ds_read_b128 v[36:39], v1 offset:16
    v_fma_f32 v18, v8, v22, v26
    v_mfma_f32_16x16x32_bf16 a[60:63], v[40:43], v[232:235], a[60:63]
    v_fma_f32 v19, v8, v23, v27
    v_fma_f32 v20, -v9, v23, v18
    s_waitcnt lgkmcnt(6)
    v_mfma_f32_16x16x32_bf16 a[56:59], v[44:47], v[172:175], a[56:59]
    ds_read_b128 v[40:43], v1 offset:32
    v_fma_f32 v21, v9, v22, v19
    v_accvgpr_read_b32 v24, a51
    v_mfma_f32_16x16x32_bf16 a[60:63], v[44:47], v[236:239], a[60:63]
    v_accvgpr_read_b32 v25, a55
    v_mul_f32 v26, v12, v24
    s_waitcnt lgkmcnt(6)
    v_mfma_f32_16x16x32_bf16 a[56:59], v[48:51], v[176:179], a[56:59]
    ds_read_b128 v[44:47], v1 offset:48
    v_mul_f32 v27, v12, v25
    v_mfma_f32_16x16x32_bf16 a[60:63], v[48:51], v[240:243], a[60:63]
    v_fma_f32 v26, -v13, v25, v26
    v_fma_f32 v27, v13, v24, v27
    s_waitcnt lgkmcnt(6)
    v_mfma_f32_16x16x32_bf16 a[56:59], v[52:55], v[180:183], a[56:59]
    ds_read_b128 v[48:51], v1 offset:64
    v_accvgpr_write_b32 a51, v26
    v_accvgpr_write_b32 a55, v27
    v_mfma_f32_16x16x32_bf16 a[60:63], v[52:55], v[244:247], a[60:63]
    v_fma_f32 v18, v8, v20, v26
    v_fma_f32 v19, v8, v21, v27
    s_waitcnt lgkmcnt(6)
    v_mfma_f32_16x16x32_bf16 a[56:59], v[56:59], v[184:187], a[56:59]
    ds_read_b128 v[52:55], v1 offset:80
    v_fma_f32 v22, -v9, v21, v18
    v_mfma_f32_16x16x32_bf16 a[60:63], v[56:59], v[248:251], a[60:63]
    v_fma_f32 v23, v9, v20, v19
    s_waitcnt lgkmcnt(6)
    v_mfma_f32_16x16x32_bf16 a[56:59], v[60:63], v[188:191], a[56:59]
    ds_read_b128 v[56:59], v1 offset:96
    v_mfma_f32_16x16x32_bf16 a[60:63], v[60:63], v[252:255], a[60:63]
    s_waitcnt lgkmcnt(6)
    v_mfma_f32_16x16x32_bf16 a[64:67], v[32:35], v[128:131], 0
    ds_read_b128 v[60:63], v1 offset:112
    v_mfma_f32_16x16x32_bf16 a[68:71], v[32:35], v[192:195], 0
    s_waitcnt lgkmcnt(6)
    v_mfma_f32_16x16x32_bf16 a[64:67], v[36:39], v[132:135], a[64:67]
    ds_read_b128 v[32:35], v1 offset:128
    v_accvgpr_read_b32 v24, a56
    v_accvgpr_read_b32 v25, a60
    v_mfma_f32_16x16x32_bf16 a[68:71], v[36:39], v[196:199], a[68:71]
    v_mul_f32 v26, v12, v24
    v_mul_f32 v27, v12, v25
    s_waitcnt lgkmcnt(6)
    v_mfma_f32_16x16x32_bf16 a[64:67], v[40:43], v[136:139], a[64:67]
    ds_read_b128 v[36:39], v1 offset:144
    v_fma_f32 v26, -v13, v25, v26
    v_mfma_f32_16x16x32_bf16 a[68:71], v[40:43], v[200:203], a[68:71]
    v_fma_f32 v27, v13, v24, v27
    v_accvgpr_write_b32 a56, v26
    s_waitcnt lgkmcnt(6)
    v_mfma_f32_16x16x32_bf16 a[64:67], v[44:47], v[140:143], a[64:67]
    ds_read_b128 v[40:43], v1 offset:160
    v_accvgpr_write_b32 a60, v27
    v_fma_f32 v18, v8, v22, v26
    v_mfma_f32_16x16x32_bf16 a[68:71], v[44:47], v[204:207], a[68:71]
    v_fma_f32 v19, v8, v23, v27
    v_fma_f32 v20, -v9, v23, v18
    s_waitcnt lgkmcnt(6)
    v_mfma_f32_16x16x32_bf16 a[64:67], v[48:51], v[144:147], a[64:67]
    ds_read_b128 v[44:47], v1 offset:176
    v_fma_f32 v21, v9, v22, v19
    v_mfma_f32_16x16x32_bf16 a[68:71], v[48:51], v[208:211], a[68:71]
    v_accvgpr_read_b32 v24, a57
    v_accvgpr_read_b32 v25, a61
    s_waitcnt lgkmcnt(6)
    v_mfma_f32_16x16x32_bf16 a[64:67], v[52:55], v[148:151], a[64:67]
    ds_read_b128 v[48:51], v1 offset:192
    v_mul_f32 v26, v12, v24
    v_mul_f32 v27, v12, v25
    v_mfma_f32_16x16x32_bf16 a[68:71], v[52:55], v[212:215], a[68:71]
    v_fma_f32 v26, -v13, v25, v26
    v_fma_f32 v27, v13, v24, v27
    s_waitcnt lgkmcnt(6)
    v_mfma_f32_16x16x32_bf16 a[64:67], v[56:59], v[152:155], a[64:67]
    ds_read_b128 v[52:55], v1 offset:208
    v_accvgpr_write_b32 a57, v26
    v_mfma_f32_16x16x32_bf16 a[68:71], v[56:59], v[216:219], a[68:71]
    v_accvgpr_write_b32 a61, v27
    v_fma_f32 v18, v8, v20, v26
    s_waitcnt lgkmcnt(6)
    v_mfma_f32_16x16x32_bf16 a[64:67], v[60:63], v[156:159], a[64:67]
    ds_read_b128 v[56:59], v1 offset:224
    v_fma_f32 v19, v8, v21, v27
    v_fma_f32 v22, -v9, v21, v18
    v_mfma_f32_16x16x32_bf16 a[68:71], v[60:63], v[220:223], a[68:71]
    v_fma_f32 v23, v9, v20, v19
    v_accvgpr_read_b32 v24, a58
    s_waitcnt lgkmcnt(6)
    v_mfma_f32_16x16x32_bf16 a[64:67], v[32:35], v[160:163], a[64:67]
    ds_read_b128 v[60:63], v1 offset:240
    v_accvgpr_read_b32 v25, a62
    v_mfma_f32_16x16x32_bf16 a[68:71], v[32:35], v[224:227], a[68:71]
    v_mul_f32 v26, v12, v24
    v_mul_f32 v27, v12, v25
    s_add_u32 m0, s38, 99840
    s_add_u32 s37, s39, 57344
    buffer_load_dwordx4 v0, s[28:31], s37 offen offset:0 lds
    s_add_u32 m0, m0, 16
    s_nop 0
    buffer_load_dwordx4 v0, s[28:31], s37 offen offset:1024 lds
    s_add_u32 m0, m0, 16
    s_nop 0
    buffer_load_dwordx4 v0, s[28:31], s37 offen offset:2048 lds
    s_add_u32 m0, m0, 16
    s_nop 0
    buffer_load_dwordx4 v0, s[28:31], s37 offen offset:3072 lds
    s_waitcnt vmcnt(20)
    s_barrier
    s_waitcnt lgkmcnt(6)
    v_mfma_f32_16x16x32_bf16 a[64:67], v[36:39], v[164:167], a[64:67]
    ds_read_b128 v[32:35], v1 offset:16640
    v_fma_f32 v26, -v13, v25, v26
    v_fma_f32 v27, v13, v24, v27
    v_mfma_f32_16x16x32_bf16 a[68:71], v[36:39], v[228:231], a[68:71]
    v_accvgpr_write_b32 a58, v26
    v_accvgpr_write_b32 a62, v27
    s_waitcnt lgkmcnt(6)
    v_mfma_f32_16x16x32_bf16 a[64:67], v[40:43], v[168:171], a[64:67]
    ds_read_b128 v[36:39], v1 offset:16656
    v_fma_f32 v18, v8, v22, v26
    v_mfma_f32_16x16x32_bf16 a[68:71], v[40:43], v[232:235], a[68:71]
    v_fma_f32 v19, v8, v23, v27
    v_fma_f32 v20, -v9, v23, v18
    s_waitcnt lgkmcnt(6)
    v_mfma_f32_16x16x32_bf16 a[64:67], v[44:47], v[172:175], a[64:67]
    ds_read_b128 v[40:43], v1 offset:16672
    v_fma_f32 v21, v9, v22, v19
    v_accvgpr_read_b32 v24, a59
    v_mfma_f32_16x16x32_bf16 a[68:71], v[44:47], v[236:239], a[68:71]
    v_accvgpr_read_b32 v25, a63
    v_mul_f32 v26, v12, v24
    s_waitcnt lgkmcnt(6)
    v_mfma_f32_16x16x32_bf16 a[64:67], v[48:51], v[176:179], a[64:67]
    ds_read_b128 v[44:47], v1 offset:16688
    v_mul_f32 v27, v12, v25
    v_mfma_f32_16x16x32_bf16 a[68:71], v[48:51], v[240:243], a[68:71]
    v_fma_f32 v26, -v13, v25, v26
    v_fma_f32 v27, v13, v24, v27
    s_waitcnt lgkmcnt(6)
    v_mfma_f32_16x16x32_bf16 a[64:67], v[52:55], v[180:183], a[64:67]
    ds_read_b128 v[48:51], v1 offset:16704
    v_accvgpr_write_b32 a59, v26
    v_accvgpr_write_b32 a63, v27
    v_mfma_f32_16x16x32_bf16 a[68:71], v[52:55], v[244:247], a[68:71]
    v_fma_f32 v18, v8, v20, v26
    v_fma_f32 v19, v8, v21, v27
    s_waitcnt lgkmcnt(6)
    v_mfma_f32_16x16x32_bf16 a[64:67], v[56:59], v[184:187], a[64:67]
    ds_read_b128 v[52:55], v1 offset:16720
    v_fma_f32 v22, -v9, v21, v18
    v_mfma_f32_16x16x32_bf16 a[68:71], v[56:59], v[248:251], a[68:71]
    v_fma_f32 v23, v9, v20, v19
    s_waitcnt lgkmcnt(6)
    v_mfma_f32_16x16x32_bf16 a[64:67], v[60:63], v[188:191], a[64:67]
    ds_read_b128 v[56:59], v1 offset:16736
    v_mfma_f32_16x16x32_bf16 a[68:71], v[60:63], v[252:255], a[68:71]
    s_waitcnt lgkmcnt(6)
    v_mfma_f32_16x16x32_bf16 a[72:75], v[32:35], v[128:131], 0
    ds_read_b128 v[60:63], v1 offset:16752
    v_mfma_f32_16x16x32_bf16 a[76:79], v[32:35], v[192:195], 0
    s_waitcnt lgkmcnt(6)
    v_mfma_f32_16x16x32_bf16 a[72:75], v[36:39], v[132:135], a[72:75]
    ds_read_b128 v[32:35], v1 offset:16768
    v_accvgpr_read_b32 v24, a64
    v_accvgpr_read_b32 v25, a68
    v_mfma_f32_16x16x32_bf16 a[76:79], v[36:39], v[196:199], a[76:79]
    v_mul_f32 v26, v12, v24
    v_mul_f32 v27, v12, v25
    s_waitcnt lgkmcnt(6)
    v_mfma_f32_16x16x32_bf16 a[72:75], v[40:43], v[136:139], a[72:75]
    ds_read_b128 v[36:39], v1 offset:16784
    v_fma_f32 v26, -v13, v25, v26
    v_mfma_f32_16x16x32_bf16 a[76:79], v[40:43], v[200:203], a[76:79]
    v_fma_f32 v27, v13, v24, v27
    v_accvgpr_write_b32 a64, v26
    s_waitcnt lgkmcnt(6)
    v_mfma_f32_16x16x32_bf16 a[72:75], v[44:47], v[140:143], a[72:75]
    ds_read_b128 v[40:43], v1 offset:16800
    v_accvgpr_write_b32 a68, v27
    v_fma_f32 v18, v8, v22, v26
    v_mfma_f32_16x16x32_bf16 a[76:79], v[44:47], v[204:207], a[76:79]
    v_fma_f32 v19, v8, v23, v27
    v_fma_f32 v20, -v9, v23, v18
    s_waitcnt lgkmcnt(6)
    v_mfma_f32_16x16x32_bf16 a[72:75], v[48:51], v[144:147], a[72:75]
    ds_read_b128 v[44:47], v1 offset:16816
    v_fma_f32 v21, v9, v22, v19
    v_mfma_f32_16x16x32_bf16 a[76:79], v[48:51], v[208:211], a[76:79]
    v_accvgpr_read_b32 v24, a65
    v_accvgpr_read_b32 v25, a69
    s_waitcnt lgkmcnt(6)
    v_mfma_f32_16x16x32_bf16 a[72:75], v[52:55], v[148:151], a[72:75]
    ds_read_b128 v[48:51], v1 offset:16832
    v_mul_f32 v26, v12, v24
    v_mul_f32 v27, v12, v25
    v_mfma_f32_16x16x32_bf16 a[76:79], v[52:55], v[212:215], a[76:79]
    v_fma_f32 v26, -v13, v25, v26
    v_fma_f32 v27, v13, v24, v27
    s_waitcnt lgkmcnt(6)
    v_mfma_f32_16x16x32_bf16 a[72:75], v[56:59], v[152:155], a[72:75]
    ds_read_b128 v[52:55], v1 offset:16848
    v_accvgpr_write_b32 a65, v26
    v_mfma_f32_16x16x32_bf16 a[76:79], v[56:59], v[216:219], a[76:79]
    v_accvgpr_write_b32 a69, v27
    v_fma_f32 v18, v8, v20, v26
    s_waitcnt lgkmcnt(6)
    v_mfma_f32_16x16x32_bf16 a[72:75], v[60:63], v[156:159], a[72:75]
    ds_read_b128 v[56:59], v1 offset:16864
    v_fma_f32 v19, v8, v21, v27
    v_fma_f32 v22, -v9, v21, v18
    v_mfma_f32_16x16x32_bf16 a[76:79], v[60:63], v[220:223], a[76:79]
    v_fma_f32 v23, v9, v20, v19
    v_accvgpr_read_b32 v24, a66
    s_waitcnt lgkmcnt(6)
    v_mfma_f32_16x16x32_bf16 a[72:75], v[32:35], v[160:163], a[72:75]
    ds_read_b128 v[60:63], v1 offset:16880
    v_accvgpr_read_b32 v25, a70
    v_mfma_f32_16x16x32_bf16 a[76:79], v[32:35], v[224:227], a[76:79]
    v_mul_f32 v26, v12, v24
    v_mul_f32 v27, v12, v25
    s_add_u32 m0, s38, 116480
    s_add_u32 s37, s39, 61440
    buffer_load_dwordx4 v0, s[28:31], s37 offen offset:0 lds
    s_add_u32 m0, m0, 16
    s_nop 0
    buffer_load_dwordx4 v0, s[28:31], s37 offen offset:1024 lds
    s_add_u32 m0, m0, 16
    s_nop 0
    buffer_load_dwordx4 v0, s[28:31], s37 offen offset:2048 lds
    s_add_u32 m0, m0, 16
    s_nop 0
    buffer_load_dwordx4 v0, s[28:31], s37 offen offset:3072 lds
    s_waitcnt vmcnt(20)
    s_barrier
    s_waitcnt lgkmcnt(6)
    v_mfma_f32_16x16x32_bf16 a[72:75], v[36:39], v[164:167], a[72:75]
    ds_read_b128 v[32:35], v1 offset:33280
    v_fma_f32 v26, -v13, v25, v26
    v_fma_f32 v27, v13, v24, v27
    v_mfma_f32_16x16x32_bf16 a[76:79], v[36:39], v[228:231], a[76:79]
    v_accvgpr_write_b32 a66, v26
    v_accvgpr_write_b32 a70, v27
    s_waitcnt lgkmcnt(6)
    v_mfma_f32_16x16x32_bf16 a[72:75], v[40:43], v[168:171], a[72:75]
    ds_read_b128 v[36:39], v1 offset:33296
    v_fma_f32 v18, v8, v22, v26
    v_mfma_f32_16x16x32_bf16 a[76:79], v[40:43], v[232:235], a[76:79]
    v_fma_f32 v19, v8, v23, v27
    v_fma_f32 v20, -v9, v23, v18
    s_waitcnt lgkmcnt(6)
    v_mfma_f32_16x16x32_bf16 a[72:75], v[44:47], v[172:175], a[72:75]
    ds_read_b128 v[40:43], v1 offset:33312
    v_fma_f32 v21, v9, v22, v19
    v_accvgpr_read_b32 v24, a67
    v_mfma_f32_16x16x32_bf16 a[76:79], v[44:47], v[236:239], a[76:79]
    v_accvgpr_read_b32 v25, a71
    v_mul_f32 v26, v12, v24
    s_waitcnt lgkmcnt(6)
    v_mfma_f32_16x16x32_bf16 a[72:75], v[48:51], v[176:179], a[72:75]
    ds_read_b128 v[44:47], v1 offset:33328
    v_mul_f32 v27, v12, v25
    v_mfma_f32_16x16x32_bf16 a[76:79], v[48:51], v[240:243], a[76:79]
    v_fma_f32 v26, -v13, v25, v26
    v_fma_f32 v27, v13, v24, v27
    s_waitcnt lgkmcnt(6)
    v_mfma_f32_16x16x32_bf16 a[72:75], v[52:55], v[180:183], a[72:75]
    ds_read_b128 v[48:51], v1 offset:33344
    v_accvgpr_write_b32 a67, v26
    v_accvgpr_write_b32 a71, v27
    v_mfma_f32_16x16x32_bf16 a[76:79], v[52:55], v[244:247], a[76:79]
    v_fma_f32 v18, v8, v20, v26
    v_fma_f32 v19, v8, v21, v27
    s_waitcnt lgkmcnt(6)
    v_mfma_f32_16x16x32_bf16 a[72:75], v[56:59], v[184:187], a[72:75]
    ds_read_b128 v[52:55], v1 offset:33360
    v_fma_f32 v22, -v9, v21, v18
    v_mfma_f32_16x16x32_bf16 a[76:79], v[56:59], v[248:251], a[76:79]
    v_fma_f32 v23, v9, v20, v19
    s_waitcnt lgkmcnt(6)
    v_mfma_f32_16x16x32_bf16 a[72:75], v[60:63], v[188:191], a[72:75]
    ds_read_b128 v[56:59], v1 offset:33376
    v_mfma_f32_16x16x32_bf16 a[76:79], v[60:63], v[252:255], a[76:79]
    s_waitcnt lgkmcnt(6)
    v_mfma_f32_16x16x32_bf16 a[80:83], v[32:35], v[128:131], 0
    ds_read_b128 v[60:63], v1 offset:33392
    v_mfma_f32_16x16x32_bf16 a[84:87], v[32:35], v[192:195], 0
    s_waitcnt lgkmcnt(6)
    v_mfma_f32_16x16x32_bf16 a[80:83], v[36:39], v[132:135], a[80:83]
    ds_read_b128 v[32:35], v1 offset:33408
    v_accvgpr_read_b32 v24, a72
    v_accvgpr_read_b32 v25, a76
    v_mfma_f32_16x16x32_bf16 a[84:87], v[36:39], v[196:199], a[84:87]
    v_mul_f32 v26, v12, v24
    v_mul_f32 v27, v12, v25
    s_waitcnt lgkmcnt(6)
    v_mfma_f32_16x16x32_bf16 a[80:83], v[40:43], v[136:139], a[80:83]
    ds_read_b128 v[36:39], v1 offset:33424
    v_fma_f32 v26, -v13, v25, v26
    v_mfma_f32_16x16x32_bf16 a[84:87], v[40:43], v[200:203], a[84:87]
    v_fma_f32 v27, v13, v24, v27
    v_accvgpr_write_b32 a72, v26
    s_waitcnt lgkmcnt(6)
    v_mfma_f32_16x16x32_bf16 a[80:83], v[44:47], v[140:143], a[80:83]
    ds_read_b128 v[40:43], v1 offset:33440
    v_accvgpr_write_b32 a76, v27
    v_fma_f32 v18, v8, v22, v26
    v_mfma_f32_16x16x32_bf16 a[84:87], v[44:47], v[204:207], a[84:87]
    v_fma_f32 v19, v8, v23, v27
    v_fma_f32 v20, -v9, v23, v18
    s_waitcnt lgkmcnt(6)
    v_mfma_f32_16x16x32_bf16 a[80:83], v[48:51], v[144:147], a[80:83]
    ds_read_b128 v[44:47], v1 offset:33456
    v_fma_f32 v21, v9, v22, v19
    v_mfma_f32_16x16x32_bf16 a[84:87], v[48:51], v[208:211], a[84:87]
    v_accvgpr_read_b32 v24, a73
    v_accvgpr_read_b32 v25, a77
    s_waitcnt lgkmcnt(6)
    v_mfma_f32_16x16x32_bf16 a[80:83], v[52:55], v[148:151], a[80:83]
    ds_read_b128 v[48:51], v1 offset:33472
    v_mul_f32 v26, v12, v24
    v_mul_f32 v27, v12, v25
    v_mfma_f32_16x16x32_bf16 a[84:87], v[52:55], v[212:215], a[84:87]
    v_fma_f32 v26, -v13, v25, v26
    v_fma_f32 v27, v13, v24, v27
    s_waitcnt lgkmcnt(6)
    v_mfma_f32_16x16x32_bf16 a[80:83], v[56:59], v[152:155], a[80:83]
    ds_read_b128 v[52:55], v1 offset:33488
    v_accvgpr_write_b32 a73, v26
    v_mfma_f32_16x16x32_bf16 a[84:87], v[56:59], v[216:219], a[84:87]
    v_accvgpr_write_b32 a77, v27
    v_fma_f32 v18, v8, v20, v26
    s_waitcnt lgkmcnt(6)
    v_mfma_f32_16x16x32_bf16 a[80:83], v[60:63], v[156:159], a[80:83]
    ds_read_b128 v[56:59], v1 offset:33504
    v_fma_f32 v19, v8, v21, v27
    v_fma_f32 v22, -v9, v21, v18
    v_mfma_f32_16x16x32_bf16 a[84:87], v[60:63], v[220:223], a[84:87]
    v_fma_f32 v23, v9, v20, v19
    v_accvgpr_read_b32 v24, a74
    s_waitcnt lgkmcnt(6)
    v_mfma_f32_16x16x32_bf16 a[80:83], v[32:35], v[160:163], a[80:83]
    ds_read_b128 v[60:63], v1 offset:33520
    v_accvgpr_read_b32 v25, a78
    v_mfma_f32_16x16x32_bf16 a[84:87], v[32:35], v[224:227], a[84:87]
    v_mul_f32 v26, v12, v24
    v_mul_f32 v27, v12, v25
    s_waitcnt vmcnt(16)
    s_barrier
    s_waitcnt lgkmcnt(6)
    v_mfma_f32_16x16x32_bf16 a[80:83], v[36:39], v[164:167], a[80:83]
    ds_read_b128 v[32:35], v2 offset:0
    v_fma_f32 v26, -v13, v25, v26
    v_fma_f32 v27, v13, v24, v27
    v_mfma_f32_16x16x32_bf16 a[84:87], v[36:39], v[228:231], a[84:87]
    v_accvgpr_write_b32 a74, v26
    v_accvgpr_write_b32 a78, v27
    s_waitcnt lgkmcnt(6)
    v_mfma_f32_16x16x32_bf16 a[80:83], v[40:43], v[168:171], a[80:83]
    ds_read_b128 v[36:39], v2 offset:16
    v_fma_f32 v18, v8, v22, v26
    v_mfma_f32_16x16x32_bf16 a[84:87], v[40:43], v[232:235], a[84:87]
    v_fma_f32 v19, v8, v23, v27
    v_fma_f32 v20, -v9, v23, v18
    s_waitcnt lgkmcnt(6)
    v_mfma_f32_16x16x32_bf16 a[80:83], v[44:47], v[172:175], a[80:83]
    ds_read_b128 v[40:43], v2 offset:32
    v_fma_f32 v21, v9, v22, v19
    v_accvgpr_read_b32 v24, a75
    v_mfma_f32_16x16x32_bf16 a[84:87], v[44:47], v[236:239], a[84:87]
    v_accvgpr_read_b32 v25, a79
    v_mul_f32 v26, v12, v24
    s_waitcnt lgkmcnt(6)
    v_mfma_f32_16x16x32_bf16 a[80:83], v[48:51], v[176:179], a[80:83]
    ds_read_b128 v[44:47], v2 offset:48
    v_mul_f32 v27, v12, v25
    v_mfma_f32_16x16x32_bf16 a[84:87], v[48:51], v[240:243], a[84:87]
    v_fma_f32 v26, -v13, v25, v26
    v_fma_f32 v27, v13, v24, v27
    s_waitcnt lgkmcnt(6)
    v_mfma_f32_16x16x32_bf16 a[80:83], v[52:55], v[180:183], a[80:83]
    ds_read_b128 v[48:51], v2 offset:64
    v_accvgpr_write_b32 a75, v26
    v_accvgpr_write_b32 a79, v27
    v_mfma_f32_16x16x32_bf16 a[84:87], v[52:55], v[244:247], a[84:87]
    v_fma_f32 v18, v8, v20, v26
    v_fma_f32 v19, v8, v21, v27
    s_waitcnt lgkmcnt(6)
    v_mfma_f32_16x16x32_bf16 a[80:83], v[56:59], v[184:187], a[80:83]
    ds_read_b128 v[52:55], v2 offset:80
    v_fma_f32 v22, -v9, v21, v18
    v_mfma_f32_16x16x32_bf16 a[84:87], v[56:59], v[248:251], a[84:87]
    v_fma_f32 v23, v9, v20, v19
    s_waitcnt lgkmcnt(6)
    v_mfma_f32_16x16x32_bf16 a[80:83], v[60:63], v[188:191], a[80:83]
    ds_read_b128 v[56:59], v2 offset:96
    v_mfma_f32_16x16x32_bf16 a[84:87], v[60:63], v[252:255], a[84:87]
    s_waitcnt lgkmcnt(6)
    v_mfma_f32_16x16x32_bf16 a[88:91], v[32:35], v[128:131], 0
    ds_read_b128 v[60:63], v2 offset:112
    v_mfma_f32_16x16x32_bf16 a[92:95], v[32:35], v[192:195], 0
    s_waitcnt lgkmcnt(6)
    v_mfma_f32_16x16x32_bf16 a[88:91], v[36:39], v[132:135], a[88:91]
    ds_read_b128 v[32:35], v2 offset:128
    v_accvgpr_read_b32 v24, a80
    v_accvgpr_read_b32 v25, a84
    v_mfma_f32_16x16x32_bf16 a[92:95], v[36:39], v[196:199], a[92:95]
    v_mul_f32 v26, v12, v24
    v_mul_f32 v27, v12, v25
    s_waitcnt lgkmcnt(6)
    v_mfma_f32_16x16x32_bf16 a[88:91], v[40:43], v[136:139], a[88:91]
    ds_read_b128 v[36:39], v2 offset:144
    v_fma_f32 v26, -v13, v25, v26
    v_mfma_f32_16x16x32_bf16 a[92:95], v[40:43], v[200:203], a[92:95]
    v_fma_f32 v27, v13, v24, v27
    v_accvgpr_write_b32 a80, v26
    s_waitcnt lgkmcnt(6)
    v_mfma_f32_16x16x32_bf16 a[88:91], v[44:47], v[140:143], a[88:91]
    ds_read_b128 v[40:43], v2 offset:160
    v_accvgpr_write_b32 a84, v27
    v_fma_f32 v18, v8, v22, v26
    v_mfma_f32_16x16x32_bf16 a[92:95], v[44:47], v[204:207], a[92:95]
    v_fma_f32 v19, v8, v23, v27
    v_fma_f32 v20, -v9, v23, v18
    s_waitcnt lgkmcnt(6)
    v_mfma_f32_16x16x32_bf16 a[88:91], v[48:51], v[144:147], a[88:91]
    ds_read_b128 v[44:47], v2 offset:176
    v_fma_f32 v21, v9, v22, v19
    v_mfma_f32_16x16x32_bf16 a[92:95], v[48:51], v[208:211], a[92:95]
    v_accvgpr_read_b32 v24, a81
    v_accvgpr_read_b32 v25, a85
    s_waitcnt lgkmcnt(6)
    v_mfma_f32_16x16x32_bf16 a[88:91], v[52:55], v[148:151], a[88:91]
    ds_read_b128 v[48:51], v2 offset:192
    v_mul_f32 v26, v12, v24
    v_mul_f32 v27, v12, v25
    v_mfma_f32_16x16x32_bf16 a[92:95], v[52:55], v[212:215], a[92:95]
    v_fma_f32 v26, -v13, v25, v26
    v_fma_f32 v27, v13, v24, v27
    s_waitcnt lgkmcnt(6)
    v_mfma_f32_16x16x32_bf16 a[88:91], v[56:59], v[152:155], a[88:91]
    ds_read_b128 v[52:55], v2 offset:208
    v_accvgpr_write_b32 a81, v26
    v_mfma_f32_16x16x32_bf16 a[92:95], v[56:59], v[216:219], a[92:95]
    v_accvgpr_write_b32 a85, v27
    v_fma_f32 v18, v8, v20, v26
    s_waitcnt lgkmcnt(6)
    v_mfma_f32_16x16x32_bf16 a[88:91], v[60:63], v[156:159], a[88:91]
    ds_read_b128 v[56:59], v2 offset:224
    v_fma_f32 v19, v8, v21, v27
    v_fma_f32 v22, -v9, v21, v18
    v_mfma_f32_16x16x32_bf16 a[92:95], v[60:63], v[220:223], a[92:95]
    v_fma_f32 v23, v9, v20, v19
    v_accvgpr_read_b32 v24, a82
    s_waitcnt lgkmcnt(6)
    v_mfma_f32_16x16x32_bf16 a[88:91], v[32:35], v[160:163], a[88:91]
    ds_read_b128 v[60:63], v2 offset:240
    v_accvgpr_read_b32 v25, a86
    v_mfma_f32_16x16x32_bf16 a[92:95], v[32:35], v[224:227], a[92:95]
    v_mul_f32 v26, v12, v24
    v_mul_f32 v27, v12, v25
    s_waitcnt vmcnt(12)
    s_barrier
    s_waitcnt lgkmcnt(6)
    v_mfma_f32_16x16x32_bf16 a[88:91], v[36:39], v[164:167], a[88:91]
    ds_read_b128 v[32:35], v2 offset:16640
    v_fma_f32 v26, -v13, v25, v26
    v_fma_f32 v27, v13, v24, v27
    v_mfma_f32_16x16x32_bf16 a[92:95], v[36:39], v[228:231], a[92:95]
    v_accvgpr_write_b32 a82, v26
    v_accvgpr_write_b32 a86, v27
    s_waitcnt lgkmcnt(6)
    v_mfma_f32_16x16x32_bf16 a[88:91], v[40:43], v[168:171], a[88:91]
    ds_read_b128 v[36:39], v2 offset:16656
    v_fma_f32 v18, v8, v22, v26
    v_mfma_f32_16x16x32_bf16 a[92:95], v[40:43], v[232:235], a[92:95]
    v_fma_f32 v19, v8, v23, v27
    v_fma_f32 v20, -v9, v23, v18
    s_waitcnt lgkmcnt(6)
    v_mfma_f32_16x16x32_bf16 a[88:91], v[44:47], v[172:175], a[88:91]
    ds_read_b128 v[40:43], v2 offset:16672
    v_fma_f32 v21, v9, v22, v19
    v_accvgpr_read_b32 v24, a83
    v_mfma_f32_16x16x32_bf16 a[92:95], v[44:47], v[236:239], a[92:95]
    v_accvgpr_read_b32 v25, a87
    v_mul_f32 v26, v12, v24
    s_waitcnt lgkmcnt(6)
    v_mfma_f32_16x16x32_bf16 a[88:91], v[48:51], v[176:179], a[88:91]
    ds_read_b128 v[44:47], v2 offset:16688
    v_mul_f32 v27, v12, v25
    v_mfma_f32_16x16x32_bf16 a[92:95], v[48:51], v[240:243], a[92:95]
    v_fma_f32 v26, -v13, v25, v26
    v_fma_f32 v27, v13, v24, v27
    s_waitcnt lgkmcnt(6)
    v_mfma_f32_16x16x32_bf16 a[88:91], v[52:55], v[180:183], a[88:91]
    ds_read_b128 v[48:51], v2 offset:16704
    v_accvgpr_write_b32 a83, v26
    v_accvgpr_write_b32 a87, v27
    v_mfma_f32_16x16x32_bf16 a[92:95], v[52:55], v[244:247], a[92:95]
    v_fma_f32 v18, v8, v20, v26
    v_fma_f32 v19, v8, v21, v27
    s_waitcnt lgkmcnt(6)
    v_mfma_f32_16x16x32_bf16 a[88:91], v[56:59], v[184:187], a[88:91]
    ds_read_b128 v[52:55], v2 offset:16720
    v_fma_f32 v22, -v9, v21, v18
    v_mfma_f32_16x16x32_bf16 a[92:95], v[56:59], v[248:251], a[92:95]
    v_fma_f32 v23, v9, v20, v19
    s_waitcnt lgkmcnt(6)
    v_mfma_f32_16x16x32_bf16 a[88:91], v[60:63], v[188:191], a[88:91]
    ds_read_b128 v[56:59], v2 offset:16736
    v_mfma_f32_16x16x32_bf16 a[92:95], v[60:63], v[252:255], a[92:95]
    s_waitcnt lgkmcnt(6)
    v_mfma_f32_16x16x32_bf16 a[96:99], v[32:35], v[128:131], 0
    ds_read_b128 v[60:63], v2 offset:16752
    v_mfma_f32_16x16x32_bf16 a[100:103], v[32:35], v[192:195], 0
    s_waitcnt lgkmcnt(6)
    v_mfma_f32_16x16x32_bf16 a[96:99], v[36:39], v[132:135], a[96:99]
    ds_read_b128 v[32:35], v2 offset:16768
    v_accvgpr_read_b32 v24, a88
    v_accvgpr_read_b32 v25, a92
    v_mfma_f32_16x16x32_bf16 a[100:103], v[36:39], v[196:199], a[100:103]
    v_mul_f32 v26, v12, v24
    v_mul_f32 v27, v12, v25
    s_waitcnt lgkmcnt(6)
    v_mfma_f32_16x16x32_bf16 a[96:99], v[40:43], v[136:139], a[96:99]
    ds_read_b128 v[36:39], v2 offset:16784
    v_fma_f32 v26, -v13, v25, v26
    v_mfma_f32_16x16x32_bf16 a[100:103], v[40:43], v[200:203], a[100:103]
    v_fma_f32 v27, v13, v24, v27
    v_accvgpr_write_b32 a88, v26
    s_waitcnt lgkmcnt(6)
    v_mfma_f32_16x16x32_bf16 a[96:99], v[44:47], v[140:143], a[96:99]
    ds_read_b128 v[40:43], v2 offset:16800
    v_accvgpr_write_b32 a92, v27
    v_fma_f32 v18, v8, v22, v26
    v_mfma_f32_16x16x32_bf16 a[100:103], v[44:47], v[204:207], a[100:103]
    v_fma_f32 v19, v8, v23, v27
    v_fma_f32 v20, -v9, v23, v18
    s_waitcnt lgkmcnt(6)
    v_mfma_f32_16x16x32_bf16 a[96:99], v[48:51], v[144:147], a[96:99]
    ds_read_b128 v[44:47], v2 offset:16816
    v_fma_f32 v21, v9, v22, v19
    v_mfma_f32_16x16x32_bf16 a[100:103], v[48:51], v[208:211], a[100:103]
    v_accvgpr_read_b32 v24, a89
    v_accvgpr_read_b32 v25, a93
    s_waitcnt lgkmcnt(6)
    v_mfma_f32_16x16x32_bf16 a[96:99], v[52:55], v[148:151], a[96:99]
    ds_read_b128 v[48:51], v2 offset:16832
    v_mul_f32 v26, v12, v24
    v_mul_f32 v27, v12, v25
    v_mfma_f32_16x16x32_bf16 a[100:103], v[52:55], v[212:215], a[100:103]
    v_fma_f32 v26, -v13, v25, v26
    v_fma_f32 v27, v13, v24, v27
    s_waitcnt lgkmcnt(6)
    v_mfma_f32_16x16x32_bf16 a[96:99], v[56:59], v[152:155], a[96:99]
    ds_read_b128 v[52:55], v2 offset:16848
    v_accvgpr_write_b32 a89, v26
    v_mfma_f32_16x16x32_bf16 a[100:103], v[56:59], v[216:219], a[100:103]
    v_accvgpr_write_b32 a93, v27
    v_fma_f32 v18, v8, v20, v26
    s_waitcnt lgkmcnt(6)
    v_mfma_f32_16x16x32_bf16 a[96:99], v[60:63], v[156:159], a[96:99]
    ds_read_b128 v[56:59], v2 offset:16864
    v_fma_f32 v19, v8, v21, v27
    v_fma_f32 v22, -v9, v21, v18
    v_mfma_f32_16x16x32_bf16 a[100:103], v[60:63], v[220:223], a[100:103]
    v_fma_f32 v23, v9, v20, v19
    v_accvgpr_read_b32 v24, a90
    s_waitcnt lgkmcnt(6)
    v_mfma_f32_16x16x32_bf16 a[96:99], v[32:35], v[160:163], a[96:99]
    ds_read_b128 v[60:63], v2 offset:16880
    v_accvgpr_read_b32 v25, a94
    v_mfma_f32_16x16x32_bf16 a[100:103], v[32:35], v[224:227], a[100:103]
    v_mul_f32 v26, v12, v24
    v_mul_f32 v27, v12, v25
    s_waitcnt vmcnt(8)
    s_barrier
    s_waitcnt lgkmcnt(6)
    v_mfma_f32_16x16x32_bf16 a[96:99], v[36:39], v[164:167], a[96:99]
    ds_read_b128 v[32:35], v2 offset:33280
    v_fma_f32 v26, -v13, v25, v26
    v_fma_f32 v27, v13, v24, v27
    v_mfma_f32_16x16x32_bf16 a[100:103], v[36:39], v[228:231], a[100:103]
    v_accvgpr_write_b32 a90, v26
    v_accvgpr_write_b32 a94, v27
    s_waitcnt lgkmcnt(6)
    v_mfma_f32_16x16x32_bf16 a[96:99], v[40:43], v[168:171], a[96:99]
    ds_read_b128 v[36:39], v2 offset:33296
    v_fma_f32 v18, v8, v22, v26
    v_mfma_f32_16x16x32_bf16 a[100:103], v[40:43], v[232:235], a[100:103]
    v_fma_f32 v19, v8, v23, v27
    v_fma_f32 v20, -v9, v23, v18
    s_waitcnt lgkmcnt(6)
    v_mfma_f32_16x16x32_bf16 a[96:99], v[44:47], v[172:175], a[96:99]
    ds_read_b128 v[40:43], v2 offset:33312
    v_fma_f32 v21, v9, v22, v19
    v_accvgpr_read_b32 v24, a91
    v_mfma_f32_16x16x32_bf16 a[100:103], v[44:47], v[236:239], a[100:103]
    v_accvgpr_read_b32 v25, a95
    v_mul_f32 v26, v12, v24
    s_waitcnt lgkmcnt(6)
    v_mfma_f32_16x16x32_bf16 a[96:99], v[48:51], v[176:179], a[96:99]
    ds_read_b128 v[44:47], v2 offset:33328
    v_mul_f32 v27, v12, v25
    v_mfma_f32_16x16x32_bf16 a[100:103], v[48:51], v[240:243], a[100:103]
    v_fma_f32 v26, -v13, v25, v26
    v_fma_f32 v27, v13, v24, v27
    s_waitcnt lgkmcnt(6)
    v_mfma_f32_16x16x32_bf16 a[96:99], v[52:55], v[180:183], a[96:99]
    ds_read_b128 v[48:51], v2 offset:33344
    v_accvgpr_write_b32 a91, v26
    v_accvgpr_write_b32 a95, v27
    v_mfma_f32_16x16x32_bf16 a[100:103], v[52:55], v[244:247], a[100:103]
    v_fma_f32 v18, v8, v20, v26
    v_fma_f32 v19, v8, v21, v27
    s_waitcnt lgkmcnt(6)
    v_mfma_f32_16x16x32_bf16 a[96:99], v[56:59], v[184:187], a[96:99]
    ds_read_b128 v[52:55], v2 offset:33360
    v_fma_f32 v22, -v9, v21, v18
    v_mfma_f32_16x16x32_bf16 a[100:103], v[56:59], v[248:251], a[100:103]
    v_fma_f32 v23, v9, v20, v19
    s_waitcnt lgkmcnt(6)
    v_mfma_f32_16x16x32_bf16 a[96:99], v[60:63], v[188:191], a[96:99]
    ds_read_b128 v[56:59], v2 offset:33376
    v_mfma_f32_16x16x32_bf16 a[100:103], v[60:63], v[252:255], a[100:103]
    s_waitcnt lgkmcnt(6)
    v_mfma_f32_16x16x32_bf16 a[104:107], v[32:35], v[128:131], 0
    ds_read_b128 v[60:63], v2 offset:33392
    v_mfma_f32_16x16x32_bf16 a[108:111], v[32:35], v[192:195], 0
    s_waitcnt lgkmcnt(6)
    v_mfma_f32_16x16x32_bf16 a[104:107], v[36:39], v[132:135], a[104:107]
    ds_read_b128 v[32:35], v2 offset:33408
    v_accvgpr_read_b32 v24, a96
    v_accvgpr_read_b32 v25, a100
    v_mfma_f32_16x16x32_bf16 a[108:111], v[36:39], v[196:199], a[108:111]
    v_mul_f32 v26, v12, v24
    v_mul_f32 v27, v12, v25
    s_waitcnt lgkmcnt(6)
    v_mfma_f32_16x16x32_bf16 a[104:107], v[40:43], v[136:139], a[104:107]
    ds_read_b128 v[36:39], v2 offset:33424
    v_fma_f32 v26, -v13, v25, v26
    v_mfma_f32_16x16x32_bf16 a[108:111], v[40:43], v[200:203], a[108:111]
    v_fma_f32 v27, v13, v24, v27
    v_accvgpr_write_b32 a96, v26
    s_waitcnt lgkmcnt(6)
    v_mfma_f32_16x16x32_bf16 a[104:107], v[44:47], v[140:143], a[104:107]
    ds_read_b128 v[40:43], v2 offset:33440
    v_accvgpr_write_b32 a100, v27
    v_fma_f32 v18, v8, v22, v26
    v_mfma_f32_16x16x32_bf16 a[108:111], v[44:47], v[204:207], a[108:111]
    v_fma_f32 v19, v8, v23, v27
    v_fma_f32 v20, -v9, v23, v18
    s_waitcnt lgkmcnt(6)
    v_mfma_f32_16x16x32_bf16 a[104:107], v[48:51], v[144:147], a[104:107]
    ds_read_b128 v[44:47], v2 offset:33456
    v_fma_f32 v21, v9, v22, v19
    v_mfma_f32_16x16x32_bf16 a[108:111], v[48:51], v[208:211], a[108:111]
    v_accvgpr_read_b32 v24, a97
    v_accvgpr_read_b32 v25, a101
    s_waitcnt lgkmcnt(6)
    v_mfma_f32_16x16x32_bf16 a[104:107], v[52:55], v[148:151], a[104:107]
    ds_read_b128 v[48:51], v2 offset:33472
    v_mul_f32 v26, v12, v24
    v_mul_f32 v27, v12, v25
    v_mfma_f32_16x16x32_bf16 a[108:111], v[52:55], v[212:215], a[108:111]
    v_fma_f32 v26, -v13, v25, v26
    v_fma_f32 v27, v13, v24, v27
    s_waitcnt lgkmcnt(6)
    v_mfma_f32_16x16x32_bf16 a[104:107], v[56:59], v[152:155], a[104:107]
    ds_read_b128 v[52:55], v2 offset:33488
    v_accvgpr_write_b32 a97, v26
    v_mfma_f32_16x16x32_bf16 a[108:111], v[56:59], v[216:219], a[108:111]
    v_accvgpr_write_b32 a101, v27
    v_fma_f32 v18, v8, v20, v26
    s_waitcnt lgkmcnt(6)
    v_mfma_f32_16x16x32_bf16 a[104:107], v[60:63], v[156:159], a[104:107]
    ds_read_b128 v[56:59], v2 offset:33504
    v_fma_f32 v19, v8, v21, v27
    v_fma_f32 v22, -v9, v21, v18
    v_mfma_f32_16x16x32_bf16 a[108:111], v[60:63], v[220:223], a[108:111]
    v_fma_f32 v23, v9, v20, v19
    v_accvgpr_read_b32 v24, a98
    s_waitcnt lgkmcnt(6)
    v_mfma_f32_16x16x32_bf16 a[104:107], v[32:35], v[160:163], a[104:107]
    ds_read_b128 v[60:63], v2 offset:33520
    v_accvgpr_read_b32 v25, a102
    v_mfma_f32_16x16x32_bf16 a[108:111], v[32:35], v[224:227], a[108:111]
    v_mul_f32 v26, v12, v24
    v_mul_f32 v27, v12, v25
    s_waitcnt vmcnt(4)
    s_barrier
    s_waitcnt lgkmcnt(6)
    v_mfma_f32_16x16x32_bf16 a[104:107], v[36:39], v[164:167], a[104:107]
    ds_read_b128 v[32:35], v3 offset:0
    v_fma_f32 v26, -v13, v25, v26
    v_fma_f32 v27, v13, v24, v27
    v_mfma_f32_16x16x32_bf16 a[108:111], v[36:39], v[228:231], a[108:111]
    v_accvgpr_write_b32 a98, v26
    v_accvgpr_write_b32 a102, v27
    s_waitcnt lgkmcnt(6)
    v_mfma_f32_16x16x32_bf16 a[104:107], v[40:43], v[168:171], a[104:107]
    ds_read_b128 v[36:39], v3 offset:16
    v_fma_f32 v18, v8, v22, v26
    v_mfma_f32_16x16x32_bf16 a[108:111], v[40:43], v[232:235], a[108:111]
    v_fma_f32 v19, v8, v23, v27
    v_fma_f32 v20, -v9, v23, v18
    s_waitcnt lgkmcnt(6)
    v_mfma_f32_16x16x32_bf16 a[104:107], v[44:47], v[172:175], a[104:107]
    ds_read_b128 v[40:43], v3 offset:32
    v_fma_f32 v21, v9, v22, v19
    v_accvgpr_read_b32 v24, a99
    v_mfma_f32_16x16x32_bf16 a[108:111], v[44:47], v[236:239], a[108:111]
    v_accvgpr_read_b32 v25, a103
    v_mul_f32 v26, v12, v24
    s_waitcnt lgkmcnt(6)
    v_mfma_f32_16x16x32_bf16 a[104:107], v[48:51], v[176:179], a[104:107]
    ds_read_b128 v[44:47], v3 offset:48
    v_mul_f32 v27, v12, v25
    v_mfma_f32_16x16x32_bf16 a[108:111], v[48:51], v[240:243], a[108:111]
    v_fma_f32 v26, -v13, v25, v26
    v_fma_f32 v27, v13, v24, v27
    s_waitcnt lgkmcnt(6)
    v_mfma_f32_16x16x32_bf16 a[104:107], v[52:55], v[180:183], a[104:107]
    ds_read_b128 v[48:51], v3 offset:64
    v_accvgpr_write_b32 a99, v26
    v_accvgpr_write_b32 a103, v27
    v_mfma_f32_16x16x32_bf16 a[108:111], v[52:55], v[244:247], a[108:111]
    v_fma_f32 v18, v8, v20, v26
    v_fma_f32 v19, v8, v21, v27
    s_waitcnt lgkmcnt(6)
    v_mfma_f32_16x16x32_bf16 a[104:107], v[56:59], v[184:187], a[104:107]
    ds_read_b128 v[52:55], v3 offset:80
    v_fma_f32 v22, -v9, v21, v18
    v_mfma_f32_16x16x32_bf16 a[108:111], v[56:59], v[248:251], a[108:111]
    v_fma_f32 v23, v9, v20, v19
    s_waitcnt lgkmcnt(6)
    v_mfma_f32_16x16x32_bf16 a[104:107], v[60:63], v[188:191], a[104:107]
    ds_read_b128 v[56:59], v3 offset:96
    v_mfma_f32_16x16x32_bf16 a[108:111], v[60:63], v[252:255], a[108:111]
    s_waitcnt lgkmcnt(6)
    v_mfma_f32_16x16x32_bf16 a[112:115], v[32:35], v[128:131], 0
    ds_read_b128 v[60:63], v3 offset:112
    v_mfma_f32_16x16x32_bf16 a[116:119], v[32:35], v[192:195], 0
    s_waitcnt lgkmcnt(6)
    v_mfma_f32_16x16x32_bf16 a[112:115], v[36:39], v[132:135], a[112:115]
    ds_read_b128 v[32:35], v3 offset:128
    v_accvgpr_read_b32 v24, a104
    v_accvgpr_read_b32 v25, a108
    v_mfma_f32_16x16x32_bf16 a[116:119], v[36:39], v[196:199], a[116:119]
    v_mul_f32 v26, v12, v24
    v_mul_f32 v27, v12, v25
    s_waitcnt lgkmcnt(6)
    v_mfma_f32_16x16x32_bf16 a[112:115], v[40:43], v[136:139], a[112:115]
    ds_read_b128 v[36:39], v3 offset:144
    v_fma_f32 v26, -v13, v25, v26
    v_mfma_f32_16x16x32_bf16 a[116:119], v[40:43], v[200:203], a[116:119]
    v_fma_f32 v27, v13, v24, v27
    v_accvgpr_write_b32 a104, v26
    s_waitcnt lgkmcnt(6)
    v_mfma_f32_16x16x32_bf16 a[112:115], v[44:47], v[140:143], a[112:115]
    ds_read_b128 v[40:43], v3 offset:160
    v_accvgpr_write_b32 a108, v27
    v_fma_f32 v18, v8, v22, v26
    v_mfma_f32_16x16x32_bf16 a[116:119], v[44:47], v[204:207], a[116:119]
    v_fma_f32 v19, v8, v23, v27
    v_fma_f32 v20, -v9, v23, v18
    s_waitcnt lgkmcnt(6)
    v_mfma_f32_16x16x32_bf16 a[112:115], v[48:51], v[144:147], a[112:115]
    ds_read_b128 v[44:47], v3 offset:176
    v_fma_f32 v21, v9, v22, v19
    v_mfma_f32_16x16x32_bf16 a[116:119], v[48:51], v[208:211], a[116:119]
    v_accvgpr_read_b32 v24, a105
    v_accvgpr_read_b32 v25, a109
    s_waitcnt lgkmcnt(6)
    v_mfma_f32_16x16x32_bf16 a[112:115], v[52:55], v[148:151], a[112:115]
    ds_read_b128 v[48:51], v3 offset:192
    v_mul_f32 v26, v12, v24
    v_mul_f32 v27, v12, v25
    v_mfma_f32_16x16x32_bf16 a[116:119], v[52:55], v[212:215], a[116:119]
    v_fma_f32 v26, -v13, v25, v26
    v_fma_f32 v27, v13, v24, v27
    s_waitcnt lgkmcnt(6)
    v_mfma_f32_16x16x32_bf16 a[112:115], v[56:59], v[152:155], a[112:115]
    ds_read_b128 v[52:55], v3 offset:208
    v_accvgpr_write_b32 a105, v26
    v_mfma_f32_16x16x32_bf16 a[116:119], v[56:59], v[216:219], a[116:119]
    v_accvgpr_write_b32 a109, v27
    v_fma_f32 v18, v8, v20, v26
    s_waitcnt lgkmcnt(6)
    v_mfma_f32_16x16x32_bf16 a[112:115], v[60:63], v[156:159], a[112:115]
    ds_read_b128 v[56:59], v3 offset:224
    v_fma_f32 v19, v8, v21, v27
    v_fma_f32 v22, -v9, v21, v18
    v_mfma_f32_16x16x32_bf16 a[116:119], v[60:63], v[220:223], a[116:119]
    v_fma_f32 v23, v9, v20, v19
    v_accvgpr_read_b32 v24, a106
    s_waitcnt lgkmcnt(6)
    v_mfma_f32_16x16x32_bf16 a[112:115], v[32:35], v[160:163], a[112:115]
    ds_read_b128 v[60:63], v3 offset:240
    v_accvgpr_read_b32 v25, a110
    v_mfma_f32_16x16x32_bf16 a[116:119], v[32:35], v[224:227], a[116:119]
    v_mul_f32 v26, v12, v24
    v_mul_f32 v27, v12, v25
    s_waitcnt vmcnt(0)
    s_barrier
    s_waitcnt lgkmcnt(6)
    v_mfma_f32_16x16x32_bf16 a[112:115], v[36:39], v[164:167], a[112:115]
    ds_read_b128 v[32:35], v3 offset:16640
    v_fma_f32 v26, -v13, v25, v26
    v_fma_f32 v27, v13, v24, v27
    v_mfma_f32_16x16x32_bf16 a[116:119], v[36:39], v[228:231], a[116:119]
    v_accvgpr_write_b32 a106, v26
    v_accvgpr_write_b32 a110, v27
    s_waitcnt lgkmcnt(6)
    v_mfma_f32_16x16x32_bf16 a[112:115], v[40:43], v[168:171], a[112:115]
    ds_read_b128 v[36:39], v3 offset:16656
    v_fma_f32 v18, v8, v22, v26
    v_mfma_f32_16x16x32_bf16 a[116:119], v[40:43], v[232:235], a[116:119]
    v_fma_f32 v19, v8, v23, v27
    v_fma_f32 v20, -v9, v23, v18
    s_waitcnt lgkmcnt(6)
    v_mfma_f32_16x16x32_bf16 a[112:115], v[44:47], v[172:175], a[112:115]
    ds_read_b128 v[40:43], v3 offset:16672
    v_fma_f32 v21, v9, v22, v19
    v_accvgpr_read_b32 v24, a107
    v_mfma_f32_16x16x32_bf16 a[116:119], v[44:47], v[236:239], a[116:119]
    v_accvgpr_read_b32 v25, a111
    v_mul_f32 v26, v12, v24
    s_waitcnt lgkmcnt(6)
    v_mfma_f32_16x16x32_bf16 a[112:115], v[48:51], v[176:179], a[112:115]
    ds_read_b128 v[44:47], v3 offset:16688
    v_mul_f32 v27, v12, v25
    v_mfma_f32_16x16x32_bf16 a[116:119], v[48:51], v[240:243], a[116:119]
    v_fma_f32 v26, -v13, v25, v26
    v_fma_f32 v27, v13, v24, v27
    s_waitcnt lgkmcnt(6)
    v_mfma_f32_16x16x32_bf16 a[112:115], v[52:55], v[180:183], a[112:115]
    ds_read_b128 v[48:51], v3 offset:16704
    v_accvgpr_write_b32 a107, v26
    v_accvgpr_write_b32 a111, v27
    v_mfma_f32_16x16x32_bf16 a[116:119], v[52:55], v[244:247], a[116:119]
    v_fma_f32 v18, v8, v20, v26
    v_fma_f32 v19, v8, v21, v27
    s_waitcnt lgkmcnt(6)
    v_mfma_f32_16x16x32_bf16 a[112:115], v[56:59], v[184:187], a[112:115]
    ds_read_b128 v[52:55], v3 offset:16720
    v_fma_f32 v22, -v9, v21, v18
    v_mfma_f32_16x16x32_bf16 a[116:119], v[56:59], v[248:251], a[116:119]
    v_fma_f32 v23, v9, v20, v19
    s_waitcnt lgkmcnt(6)
    v_mfma_f32_16x16x32_bf16 a[112:115], v[60:63], v[188:191], a[112:115]
    ds_read_b128 v[56:59], v3 offset:16736
    v_mfma_f32_16x16x32_bf16 a[116:119], v[60:63], v[252:255], a[116:119]
    s_waitcnt lgkmcnt(6)
    v_mfma_f32_16x16x32_bf16 a[120:123], v[32:35], v[128:131], 0
    ds_read_b128 v[60:63], v3 offset:16752
    v_mfma_f32_16x16x32_bf16 a[124:127], v[32:35], v[192:195], 0
    s_waitcnt lgkmcnt(6)
    v_mfma_f32_16x16x32_bf16 a[120:123], v[36:39], v[132:135], a[120:123]
    ds_read_b128 v[32:35], v3 offset:16768
    v_accvgpr_read_b32 v24, a112
    v_accvgpr_read_b32 v25, a116
    v_mfma_f32_16x16x32_bf16 a[124:127], v[36:39], v[196:199], a[124:127]
    v_mul_f32 v26, v12, v24
    v_mul_f32 v27, v12, v25
    s_waitcnt lgkmcnt(6)
    v_mfma_f32_16x16x32_bf16 a[120:123], v[40:43], v[136:139], a[120:123]
    ds_read_b128 v[36:39], v3 offset:16784
    v_fma_f32 v26, -v13, v25, v26
    v_mfma_f32_16x16x32_bf16 a[124:127], v[40:43], v[200:203], a[124:127]
    v_fma_f32 v27, v13, v24, v27
    v_accvgpr_write_b32 a112, v26
    s_waitcnt lgkmcnt(6)
    v_mfma_f32_16x16x32_bf16 a[120:123], v[44:47], v[140:143], a[120:123]
    ds_read_b128 v[40:43], v3 offset:16800
    v_accvgpr_write_b32 a116, v27
    v_fma_f32 v18, v8, v22, v26
    v_mfma_f32_16x16x32_bf16 a[124:127], v[44:47], v[204:207], a[124:127]
    v_fma_f32 v19, v8, v23, v27
    v_fma_f32 v20, -v9, v23, v18
    s_waitcnt lgkmcnt(6)
    v_mfma_f32_16x16x32_bf16 a[120:123], v[48:51], v[144:147], a[120:123]
    ds_read_b128 v[44:47], v3 offset:16816
    v_fma_f32 v21, v9, v22, v19
    v_mfma_f32_16x16x32_bf16 a[124:127], v[48:51], v[208:211], a[124:127]
    v_accvgpr_read_b32 v24, a113
    v_accvgpr_read_b32 v25, a117
    s_waitcnt lgkmcnt(6)
    v_mfma_f32_16x16x32_bf16 a[120:123], v[52:55], v[148:151], a[120:123]
    ds_read_b128 v[48:51], v3 offset:16832
    v_mul_f32 v26, v12, v24
    v_mul_f32 v27, v12, v25
    v_mfma_f32_16x16x32_bf16 a[124:127], v[52:55], v[212:215], a[124:127]
    v_fma_f32 v26, -v13, v25, v26
    v_fma_f32 v27, v13, v24, v27
    s_waitcnt lgkmcnt(6)
    v_mfma_f32_16x16x32_bf16 a[120:123], v[56:59], v[152:155], a[120:123]
    ds_read_b128 v[52:55], v3 offset:16848
    v_accvgpr_write_b32 a113, v26
    v_mfma_f32_16x16x32_bf16 a[124:127], v[56:59], v[216:219], a[124:127]
    v_accvgpr_write_b32 a117, v27
    v_fma_f32 v18, v8, v20, v26
    s_waitcnt lgkmcnt(6)
    v_mfma_f32_16x16x32_bf16 a[120:123], v[60:63], v[156:159], a[120:123]
    ds_read_b128 v[56:59], v3 offset:16864
    v_fma_f32 v19, v8, v21, v27
    v_fma_f32 v22, -v9, v21, v18
    v_mfma_f32_16x16x32_bf16 a[124:127], v[60:63], v[220:223], a[124:127]
    v_fma_f32 v23, v9, v20, v19
    v_accvgpr_read_b32 v24, a114
    s_waitcnt lgkmcnt(6)
    v_mfma_f32_16x16x32_bf16 a[120:123], v[32:35], v[160:163], a[120:123]
    ds_read_b128 v[60:63], v3 offset:16880
    v_accvgpr_read_b32 v25, a118
    v_mfma_f32_16x16x32_bf16 a[124:127], v[32:35], v[224:227], a[124:127]
    v_mul_f32 v26, v12, v24
    v_mul_f32 v27, v12, v25
    s_waitcnt lgkmcnt(6)
    v_mfma_f32_16x16x32_bf16 a[120:123], v[36:39], v[164:167], a[120:123]
    v_fma_f32 v26, -v13, v25, v26
    v_fma_f32 v27, v13, v24, v27
    v_mfma_f32_16x16x32_bf16 a[124:127], v[36:39], v[228:231], a[124:127]
    v_accvgpr_write_b32 a114, v26
    v_accvgpr_write_b32 a118, v27
    s_waitcnt lgkmcnt(5)
    v_mfma_f32_16x16x32_bf16 a[120:123], v[40:43], v[168:171], a[120:123]
    v_fma_f32 v18, v8, v22, v26
    v_mfma_f32_16x16x32_bf16 a[124:127], v[40:43], v[232:235], a[124:127]
    v_fma_f32 v19, v8, v23, v27
    v_fma_f32 v20, -v9, v23, v18
    s_waitcnt lgkmcnt(4)
    v_mfma_f32_16x16x32_bf16 a[120:123], v[44:47], v[172:175], a[120:123]
    v_fma_f32 v21, v9, v22, v19
    v_accvgpr_read_b32 v24, a115
    v_mfma_f32_16x16x32_bf16 a[124:127], v[44:47], v[236:239], a[124:127]
    v_accvgpr_read_b32 v25, a119
    v_mul_f32 v26, v12, v24
    s_waitcnt lgkmcnt(3)
    v_mfma_f32_16x16x32_bf16 a[120:123], v[48:51], v[176:179], a[120:123]
    v_mul_f32 v27, v12, v25
    v_mfma_f32_16x16x32_bf16 a[124:127], v[48:51], v[240:243], a[124:127]
    v_fma_f32 v26, -v13, v25, v26
    v_fma_f32 v27, v13, v24, v27
    s_waitcnt lgkmcnt(2)
    v_mfma_f32_16x16x32_bf16 a[120:123], v[52:55], v[180:183], a[120:123]
    v_accvgpr_write_b32 a115, v26
    v_accvgpr_write_b32 a119, v27
    v_mfma_f32_16x16x32_bf16 a[124:127], v[52:55], v[244:247], a[124:127]
    v_fma_f32 v18, v8, v20, v26
    v_fma_f32 v19, v8, v21, v27
    s_waitcnt lgkmcnt(1)
    v_mfma_f32_16x16x32_bf16 a[120:123], v[56:59], v[184:187], a[120:123]
    v_fma_f32 v22, -v9, v21, v18
    v_mfma_f32_16x16x32_bf16 a[124:127], v[56:59], v[248:251], a[124:127]
    v_fma_f32 v23, v9, v20, v19
    s_waitcnt lgkmcnt(0)
    v_mfma_f32_16x16x32_bf16 a[120:123], v[60:63], v[188:191], a[120:123]
    v_mfma_f32_16x16x32_bf16 a[124:127], v[60:63], v[252:255], a[124:127]
    s_nop 7
    v_accvgpr_read_b32 v24, a120
    v_accvgpr_read_b32 v25, a124
    v_mul_f32 v26, v12, v24
    v_mul_f32 v27, v12, v25
    v_fma_f32 v26, -v13, v25, v26
    v_fma_f32 v27, v13, v24, v27
    v_accvgpr_write_b32 a120, v26
    v_accvgpr_write_b32 a124, v27
    v_fma_f32 v18, v8, v22, v26
    v_fma_f32 v19, v8, v23, v27
    v_fma_f32 v20, -v9, v23, v18
    v_fma_f32 v21, v9, v22, v19
    v_accvgpr_read_b32 v24, a121
    v_accvgpr_read_b32 v25, a125
    v_mul_f32 v26, v12, v24
    v_mul_f32 v27, v12, v25
    v_fma_f32 v26, -v13, v25, v26
    v_fma_f32 v27, v13, v24, v27
    v_accvgpr_write_b32 a121, v26
    v_accvgpr_write_b32 a125, v27
    v_fma_f32 v18, v8, v20, v26
    v_fma_f32 v19, v8, v21, v27
    v_fma_f32 v22, -v9, v21, v18
    v_fma_f32 v23, v9, v20, v19
    v_accvgpr_read_b32 v24, a122
    v_accvgpr_read_b32 v25, a126
    v_mul_f32 v26, v12, v24
    v_mul_f32 v27, v12, v25
    v_fma_f32 v26, -v13, v25, v26
    v_fma_f32 v27, v13, v24, v27
    v_accvgpr_write_b32 a122, v26
    v_accvgpr_write_b32 a126, v27
    v_fma_f32 v18, v8, v22, v26
    v_fma_f32 v19, v8, v23, v27
    v_fma_f32 v20, -v9, v23, v18
    v_fma_f32 v21, v9, v22, v19
    v_accvgpr_read_b32 v24, a123
    v_accvgpr_read_b32 v25, a127
    v_mul_f32 v26, v12, v24
    v_mul_f32 v27, v12, v25
    v_fma_f32 v26, -v13, v25, v26
    v_fma_f32 v27, v13, v24, v27
    v_accvgpr_write_b32 a123, v26
    v_accvgpr_write_b32 a127, v27
    v_fma_f32 v18, v8, v20, v26
    v_fma_f32 v19, v8, v21, v27
    v_fma_f32 v22, -v9, v21, v18
    v_fma_f32 v23, v9, v20, v19
    v_lshl_add_u32 v24, v16, 7, v6
    buffer_store_dwordx2 v[22:23], v24, s[8:11], s44 offen sc1
    s_mov_b32 s42, 1
    s_waitcnt vmcnt(0) lgkmcnt(0)
    s_barrier
    s_cmp_eq_u32 s3, 0
    s_cbranch_scc0 L_r3_e
    v_mov_b32 v18, s42
    s_mov_b64 exec, 1
    buffer_store_dword v18, off, s[8:11], s41 offset:4 sc1
    s_mov_b64 exec, -1
L_r3_e:
    v_lshrrev_b32 v65, 2, v0
    s_mov_b32 s43, 0
L_r3_wi:
    buffer_load_dword v64, v65, s[12:15], 0 offen sc1
    s_waitcnt vmcnt(0)
    v_cmp_ne_u32 vcc, 32, v64
    s_nop 3
    s_and_b32 vcc_lo, vcc_lo, 0x120002
    s_and_b32 vcc_hi, vcc_hi, 0x920012
    s_or_b64 vcc, vcc, vcc
    s_cbranch_vccz L_r3_wi_ok
    s_sleep 8
    s_add_u32 s43, s43, 1
    s_cmp_lt_u32 s43, 0x40000
    s_cbranch_scc1 L_r3_wi
    s_endpgm
L_r3_wi_ok:
    v_lshlrev_b32 v64, 3, v0
    v_and_b32 v64, 0x1180, v64
    s_and_b32 s36, s41, 0xe00
    s_add_u32 s36, s36, 20480
    s_mov_b32 s43, 0
L_r3_we:
    buffer_load_dword v65, v64, s[8:11], s36 offen offset:4 sc1
    s_waitcnt vmcnt(0)
    v_cmp_eq_u32 vcc, 0, v65
    s_cbranch_vccz L_r3_we_ok
    s_sleep 2
    s_add_u32 s43, s43, 1
    s_cmp_lt_u32 s43, 0x40000
    s_cbranch_scc1 L_r3_we
    s_endpgm
L_r3_we_ok:
    buffer_load_dwordx2 v[32:33], v6, s[8:11], s44 offen offset:0 sc1
    buffer_load_dwordx2 v[34:35], v6, s[8:11], s44 offen offset:128 sc1
    buffer_load_dwordx2 v[36:37], v6, s[8:11], s44 offen offset:256 sc1
    buffer_load_dwordx2 v[38:39], v6, s[8:11], s44 offen offset:384 sc1
    buffer_load_dwordx2 v[40:41], v6, s[8:11], s44 offen offset:512 sc1
    buffer_load_dwordx2 v[42:43], v6, s[8:11], s44 offen offset:640 sc1
    buffer_load_dwordx2 v[44:45], v6, s[8:11], s44 offen offset:768 sc1
    buffer_load_dwordx2 v[46:47], v6, s[8:11], s44 offen offset:896 sc1
    buffer_load_dwordx2 v[48:49], v6, s[8:11], s44 offen offset:1024 sc1
    buffer_load_dwordx2 v[50:51], v6, s[8:11], s44 offen offset:1152 sc1
    buffer_load_dwordx2 v[52:53], v6, s[8:11], s44 offen offset:1280 sc1
    buffer_load_dwordx2 v[54:55], v6, s[8:11], s44 offen offset:1408 sc1
    buffer_load_dwordx2 v[56:57], v6, s[8:11], s44 offen offset:1536 sc1
    buffer_load_dwordx2 v[58:59], v6, s[8:11], s44 offen offset:1664 sc1
    buffer_load_dwordx2 v[60:61], v6, s[8:11], s44 offen offset:1792 sc1
    buffer_load_dwordx2 v[62:63], v6, s[8:11], s44 offen offset:1920 sc1
    buffer_load_dwordx2 v[64:65], v6, s[8:11], s44 offen offset:2048 sc1
    buffer_load_dwordx2 v[66:67], v6, s[8:11], s44 offen offset:2176 sc1
    buffer_load_dwordx2 v[68:69], v6, s[8:11], s44 offen offset:2304 sc1
    buffer_load_dwordx2 v[70:71], v6, s[8:11], s44 offen offset:2432 sc1
    buffer_load_dwordx2 v[72:73], v6, s[8:11], s44 offen offset:2560 sc1
    buffer_load_dwordx2 v[74:75], v6, s[8:11], s44 offen offset:2688 sc1
    buffer_load_dwordx2 v[76:77], v6, s[8:11], s44 offen offset:2816 sc1
    buffer_load_dwordx2 v[78:79], v6, s[8:11], s44 offen offset:2944 sc1
    buffer_load_dwordx2 v[80:81], v6, s[8:11], s44 offen offset:3072 sc1
    buffer_load_dwordx2 v[82:83], v6, s[8:11], s44 offen offset:3200 sc1
    buffer_load_dwordx2 v[84:85], v6, s[8:11], s44 offen offset:3328 sc1
    buffer_load_dwordx2 v[86:87], v6, s[8:11], s44 offen offset:3456 sc1
    buffer_load_dwordx2 v[88:89], v6, s[8:11], s44 offen offset:3584 sc1
    buffer_load_dwordx2 v[90:91], v6, s[8:11], s44 offen offset:3712 sc1
    buffer_load_dwordx2 v[92:93], v6, s[8:11], s44 offen offset:3840 sc1
    v_mov_b32 v24, 0
    v_mov_b32 v25, 0
    s_load_dwordx2 s[16:17], s[0:1], 112
    s_waitcnt lgkmcnt(0)
    s_mov_b32 s18, 0x400000
    s_mov_b32 s19, 0x20000
    s_lshl_b32 s36, s3, 20
    s_lshl_b32 s37, s5, 13
    s_add_u32 s36, s36, s37
    v_lshlrev_b32 v126, 3, v0
    buffer_load_dword v127, v126, s[16:19], s36 offen
    s_add_u32 s36, s36, 0x40000
    buffer_load_dword v127, v126, s[16:19], s36 offen
    s_add_u32 s36, s36, 0x40000
    s_waitcnt vmcnt(2)
    v_cmp_eq_u32 vcc, 1, v16
    v_fma_f32 v18, v10, v14, v32
    v_fma_f32 v19, v10, v15, v33
    v_fma_f32 v20, -v11, v15, v18
    v_fma_f32 v21, v11, v14, v19
    v_cndmask_b32 v24, v24, v20, vcc
    v_cndmask_b32 v25, v25, v21, vcc
    v_cmp_eq_u32 vcc, 2, v16
    v_fma_f32 v18, v10, v20, v34
    v_fma_f32 v19, v10, v21, v35
    v_fma_f32 v22, -v11, v21, v18
    v_fma_f32 v23, v11, v20, v19
    v_cndmask_b32 v24, v24, v22, vcc
    v_cndmask_b32 v25, v25, v23, vcc
    v_cmp_eq_u32 vcc, 3, v16
    v_fma_f32 v18, v10, v22, v36
    v_fma_f32 v19, v10, v23, v37
    v_fma_f32 v20, -v11, v23, v18
    v_fma_f32 v21, v11, v22, v19
    v_cndmask_b32 v24, v24, v20, vcc
    v_cndmask_b32 v25, v25, v21, vcc
    v_cmp_eq_u32 vcc, 4, v16
    v_fma_f32 v18, v10, v20, v38
    v_fma_f32 v19, v10, v21, v39
    v_fma_f32 v22, -v11, v21, v18
    v_fma_f32 v23, v11, v20, v19
    v_cndmask_b32 v24, v24, v22, vcc
    v_cndmask_b32 v25, v25, v23, vcc
    v_cmp_eq_u32 vcc, 5, v16
    v_fma_f32 v18, v10, v22, v40
    v_fma_f32 v19, v10, v23, v41
    v_fma_f32 v20, -v11, v23, v18
    v_fma_f32 v21, v11, v22, v19
    v_cndmask_b32 v24, v24, v20, vcc
    v_cndmask_b32 v25, v25, v21, vcc
    v_cmp_eq_u32 vcc, 6, v16
    v_fma_f32 v18, v10, v20, v42
    v_fma_f32 v19, v10, v21, v43
    v_fma_f32 v22, -v11, v21, v18
    v_fma_f32 v23, v11, v20, v19
    v_cndmask_b32 v24, v24, v22, vcc
    v_cndmask_b32 v25, v25, v23, vcc
    v_cmp_eq_u32 vcc, 7, v16
    v_fma_f32 v18, v10, v22, v44
    v_fma_f32 v19, v10, v23, v45
    v_fma_f32 v20, -v11, v23, v18
    v_fma_f32 v21, v11, v22, v19
    v_cndmask_b32 v24, v24, v20, vcc
    v_cndmask_b32 v25, v25, v21, vcc
    v_cmp_eq_u32 vcc, 8, v16
    v_fma_f32 v18, v10, v20, v46
    v_fma_f32 v19, v10, v21, v47
    v_fma_f32 v22, -v11, v21, v18
    v_fma_f32 v23, v11, v20, v19
    v_cndmask_b32 v24, v24, v22, vcc
    v_cndmask_b32 v25, v25, v23, vcc
    v_cmp_eq_u32 vcc, 9, v16
    v_fma_f32 v18, v10, v22, v48
    v_fma_f32 v19, v10, v23, v49
    v_fma_f32 v20, -v11, v23, v18
    v_fma_f32 v21, v11, v22, v19
    v_cndmask_b32 v24, v24, v20, vcc
    v_cndmask_b32 v25, v25, v21, vcc
    v_cmp_eq_u32 vcc, 10, v16
    v_fma_f32 v18, v10, v20, v50
    v_fma_f32 v19, v10, v21, v51
    v_fma_f32 v22, -v11, v21, v18
    v_fma_f32 v23, v11, v20, v19
    v_cndmask_b32 v24, v24, v22, vcc
    v_cndmask_b32 v25, v25, v23, vcc
    v_cmp_eq_u32 vcc, 11, v16
    v_fma_f32 v18, v10, v22, v52
    v_fma_f32 v19, v10, v23, v53
    v_fma_f32 v20, -v11, v23, v18
    v_fma_f32 v21, v11, v22, v19
    v_cndmask_b32 v24, v24, v20, vcc
    v_cndmask_b32 v25, v25, v21, vcc
    v_cmp_eq_u32 vcc, 12, v16
    v_fma_f32 v18, v10, v20, v54
    v_fma_f32 v19, v10, v21, v55
    v_fma_f32 v22, -v11, v21, v18
    v_fma_f32 v23, v11, v20, v19
    v_cndmask_b32 v24, v24, v22, vcc
    v_cndmask_b32 v25, v25, v23, vcc
    v_cmp_eq_u32 vcc, 13, v16
    v_fma_f32 v18, v10, v22, v56
    v_fma_f32 v19, v10, v23, v57
    v_fma_f32 v20, -v11, v23, v18
    v_fma_f32 v21, v11, v22, v19
    v_cndmask_b32 v24, v24, v20, vcc
    v_cndmask_b32 v25, v25, v21, vcc
    v_cmp_eq_u32 vcc, 14, v16
    v_fma_f32 v18, v10, v20, v58
    v_fma_f32 v19, v10, v21, v59
    v_fma_f32 v22, -v11, v21, v18
    v_fma_f32 v23, v11, v20, v19
    v_cndmask_b32 v24, v24, v22, vcc
    v_cndmask_b32 v25, v25, v23, vcc
    v_cmp_eq_u32 vcc, 15, v16
    v_fma_f32 v18, v10, v22, v60
    v_fma_f32 v19, v10, v23, v61
    v_fma_f32 v20, -v11, v23, v18
    v_fma_f32 v21, v11, v22, v19
    v_cndmask_b32 v24, v24, v20, vcc
    v_cndmask_b32 v25, v25, v21, vcc
    v_cmp_eq_u32 vcc, 16, v16
    v_fma_f32 v18, v10, v20, v62
    v_fma_f32 v19, v10, v21, v63
    v_fma_f32 v22, -v11, v21, v18
    v_fma_f32 v23, v11, v20, v19
    v_cndmask_b32 v24, v24, v22, vcc
    v_cndmask_b32 v25, v25, v23, vcc
    v_cmp_eq_u32 vcc, 17, v16
    v_fma_f32 v18, v10, v22, v64
    v_fma_f32 v19, v10, v23, v65
    v_fma_f32 v20, -v11, v23, v18
    v_fma_f32 v21, v11, v22, v19
    v_cndmask_b32 v24, v24, v20, vcc
    v_cndmask_b32 v25, v25, v21, vcc
    v_cmp_eq_u32 vcc, 18, v16
    v_fma_f32 v18, v10, v20, v66
    v_fma_f32 v19, v10, v21, v67
    v_fma_f32 v22, -v11, v21, v18
    v_fma_f32 v23, v11, v20, v19
    v_cndmask_b32 v24, v24, v22, vcc
    v_cndmask_b32 v25, v25, v23, vcc
    v_cmp_eq_u32 vcc, 19, v16
    v_fma_f32 v18, v10, v22, v68
    v_fma_f32 v19, v10, v23, v69
    v_fma_f32 v20, -v11, v23, v18
    v_fma_f32 v21, v11, v22, v19
    v_cndmask_b32 v24, v24, v20, vcc
    v_cndmask_b32 v25, v25, v21, vcc
    v_cmp_eq_u32 vcc, 20, v16
    v_fma_f32 v18, v10, v20, v70
    v_fma_f32 v19, v10, v21, v71
    v_fma_f32 v22, -v11, v21, v18
    v_fma_f32 v23, v11, v20, v19
    v_cndmask_b32 v24, v24, v22, vcc
    v_cndmask_b32 v25, v25, v23, vcc
    v_cmp_eq_u32 vcc, 21, v16
    v_fma_f32 v18, v10, v22, v72
    v_fma_f32 v19, v10, v23, v73
    v_fma_f32 v20, -v11, v23, v18
    v_fma_f32 v21, v11, v22, v19
    v_cndmask_b32 v24, v24, v20, vcc
    v_cndmask_b32 v25, v25, v21, vcc
    v_cmp_eq_u32 vcc, 22, v16
    v_fma_f32 v18, v10, v20, v74
    v_fma_f32 v19, v10, v21, v75
    v_fma_f32 v22, -v11, v21, v18
    v_fma_f32 v23, v11, v20, v19
    v_cndmask_b32 v24, v24, v22, vcc
    v_cndmask_b32 v25, v25, v23, vcc
    v_cmp_eq_u32 vcc, 23, v16
    v_fma_f32 v18, v10, v22, v76
    v_fma_f32 v19, v10, v23, v77
    v_fma_f32 v20, -v11, v23, v18
    v_fma_f32 v21, v11, v22, v19
    v_cndmask_b32 v24, v24, v20, vcc
    v_cndmask_b32 v25, v25, v21, vcc
    v_cmp_eq_u32 vcc, 24, v16
    v_fma_f32 v18, v10, v20, v78
    v_fma_f32 v19, v10, v21, v79
    v_fma_f32 v22, -v11, v21, v18
    v_fma_f32 v23, v11, v20, v19
    v_cndmask_b32 v24, v24, v22, vcc
    v_cndmask_b32 v25, v25, v23, vcc
    v_cmp_eq_u32 vcc, 25, v16
    v_fma_f32 v18, v10, v22, v80
    v_fma_f32 v19, v10, v23, v81
    v_fma_f32 v20, -v11, v23, v18
    v_fma_f32 v21, v11, v22, v19
    v_cndmask_b32 v24, v24, v20, vcc
    v_cndmask_b32 v25, v25, v21, vcc
    v_cmp_eq_u32 vcc, 26, v16
    v_fma_f32 v18, v10, v20, v82
    v_fma_f32 v19, v10, v21, v83
    v_fma_f32 v22, -v11, v21, v18
    v_fma_f32 v23, v11, v20, v19
    v_cndmask_b32 v24, v24, v22, vcc
    v_cndmask_b32 v25, v25, v23, vcc
    v_cmp_eq_u32 vcc, 27, v16
    v_fma_f32 v18, v10, v22, v84
    v_fma_f32 v19, v10, v23, v85
    v_fma_f32 v20, -v11, v23, v18
    v_fma_f32 v21, v11, v22, v19
    v_cndmask_b32 v24, v24, v20, vcc
    v_cndmask_b32 v25, v25, v21, vcc
    v_cmp_eq_u32 vcc, 28, v16
    v_fma_f32 v18, v10, v20, v86
    v_fma_f32 v19, v10, v21, v87
    v_fma_f32 v22, -v11, v21, v18
    v_fma_f32 v23, v11, v20, v19
    v_cndmask_b32 v24, v24, v22, vcc
    v_cndmask_b32 v25, v25, v23, vcc
    v_cmp_eq_u32 vcc, 29, v16
    v_fma_f32 v18, v10, v22, v88
    v_fma_f32 v19, v10, v23, v89
    v_fma_f32 v20, -v11, v23, v18
    v_fma_f32 v21, v11, v22, v19
    v_cndmask_b32 v24, v24, v20, vcc
    v_cndmask_b32 v25, v25, v21, vcc
    v_cmp_eq_u32 vcc, 30, v16
    v_fma_f32 v18, v10, v20, v90
    v_fma_f32 v19, v10, v21, v91
    v_fma_f32 v22, -v11, v21, v18
    v_fma_f32 v23, v11, v20, v19
    v_cndmask_b32 v24, v24, v22, vcc
    v_cndmask_b32 v25, v25, v23, vcc
    v_cmp_eq_u32 vcc, 31, v16
    v_fma_f32 v18, v10, v22, v92
    v_fma_f32 v19, v10, v23, v93
    v_fma_f32 v20, -v11, v23, v18
    v_fma_f32 v21, v11, v22, v19
    v_cndmask_b32 v24, v24, v20, vcc
    v_cndmask_b32 v25, v25, v21, vcc
    v_accvgpr_read_b32 v26, a0
    v_accvgpr_read_b32 v27, a4
    v_fma_f32 v18, v8, v24, v26
    v_fma_f32 v19, v8, v25, v27
    v_fma_f32 v20, -v9, v25, v18
    v_fma_f32 v21, v9, v24, v19
    v_cvt_pk_bf16_f32 v64, v20, -v21
    ds_write_b32 v4, v64 offset:0
    v_accvgpr_read_b32 v26, a1
    v_accvgpr_read_b32 v27, a5
    v_fma_f32 v18, v8, v20, v26
    v_fma_f32 v19, v8, v21, v27
    v_fma_f32 v22, -v9, v21, v18
    v_fma_f32 v23, v9, v20, v19
    v_cvt_pk_bf16_f32 v65, v22, -v23
    ds_write_b32 v4, v65 offset:16
    v_accvgpr_read_b32 v26, a2
    v_accvgpr_read_b32 v27, a6
    v_fma_f32 v18, v8, v22, v26
    v_fma_f32 v19, v8, v23, v27
    v_fma_f32 v20, -v9, v23, v18
    v_fma_f32 v21, v9, v22, v19
    v_cvt_pk_bf16_f32 v66, v20, -v21
    ds_write_b32 v4, v66 offset:32
    v_accvgpr_read_b32 v26, a3
    v_accvgpr_read_b32 v27, a7
    v_fma_f32 v18, v8, v20, v26
    v_fma_f32 v19, v8, v21, v27
    v_fma_f32 v22, -v9, v21, v18
    v_fma_f32 v23, v9, v20, v19
    v_cvt_pk_bf16_f32 v67, v22, -v23
    ds_write_b32 v4, v67 offset:48
    s_waitcnt lgkmcnt(3)
    v_accvgpr_read_b32 v26, a8
    v_accvgpr_read_b32 v27, a12
    v_fma_f32 v18, v8, v22, v26
    v_fma_f32 v19, v8, v23, v27
    v_fma_f32 v20, -v9, v23, v18
    v_fma_f32 v21, v9, v22, v19
    v_cvt_pk_bf16_f32 v68, v20, -v21
    ds_write_b32 v4, v68 offset:64
    v_accvgpr_read_b32 v26, a9
    v_accvgpr_read_b32 v27, a13
    v_fma_f32 v18, v8, v20, v26
    v_fma_f32 v19, v8, v21, v27
    v_fma_f32 v22, -v9, v21, v18
    v_fma_f32 v23, v9, v20, v19
    v_cvt_pk_bf16_f32 v69, v22, -v23
    ds_write_b32 v4, v69 offset:80
    v_accvgpr_read_b32 v26, a10
    v_accvgpr_read_b32 v27, a14
    v_fma_f32 v18, v8, v22, v26
    v_fma_f32 v19, v8, v23, v27
    v_fma_f32 v20, -v9, v23, v18
    v_fma_f32 v21, v9, v22, v19
    v_cvt_pk_bf16_f32 v70, v20, -v21
    ds_write_b32 v4, v70 offset:96
    v_accvgpr_read_b32 v26, a11
    v_accvgpr_read_b32 v27, a15
    v_fma_f32 v18, v8, v20, v26
    v_fma_f32 v19, v8, v21, v27
    v_fma_f32 v22, -v9, v21, v18
    v_fma_f32 v23, v9, v20, v19
    v_cvt_pk_bf16_f32 v71, v22, -v23
    ds_write_b32 v4, v71 offset:112
    s_waitcnt lgkmcnt(3)
    v_accvgpr_read_b32 v26, a16
    v_accvgpr_read_b32 v27, a20
    v_fma_f32 v18, v8, v22, v26
    v_fma_f32 v19, v8, v23, v27
    v_fma_f32 v20, -v9, v23, v18
    v_fma_f32 v21, v9, v22, v19
    v_cvt_pk_bf16_f32 v64, v20, -v21
    ds_write_b32 v4, v64 offset:128
    v_accvgpr_read_b32 v26, a17
    v_accvgpr_read_b32 v27, a21
    v_fma_f32 v18, v8, v20, v26
    v_fma_f32 v19, v8, v21, v27
    v_fma_f32 v22, -v9, v21, v18
    v_fma_f32 v23, v9, v20, v19
    v_cvt_pk_bf16_f32 v65, v22, -v23
    ds_write_b32 v4, v65 offset:144
    v_accvgpr_read_b32 v26, a18
    v_accvgpr_read_b32 v27, a22
    v_fma_f32 v18, v8, v22, v26
    v_fma_f32 v19, v8, v23, v27
    v_fma_f32 v20, -v9, v23, v18
    v_fma_f32 v21, v9, v22, v19
    v_cvt_pk_bf16_f32 v66, v20, -v21
    ds_write_b32 v4, v66 offset:160
    v_accvgpr_read_b32 v26, a19
    v_accvgpr_read_b32 v27, a23
    v_fma_f32 v18, v8, v20, v26
    v_fma_f32 v19, v8, v21, v27
    v_fma_f32 v22, -v9, v21, v18
    v_fma_f32 v23, v9, v20, v19
    v_cvt_pk_bf16_f32 v67, v22, -v23
    ds_write_b32 v4, v67 offset:176
    s_waitcnt lgkmcnt(3)
    v_accvgpr_read_b32 v26, a24
    v_accvgpr_read_b32 v27, a28
    v_fma_f32 v18, v8, v22, v26
    v_fma_f32 v19, v8, v23, v27
    v_fma_f32 v20, -v9, v23, v18
    v_fma_f32 v21, v9, v22, v19
    v_cvt_pk_bf16_f32 v68, v20, -v21
    ds_write_b32 v4, v68 offset:192
    v_accvgpr_read_b32 v26, a25
    v_accvgpr_read_b32 v27, a29
    v_fma_f32 v18, v8, v20, v26
    v_fma_f32 v19, v8, v21, v27
    v_fma_f32 v22, -v9, v21, v18
    v_fma_f32 v23, v9, v20, v19
    v_cvt_pk_bf16_f32 v69, v22, -v23
    ds_write_b32 v4, v69 offset:208
    v_accvgpr_read_b32 v26, a26
    v_accvgpr_read_b32 v27, a30
    v_fma_f32 v18, v8, v22, v26
    v_fma_f32 v19, v8, v23, v27
    v_fma_f32 v20, -v9, v23, v18
    v_fma_f32 v21, v9, v22, v19
    v_cvt_pk_bf16_f32 v70, v20, -v21
    ds_write_b32 v4, v70 offset:224
    v_accvgpr_read_b32 v26, a27
    v_accvgpr_read_b32 v27, a31
    v_fma_f32 v18, v8, v20, v26
    v_fma_f32 v19, v8, v21, v27
    v_fma_f32 v22, -v9, v21, v18
    v_fma_f32 v23, v9, v20, v19
    v_cvt_pk_bf16_f32 v71, v22, -v23
    ds_write_b32 v4, v71 offset:240
    s_waitcnt lgkmcnt(3)
    ds_read_b128 v[32:35], v5 offset:0
    ds_read_b128 v[36:39], v5 offset:1088
    ds_read_b128 v[40:43], v5 offset:2176
    ds_read_b128 v[44:47], v5 offset:3264
    v_accvgpr_read_b32 v26, a32
    v_accvgpr_read_b32 v27, a36
    v_fma_f32 v18, v8, v22, v26
    v_fma_f32 v19, v8, v23, v27
    v_fma_f32 v20, -v9, v23, v18
    v_fma_f32 v21, v9, v22, v19
    v_cvt_pk_bf16_f32 v64, v20, -v21
    ds_write_b32 v4, v64 offset:0
    v_accvgpr_read_b32 v26, a33
    v_accvgpr_read_b32 v27, a37
    v_fma_f32 v18, v8, v20, v26
    v_fma_f32 v19, v8, v21, v27
    v_fma_f32 v22, -v9, v21, v18
    v_fma_f32 v23, v9, v20, v19
    v_cvt_pk_bf16_f32 v65, v22, -v23
    ds_write_b32 v4, v65 offset:16
    v_accvgpr_read_b32 v26, a34
    v_accvgpr_read_b32 v27, a38
    v_fma_f32 v18, v8, v22, v26
    v_fma_f32 v19, v8, v23, v27
    v_fma_f32 v20, -v9, v23, v18
    v_fma_f32 v21, v9, v22, v19
    v_cvt_pk_bf16_f32 v66, v20, -v21
    ds_write_b32 v4, v66 offset:32
    v_accvgpr_read_b32 v26, a35
    v_accvgpr_read_b32 v27, a39
    v_fma_f32 v18, v8, v20, v26
    v_fma_f32 v19, v8, v21, v27
    v_fma_f32 v22, -v9, v21, v18
    v_fma_f32 v23, v9, v20, v19
    v_cvt_pk_bf16_f32 v67, v22, -v23
    ds_write_b32 v4, v67 offset:48
    s_waitcnt lgkmcnt(3)
    s_add_u32 s36, s40, 0
    buffer_store_dwordx4 v[32:35], v0, s[8:11], s36 offen sc1
    s_add_u32 s36, s36, 0x20000
    buffer_store_dwordx4 v[36:39], v0, s[8:11], s36 offen sc1
    s_add_u32 s36, s36, 0x20000
    buffer_store_dwordx4 v[40:43], v0, s[8:11], s36 offen sc1
    s_add_u32 s36, s36, 0x20000
    buffer_store_dwordx4 v[44:47], v0, s[8:11], s36 offen sc1
    v_accvgpr_read_b32 v26, a40
    v_accvgpr_read_b32 v27, a44
    v_fma_f32 v18, v8, v22, v26
    v_fma_f32 v19, v8, v23, v27
    v_fma_f32 v20, -v9, v23, v18
    v_fma_f32 v21, v9, v22, v19
    v_cvt_pk_bf16_f32 v68, v20, -v21
    ds_write_b32 v4, v68 offset:64
    v_accvgpr_read_b32 v26, a41
    v_accvgpr_read_b32 v27, a45
    v_fma_f32 v18, v8, v20, v26
    v_fma_f32 v19, v8, v21, v27
    v_fma_f32 v22, -v9, v21, v18
    v_fma_f32 v23, v9, v20, v19
    v_cvt_pk_bf16_f32 v69, v22, -v23
    ds_write_b32 v4, v69 offset:80
    v_accvgpr_read_b32 v26, a42
    v_accvgpr_read_b32 v27, a46
    v_fma_f32 v18, v8, v22, v26
    v_fma_f32 v19, v8, v23, v27
    v_fma_f32 v20, -v9, v23, v18
    v_fma_f32 v21, v9, v22, v19
    v_cvt_pk_bf16_f32 v70, v20, -v21
    ds_write_b32 v4, v70 offset:96
    v_accvgpr_read_b32 v26, a43
    v_accvgpr_read_b32 v27, a47
    v_fma_f32 v18, v8, v20, v26
    v_fma_f32 v19, v8, v21, v27
    v_fma_f32 v22, -v9, v21, v18
    v_fma_f32 v23, v9, v20, v19
    v_cvt_pk_bf16_f32 v71, v22, -v23
    ds_write_b32 v4, v71 offset:112
    s_waitcnt lgkmcnt(3)
    v_accvgpr_read_b32 v26, a48
    v_accvgpr_read_b32 v27, a52
    v_fma_f32 v18, v8, v22, v26
    v_fma_f32 v19, v8, v23, v27
    v_fma_f32 v20, -v9, v23, v18
    v_fma_f32 v21, v9, v22, v19
    v_cvt_pk_bf16_f32 v64, v20, -v21
    ds_write_b32 v4, v64 offset:128
    v_accvgpr_read_b32 v26, a49
    v_accvgpr_read_b32 v27, a53
    v_fma_f32 v18, v8, v20, v26
    v_fma_f32 v19, v8, v21, v27
    v_fma_f32 v22, -v9, v21, v18
    v_fma_f32 v23, v9, v20, v19
    v_cvt_pk_bf16_f32 v65, v22, -v23
    ds_write_b32 v4, v65 offset:144
    v_accvgpr_read_b32 v26, a50
    v_accvgpr_read_b32 v27, a54
    v_fma_f32 v18, v8, v22, v26
    v_fma_f32 v19, v8, v23, v27
    v_fma_f32 v20, -v9, v23, v18
    v_fma_f32 v21, v9, v22, v19
    v_cvt_pk_bf16_f32 v66, v20, -v21
    ds_write_b32 v4, v66 offset:160
    v_accvgpr_read_b32 v26, a51
    v_accvgpr_read_b32 v27, a55
    v_fma_f32 v18, v8, v20, v26
    v_fma_f32 v19, v8, v21, v27
    v_fma_f32 v22, -v9, v21, v18
    v_fma_f32 v23, v9, v20, v19
    v_cvt_pk_bf16_f32 v67, v22, -v23
    ds_write_b32 v4, v67 offset:176
    s_waitcnt lgkmcnt(3)
    v_accvgpr_read_b32 v26, a56
    v_accvgpr_read_b32 v27, a60
    v_fma_f32 v18, v8, v22, v26
    v_fma_f32 v19, v8, v23, v27
    v_fma_f32 v20, -v9, v23, v18
    v_fma_f32 v21, v9, v22, v19
    v_cvt_pk_bf16_f32 v68, v20, -v21
    ds_write_b32 v4, v68 offset:192
    v_accvgpr_read_b32 v26, a57
    v_accvgpr_read_b32 v27, a61
    v_fma_f32 v18, v8, v20, v26
    v_fma_f32 v19, v8, v21, v27
    v_fma_f32 v22, -v9, v21, v18
    v_fma_f32 v23, v9, v20, v19
    v_cvt_pk_bf16_f32 v69, v22, -v23
    ds_write_b32 v4, v69 offset:208
    v_accvgpr_read_b32 v26, a58
    v_accvgpr_read_b32 v27, a62
    v_fma_f32 v18, v8, v22, v26
    v_fma_f32 v19, v8, v23, v27
    v_fma_f32 v20, -v9, v23, v18
    v_fma_f32 v21, v9, v22, v19
    v_cvt_pk_bf16_f32 v70, v20, -v21
    ds_write_b32 v4, v70 offset:224
    v_accvgpr_read_b32 v26, a59
    v_accvgpr_read_b32 v27, a63
    v_fma_f32 v18, v8, v20, v26
    v_fma_f32 v19, v8, v21, v27
    v_fma_f32 v22, -v9, v21, v18
    v_fma_f32 v23, v9, v20, v19
    v_cvt_pk_bf16_f32 v71, v22, -v23
    ds_write_b32 v4, v71 offset:240
    s_waitcnt lgkmcnt(3)
    ds_read_b128 v[48:51], v5 offset:0
    ds_read_b128 v[52:55], v5 offset:1088
    ds_read_b128 v[56:59], v5 offset:2176
    ds_read_b128 v[60:63], v5 offset:3264
    v_accvgpr_read_b32 v26, a64
    v_accvgpr_read_b32 v27, a68
    v_fma_f32 v18, v8, v22, v26
    v_fma_f32 v19, v8, v23, v27
    v_fma_f32 v20, -v9, v23, v18
    v_fma_f32 v21, v9, v22, v19
    v_cvt_pk_bf16_f32 v64, v20, -v21
    ds_write_b32 v4, v64 offset:0
    v_accvgpr_read_b32 v26, a65
    v_accvgpr_read_b32 v27, a69
    v_fma_f32 v18, v8, v20, v26
    v_fma_f32 v19, v8, v21, v27
    v_fma_f32 v22, -v9, v21, v18
    v_fma_f32 v23, v9, v20, v19
    v_cvt_pk_bf16_f32 v65, v22, -v23
    ds_write_b32 v4, v65 offset:16
    v_accvgpr_read_b32 v26, a66
    v_accvgpr_read_b32 v27, a70
    v_fma_f32 v18, v8, v22, v26
    v_fma_f32 v19, v8, v23, v27
    v_fma_f32 v20, -v9, v23, v18
    v_fma_f32 v21, v9, v22, v19
    v_cvt_pk_bf16_f32 v66, v20, -v21
    ds_write_b32 v4, v66 offset:32
    v_accvgpr_read_b32 v26, a67
    v_accvgpr_read_b32 v27, a71
    v_fma_f32 v18, v8, v20, v26
    v_fma_f32 v19, v8, v21, v27
    v_fma_f32 v22, -v9, v21, v18
    v_fma_f32 v23, v9, v20, v19
    v_cvt_pk_bf16_f32 v67, v22, -v23
    ds_write_b32 v4, v67 offset:48
    s_waitcnt lgkmcnt(3)
    s_add_u32 s36, s40, 32768
    buffer_store_dwordx4 v[48:51], v0, s[8:11], s36 offen sc1
    s_add_u32 s36, s36, 0x20000
    buffer_store_dwordx4 v[52:55], v0, s[8:11], s36 offen sc1
    s_add_u32 s36, s36, 0x20000
    buffer_store_dwordx4 v[56:59], v0, s[8:11], s36 offen sc1
    s_add_u32 s36, s36, 0x20000
    buffer_store_dwordx4 v[60:63], v0, s[8:11], s36 offen sc1
    v_accvgpr_read_b32 v26, a72
    v_accvgpr_read_b32 v27, a76
    v_fma_f32 v18, v8, v22, v26
    v_fma_f32 v19, v8, v23, v27
    v_fma_f32 v20, -v9, v23, v18
    v_fma_f32 v21, v9, v22, v19
    v_cvt_pk_bf16_f32 v68, v20, -v21
    ds_write_b32 v4, v68 offset:64
    v_accvgpr_read_b32 v26, a73
    v_accvgpr_read_b32 v27, a77
    v_fma_f32 v18, v8, v20, v26
    v_fma_f32 v19, v8, v21, v27
    v_fma_f32 v22, -v9, v21, v18
    v_fma_f32 v23, v9, v20, v19
    v_cvt_pk_bf16_f32 v69, v22, -v23
    ds_write_b32 v4, v69 offset:80
    v_accvgpr_read_b32 v26, a74
    v_accvgpr_read_b32 v27, a78
    v_fma_f32 v18, v8, v22, v26
    v_fma_f32 v19, v8, v23, v27
    v_fma_f32 v20, -v9, v23, v18
    v_fma_f32 v21, v9, v22, v19
    v_cvt_pk_bf16_f32 v70, v20, -v21
    ds_write_b32 v4, v70 offset:96
    v_accvgpr_read_b32 v26, a75
    v_accvgpr_read_b32 v27, a79
    v_fma_f32 v18, v8, v20, v26
    v_fma_f32 v19, v8, v21, v27
    v_fma_f32 v22, -v9, v21, v18
    v_fma_f32 v23, v9, v20, v19
    v_cvt_pk_bf16_f32 v71, v22, -v23
    ds_write_b32 v4, v71 offset:112
    s_waitcnt lgkmcnt(3)
    v_accvgpr_read_b32 v26, a80
    v_accvgpr_read_b32 v27, a84
    v_fma_f32 v18, v8, v22, v26
    v_fma_f32 v19, v8, v23, v27
    v_fma_f32 v20, -v9, v23, v18
    v_fma_f32 v21, v9, v22, v19
    v_cvt_pk_bf16_f32 v64, v20, -v21
    ds_write_b32 v4, v64 offset:128
    v_accvgpr_read_b32 v26, a81
    v_accvgpr_read_b32 v27, a85
    v_fma_f32 v18, v8, v20, v26
    v_fma_f32 v19, v8, v21, v27
    v_fma_f32 v22, -v9, v21, v18
    v_fma_f32 v23, v9, v20, v19
    v_cvt_pk_bf16_f32 v65, v22, -v23
    ds_write_b32 v4, v65 offset:144
    v_accvgpr_read_b32 v26, a82
    v_accvgpr_read_b32 v27, a86
    v_fma_f32 v18, v8, v22, v26
    v_fma_f32 v19, v8, v23, v27
    v_fma_f32 v20, -v9, v23, v18
    v_fma_f32 v21, v9, v22, v19
    v_cvt_pk_bf16_f32 v66, v20, -v21
    ds_write_b32 v4, v66 offset:160
    v_accvgpr_read_b32 v26, a83
    v_accvgpr_read_b32 v27, a87
    v_fma_f32 v18, v8, v20, v26
    v_fma_f32 v19, v8, v21, v27
    v_fma_f32 v22, -v9, v21, v18
    v_fma_f32 v23, v9, v20, v19
    v_cvt_pk_bf16_f32 v67, v22, -v23
    ds_write_b32 v4, v67 offset:176
    s_waitcnt lgkmcnt(3)
    v_accvgpr_read_b32 v26, a88
    v_accvgpr_read_b32 v27, a92
    v_fma_f32 v18, v8, v22, v26
    v_fma_f32 v19, v8, v23, v27
    v_fma_f32 v20, -v9, v23, v18
    v_fma_f32 v21, v9, v22, v19
    v_cvt_pk_bf16_f32 v68, v20, -v21
    ds_write_b32 v4, v68 offset:192
    v_accvgpr_read_b32 v26, a89
    v_accvgpr_read_b32 v27, a93
    v_fma_f32 v18, v8, v20, v26
    v_fma_f32 v19, v8, v21, v27
    v_fma_f32 v22, -v9, v21, v18
    v_fma_f32 v23, v9, v20, v19
    v_cvt_pk_bf16_f32 v69, v22, -v23
    ds_write_b32 v4, v69 offset:208
    v_accvgpr_read_b32 v26, a90
    v_accvgpr_read_b32 v27, a94
    v_fma_f32 v18, v8, v22, v26
    v_fma_f32 v19, v8, v23, v27
    v_fma_f32 v20, -v9, v23, v18
    v_fma_f32 v21, v9, v22, v19
    v_cvt_pk_bf16_f32 v70, v20, -v21
    ds_write_b32 v4, v70 offset:224
    v_accvgpr_read_b32 v26, a91
    v_accvgpr_read_b32 v27, a95
    v_fma_f32 v18, v8, v20, v26
    v_fma_f32 v19, v8, v21, v27
    v_fma_f32 v22, -v9, v21, v18
    v_fma_f32 v23, v9, v20, v19
    v_cvt_pk_bf16_f32 v71, v22, -v23
    ds_write_b32 v4, v71 offset:240
    s_waitcnt lgkmcnt(3)
    ds_read_b128 v[32:35], v5 offset:0
    ds_read_b128 v[36:39], v5 offset:1088
    ds_read_b128 v[40:43], v5 offset:2176
    ds_read_b128 v[44:47], v5 offset:3264
    v_accvgpr_read_b32 v26, a96
    v_accvgpr_read_b32 v27, a100
    v_fma_f32 v18, v8, v22, v26
    v_fma_f32 v19, v8, v23, v27
    v_fma_f32 v20, -v9, v23, v18
    v_fma_f32 v21, v9, v22, v19
    v_cvt_pk_bf16_f32 v64, v20, -v21
    ds_write_b32 v4, v64 offset:0
    v_accvgpr_read_b32 v26, a97
    v_accvgpr_read_b32 v27, a101
    v_fma_f32 v18, v8, v20, v26
    v_fma_f32 v19, v8, v21, v27
    v_fma_f32 v22, -v9, v21, v18
    v_fma_f32 v23, v9, v20, v19
    v_cvt_pk_bf16_f32 v65, v22, -v23
    ds_write_b32 v4, v65 offset:16
    v_accvgpr_read_b32 v26, a98
    v_accvgpr_read_b32 v27, a102
    v_fma_f32 v18, v8, v22, v26
    v_fma_f32 v19, v8, v23, v27
    v_fma_f32 v20, -v9, v23, v18
    v_fma_f32 v21, v9, v22, v19
    v_cvt_pk_bf16_f32 v66, v20, -v21
    ds_write_b32 v4, v66 offset:32
    v_accvgpr_read_b32 v26, a99
    v_accvgpr_read_b32 v27, a103
    v_fma_f32 v18, v8, v20, v26
    v_fma_f32 v19, v8, v21, v27
    v_fma_f32 v22, -v9, v21, v18
    v_fma_f32 v23, v9, v20, v19
    v_cvt_pk_bf16_f32 v67, v22, -v23
    ds_write_b32 v4, v67 offset:48
    s_waitcnt lgkmcnt(3)
    s_add_u32 s36, s40, 65536
    buffer_store_dwordx4 v[32:35], v0, s[8:11], s36 offen sc1
    s_add_u32 s36, s36, 0x20000
    buffer_store_dwordx4 v[36:39], v0, s[8:11], s36 offen sc1
    s_add_u32 s36, s36, 0x20000
    buffer_store_dwordx4 v[40:43], v0, s[8:11], s36 offen sc1
    s_add_u32 s36, s36, 0x20000
    buffer_store_dwordx4 v[44:47], v0, s[8:11], s36 offen sc1
    v_accvgpr_read_b32 v26, a104
    v_accvgpr_read_b32 v27, a108
    v_fma_f32 v18, v8, v22, v26
    v_fma_f32 v19, v8, v23, v27
    v_fma_f32 v20, -v9, v23, v18
    v_fma_f32 v21, v9, v22, v19
    v_cvt_pk_bf16_f32 v68, v20, -v21
    ds_write_b32 v4, v68 offset:64
    v_accvgpr_read_b32 v26, a105
    v_accvgpr_read_b32 v27, a109
    v_fma_f32 v18, v8, v20, v26
    v_fma_f32 v19, v8, v21, v27
    v_fma_f32 v22, -v9, v21, v18
    v_fma_f32 v23, v9, v20, v19
    v_cvt_pk_bf16_f32 v69, v22, -v23
    ds_write_b32 v4, v69 offset:80
    v_accvgpr_read_b32 v26, a106
    v_accvgpr_read_b32 v27, a110
    v_fma_f32 v18, v8, v22, v26
    v_fma_f32 v19, v8, v23, v27
    v_fma_f32 v20, -v9, v23, v18
    v_fma_f32 v21, v9, v22, v19
    v_cvt_pk_bf16_f32 v70, v20, -v21
    ds_write_b32 v4, v70 offset:96
    v_accvgpr_read_b32 v26, a107
    v_accvgpr_read_b32 v27, a111
    v_fma_f32 v18, v8, v20, v26
    v_fma_f32 v19, v8, v21, v27
    v_fma_f32 v22, -v9, v21, v18
    v_fma_f32 v23, v9, v20, v19
    v_cvt_pk_bf16_f32 v71, v22, -v23
    ds_write_b32 v4, v71 offset:112
    s_waitcnt lgkmcnt(3)
    v_accvgpr_read_b32 v26, a112
    v_accvgpr_read_b32 v27, a116
    v_fma_f32 v18, v8, v22, v26
    v_fma_f32 v19, v8, v23, v27
    v_fma_f32 v20, -v9, v23, v18
    v_fma_f32 v21, v9, v22, v19
    v_cvt_pk_bf16_f32 v64, v20, -v21
    ds_write_b32 v4, v64 offset:128
    v_accvgpr_read_b32 v26, a113
    v_accvgpr_read_b32 v27, a117
    v_fma_f32 v18, v8, v20, v26
    v_fma_f32 v19, v8, v21, v27
    v_fma_f32 v22, -v9, v21, v18
    v_fma_f32 v23, v9, v20, v19
    v_cvt_pk_bf16_f32 v65, v22, -v23
    ds_write_b32 v4, v65 offset:144
    v_accvgpr_read_b32 v26, a114
    v_accvgpr_read_b32 v27, a118
    v_fma_f32 v18, v8, v22, v26
    v_fma_f32 v19, v8, v23, v27
    v_fma_f32 v20, -v9, v23, v18
    v_fma_f32 v21, v9, v22, v19
    v_cvt_pk_bf16_f32 v66, v20, -v21
    ds_write_b32 v4, v66 offset:160
    v_accvgpr_read_b32 v26, a115
    v_accvgpr_read_b32 v27, a119
    v_fma_f32 v18, v8, v20, v26
    v_fma_f32 v19, v8, v21, v27
    v_fma_f32 v22, -v9, v21, v18
    v_fma_f32 v23, v9, v20, v19
    v_cvt_pk_bf16_f32 v67, v22, -v23
    ds_write_b32 v4, v67 offset:176
    s_waitcnt lgkmcnt(3)
    v_accvgpr_read_b32 v26, a120
    v_accvgpr_read_b32 v27, a124
    v_fma_f32 v18, v8, v22, v26
    v_fma_f32 v19, v8, v23, v27
    v_fma_f32 v20, -v9, v23, v18
    v_fma_f32 v21, v9, v22, v19
    v_cvt_pk_bf16_f32 v68, v20, -v21
    ds_write_b32 v4, v68 offset:192
    v_accvgpr_read_b32 v26, a121
    v_accvgpr_read_b32 v27, a125
    v_fma_f32 v18, v8, v20, v26
    v_fma_f32 v19, v8, v21, v27
    v_fma_f32 v22, -v9, v21, v18
    v_fma_f32 v23, v9, v20, v19
    v_cvt_pk_bf16_f32 v69, v22, -v23
    ds_write_b32 v4, v69 offset:208
    v_accvgpr_read_b32 v26, a122
    v_accvgpr_read_b32 v27, a126
    v_fma_f32 v18, v8, v22, v26
    v_fma_f32 v19, v8, v23, v27
    v_fma_f32 v20, -v9, v23, v18
    v_fma_f32 v21, v9, v22, v19
    v_cvt_pk_bf16_f32 v70, v20, -v21
    ds_write_b32 v4, v70 offset:224
    v_accvgpr_read_b32 v26, a123
    v_accvgpr_read_b32 v27, a127
    v_fma_f32 v18, v8, v20, v26
    v_fma_f32 v19, v8, v21, v27
    v_fma_f32 v22, -v9, v21, v18
    v_fma_f32 v23, v9, v20, v19
    v_cvt_pk_bf16_f32 v71, v22, -v23
    ds_write_b32 v4, v71 offset:240
    s_waitcnt lgkmcnt(3)
    ds_read_b128 v[48:51], v5 offset:0
    ds_read_b128 v[52:55], v5 offset:1088
    ds_read_b128 v[56:59], v5 offset:2176
    ds_read_b128 v[60:63], v5 offset:3264
    s_waitcnt lgkmcnt(0)
    s_add_u32 s36, s40, 98304
    buffer_store_dwordx4 v[48:51], v0, s[8:11], s36 offen sc1
    s_add_u32 s36, s36, 0x20000
    buffer_store_dwordx4 v[52:55], v0, s[8:11], s36 offen sc1
    s_add_u32 s36, s36, 0x20000
    buffer_store_dwordx4 v[56:59], v0, s[8:11], s36 offen sc1
    s_add_u32 s36, s36, 0x20000
    buffer_store_dwordx4 v[60:63], v0, s[8:11], s36 offen sc1
    s_mov_b32 s42, 4
    s_waitcnt vmcnt(0) lgkmcnt(0)
    s_barrier
    s_cmp_eq_u32 s3, 0
    s_cbranch_scc0 L_r3_f
    v_mov_b32 v18, s42
    s_mov_b64 exec, 1
    buffer_store_dword v18, off, s[8:11], s41 offset:0 sc1
    s_mov_b64 exec, -1
L_r3_f:
    v_lshrrev_b32 v0, 4, v0
L_r2:
    s_load_dwordx2 s[16:17], s[0:1], 112
    s_load_dwordx2 s[20:21], s[0:1], 40
    s_load_dwordx2 s[24:25], s[0:1], 48
    s_load_dwordx2 s[28:29], s[0:1], 0
    s_load_dwordx2 s[32:33], s[0:1], 136
    s_load_dwordx2 s[52:53], s[0:1], 128
    s_load_dwordx2 s[56:57], s[0:1], 64
    s_lshr_b32 s36, s5, 1
    s_and_b32 s37, s5, 1
    s_sub_u32 s38, s4, 5
    s_cmp_eq_u32 s4, 7
    s_cselect_b32 s38, 63, s38
    s_lshl_b32 s39, s38, 1
    s_add_u32 s39, s39, s37
    s_lshl_b32 s42, s39, 17
    s_lshl_b32 s40, s3, 15
    s_add_u32 s42, s42, s40
    s_add_u32 s42, s42, 0x4000000
    s_lshl_b32 s43, s39, 15
    s_lshl_b32 s40, s3, 13
    s_add_u32 s43, s43, s40
    s_add_u32 s43, s43, 0x400000
    s_lshl_b32 s44, s39, 14
    s_lshl_b32 s40, s3, 12
    s_add_u32 s44, s44, s40
    s_lshl_b32 s45, s39, 15
    s_mov_b32 s49, 0xbfb8aa3b
    s_mov_b32 s50, 0
    s_mov_b32 s51, 0
    v_and_b32 v64, 63, v0
    v_and_b32 v65, 15, v64
    v_lshrrev_b32 v66, 4, v64
    v_lshlrev_b32 v0, 4, v64
    v_mul_u32_u24 v67, 1040, v65
    v_lshl_add_u32 v68, v66, 8, v67
    s_lshl_b32 s39, s3, 6
    v_add_u32 v1, s39, v68
    v_lshl_add_u32 v68, v66, 3, v67
    s_and_b32 s41, s3, 1
    s_lshl_b32 s39, s41, 10
    v_add_u32 v12, s39, v0
    s_lshl_b32 s39, s36, 1
    s_add_u32 s41, s41, s39
    s_lshl_b32 s41, s41, 5
    v_add_u32 v6, s41, v68
    v_lshlrev_b32 v67, 11, v65
    v_lshl_add_u32 v67, v66, 4, v67
    s_lshl_b32 s39, s41, 1
    v_add_u32 v5, s39, v67
    v_and_b32 v67, 7, v64
    s_lshl_b32 s39, s3, 3
    v_add_u32 v67, s39, v67
    v_lshlrev_b32 v2, 9, v67
    v_and_b32 v68, 8, v64
    v_add_u32 v2, v68, v2
    s_mul_i32 s40, s37, 4
    s_add_u32 s40, s40, 4112
    v_add_u32 v2, s40, v2
    v_lshlrev_b32 v3, 7, v67
    v_and_b32 v68, 8, v64
    v_lshl_add_u32 v3, v68, 9, v3
    v_add_u32 v3, 20480, v3
    s_mul_i32 s39, s3, 3072
    v_add_u32 v4, s39, v0
    v_lshlrev_b32 v67, 12, v66
    v_lshrrev_b32 v68, 3, v65
    v_lshl_add_u32 v67, v68, 10, v67
    v_bfe_u32 v68, v65, 2, 1
    v_lshl_add_u32 v67, v68, 14, v67
    v_and_b32 v68, 3, v65
    v_lshl_add_u32 v67, v68, 4, v67
    s_lshl_b32 s39, s3, 20
    s_lshl_b32 s40, s36, 6
    s_add_u32 s39, s39, s40
    v_add_u32 v31, s39, v67
    v_lshlrev_b32 v68, 3, v68
    v_sub_u32 v7, v4, v68
    v_lshlrev_b32 v67, 10, v66
    v_lshl_add_u32 v67, v65, 4, v67
    s_lshl_b32 s39, s36, 15
    s_lshl_b32 s40, s3, 8
    s_add_u32 s39, s39, s40
    v_add_u32 v30, s39, v67
    v_lshlrev_b32 v67, 8, v65
    v_lshl_add_u32 v67, v66, 3, v67
    s_lshl_b32 s48, s3, 14
    s_add_u32 s48, s48, 49152
    v_add_u32 v27, s48, v67
    v_lshlrev_b32 v67, 8, v66
    s_lshl_b32 s40, s3, 6
    v_add_u32 v29, s40, v67
    v_lshlrev_b32 v67, 3, v66
    v_add_u32 v28, s41, v67
    s_waitcnt lgkmcnt(0)
    s_mov_b32 s18, 0x400000
    s_mov_b32 s19, 0x20000
    s_mov_b32 s22, 0x80000
    s_mov_b32 s23, 0x20000
    s_mov_b32 s26, 0x80000
    s_mov_b32 s27, 0x20000
    s_mov_b32 s30, 0x200000
    s_mov_b32 s31, 0x20000
    s_mov_b32 s34, 0x400000
    s_mov_b32 s35, 0x20000
    s_mov_b32 s54, 0x400
    s_mov_b32 s55, 0x20000
    s_mov_b32 s58, 0x400
    s_mov_b32 s59, 0x20000
    buffer_load_dwordx4 v[192:195], v29, s[52:55], 0 offen offset:0
    buffer_load_dwordx4 v[196:199], v29, s[52:55], 0 offen offset:16
    buffer_load_dwordx4 v[200:203], v29, s[52:55], 0 offen offset:32
    buffer_load_dwordx4 v[204:207], v29, s[52:55], 0 offen offset:48
    buffer_load_dwordx2 v[24:25], v28, s[56:59], 0 offen
    s_add_u32 m0, s48, 0
    s_mov_b32 s39, 0
    buffer_load_dwordx4 v30, s[20:23], s39 offen lds
    s_add_u32 m0, s48, 1024
    s_mov_b32 s39, 4096
    buffer_load_dwordx4 v30, s[20:23], s39 offen lds
    s_add_u32 m0, s48, 2048
    s_mov_b32 s39, 8192
    buffer_load_dwordx4 v30, s[20:23], s39 offen lds
    s_add_u32 m0, s48, 3072
    s_mov_b32 s39, 12288
    buffer_load_dwordx4 v30, s[20:23], s39 offen lds
    s_add_u32 m0, s48, 4096
    s_mov_b32 s39, 16384
    buffer_load_dwordx4 v30, s[20:23], s39 offen lds
    s_add_u32 m0, s48, 5120
    s_mov_b32 s39, 20480
    buffer_load_dwordx4 v30, s[20:23], s39 offen lds
    s_add_u32 m0, s48, 6144
    s_mov_b32 s39, 24576
    buffer_load_dwordx4 v30, s[20:23], s39 offen lds
    s_add_u32 m0, s48, 7168
    s_mov_b32 s39, 28672
    buffer_load_dwordx4 v30, s[20:23], s39 offen lds
    s_add_u32 m0, s48, 8192
    s_mov_b32 s39, 0
    buffer_load_dwordx4 v30, s[24:27], s39 offen lds
    s_add_u32 m0, s48, 9216
    s_mov_b32 s39, 4096
    buffer_load_dwordx4 v30, s[24:27], s39 offen lds
    s_add_u32 m0, s48, 10240
    s_mov_b32 s39, 8192
    buffer_load_dwordx4 v30, s[24:27], s39 offen lds
    s_add_u32 m0, s48, 11264
    s_mov_b32 s39, 12288
    buffer_load_dwordx4 v30, s[24:27], s39 offen lds
    s_add_u32 m0, s48, 12288
    s_mov_b32 s39, 16384
    buffer_load_dwordx4 v30, s[24:27], s39 offen lds
    s_add_u32 m0, s48, 13312
    s_mov_b32 s39, 20480
    buffer_load_dwordx4 v30, s[24:27], s39 offen lds
    s_add_u32 m0, s48, 14336
    s_mov_b32 s39, 24576
    buffer_load_dwordx4 v30, s[24:27], s39 offen lds
    s_add_u32 m0, s48, 15360
    s_mov_b32 s39, 28672
    buffer_load_dwordx4 v30, s[24:27], s39 offen lds
    s_mov_b32 s39, 0x0
    buffer_load_dwordx4 v[32:35], v31, s[16:19], s39 offen
    s_mov_b32 s39, 0x800
    buffer_load_dwordx4 v[36:39], v31, s[16:19], s39 offen
    s_mov_b32 s39, 0x8000
    buffer_load_dwordx4 v[40:43], v31, s[16:19], s39 offen
    s_mov_b32 s39, 0x8800
    buffer_load_dwordx4 v[44:47], v31, s[16:19], s39 offen
    s_mov_b32 s39, 0x10000
    buffer_load_dwordx4 v[48:51], v31, s[16:19], s39 offen
    s_mov_b32 s39, 0x10800
    buffer_load_dwordx4 v[52:55], v31, s[16:19], s39 offen
    s_mov_b32 s39, 0x18000
    buffer_load_dwordx4 v[56:59], v31, s[16:19], s39 offen
    s_mov_b32 s39, 0x18800
    buffer_load_dwordx4 v[60:63], v31, s[16:19], s39 offen
    s_mov_b32 s39, 0x20000
    buffer_load_dwordx4 v[64:67], v31, s[16:19], s39 offen
    s_mov_b32 s39, 0x20800
    buffer_load_dwordx4 v[68:71], v31, s[16:19], s39 offen
    s_mov_b32 s39, 0x28000
    buffer_load_dwordx4 v[72:75], v31, s[16:19], s39 offen
    s_mov_b32 s39, 0x28800
    buffer_load_dwordx4 v[76:79], v31, s[16:19], s39 offen
    s_mov_b32 s39, 0x30000
    buffer_load_dwordx4 v[80:83], v31, s[16:19], s39 offen
    s_mov_b32 s39, 0x30800
    buffer_load_dwordx4 v[84:87], v31, s[16:19], s39 offen
    s_mov_b32 s39, 0x38000
    buffer_load_dwordx4 v[88:91], v31, s[16:19], s39 offen
    s_mov_b32 s39, 0x38800
    buffer_load_dwordx4 v[92:95], v31, s[16:19], s39 offen
    s_mov_b32 s39, 0x40000
    buffer_load_dwordx4 v[96:99], v31, s[16:19], s39 offen
    s_mov_b32 s39, 0x40800
    buffer_load_dwordx4 v[100:103], v31, s[16:19], s39 offen
    s_mov_b32 s39, 0x48000
    buffer_load_dwordx4 v[104:107], v31, s[16:19], s39 offen
    s_mov_b32 s39, 0x48800
    buffer_load_dwordx4 v[108:111], v31, s[16:19], s39 offen
    s_mov_b32 s39, 0x50000
    buffer_load_dwordx4 v[112:115], v31, s[16:19], s39 offen
    s_mov_b32 s39, 0x50800
    buffer_load_dwordx4 v[116:119], v31, s[16:19], s39 offen
    s_mov_b32 s39, 0x58000
    buffer_load_dwordx4 v[120:123], v31, s[16:19], s39 offen
    s_waitcnt vmcnt(22)
    ds_write_b128 v4, v[32:35] offset:0
    ds_read_b64_tr_b16 a[0:1], v7 offset:0
    ds_read_b64_tr_b16 a[8:9], v7 offset:32
    s_mov_b32 s39, 0x58800
    buffer_load_dwordx4 v[124:127], v31, s[16:19], s39 offen
    s_waitcnt vmcnt(22)
    ds_write_b128 v4, v[36:39] offset:0
    ds_read_b64_tr_b16 a[2:3], v7 offset:0
    ds_read_b64_tr_b16 a[10:11], v7 offset:32
    s_waitcnt lgkmcnt(5)
    s_mov_b32 s39, 0x60000
    buffer_load_dwordx4 v[32:35], v31, s[16:19], s39 offen
    s_waitcnt vmcnt(22)
    ds_write_b128 v4, v[40:43] offset:0
    ds_read_b64_tr_b16 a[4:5], v7 offset:0
    ds_read_b64_tr_b16 a[12:13], v7 offset:32
    s_mov_b32 s39, 0x60800
    buffer_load_dwordx4 v[36:39], v31, s[16:19], s39 offen
    s_mov_b32 s40, 0x05040100
    s_mov_b32 s41, 0x07060302
    s_waitcnt lgkmcnt(0)
    ds_read_b64 v[208:209], v27 offset:0
    ds_read_b64 v[210:211], v27 offset:8192
    ds_read_b64 v[212:213], v27 offset:32
    ds_read_b64 v[214:215], v27 offset:8224
    ds_read_b64 v[216:217], v27 offset:64
    ds_read_b64 v[218:219], v27 offset:8256
    ds_read_b64 v[220:221], v27 offset:96
    ds_read_b64 v[222:223], v27 offset:8288
    s_waitcnt lgkmcnt(0)
    v_perm_b32 v128, v210, v208, s40
    v_perm_b32 v129, v210, v208, s41
    v_perm_b32 v130, v211, v209, s40
    v_perm_b32 v131, v211, v209, s41
    v_perm_b32 v132, v214, v212, s40
    v_perm_b32 v133, v214, v212, s41
    v_perm_b32 v134, v215, v213, s40
    v_perm_b32 v135, v215, v213, s41
    v_perm_b32 v136, v218, v216, s40
    v_perm_b32 v137, v218, v216, s41
    v_perm_b32 v138, v219, v217, s40
    v_perm_b32 v139, v219, v217, s41
    v_perm_b32 v140, v222, v220, s40
    v_perm_b32 v141, v222, v220, s41
    v_perm_b32 v142, v223, v221, s40
    v_perm_b32 v143, v223, v221, s41
    s_waitcnt vmcnt(22)
    ds_write_b128 v4, v[44:47] offset:0
    ds_read_b64_tr_b16 a[6:7], v7 offset:0
    ds_read_b64_tr_b16 a[14:15], v7 offset:32
    s_waitcnt lgkmcnt(5)
    s_mov_b32 s39, 0x68000
    buffer_load_dwordx4 v[40:43], v31, s[16:19], s39 offen
    s_waitcnt vmcnt(22)
    ds_write_b128 v4, v[48:51] offset:0
    ds_read_b64_tr_b16 a[16:17], v7 offset:0
    ds_read_b64_tr_b16 a[24:25], v7 offset:32
    s_mov_b32 s39, 0x68800
    buffer_load_dwordx4 v[44:47], v31, s[16:19], s39 offen
    s_waitcnt vmcnt(22)
    ds_write_b128 v4, v[52:55] offset:0
    ds_read_b64_tr_b16 a[18:19], v7 offset:0
    ds_read_b64_tr_b16 a[26:27], v7 offset:32
    s_waitcnt lgkmcnt(5)
    s_mov_b32 s39, 0x70000
    buffer_load_dwordx4 v[48:51], v31, s[16:19], s39 offen
    s_waitcnt vmcnt(22)
    ds_write_b128 v4, v[56:59] offset:0
    ds_read_b64_tr_b16 a[20:21], v7 offset:0
    ds_read_b64_tr_b16 a[28:29], v7 offset:32
    s_mov_b32 s39, 0x70800
    buffer_load_dwordx4 v[52:55], v31, s[16:19], s39 offen
    s_mov_b32 s40, 0x05040100
    s_mov_b32 s41, 0x07060302
    s_waitcnt lgkmcnt(0)
    ds_read_b64 v[208:209], v27 offset:128
    ds_read_b64 v[210:211], v27 offset:8320
    ds_read_b64 v[212:213], v27 offset:160
    ds_read_b64 v[214:215], v27 offset:8352
    ds_read_b64 v[216:217], v27 offset:192
    ds_read_b64 v[218:219], v27 offset:8384
    ds_read_b64 v[220:221], v27 offset:224
    ds_read_b64 v[222:223], v27 offset:8416
    s_waitcnt lgkmcnt(0)
    v_perm_b32 v144, v210, v208, s40
    v_perm_b32 v145, v210, v208, s41
    v_perm_b32 v146, v211, v209, s40
    v_perm_b32 v147, v211, v209, s41
    v_perm_b32 v148, v214, v212, s40
    v_perm_b32 v149, v214, v212, s41
    v_perm_b32 v150, v215, v213, s40
    v_perm_b32 v151, v215, v213, s41
    v_perm_b32 v152, v218, v216, s40
    v_perm_b32 v153, v218, v216, s41
    v_perm_b32 v154, v219, v217, s40
    v_perm_b32 v155, v219, v217, s41
    v_perm_b32 v156, v222, v220, s40
    v_perm_b32 v157, v222, v220, s41
    v_perm_b32 v158, v223, v221, s40
    v_perm_b32 v159, v223, v221, s41
    s_waitcnt vmcnt(22)
    ds_write_b128 v4, v[60:63] offset:0
    ds_read_b64_tr_b16 a[22:23], v7 offset:0
    ds_read_b64_tr_b16 a[30:31], v7 offset:32
    s_waitcnt lgkmcnt(5)
    s_mov_b32 s39, 0x78000
    buffer_load_dwordx4 v[56:59], v31, s[16:19], s39 offen
    s_waitcnt vmcnt(22)
    ds_write_b128 v4, v[64:67] offset:0
    ds_read_b64_tr_b16 a[32:33], v7 offset:0
    ds_read_b64_tr_b16 a[40:41], v7 offset:32
    s_mov_b32 s39, 0x78800
    buffer_load_dwordx4 v[60:63], v31, s[16:19], s39 offen
    s_waitcnt vmcnt(22)
    ds_write_b128 v4, v[68:71] offset:0
    ds_read_b64_tr_b16 a[34:35], v7 offset:0
    ds_read_b64_tr_b16 a[42:43], v7 offset:32
    s_waitcnt lgkmcnt(5)
    s_mov_b32 s39, 0x80000
    buffer_load_dwordx4 v[64:67], v31, s[16:19], s39 offen
    s_waitcnt vmcnt(22)
    ds_write_b128 v4, v[72:75] offset:0
    ds_read_b64_tr_b16 a[36:37], v7 offset:0
    ds_read_b64_tr_b16 a[44:45], v7 offset:32
    s_mov_b32 s39, 0x80800
    buffer_load_dwordx4 v[68:71], v31, s[16:19], s39 offen
    s_mov_b32 s40, 0x05040100
    s_mov_b32 s41, 0x07060302
    s_waitcnt lgkmcnt(0)
    ds_read_b64 v[208:209], v27 offset:4096
    ds_read_b64 v[210:211], v27 offset:12288
    ds_read_b64 v[212:213], v27 offset:4128
    ds_read_b64 v[214:215], v27 offset:12320
    ds_read_b64 v[216:217], v27 offset:4160
    ds_read_b64 v[218:219], v27 offset:12352
    ds_read_b64 v[220:221], v27 offset:4192
    ds_read_b64 v[222:223], v27 offset:12384
    s_waitcnt lgkmcnt(0)
    v_perm_b32 v160, v210, v208, s40
    v_perm_b32 v161, v210, v208, s41
    v_perm_b32 v162, v211, v209, s40
    v_perm_b32 v163, v211, v209, s41
    v_perm_b32 v164, v214, v212, s40
    v_perm_b32 v165, v214, v212, s41
    v_perm_b32 v166, v215, v213, s40
    v_perm_b32 v167, v215, v213, s41
    v_perm_b32 v168, v218, v216, s40
    v_perm_b32 v169, v218, v216, s41
    v_perm_b32 v170, v219, v217, s40
    v_perm_b32 v171, v219, v217, s41
    v_perm_b32 v172, v222, v220, s40
    v_perm_b32 v173, v222, v220, s41
    v_perm_b32 v174, v223, v221, s40
    v_perm_b32 v175, v223, v221, s41
    s_waitcnt vmcnt(22)
    ds_write_b128 v4, v[76:79] offset:0
    ds_read_b64_tr_b16 a[38:39], v7 offset:0
    ds_read_b64_tr_b16 a[46:47], v7 offset:32
    s_waitcnt lgkmcnt(5)
    s_mov_b32 s39, 0x88000
    buffer_load_dwordx4 v[72:75], v31, s[16:19], s39 offen
    s_waitcnt vmcnt(22)
    ds_write_b128 v4, v[80:83] offset:0
    ds_read_b64_tr_b16 a[48:49], v7 offset:0
    ds_read_b64_tr_b16 a[56:57], v7 offset:32
    s_mov_b32 s39, 0x88800
    buffer_load_dwordx4 v[76:79], v31, s[16:19], s39 offen
    s_waitcnt vmcnt(22)
    ds_write_b128 v4, v[84:87] offset:0
    ds_read_b64_tr_b16 a[50:51], v7 offset:0
    ds_read_b64_tr_b16 a[58:59], v7 offset:32
    s_waitcnt lgkmcnt(5)
    s_mov_b32 s39, 0x90000
    buffer_load_dwordx4 v[80:83], v31, s[16:19], s39 offen
    s_waitcnt vmcnt(22)
    ds_write_b128 v4, v[88:91] offset:0
    ds_read_b64_tr_b16 a[52:53], v7 offset:0
    ds_read_b64_tr_b16 a[60:61], v7 offset:32
    s_mov_b32 s39, 0x90800
    buffer_load_dwordx4 v[84:87], v31, s[16:19], s39 offen
    s_mov_b32 s40, 0x05040100
    s_mov_b32 s41, 0x07060302
    s_waitcnt lgkmcnt(0)
    ds_read_b64 v[208:209], v27 offset:4224
    ds_read_b64 v[210:211], v27 offset:12416
    ds_read_b64 v[212:213], v27 offset:4256
    ds_read_b64 v[214:215], v27 offset:12448
    ds_read_b64 v[216:217], v27 offset:4288
    ds_read_b64 v[218:219], v27 offset:12480
    ds_read_b64 v[220:221], v27 offset:4320
    ds_read_b64 v[222:223], v27 offset:12512
    s_waitcnt lgkmcnt(0)
    v_perm_b32 v176, v210, v208, s40
    v_perm_b32 v177, v210, v208, s41
    v_perm_b32 v178, v211, v209, s40
    v_perm_b32 v179, v211, v209, s41
    v_perm_b32 v180, v214, v212, s40
    v_perm_b32 v181, v214, v212, s41
    v_perm_b32 v182, v215, v213, s40
    v_perm_b32 v183, v215, v213, s41
    v_perm_b32 v184, v218, v216, s40
    v_perm_b32 v185, v218, v216, s41
    v_perm_b32 v186, v219, v217, s40
    v_perm_b32 v187, v219, v217, s41
    v_perm_b32 v188, v222, v220, s40
    v_perm_b32 v189, v222, v220, s41
    v_perm_b32 v190, v223, v221, s40
    v_perm_b32 v191, v223, v221, s41
    s_waitcnt vmcnt(22)
    ds_write_b128 v4, v[92:95] offset:0
    ds_read_b64_tr_b16 a[54:55], v7 offset:0
    ds_read_b64_tr_b16 a[62:63], v7 offset:32
    s_waitcnt lgkmcnt(5)
    s_mov_b32 s39, 0x98000
    buffer_load_dwordx4 v[88:91], v31, s[16:19], s39 offen
    s_waitcnt vmcnt(22)
    ds_write_b128 v4, v[96:99] offset:0
    ds_read_b64_tr_b16 a[64:65], v7 offset:0
    ds_read_b64_tr_b16 a[72:73], v7 offset:32
    s_mov_b32 s39, 0x98800
    buffer_load_dwordx4 v[92:95], v31, s[16:19], s39 offen
    s_waitcnt vmcnt(22)
    ds_write_b128 v4, v[100:103] offset:0
    ds_read_b64_tr_b16 a[66:67], v7 offset:0
    ds_read_b64_tr_b16 a[74:75], v7 offset:32
    s_waitcnt lgkmcnt(5)
    s_mov_b32 s39, 0xa0000
    buffer_load_dwordx4 v[96:99], v31, s[16:19], s39 offen
    s_waitcnt vmcnt(22)
    ds_write_b128 v4, v[104:107] offset:0
    ds_read_b64_tr_b16 a[68:69], v7 offset:0
    ds_read_b64_tr_b16 a[76:77], v7 offset:32
    s_mov_b32 s39, 0xa0800
    buffer_load_dwordx4 v[100:103], v31, s[16:19], s39 offen
    s_waitcnt vmcnt(22)
    ds_write_b128 v4, v[108:111] offset:0
    ds_read_b64_tr_b16 a[70:71], v7 offset:0
    ds_read_b64_tr_b16 a[78:79], v7 offset:32
    s_waitcnt lgkmcnt(5)
    s_mov_b32 s39, 0xa8000
    buffer_load_dwordx4 v[104:107], v31, s[16:19], s39 offen
    s_waitcnt vmcnt(22)
    ds_write_b128 v4, v[112:115] offset:0
    ds_read_b64_tr_b16 a[80:81], v7 offset:0
    ds_read_b64_tr_b16 a[88:89], v7 offset:32
    s_mov_b32 s39, 0xa8800
    buffer_load_dwordx4 v[108:111], v31, s[16:19], s39 offen
    s_waitcnt vmcnt(22)
    ds_write_b128 v4, v[116:119] offset:0
    ds_read_b64_tr_b16 a[82:83], v7 offset:0
    ds_read_b64_tr_b16 a[90:91], v7 offset:32
    s_waitcnt lgkmcnt(5)
    s_mov_b32 s39, 0xb0000
    buffer_load_dwordx4 v[112:115], v31, s[16:19], s39 offen
    s_waitcnt vmcnt(22)
    ds_write_b128 v4, v[120:123] offset:0
    ds_read_b64_tr_b16 a[84:85], v7 offset:0
    ds_read_b64_tr_b16 a[92:93], v7 offset:32
    s_mov_b32 s39, 0xb0800
    buffer_load_dwordx4 v[116:119], v31, s[16:19], s39 offen
    s_waitcnt vmcnt(22)
    ds_write_b128 v4, v[124:127] offset:0
    ds_read_b64_tr_b16 a[86:87], v7 offset:0
    ds_read_b64_tr_b16 a[94:95], v7 offset:32
    s_waitcnt lgkmcnt(5)
    s_mov_b32 s39, 0xb8000
    buffer_load_dwordx4 v[120:123], v31, s[16:19], s39 offen
    s_waitcnt vmcnt(22)
    ds_write_b128 v4, v[32:35] offset:0
    ds_read_b64_tr_b16 a[96:97], v7 offset:0
    ds_read_b64_tr_b16 a[104:105], v7 offset:32
    s_mov_b32 s39, 0xb8800
    buffer_load_dwordx4 v[124:127], v31, s[16:19], s39 offen
    s_waitcnt vmcnt(22)
    ds_write_b128 v4, v[36:39] offset:0
    ds_read_b64_tr_b16 a[98:99], v7 offset:0
    ds_read_b64_tr_b16 a[106:107], v7 offset:32
    s_waitcnt lgkmcnt(5)
    s_mov_b32 s39, 0xc0000
    buffer_load_dwordx4 v[32:35], v31, s[16:19], s39 offen
    s_waitcnt vmcnt(22)
    ds_write_b128 v4, v[40:43] offset:0
    ds_read_b64_tr_b16 a[100:101], v7 offset:0
    ds_read_b64_tr_b16 a[108:109], v7 offset:32
    s_mov_b32 s39, 0xc0800
    buffer_load_dwordx4 v[36:39], v31, s[16:19], s39 offen
    s_waitcnt vmcnt(22)
    ds_write_b128 v4, v[44:47] offset:0
    ds_read_b64_tr_b16 a[102:103], v7 offset:0
    ds_read_b64_tr_b16 a[110:111], v7 offset:32
    s_waitcnt lgkmcnt(5)
    s_mov_b32 s39, 0xc8000
    buffer_load_dwordx4 v[40:43], v31, s[16:19], s39 offen
    s_waitcnt vmcnt(22)
    ds_write_b128 v4, v[48:51] offset:0
    ds_read_b64_tr_b16 a[112:113], v7 offset:0
    ds_read_b64_tr_b16 a[120:121], v7 offset:32
    s_mov_b32 s39, 0xc8800
    buffer_load_dwordx4 v[44:47], v31, s[16:19], s39 offen
    s_waitcnt vmcnt(22)
    ds_write_b128 v4, v[52:55] offset:0
    ds_read_b64_tr_b16 a[114:115], v7 offset:0
    ds_read_b64_tr_b16 a[122:123], v7 offset:32
    s_waitcnt lgkmcnt(5)
    s_mov_b32 s39, 0xd0000
    buffer_load_dwordx4 v[48:51], v31, s[16:19], s39 offen
    s_waitcnt vmcnt(22)
    ds_write_b128 v4, v[56:59] offset:0
    ds_read_b64_tr_b16 a[116:117], v7 offset:0
    ds_read_b64_tr_b16 a[124:125], v7 offset:32
    s_mov_b32 s39, 0xd0800
    buffer_load_dwordx4 v[52:55], v31, s[16:19], s39 offen
    s_waitcnt vmcnt(22)
    ds_write_b128 v4, v[60:63] offset:0
    ds_read_b64_tr_b16 a[118:119], v7 offset:0
    ds_read_b64_tr_b16 a[126:127], v7 offset:32
    s_waitcnt lgkmcnt(5)
    s_mov_b32 s39, 0xd8000
    buffer_load_dwordx4 v[56:59], v31, s[16:19], s39 offen
    s_waitcnt vmcnt(22)
    ds_write_b128 v4, v[64:67] offset:0
    ds_read_b64_tr_b16 a[128:129], v7 offset:0
    ds_read_b64_tr_b16 a[136:137], v7 offset:32
    s_mov_b32 s39, 0xd8800
    buffer_load_dwordx4 v[60:63], v31, s[16:19], s39 offen
    s_waitcnt vmcnt(22)
    ds_write_b128 v4, v[68:71] offset:0
    ds_read_b64_tr_b16 a[130:131], v7 offset:0
    ds_read_b64_tr_b16 a[138:139], v7 offset:32
    s_waitcnt lgkmcnt(5)
    s_mov_b32 s39, 0xe0000
    buffer_load_dwordx4 v[64:67], v31, s[16:19], s39 offen
    s_waitcnt vmcnt(22)
    ds_write_b128 v4, v[72:75] offset:0
    ds_read_b64_tr_b16 a[132:133], v7 offset:0
    ds_read_b64_tr_b16 a[140:141], v7 offset:32
    s_mov_b32 s39, 0xe0800
    buffer_load_dwordx4 v[68:71], v31, s[16:19], s39 offen
    s_waitcnt vmcnt(22)
    ds_write_b128 v4, v[76:79] offset:0
    ds_read_b64_tr_b16 a[134:135], v7 offset:0
    ds_read_b64_tr_b16 a[142:143], v7 offset:32
    s_waitcnt lgkmcnt(5)
    s_mov_b32 s39, 0xe8000
    buffer_load_dwordx4 v[72:75], v31, s[16:19], s39 offen
    s_waitcnt vmcnt(22)
    ds_write_b128 v4, v[80:83] offset:0
    ds_read_b64_tr_b16 a[144:145], v7 offset:0
    ds_read_b64_tr_b16 a[152:153], v7 offset:32
    s_mov_b32 s39, 0xe8800
    buffer_load_dwordx4 v[76:79], v31, s[16:19], s39 offen
    s_waitcnt vmcnt(22)
    ds_write_b128 v4, v[84:87] offset:0
    ds_read_b64_tr_b16 a[146:147], v7 offset:0
    ds_read_b64_tr_b16 a[154:155], v7 offset:32
    s_waitcnt lgkmcnt(5)
    s_mov_b32 s39, 0xf0000
    buffer_load_dwordx4 v[80:83], v31, s[16:19], s39 offen
    s_waitcnt vmcnt(22)
    ds_write_b128 v4, v[88:91] offset:0
    ds_read_b64_tr_b16 a[148:149], v7 offset:0
    ds_read_b64_tr_b16 a[156:157], v7 offset:32
    s_mov_b32 s39, 0xf0800
    buffer_load_dwordx4 v[84:87], v31, s[16:19], s39 offen
    s_waitcnt vmcnt(22)
    ds_write_b128 v4, v[92:95] offset:0
    ds_read_b64_tr_b16 a[150:151], v7 offset:0
    ds_read_b64_tr_b16 a[158:159], v7 offset:32
    s_waitcnt lgkmcnt(5)
    s_mov_b32 s39, 0xf8000
    buffer_load_dwordx4 v[88:91], v31, s[16:19], s39 offen
    s_waitcnt vmcnt(22)
    ds_write_b128 v4, v[96:99] offset:0
    ds_read_b64_tr_b16 a[160:161], v7 offset:0
    ds_read_b64_tr_b16 a[168:169], v7 offset:32
    s_mov_b32 s39, 0xf8800
    buffer_load_dwordx4 v[92:95], v31, s[16:19], s39 offen
    s_waitcnt vmcnt(22)
    ds_write_b128 v4, v[100:103] offset:0
    ds_read_b64_tr_b16 a[162:163], v7 offset:0
    ds_read_b64_tr_b16 a[170:171], v7 offset:32
    s_waitcnt lgkmcnt(5)
    s_waitcnt vmcnt(21)
    ds_write_b128 v4, v[104:107] offset:0
    ds_read_b64_tr_b16 a[164:165], v7 offset:0
    ds_read_b64_tr_b16 a[172:173], v7 offset:32
    s_waitcnt vmcnt(20)
    ds_write_b128 v4, v[108:111] offset:0
    ds_read_b64_tr_b16 a[166:167], v7 offset:0
    ds_read_b64_tr_b16 a[174:175], v7 offset:32
    s_waitcnt lgkmcnt(5)
    s_waitcnt vmcnt(19)
    ds_write_b128 v4, v[112:115] offset:0
    ds_read_b64_tr_b16 a[176:177], v7 offset:0
    ds_read_b64_tr_b16 a[184:185], v7 offset:32
    s_waitcnt vmcnt(18)
    ds_write_b128 v4, v[116:119] offset:0
    ds_read_b64_tr_b16 a[178:179], v7 offset:0
    ds_read_b64_tr_b16 a[186:187], v7 offset:32
    s_waitcnt lgkmcnt(5)
    s_waitcnt vmcnt(17)
    ds_write_b128 v4, v[120:123] offset:0
    ds_read_b64_tr_b16 a[180:181], v7 offset:0
    ds_read_b64_tr_b16 a[188:189], v7 offset:32
    s_waitcnt vmcnt(16)
    ds_write_b128 v4, v[124:127] offset:0
    ds_read_b64_tr_b16 a[182:183], v7 offset:0
    ds_read_b64_tr_b16 a[190:191], v7 offset:32
    s_waitcnt lgkmcnt(5)
    s_waitcnt vmcnt(15)
    ds_write_b128 v4, v[32:35] offset:0
    ds_read_b64_tr_b16 a[192:193], v7 offset:0
    ds_read_b64_tr_b16 a[200:201], v7 offset:32
    s_waitcnt vmcnt(14)
    ds_write_b128 v4, v[36:39] offset:0
    ds_read_b64_tr_b16 a[194:195], v7 offset:0
    ds_read_b64_tr_b16 a[202:203], v7 offset:32
    s_waitcnt lgkmcnt(5)
    s_waitcnt vmcnt(13)
    ds_write_b128 v4, v[40:43] offset:0
    ds_read_b64_tr_b16 a[196:197], v7 offset:0
    ds_read_b64_tr_b16 a[204:205], v7 offset:32
    s_waitcnt vmcnt(12)
    ds_write_b128 v4, v[44:47] offset:0
    ds_read_b64_tr_b16 a[198:199], v7 offset:0
    ds_read_b64_tr_b16 a[206:207], v7 offset:32
    s_waitcnt lgkmcnt(5)
    s_waitcnt vmcnt(11)
    ds_write_b128 v4, v[48:51] offset:0
    ds_read_b64_tr_b16 a[208:209], v7 offset:0
    ds_read_b64_tr_b16 a[216:217], v7 offset:32
    s_waitcnt vmcnt(10)
    ds_write_b128 v4, v[52:55] offset:0
    ds_read_b64_tr_b16 a[210:211], v7 offset:0
    ds_read_b64_tr_b16 a[218:219], v7 offset:32
    s_waitcnt lgkmcnt(5)
    s_waitcnt vmcnt(9)
    ds_write_b128 v4, v[56:59] offset:0
    ds_read_b64_tr_b16 a[212:213], v7 offset:0
    ds_read_b64_tr_b16 a[220:221], v7 offset:32
    s_waitcnt vmcnt(8)
    ds_write_b128 v4, v[60:63] offset:0
    ds_read_b64_tr_b16 a[214:215], v7 offset:0
    ds_read_b64_tr_b16 a[222:223], v7 offset:32
    s_waitcnt lgkmcnt(5)
    s_waitcnt vmcnt(7)
    ds_write_b128 v4, v[64:67] offset:0
    ds_read_b64_tr_b16 a[224:225], v7 offset:0
    ds_read_b64_tr_b16 a[232:233], v7 offset:32
    s_waitcnt vmcnt(6)
    ds_write_b128 v4, v[68:71] offset:0
    ds_read_b64_tr_b16 a[226:227], v7 offset:0
    ds_read_b64_tr_b16 a[234:235], v7 offset:32
    s_waitcnt lgkmcnt(5)
    s_waitcnt vmcnt(5)
    ds_write_b128 v4, v[72:75] offset:0
    ds_read_b64_tr_b16 a[228:229], v7 offset:0
    ds_read_b64_tr_b16 a[236:237], v7 offset:32
    s_waitcnt vmcnt(4)
    ds_write_b128 v4, v[76:79] offset:0
    ds_read_b64_tr_b16 a[230:231], v7 offset:0
    ds_read_b64_tr_b16 a[238:239], v7 offset:32
    s_waitcnt lgkmcnt(5)
    s_waitcnt vmcnt(3)
    ds_write_b128 v4, v[80:83] offset:0
    ds_read_b64_tr_b16 a[240:241], v7 offset:0
    ds_read_b64_tr_b16 a[248:249], v7 offset:32
    s_waitcnt vmcnt(2)
    ds_write_b128 v4, v[84:87] offset:0
    ds_read_b64_tr_b16 a[242:243], v7 offset:0
    ds_read_b64_tr_b16 a[250:251], v7 offset:32
    s_waitcnt lgkmcnt(5)
    s_waitcnt vmcnt(1)
    ds_write_b128 v4, v[88:91] offset:0
    ds_read_b64_tr_b16 a[244:245], v7 offset:0
    ds_read_b64_tr_b16 a[252:253], v7 offset:32
    s_waitcnt vmcnt(0)
    ds_write_b128 v4, v[92:95] offset:0
    ds_read_b64_tr_b16 a[246:247], v7 offset:0
    ds_read_b64_tr_b16 a[254:255], v7 offset:32
    s_waitcnt lgkmcnt(5)
    v_lshlrev_b32 v8, 16, v24
    v_and_b32 v9, 0xffff0000, v24
    v_lshlrev_b32 v10, 16, v25
    v_and_b32 v11, 0xffff0000, v25
    s_waitcnt lgkmcnt(0)
    s_mov_b32 s46, 0
L_r2_wh:
    buffer_load_dword v52, v3, s[8:11], 0 offen sc1
    s_waitcnt vmcnt(0)
    v_cmp_eq_u32 vcc, 0, v52
    s_cbranch_vccz L_r2_wh_ok
    s_sleep 8
    s_add_u32 s46, s46, 1
    s_cmp_lt_u32 s46, 0x40000
    s_cbranch_scc1 L_r2_wh
    s_endpgm
L_r2_wh_ok:
    v_and_b32 v13, 0, v0
    v_add_u32 v13, v13, v0
    s_mul_i32 s40, s3, 4160
    s_add_u32 m0, s40, 24576
    s_add_u32 s40, s43, 4096
    buffer_load_dwordx4 v0, s[28:31], s44 offen offset:0 lds
    s_add_u32 m0, m0, 16
    s_nop 0
    buffer_load_dwordx4 v0, s[28:31], s44 offen offset:1024 lds
    s_add_u32 m0, m0, 16
    s_nop 0
    buffer_load_dwordx4 v0, s[28:31], s44 offen offset:2048 lds
    s_add_u32 m0, m0, 16
    s_nop 0
    buffer_load_dwordx4 v0, s[28:31], s44 offen offset:3072 lds
    buffer_load_dwordx4 v[208:211], v0, s[8:11], s43 offen offset:0 sc1
    buffer_load_dwordx4 v[212:215], v0, s[8:11], s43 offen offset:1024 sc1
    buffer_load_dwordx4 v[216:219], v0, s[8:11], s43 offen offset:2048 sc1
    buffer_load_dwordx4 v[220:223], v0, s[8:11], s43 offen offset:3072 sc1
    buffer_load_dwordx4 v[224:227], v0, s[8:11], s40 offen offset:0 sc1
    buffer_load_dwordx4 v[228:231], v0, s[8:11], s40 offen offset:1024 sc1
    buffer_load_dwordx4 v[232:235], v0, s[8:11], s40 offen offset:2048 sc1
    buffer_load_dwordx4 v[236:239], v0, s[8:11], s40 offen offset:3072 sc1
    s_add_u32 s43, s43, 0x20000
    s_add_u32 s44, s44, 0x10000
    s_waitcnt vmcnt(0)
    s_barrier
    ds_read_b128 v[240:243], v1 offset:24576
    ds_read_b128 v[244:247], v1 offset:24592
    ds_read_b128 v[248:251], v1 offset:24608
    ds_read_b128 v[252:255], v1 offset:24624
    ds_read_b64 v[40:41], v6 offset:24576
    v_mfma_f32_16x16x32_bf16 v[44:47], v[128:131], v[208:211], 0
    v_mfma_f32_16x16x32_bf16 v[48:51], v[160:163], v[208:211], 0
    v_mfma_f32_16x16x32_bf16 v[44:47], v[132:135], v[212:215], v[44:47]
    v_mfma_f32_16x16x32_bf16 v[48:51], v[164:167], v[212:215], v[48:51]
    v_mfma_f32_16x16x32_bf16 v[44:47], v[136:139], v[216:219], v[44:47]
    v_mfma_f32_16x16x32_bf16 v[48:51], v[168:171], v[216:219], v[48:51]
    v_mfma_f32_16x16x32_bf16 v[44:47], v[140:143], v[220:223], v[44:47]
    v_mfma_f32_16x16x32_bf16 v[48:51], v[172:175], v[220:223], v[48:51]
    v_mfma_f32_16x16x32_bf16 v[44:47], v[144:147], v[224:227], v[44:47]
    v_mfma_f32_16x16x32_bf16 v[48:51], v[176:179], v[224:227], v[48:51]
    v_mfma_f32_16x16x32_bf16 v[44:47], v[148:151], v[228:231], v[44:47]
    v_mfma_f32_16x16x32_bf16 v[48:51], v[180:183], v[228:231], v[48:51]
    v_mfma_f32_16x16x32_bf16 v[44:47], v[152:155], v[232:235], v[44:47]
    v_mfma_f32_16x16x32_bf16 v[48:51], v[184:187], v[232:235], v[48:51]
    v_mfma_f32_16x16x32_bf16 v[44:47], v[156:159], v[236:239], v[44:47]
    v_mfma_f32_16x16x32_bf16 v[48:51], v[188:191], v[236:239], v[48:51]
    s_waitcnt lgkmcnt(0)
    v_mfma_f32_16x16x32_bf16 v[52:55], v[192:195], v[240:243], 0
    v_mfma_f32_16x16x32_bf16 v[52:55], v[196:199], v[244:247], v[52:55]
    v_mfma_f32_16x16x32_bf16 v[52:55], v[200:203], v[248:251], v[52:55]
    v_mfma_f32_16x16x32_bf16 v[52:55], v[204:207], v[252:255], v[52:55]
    ds_write_b128 v4, v[44:47] offset:0
    ds_write_b128 v4, v[48:51] offset:1024
    s_nop 5
    ds_write_b32 v4, v52 offset:2048
    s_waitcnt lgkmcnt(0)
    s_barrier
L_r2_loop:
    s_lshr_b32 s47, s38, 2
    s_and_b32 s41, s38, 3
    s_lshl_b32 s41, s41, 7
    s_add_u32 s38, s38, 2
    s_cmp_lt_u32 s38, 64
    s_cbranch_scc0 L_r2_noe
    s_mul_i32 s40, s3, 4160
    s_add_u32 m0, s40, 24576
    s_add_u32 s40, s43, 4096
    buffer_load_dwordx4 v0, s[28:31], s44 offen offset:0 lds
    s_add_u32 m0, m0, 16
    s_nop 0
    buffer_load_dwordx4 v0, s[28:31], s44 offen offset:1024 lds
    s_add_u32 m0, m0, 16
    s_nop 0
    buffer_load_dwordx4 v0, s[28:31], s44 offen offset:2048 lds
    s_add_u32 m0, m0, 16
    s_nop 0
    buffer_load_dwordx4 v0, s[28:31], s44 offen offset:3072 lds
    buffer_load_dwordx4 v[208:211], v0, s[8:11], s43 offen offset:0 sc1
    buffer_load_dwordx4 v[212:215], v0, s[8:11], s43 offen offset:1024 sc1
    buffer_load_dwordx4 v[216:219], v0, s[8:11], s43 offen offset:2048 sc1
    buffer_load_dwordx4 v[220:223], v0, s[8:11], s43 offen offset:3072 sc1
    buffer_load_dwordx4 v[224:227], v0, s[8:11], s40 offen offset:0 sc1
    buffer_load_dwordx4 v[228:231], v0, s[8:11], s40 offen offset:1024 sc1
    buffer_load_dwordx4 v[232:235], v0, s[8:11], s40 offen offset:2048 sc1
    buffer_load_dwordx4 v[236:239], v0, s[8:11], s40 offen offset:3072 sc1
    s_add_u32 s43, s43, 0x20000
    s_add_u32 s44, s44, 0x10000
L_r2_noe:
    s_cmp_lt_u32 s3, 2
    s_cbranch_scc0 L_r2_noc
    ds_read_b128 v[240:243], v12 offset:0
    ds_read_b32 v56, v0 offset:2048
    ds_read_b128 v[244:247], v12 offset:3072
    ds_read_b32 v57, v0 offset:5120
    ds_read_b128 v[248:251], v12 offset:6144
    ds_read_b32 v58, v0 offset:8192
    ds_read_b128 v[252:255], v12 offset:9216
    ds_read_b32 v59, v0 offset:11264
    s_waitcnt lgkmcnt(0)
    v_add_f32 v56, v56, v57
    v_add_f32 v58, v58, v59
    v_add_f32 v56, v56, v58
    v_mul_f32 v56, s49, v56
    v_exp_f32 v56, v56
    v_lshlrev_b32 v57, 16, v40
    v_and_b32 v58, 0xffff0000, v40
    v_fmac_f32 v240, v57, v8
    v_fmac_f32 v241, v58, v9
    v_lshlrev_b32 v57, 16, v41
    v_and_b32 v58, 0xffff0000, v41
    v_fmac_f32 v242, v57, v10
    v_fmac_f32 v243, v58, v11
    v_add_f32 v56, 1.0, v56
    v_rcp_f32 v56, v56
    v_pk_add_f32 v[240:241], v[240:241], v[244:245]
    v_pk_add_f32 v[242:243], v[242:243], v[246:247]
    v_pk_add_f32 v[240:241], v[240:241], v[248:249]
    v_pk_add_f32 v[242:243], v[242:243], v[250:251]
    v_pk_add_f32 v[240:241], v[240:241], v[252:253]
    v_pk_add_f32 v[242:243], v[242:243], v[254:255]
    v_sub_f32 v20, 1.0, v56
    v_mul_f32 v16, v240, v56
    v_mul_f32 v17, v241, v56
    v_mul_f32 v18, v242, v56
    v_mul_f32 v19, v243, v56
L_r2_noc:
    s_cmp_eq_u32 s51, 1
    s_cbranch_scc1 L_r2_have0
    s_mov_b32 s39, s42
    s_mov_b32 s46, 0
L_r2_wo:
    buffer_load_dword v21, v2, s[8:11], s41 offen sc1
    s_waitcnt vmcnt(0)
    v_cmp_ge_u32 vcc, s47, v21
    s_cbranch_vccz L_r2_wo_ok
    s_add_u32 s46, s46, 1
    s_cmp_lt_u32 s46, 0x40000
    s_cbranch_scc1 L_r2_wo
    s_endpgm
L_r2_wo_ok:
    buffer_load_dwordx4 v[64:67], v13, s[8:11], s39 offen offset:0 sc1
    buffer_load_dwordx4 v[68:71], v13, s[8:11], s39 offen offset:1024 sc1
    buffer_load_dwordx4 v[72:75], v13, s[8:11], s39 offen offset:2048 sc1
    buffer_load_dwordx4 v[76:79], v13, s[8:11], s39 offen offset:3072 sc1
    s_add_u32 s39, s39, 4096
    buffer_load_dwordx4 v[80:83], v13, s[8:11], s39 offen offset:0 sc1
    buffer_load_dwordx4 v[84:87], v13, s[8:11], s39 offen offset:1024 sc1
    buffer_load_dwordx4 v[88:91], v13, s[8:11], s39 offen offset:2048 sc1
    buffer_load_dwordx4 v[92:95], v13, s[8:11], s39 offen offset:3072 sc1
    s_add_u32 s39, s39, 4096
    buffer_load_dwordx4 v[96:99], v13, s[8:11], s39 offen offset:0 sc1
    buffer_load_dwordx4 v[100:103], v13, s[8:11], s39 offen offset:1024 sc1
    buffer_load_dwordx4 v[104:107], v13, s[8:11], s39 offen offset:2048 sc1
    buffer_load_dwordx4 v[108:111], v13, s[8:11], s39 offen offset:3072 sc1
    s_add_u32 s39, s39, 4096
    buffer_load_dwordx4 v[112:115], v13, s[8:11], s39 offen offset:0 sc1
    buffer_load_dwordx4 v[116:119], v13, s[8:11], s39 offen offset:1024 sc1
    buffer_load_dwordx4 v[120:123], v13, s[8:11], s39 offen offset:2048 sc1
    s_branch L_r2_have
L_r2_have0:
L_r2_have:
    s_xor_b32 s40, s41, 0x100
    buffer_load_dword v22, v2, s[8:11], s40 offen sc1
    s_lshr_b32 s47, s38, 2
    buffer_load_dwordx4 v[124:127], v13, s[8:11], s39 offen offset:3072 sc1
    s_add_u32 s39, s39, 4096
    s_waitcnt vmcnt(16)
    v_mfma_f32_16x16x32_bf16 v[28:31], a[0:3], v[64:67], 0
    v_and_b32 v14, 1, v64
    v_mfma_f32_16x16x32_bf16 v[32:35], a[8:11], v[64:67], 0
    buffer_load_dwordx4 v[64:67], v13, s[8:11], s39 offen offset:0 sc1
    s_waitcnt vmcnt(16)
    v_mfma_f32_16x16x32_bf16 v[28:31], a[4:7], v[68:71], v[28:31]
    v_and_b32 v14, v14, v68
    v_mfma_f32_16x16x32_bf16 v[32:35], a[12:15], v[68:71], v[32:35]
    buffer_load_dwordx4 v[68:71], v13, s[8:11], s39 offen offset:1024 sc1
    s_waitcnt vmcnt(16)
    v_mfma_f32_16x16x32_bf16 v[28:31], a[16:19], v[72:75], v[28:31]
    v_and_b32 v14, v14, v72
    v_mfma_f32_16x16x32_bf16 v[32:35], a[24:27], v[72:75], v[32:35]
    buffer_load_dwordx4 v[72:75], v13, s[8:11], s39 offen offset:2048 sc1
    s_waitcnt vmcnt(16)
    v_mfma_f32_16x16x32_bf16 v[28:31], a[20:23], v[76:79], v[28:31]
    v_and_b32 v14, v14, v76
    v_mfma_f32_16x16x32_bf16 v[32:35], a[28:31], v[76:79], v[32:35]
    buffer_load_dwordx4 v[76:79], v13, s[8:11], s39 offen offset:3072 sc1
    s_add_u32 s39, s39, 4096
    s_waitcnt vmcnt(16)
    v_mfma_f32_16x16x32_bf16 v[28:31], a[32:35], v[80:83], v[28:31]
    v_and_b32 v14, v14, v80
    v_mfma_f32_16x16x32_bf16 v[32:35], a[40:43], v[80:83], v[32:35]
    buffer_load_dwordx4 v[80:83], v13, s[8:11], s39 offen offset:0 sc1
    s_waitcnt vmcnt(16)
    v_mfma_f32_16x16x32_bf16 v[28:31], a[36:39], v[84:87], v[28:31]
    v_and_b32 v14, v14, v84
    v_mfma_f32_16x16x32_bf16 v[32:35], a[44:47], v[84:87], v[32:35]
    buffer_load_dwordx4 v[84:87], v13, s[8:11], s39 offen offset:1024 sc1
    s_waitcnt vmcnt(16)
    v_mfma_f32_16x16x32_bf16 v[28:31], a[48:51], v[88:91], v[28:31]
    v_and_b32 v14, v14, v88
    v_mfma_f32_16x16x32_bf16 v[32:35], a[56:59], v[88:91], v[32:35]
    buffer_load_dwordx4 v[88:91], v13, s[8:11], s39 offen offset:2048 sc1
    s_waitcnt vmcnt(16)
    v_mfma_f32_16x16x32_bf16 v[28:31], a[52:55], v[92:95], v[28:31]
    v_and_b32 v14, v14, v92
    v_mfma_f32_16x16x32_bf16 v[32:35], a[60:63], v[92:95], v[32:35]
    buffer_load_dwordx4 v[92:95], v13, s[8:11], s39 offen offset:3072 sc1
    s_add_u32 s39, s39, 4096
    s_waitcnt vmcnt(16)
    v_mfma_f32_16x16x32_bf16 v[28:31], a[64:67], v[96:99], v[28:31]
    v_and_b32 v14, v14, v96
    v_mfma_f32_16x16x32_bf16 v[32:35], a[72:75], v[96:99], v[32:35]
    buffer_load_dwordx4 v[96:99], v13, s[8:11], s39 offen offset:0 sc1
    s_waitcnt vmcnt(16)
    v_mfma_f32_16x16x32_bf16 v[28:31], a[68:71], v[100:103], v[28:31]
    v_and_b32 v14, v14, v100
    v_mfma_f32_16x16x32_bf16 v[32:35], a[76:79], v[100:103], v[32:35]
    buffer_load_dwordx4 v[100:103], v13, s[8:11], s39 offen offset:1024 sc1
    s_waitcnt vmcnt(16)
    v_mfma_f32_16x16x32_bf16 v[28:31], a[80:83], v[104:107], v[28:31]
    v_and_b32 v14, v14, v104
    v_mfma_f32_16x16x32_bf16 v[32:35], a[88:91], v[104:107], v[32:35]
    buffer_load_dwordx4 v[104:107], v13, s[8:11], s39 offen offset:2048 sc1
    s_waitcnt vmcnt(16)
    v_mfma_f32_16x16x32_bf16 v[28:31], a[84:87], v[108:111], v[28:31]
    v_and_b32 v14, v14, v108
    v_mfma_f32_16x16x32_bf16 v[32:35], a[92:95], v[108:111], v[32:35]
    buffer_load_dwordx4 v[108:111], v13, s[8:11], s39 offen offset:3072 sc1
    s_add_u32 s39, s39, 4096
    s_waitcnt vmcnt(16)
    v_mfma_f32_16x16x32_bf16 v[28:31], a[96:99], v[112:115], v[28:31]
    v_and_b32 v14, v14, v112
    v_mfma_f32_16x16x32_bf16 v[32:35], a[104:107], v[112:115], v[32:35]
    buffer_load_dwordx4 v[112:115], v13, s[8:11], s39 offen offset:0 sc1
    s_waitcnt vmcnt(16)
    v_mfma_f32_16x16x32_bf16 v[28:31], a[100:103], v[116:119], v[28:31]
    v_and_b32 v14, v14, v116
    v_mfma_f32_16x16x32_bf16 v[32:35], a[108:111], v[116:119], v[32:35]
    buffer_load_dwordx4 v[116:119], v13, s[8:11], s39 offen offset:1024 sc1
    s_waitcnt vmcnt(16)
    v_mfma_f32_16x16x32_bf16 v[28:31], a[112:115], v[120:123], v[28:31]
    v_and_b32 v14, v14, v120
    v_mfma_f32_16x16x32_bf16 v[32:35], a[120:123], v[120:123], v[32:35]
    buffer_load_dwordx4 v[120:123], v13, s[8:11], s39 offen offset:2048 sc1
    s_waitcnt vmcnt(15)
    v_mfma_f32_16x16x32_bf16 v[28:31], a[116:119], v[124:127], v[28:31]
    v_and_b32 v14, v14, v124
    v_mfma_f32_16x16x32_bf16 v[32:35], a[124:127], v[124:127], v[32:35]
    buffer_load_dwordx4 v[124:127], v13, s[8:11], s39 offen offset:3072 sc1
    s_add_u32 s39, s39, 4096
    s_waitcnt vmcnt(15)
    v_mfma_f32_16x16x32_bf16 v[28:31], a[128:131], v[64:67], v[28:31]
    v_and_b32 v14, v14, v64
    v_mfma_f32_16x16x32_bf16 v[32:35], a[136:139], v[64:67], v[32:35]
    v_cmp_ge_u32 vcc, s47, v22
    s_barrier
    s_cmp_lt_u32 s38, 64
    s_cbranch_scc1 L_r2_more
    s_waitcnt vmcnt(14)
    v_mfma_f32_16x16x32_bf16 v[28:31], a[132:135], v[68:71], v[28:31]
    v_and_b32 v14, v14, v68
    v_mfma_f32_16x16x32_bf16 v[32:35], a[140:143], v[68:71], v[32:35]
    s_waitcnt vmcnt(13)
    v_mfma_f32_16x16x32_bf16 v[28:31], a[144:147], v[72:75], v[28:31]
    v_and_b32 v14, v14, v72
    v_mfma_f32_16x16x32_bf16 v[32:35], a[152:155], v[72:75], v[32:35]
    s_waitcnt vmcnt(12)
    v_mfma_f32_16x16x32_bf16 v[28:31], a[148:151], v[76:79], v[28:31]
    v_and_b32 v14, v14, v76
    v_mfma_f32_16x16x32_bf16 v[32:35], a[156:159], v[76:79], v[32:35]
    s_waitcnt vmcnt(11)
    v_mfma_f32_16x16x32_bf16 v[28:31], a[160:163], v[80:83], v[28:31]
    v_and_b32 v14, v14, v80
    v_mfma_f32_16x16x32_bf16 v[32:35], a[168:171], v[80:83], v[32:35]
    s_waitcnt vmcnt(10)
    v_mfma_f32_16x16x32_bf16 v[28:31], a[164:167], v[84:87], v[28:31]
    v_and_b32 v14, v14, v84
    v_mfma_f32_16x16x32_bf16 v[32:35], a[172:175], v[84:87], v[32:35]
    s_waitcnt vmcnt(9)
    v_mfma_f32_16x16x32_bf16 v[28:31], a[176:179], v[88:91], v[28:31]
    v_and_b32 v14, v14, v88
    v_mfma_f32_16x16x32_bf16 v[32:35], a[184:187], v[88:91], v[32:35]
    s_waitcnt vmcnt(8)
    v_mfma_f32_16x16x32_bf16 v[28:31], a[180:183], v[92:95], v[28:31]
    v_and_b32 v14, v14, v92
    v_mfma_f32_16x16x32_bf16 v[32:35], a[188:191], v[92:95], v[32:35]
    s_waitcnt vmcnt(7)
    v_mfma_f32_16x16x32_bf16 v[28:31], a[192:195], v[96:99], v[28:31]
    v_and_b32 v14, v14, v96
    v_mfma_f32_16x16x32_bf16 v[32:35], a[200:203], v[96:99], v[32:35]
    s_waitcnt vmcnt(6)
    v_mfma_f32_16x16x32_bf16 v[28:31], a[196:199], v[100:103], v[28:31]
    v_and_b32 v14, v14, v100
    v_mfma_f32_16x16x32_bf16 v[32:35], a[204:207], v[100:103], v[32:35]
    s_waitcnt vmcnt(5)
    v_mfma_f32_16x16x32_bf16 v[28:31], a[208:211], v[104:107], v[28:31]
    v_and_b32 v14, v14, v104
    v_mfma_f32_16x16x32_bf16 v[32:35], a[216:219], v[104:107], v[32:35]
    s_waitcnt vmcnt(4)
    v_mfma_f32_16x16x32_bf16 v[28:31], a[212:215], v[108:111], v[28:31]
    v_and_b32 v14, v14, v108
    v_mfma_f32_16x16x32_bf16 v[32:35], a[220:223], v[108:111], v[32:35]
    s_waitcnt vmcnt(3)
    v_mfma_f32_16x16x32_bf16 v[28:31], a[224:227], v[112:115], v[28:31]
    v_and_b32 v14, v14, v112
    v_mfma_f32_16x16x32_bf16 v[32:35], a[232:235], v[112:115], v[32:35]
    s_waitcnt vmcnt(2)
    v_mfma_f32_16x16x32_bf16 v[28:31], a[228:231], v[116:119], v[28:31]
    v_and_b32 v14, v14, v116
    v_mfma_f32_16x16x32_bf16 v[32:35], a[236:239], v[116:119], v[32:35]
    s_waitcnt vmcnt(1)
    v_mfma_f32_16x16x32_bf16 v[28:31], a[240:243], v[120:123], v[28:31]
    v_and_b32 v14, v14, v120
    v_mfma_f32_16x16x32_bf16 v[32:35], a[248:251], v[120:123], v[32:35]
    s_waitcnt vmcnt(0)
    v_mfma_f32_16x16x32_bf16 v[28:31], a[244:247], v[124:127], v[28:31]
    v_and_b32 v14, v14, v124
    v_mfma_f32_16x16x32_bf16 v[32:35], a[252:255], v[124:127], v[32:35]
    s_branch L_r2_red
L_r2_more:
    s_cbranch_vccz L_r2_ahead
    s_mov_b32 s51, 0
    ds_read_b128 v[240:243], v1 offset:24576
    ds_read_b128 v[244:247], v1 offset:24592
    ds_read_b128 v[248:251], v1 offset:24608
    ds_read_b128 v[252:255], v1 offset:24624
    ds_read_b64 v[40:41], v6 offset:24576
    s_waitcnt vmcnt(14)
    v_mfma_f32_16x16x32_bf16 v[28:31], a[132:135], v[68:71], v[28:31]
    v_and_b32 v14, v14, v68
    v_mfma_f32_16x16x32_bf16 v[32:35], a[140:143], v[68:71], v[32:35]
    v_mfma_f32_16x16x32_bf16 v[44:47], v[128:131], v[208:211], 0
    v_mfma_f32_16x16x32_bf16 v[48:51], v[160:163], v[208:211], 0
    s_waitcnt vmcnt(13)
    v_mfma_f32_16x16x32_bf16 v[28:31], a[144:147], v[72:75], v[28:31]
    v_and_b32 v14, v14, v72
    v_mfma_f32_16x16x32_bf16 v[32:35], a[152:155], v[72:75], v[32:35]
    v_mfma_f32_16x16x32_bf16 v[44:47], v[132:135], v[212:215], v[44:47]
    v_mfma_f32_16x16x32_bf16 v[48:51], v[164:167], v[212:215], v[48:51]
    s_waitcnt vmcnt(12)
    v_mfma_f32_16x16x32_bf16 v[28:31], a[148:151], v[76:79], v[28:31]
    v_and_b32 v14, v14, v76
    v_mfma_f32_16x16x32_bf16 v[32:35], a[156:159], v[76:79], v[32:35]
    v_mfma_f32_16x16x32_bf16 v[44:47], v[136:139], v[216:219], v[44:47]
    v_mfma_f32_16x16x32_bf16 v[48:51], v[168:171], v[216:219], v[48:51]
    s_waitcnt vmcnt(11)
    v_mfma_f32_16x16x32_bf16 v[28:31], a[160:163], v[80:83], v[28:31]
    v_and_b32 v14, v14, v80
    v_mfma_f32_16x16x32_bf16 v[32:35], a[168:171], v[80:83], v[32:35]
    v_mfma_f32_16x16x32_bf16 v[44:47], v[140:143], v[220:223], v[44:47]
    v_mfma_f32_16x16x32_bf16 v[48:51], v[172:175], v[220:223], v[48:51]
    s_waitcnt vmcnt(10)
    v_mfma_f32_16x16x32_bf16 v[28:31], a[164:167], v[84:87], v[28:31]
    v_and_b32 v14, v14, v84
    v_mfma_f32_16x16x32_bf16 v[32:35], a[172:175], v[84:87], v[32:35]
    v_mfma_f32_16x16x32_bf16 v[44:47], v[144:147], v[224:227], v[44:47]
    v_mfma_f32_16x16x32_bf16 v[48:51], v[176:179], v[224:227], v[48:51]
    s_waitcnt vmcnt(9)
    v_mfma_f32_16x16x32_bf16 v[28:31], a[176:179], v[88:91], v[28:31]
    v_and_b32 v14, v14, v88
    v_mfma_f32_16x16x32_bf16 v[32:35], a[184:187], v[88:91], v[32:35]
    v_mfma_f32_16x16x32_bf16 v[44:47], v[148:151], v[228:231], v[44:47]
    v_mfma_f32_16x16x32_bf16 v[48:51], v[180:183], v[228:231], v[48:51]
    s_waitcnt vmcnt(8)
    v_mfma_f32_16x16x32_bf16 v[28:31], a[180:183], v[92:95], v[28:31]
    v_and_b32 v14, v14, v92
    v_mfma_f32_16x16x32_bf16 v[32:35], a[188:191], v[92:95], v[32:35]
    v_mfma_f32_16x16x32_bf16 v[44:47], v[152:155], v[232:235], v[44:47]
    v_mfma_f32_16x16x32_bf16 v[48:51], v[184:187], v[232:235], v[48:51]
    s_waitcnt vmcnt(7)
    v_mfma_f32_16x16x32_bf16 v[28:31], a[192:195], v[96:99], v[28:31]
    v_and_b32 v14, v14, v96
    v_mfma_f32_16x16x32_bf16 v[32:35], a[200:203], v[96:99], v[32:35]
    v_mfma_f32_16x16x32_bf16 v[44:47], v[156:159], v[236:239], v[44:47]
    v_mfma_f32_16x16x32_bf16 v[48:51], v[188:191], v[236:239], v[48:51]
    s_waitcnt vmcnt(6)
    v_mfma_f32_16x16x32_bf16 v[28:31], a[196:199], v[100:103], v[28:31]
    v_and_b32 v14, v14, v100
    v_mfma_f32_16x16x32_bf16 v[32:35], a[204:207], v[100:103], v[32:35]
    s_waitcnt lgkmcnt(0)
    v_mfma_f32_16x16x32_bf16 v[52:55], v[192:195], v[240:243], 0
    v_mfma_f32_16x16x32_bf16 v[52:55], v[196:199], v[244:247], v[52:55]
    s_waitcnt vmcnt(5)
    v_mfma_f32_16x16x32_bf16 v[28:31], a[208:211], v[104:107], v[28:31]
    v_and_b32 v14, v14, v104
    v_mfma_f32_16x16x32_bf16 v[32:35], a[216:219], v[104:107], v[32:35]
    v_mfma_f32_16x16x32_bf16 v[52:55], v[200:203], v[248:251], v[52:55]
    v_mfma_f32_16x16x32_bf16 v[52:55], v[204:207], v[252:255], v[52:55]
    s_waitcnt vmcnt(4)
    v_mfma_f32_16x16x32_bf16 v[28:31], a[212:215], v[108:111], v[28:31]
    v_and_b32 v14, v14, v108
    v_mfma_f32_16x16x32_bf16 v[32:35], a[220:223], v[108:111], v[32:35]
    ds_write_b128 v4, v[44:47] offset:0
    s_waitcnt vmcnt(3)
    v_mfma_f32_16x16x32_bf16 v[28:31], a[224:227], v[112:115], v[28:31]
    v_and_b32 v14, v14, v112
    v_mfma_f32_16x16x32_bf16 v[32:35], a[232:235], v[112:115], v[32:35]
    ds_write_b128 v4, v[48:51] offset:1024
    s_waitcnt vmcnt(2)
    v_mfma_f32_16x16x32_bf16 v[28:31], a[228:231], v[116:119], v[28:31]
    v_and_b32 v14, v14, v116
    v_mfma_f32_16x16x32_bf16 v[32:35], a[236:239], v[116:119], v[32:35]
    ds_write_b32 v4, v52 offset:2048
    s_waitcnt vmcnt(1)
    v_mfma_f32_16x16x32_bf16 v[28:31], a[240:243], v[120:123], v[28:31]
    v_and_b32 v14, v14, v120
    v_mfma_f32_16x16x32_bf16 v[32:35], a[248:251], v[120:123], v[32:35]
    s_waitcnt vmcnt(0)
    v_mfma_f32_16x16x32_bf16 v[28:31], a[244:247], v[124:127], v[28:31]
    v_and_b32 v14, v14, v124
    v_mfma_f32_16x16x32_bf16 v[32:35], a[252:255], v[124:127], v[32:35]
    s_branch L_r2_red
L_r2_ahead:
    s_mov_b32 s51, 1
    s_add_u32 s39, s42, 0x80000
    buffer_load_dwordx4 v[64:67], v13, s[8:11], s39 offen offset:0 sc1
    ds_read_b128 v[240:243], v1 offset:24576
    ds_read_b128 v[244:247], v1 offset:24592
    ds_read_b128 v[248:251], v1 offset:24608
    ds_read_b128 v[252:255], v1 offset:24624
    ds_read_b64 v[40:41], v6 offset:24576
    s_waitcnt vmcnt(15)
    v_mfma_f32_16x16x32_bf16 v[28:31], a[132:135], v[68:71], v[28:31]
    v_and_b32 v14, v14, v68
    v_mfma_f32_16x16x32_bf16 v[32:35], a[140:143], v[68:71], v[32:35]
    buffer_load_dwordx4 v[68:71], v13, s[8:11], s39 offen offset:1024 sc1
    v_mfma_f32_16x16x32_bf16 v[44:47], v[128:131], v[208:211], 0
    v_mfma_f32_16x16x32_bf16 v[48:51], v[160:163], v[208:211], 0
    s_waitcnt vmcnt(15)
    v_mfma_f32_16x16x32_bf16 v[28:31], a[144:147], v[72:75], v[28:31]
    v_and_b32 v14, v14, v72
    v_mfma_f32_16x16x32_bf16 v[32:35], a[152:155], v[72:75], v[32:35]
    buffer_load_dwordx4 v[72:75], v13, s[8:11], s39 offen offset:2048 sc1
    v_mfma_f32_16x16x32_bf16 v[44:47], v[132:135], v[212:215], v[44:47]
    v_mfma_f32_16x16x32_bf16 v[48:51], v[164:167], v[212:215], v[48:51]
    s_waitcnt vmcnt(15)
    v_mfma_f32_16x16x32_bf16 v[28:31], a[148:151], v[76:79], v[28:31]
    v_and_b32 v14, v14, v76
    v_mfma_f32_16x16x32_bf16 v[32:35], a[156:159], v[76:79], v[32:35]
    buffer_load_dwordx4 v[76:79], v13, s[8:11], s39 offen offset:3072 sc1
    s_add_u32 s39, s39, 4096
    v_mfma_f32_16x16x32_bf16 v[44:47], v[136:139], v[216:219], v[44:47]
    v_mfma_f32_16x16x32_bf16 v[48:51], v[168:171], v[216:219], v[48:51]
    s_waitcnt vmcnt(15)
    v_mfma_f32_16x16x32_bf16 v[28:31], a[160:163], v[80:83], v[28:31]
    v_and_b32 v14, v14, v80
    v_mfma_f32_16x16x32_bf16 v[32:35], a[168:171], v[80:83], v[32:35]
    buffer_load_dwordx4 v[80:83], v13, s[8:11], s39 offen offset:0 sc1
    v_mfma_f32_16x16x32_bf16 v[44:47], v[140:143], v[220:223], v[44:47]
    v_mfma_f32_16x16x32_bf16 v[48:51], v[172:175], v[220:223], v[48:51]
    s_waitcnt vmcnt(15)
    v_mfma_f32_16x16x32_bf16 v[28:31], a[164:167], v[84:87], v[28:31]
    v_and_b32 v14, v14, v84
    v_mfma_f32_16x16x32_bf16 v[32:35], a[172:175], v[84:87], v[32:35]
    buffer_load_dwordx4 v[84:87], v13, s[8:11], s39 offen offset:1024 sc1
    v_mfma_f32_16x16x32_bf16 v[44:47], v[144:147], v[224:227], v[44:47]
    v_mfma_f32_16x16x32_bf16 v[48:51], v[176:179], v[224:227], v[48:51]
    s_waitcnt vmcnt(15)
    v_mfma_f32_16x16x32_bf16 v[28:31], a[176:179], v[88:91], v[28:31]
    v_and_b32 v14, v14, v88
    v_mfma_f32_16x16x32_bf16 v[32:35], a[184:187], v[88:91], v[32:35]
    buffer_load_dwordx4 v[88:91], v13, s[8:11], s39 offen offset:2048 sc1
    v_mfma_f32_16x16x32_bf16 v[44:47], v[148:151], v[228:231], v[44:47]
    v_mfma_f32_16x16x32_bf16 v[48:51], v[180:183], v[228:231], v[48:51]
    s_waitcnt vmcnt(15)
    v_mfma_f32_16x16x32_bf16 v[28:31], a[180:183], v[92:95], v[28:31]
    v_and_b32 v14, v14, v92
    v_mfma_f32_16x16x32_bf16 v[32:35], a[188:191], v[92:95], v[32:35]
    buffer_load_dwordx4 v[92:95], v13, s[8:11], s39 offen offset:3072 sc1
    s_add_u32 s39, s39, 4096
    v_mfma_f32_16x16x32_bf16 v[44:47], v[152:155], v[232:235], v[44:47]
    v_mfma_f32_16x16x32_bf16 v[48:51], v[184:187], v[232:235], v[48:51]
    s_waitcnt vmcnt(15)
    v_mfma_f32_16x16x32_bf16 v[28:31], a[192:195], v[96:99], v[28:31]
    v_and_b32 v14, v14, v96
    v_mfma_f32_16x16x32_bf16 v[32:35], a[200:203], v[96:99], v[32:35]
    buffer_load_dwordx4 v[96:99], v13, s[8:11], s39 offen offset:0 sc1
    v_mfma_f32_16x16x32_bf16 v[44:47], v[156:159], v[236:239], v[44:47]
    v_mfma_f32_16x16x32_bf16 v[48:51], v[188:191], v[236:239], v[48:51]
    s_waitcnt vmcnt(15)
    v_mfma_f32_16x16x32_bf16 v[28:31], a[196:199], v[100:103], v[28:31]
    v_and_b32 v14, v14, v100
    v_mfma_f32_16x16x32_bf16 v[32:35], a[204:207], v[100:103], v[32:35]
    buffer_load_dwordx4 v[100:103], v13, s[8:11], s39 offen offset:1024 sc1
    s_waitcnt lgkmcnt(0)
    v_mfma_f32_16x16x32_bf16 v[52:55], v[192:195], v[240:243], 0
    v_mfma_f32_16x16x32_bf16 v[52:55], v[196:199], v[244:247], v[52:55]
    s_waitcnt vmcnt(15)
    v_mfma_f32_16x16x32_bf16 v[28:31], a[208:211], v[104:107], v[28:31]
    v_and_b32 v14, v14, v104
    v_mfma_f32_16x16x32_bf16 v[32:35], a[216:219], v[104:107], v[32:35]
    buffer_load_dwordx4 v[104:107], v13, s[8:11], s39 offen offset:2048 sc1
    v_mfma_f32_16x16x32_bf16 v[52:55], v[200:203], v[248:251], v[52:55]
    v_mfma_f32_16x16x32_bf16 v[52:55], v[204:207], v[252:255], v[52:55]
    s_waitcnt vmcnt(15)
    v_mfma_f32_16x16x32_bf16 v[28:31], a[212:215], v[108:111], v[28:31]
    v_and_b32 v14, v14, v108
    v_mfma_f32_16x16x32_bf16 v[32:35], a[220:223], v[108:111], v[32:35]
    buffer_load_dwordx4 v[108:111], v13, s[8:11], s39 offen offset:3072 sc1
    s_add_u32 s39, s39, 4096
    ds_write_b128 v4, v[44:47] offset:0
    s_waitcnt vmcnt(15)
    v_mfma_f32_16x16x32_bf16 v[28:31], a[224:227], v[112:115], v[28:31]
    v_and_b32 v14, v14, v112
    v_mfma_f32_16x16x32_bf16 v[32:35], a[232:235], v[112:115], v[32:35]
    buffer_load_dwordx4 v[112:115], v13, s[8:11], s39 offen offset:0 sc1
    ds_write_b128 v4, v[48:51] offset:1024
    s_waitcnt vmcnt(15)
    v_mfma_f32_16x16x32_bf16 v[28:31], a[228:231], v[116:119], v[28:31]
    v_and_b32 v14, v14, v116
    v_mfma_f32_16x16x32_bf16 v[32:35], a[236:239], v[116:119], v[32:35]
    buffer_load_dwordx4 v[116:119], v13, s[8:11], s39 offen offset:1024 sc1
    ds_write_b32 v4, v52 offset:2048
    s_waitcnt vmcnt(15)
    v_mfma_f32_16x16x32_bf16 v[28:31], a[240:243], v[120:123], v[28:31]
    v_and_b32 v14, v14, v120
    v_mfma_f32_16x16x32_bf16 v[32:35], a[248:251], v[120:123], v[32:35]
    buffer_load_dwordx4 v[120:123], v13, s[8:11], s39 offen offset:2048 sc1
    s_waitcnt vmcnt(15)
    v_mfma_f32_16x16x32_bf16 v[28:31], a[244:247], v[124:127], v[28:31]
    v_and_b32 v14, v14, v124
    v_mfma_f32_16x16x32_bf16 v[32:35], a[252:255], v[124:127], v[32:35]
L_r2_red:
    s_cmp_ge_u32 s38, 62
    s_cselect_b32 s40, 1, 0
    v_cmp_gt_u32 vcc, s40, v14
    s_cbranch_vccnz L_r2_redo
    s_add_u32 s42, s42, 0x80000
    s_nop 0
    ds_write_b128 v4, v[28:31] offset:12288
    s_nop 2
    ds_write_b128 v4, v[32:35] offset:13312
    s_waitcnt lgkmcnt(0)
    s_barrier
    s_cmp_lt_u32 s3, 2
    s_cbranch_scc0 L_r2_n
    ds_read_b128 v[240:243], v12 offset:12288
    ds_read_b128 v[244:247], v12 offset:15360
    ds_read_b128 v[248:251], v12 offset:18432
    ds_read_b128 v[252:255], v12 offset:21504
    s_waitcnt lgkmcnt(2)
    v_pk_add_f32 v[240:241], v[240:241], v[244:245]
    v_pk_add_f32 v[242:243], v[242:243], v[246:247]
    s_waitcnt lgkmcnt(0)
    v_pk_add_f32 v[248:249], v[248:249], v[252:253]
    v_pk_add_f32 v[250:251], v[250:251], v[254:255]
    v_pk_add_f32 v[240:241], v[240:241], v[248:249]
    v_pk_add_f32 v[242:243], v[242:243], v[250:251]
    v_fma_f32 v60, v240, v20, v16
    v_fma_f32 v61, v241, v20, v17
    v_fma_f32 v62, v242, v20, v18
    v_fma_f32 v63, v243, v20, v19
    buffer_store_dwordx4 v[60:63], v5, s[32:35], s45 offen
    s_add_u32 s45, s45, 0x20000
L_r2_n:
    s_cmp_lt_u32 s38, 64
    s_cbranch_scc1 L_r2_loop
    s_endpgm
L_r2_redo:
    s_add_u32 s50, s50, 1
    s_cmp_lt_u32 s50, 0x40000
    s_cbranch_scc0 L_exit
    s_mov_b32 s51, 0
    s_mov_b32 s39, s42
    buffer_load_dwordx4 v[64:67], v13, s[8:11], s39 offen offset:0 sc1
    buffer_load_dwordx4 v[68:71], v13, s[8:11], s39 offen offset:1024 sc1
    buffer_load_dwordx4 v[72:75], v13, s[8:11], s39 offen offset:2048 sc1
    buffer_load_dwordx4 v[76:79], v13, s[8:11], s39 offen offset:3072 sc1
    s_add_u32 s39, s39, 4096
    buffer_load_dwordx4 v[80:83], v13, s[8:11], s39 offen offset:0 sc1
    buffer_load_dwordx4 v[84:87], v13, s[8:11], s39 offen offset:1024 sc1
    buffer_load_dwordx4 v[88:91], v13, s[8:11], s39 offen offset:2048 sc1
    buffer_load_dwordx4 v[92:95], v13, s[8:11], s39 offen offset:3072 sc1
    s_add_u32 s39, s39, 4096
    buffer_load_dwordx4 v[96:99], v13, s[8:11], s39 offen offset:0 sc1
    buffer_load_dwordx4 v[100:103], v13, s[8:11], s39 offen offset:1024 sc1
    buffer_load_dwordx4 v[104:107], v13, s[8:11], s39 offen offset:2048 sc1
    buffer_load_dwordx4 v[108:111], v13, s[8:11], s39 offen offset:3072 sc1
    s_add_u32 s39, s39, 4096
    buffer_load_dwordx4 v[112:115], v13, s[8:11], s39 offen offset:0 sc1
    buffer_load_dwordx4 v[116:119], v13, s[8:11], s39 offen offset:1024 sc1
    buffer_load_dwordx4 v[120:123], v13, s[8:11], s39 offen offset:2048 sc1
    buffer_load_dwordx4 v[124:127], v13, s[8:11], s39 offen offset:3072 sc1
    s_add_u32 s39, s39, 4096
    s_waitcnt vmcnt(15)
    v_mfma_f32_16x16x32_bf16 v[28:31], a[0:3], v[64:67], 0
    v_and_b32 v14, 1, v64
    v_mfma_f32_16x16x32_bf16 v[32:35], a[8:11], v[64:67], 0
    buffer_load_dwordx4 v[64:67], v13, s[8:11], s39 offen offset:0 sc1
    s_waitcnt vmcnt(15)
    v_mfma_f32_16x16x32_bf16 v[28:31], a[4:7], v[68:71], v[28:31]
    v_and_b32 v14, v14, v68
    v_mfma_f32_16x16x32_bf16 v[32:35], a[12:15], v[68:71], v[32:35]
    buffer_load_dwordx4 v[68:71], v13, s[8:11], s39 offen offset:1024 sc1
    s_waitcnt vmcnt(15)
    v_mfma_f32_16x16x32_bf16 v[28:31], a[16:19], v[72:75], v[28:31]
    v_and_b32 v14, v14, v72
    v_mfma_f32_16x16x32_bf16 v[32:35], a[24:27], v[72:75], v[32:35]
    buffer_load_dwordx4 v[72:75], v13, s[8:11], s39 offen offset:2048 sc1
    s_waitcnt vmcnt(15)
    v_mfma_f32_16x16x32_bf16 v[28:31], a[20:23], v[76:79], v[28:31]
    v_and_b32 v14, v14, v76
    v_mfma_f32_16x16x32_bf16 v[32:35], a[28:31], v[76:79], v[32:35]
    buffer_load_dwordx4 v[76:79], v13, s[8:11], s39 offen offset:3072 sc1
    s_add_u32 s39, s39, 4096
    s_waitcnt vmcnt(15)
    v_mfma_f32_16x16x32_bf16 v[28:31], a[32:35], v[80:83], v[28:31]
    v_and_b32 v14, v14, v80
    v_mfma_f32_16x16x32_bf16 v[32:35], a[40:43], v[80:83], v[32:35]
    buffer_load_dwordx4 v[80:83], v13, s[8:11], s39 offen offset:0 sc1
    s_waitcnt vmcnt(15)
    v_mfma_f32_16x16x32_bf16 v[28:31], a[36:39], v[84:87], v[28:31]
    v_and_b32 v14, v14, v84
    v_mfma_f32_16x16x32_bf16 v[32:35], a[44:47], v[84:87], v[32:35]
    buffer_load_dwordx4 v[84:87], v13, s[8:11], s39 offen offset:1024 sc1
    s_waitcnt vmcnt(15)
    v_mfma_f32_16x16x32_bf16 v[28:31], a[48:51], v[88:91], v[28:31]
    v_and_b32 v14, v14, v88
    v_mfma_f32_16x16x32_bf16 v[32:35], a[56:59], v[88:91], v[32:35]
    buffer_load_dwordx4 v[88:91], v13, s[8:11], s39 offen offset:2048 sc1
    s_waitcnt vmcnt(15)
    v_mfma_f32_16x16x32_bf16 v[28:31], a[52:55], v[92:95], v[28:31]
    v_and_b32 v14, v14, v92
    v_mfma_f32_16x16x32_bf16 v[32:35], a[60:63], v[92:95], v[32:35]
    buffer_load_dwordx4 v[92:95], v13, s[8:11], s39 offen offset:3072 sc1
    s_add_u32 s39, s39, 4096
    s_waitcnt vmcnt(15)
    v_mfma_f32_16x16x32_bf16 v[28:31], a[64:67], v[96:99], v[28:31]
    v_and_b32 v14, v14, v96
    v_mfma_f32_16x16x32_bf16 v[32:35], a[72:75], v[96:99], v[32:35]
    buffer_load_dwordx4 v[96:99], v13, s[8:11], s39 offen offset:0 sc1
    s_waitcnt vmcnt(15)
    v_mfma_f32_16x16x32_bf16 v[28:31], a[68:71], v[100:103], v[28:31]
    v_and_b32 v14, v14, v100
    v_mfma_f32_16x16x32_bf16 v[32:35], a[76:79], v[100:103], v[32:35]
    buffer_load_dwordx4 v[100:103], v13, s[8:11], s39 offen offset:1024 sc1
    s_waitcnt vmcnt(15)
    v_mfma_f32_16x16x32_bf16 v[28:31], a[80:83], v[104:107], v[28:31]
    v_and_b32 v14, v14, v104
    v_mfma_f32_16x16x32_bf16 v[32:35], a[88:91], v[104:107], v[32:35]
    buffer_load_dwordx4 v[104:107], v13, s[8:11], s39 offen offset:2048 sc1
    s_waitcnt vmcnt(15)
    v_mfma_f32_16x16x32_bf16 v[28:31], a[84:87], v[108:111], v[28:31]
    v_and_b32 v14, v14, v108
    v_mfma_f32_16x16x32_bf16 v[32:35], a[92:95], v[108:111], v[32:35]
    buffer_load_dwordx4 v[108:111], v13, s[8:11], s39 offen offset:3072 sc1
    s_add_u32 s39, s39, 4096
    s_waitcnt vmcnt(15)
    v_mfma_f32_16x16x32_bf16 v[28:31], a[96:99], v[112:115], v[28:31]
    v_and_b32 v14, v14, v112
    v_mfma_f32_16x16x32_bf16 v[32:35], a[104:107], v[112:115], v[32:35]
    buffer_load_dwordx4 v[112:115], v13, s[8:11], s39 offen offset:0 sc1
    s_waitcnt vmcnt(15)
    v_mfma_f32_16x16x32_bf16 v[28:31], a[100:103], v[116:119], v[28:31]
    v_and_b32 v14, v14, v116
    v_mfma_f32_16x16x32_bf16 v[32:35], a[108:111], v[116:119], v[32:35]
    buffer_load_dwordx4 v[116:119], v13, s[8:11], s39 offen offset:1024 sc1
    s_waitcnt vmcnt(15)
    v_mfma_f32_16x16x32_bf16 v[28:31], a[112:115], v[120:123], v[28:31]
    v_and_b32 v14, v14, v120
    v_mfma_f32_16x16x32_bf16 v[32:35], a[120:123], v[120:123], v[32:35]
    buffer_load_dwordx4 v[120:123], v13, s[8:11], s39 offen offset:2048 sc1
    s_waitcnt vmcnt(15)
    v_mfma_f32_16x16x32_bf16 v[28:31], a[116:119], v[124:127], v[28:31]
    v_and_b32 v14, v14, v124
    v_mfma_f32_16x16x32_bf16 v[32:35], a[124:127], v[124:127], v[32:35]
    buffer_load_dwordx4 v[124:127], v13, s[8:11], s39 offen offset:3072 sc1
    s_add_u32 s39, s39, 4096
    s_waitcnt vmcnt(15)
    v_mfma_f32_16x16x32_bf16 v[28:31], a[128:131], v[64:67], v[28:31]
    v_and_b32 v14, v14, v64
    v_mfma_f32_16x16x32_bf16 v[32:35], a[136:139], v[64:67], v[32:35]
    s_waitcnt vmcnt(14)
    v_mfma_f32_16x16x32_bf16 v[28:31], a[132:135], v[68:71], v[28:31]
    v_and_b32 v14, v14, v68
    v_mfma_f32_16x16x32_bf16 v[32:35], a[140:143], v[68:71], v[32:35]
    s_waitcnt vmcnt(13)
    v_mfma_f32_16x16x32_bf16 v[28:31], a[144:147], v[72:75], v[28:31]
    v_and_b32 v14, v14, v72
    v_mfma_f32_16x16x32_bf16 v[32:35], a[152:155], v[72:75], v[32:35]
    s_waitcnt vmcnt(12)
    v_mfma_f32_16x16x32_bf16 v[28:31], a[148:151], v[76:79], v[28:31]
    v_and_b32 v14, v14, v76
    v_mfma_f32_16x16x32_bf16 v[32:35], a[156:159], v[76:79], v[32:35]
    s_waitcnt vmcnt(11)
    v_mfma_f32_16x16x32_bf16 v[28:31], a[160:163], v[80:83], v[28:31]
    v_and_b32 v14, v14, v80
    v_mfma_f32_16x16x32_bf16 v[32:35], a[168:171], v[80:83], v[32:35]
    s_waitcnt vmcnt(10)
    v_mfma_f32_16x16x32_bf16 v[28:31], a[164:167], v[84:87], v[28:31]
    v_and_b32 v14, v14, v84
    v_mfma_f32_16x16x32_bf16 v[32:35], a[172:175], v[84:87], v[32:35]
    s_waitcnt vmcnt(9)
    v_mfma_f32_16x16x32_bf16 v[28:31], a[176:179], v[88:91], v[28:31]
    v_and_b32 v14, v14, v88
    v_mfma_f32_16x16x32_bf16 v[32:35], a[184:187], v[88:91], v[32:35]
    s_waitcnt vmcnt(8)
    v_mfma_f32_16x16x32_bf16 v[28:31], a[180:183], v[92:95], v[28:31]
    v_and_b32 v14, v14, v92
    v_mfma_f32_16x16x32_bf16 v[32:35], a[188:191], v[92:95], v[32:35]
    s_waitcnt vmcnt(7)
    v_mfma_f32_16x16x32_bf16 v[28:31], a[192:195], v[96:99], v[28:31]
    v_and_b32 v14, v14, v96
    v_mfma_f32_16x16x32_bf16 v[32:35], a[200:203], v[96:99], v[32:35]
    s_waitcnt vmcnt(6)
    v_mfma_f32_16x16x32_bf16 v[28:31], a[196:199], v[100:103], v[28:31]
    v_and_b32 v14, v14, v100
    v_mfma_f32_16x16x32_bf16 v[32:35], a[204:207], v[100:103], v[32:35]
    s_waitcnt vmcnt(5)
    v_mfma_f32_16x16x32_bf16 v[28:31], a[208:211], v[104:107], v[28:31]
    v_and_b32 v14, v14, v104
    v_mfma_f32_16x16x32_bf16 v[32:35], a[216:219], v[104:107], v[32:35]
    s_waitcnt vmcnt(4)
    v_mfma_f32_16x16x32_bf16 v[28:31], a[212:215], v[108:111], v[28:31]
    v_and_b32 v14, v14, v108
    v_mfma_f32_16x16x32_bf16 v[32:35], a[220:223], v[108:111], v[32:35]
    s_waitcnt vmcnt(3)
    v_mfma_f32_16x16x32_bf16 v[28:31], a[224:227], v[112:115], v[28:31]
    v_and_b32 v14, v14, v112
    v_mfma_f32_16x16x32_bf16 v[32:35], a[232:235], v[112:115], v[32:35]
    s_waitcnt vmcnt(2)
    v_mfma_f32_16x16x32_bf16 v[28:31], a[228:231], v[116:119], v[28:31]
    v_and_b32 v14, v14, v116
    v_mfma_f32_16x16x32_bf16 v[32:35], a[236:239], v[116:119], v[32:35]
    s_waitcnt vmcnt(1)
    v_mfma_f32_16x16x32_bf16 v[28:31], a[240:243], v[120:123], v[28:31]
    v_and_b32 v14, v14, v120
    v_mfma_f32_16x16x32_bf16 v[32:35], a[248:251], v[120:123], v[32:35]
    s_waitcnt vmcnt(0)
    v_mfma_f32_16x16x32_bf16 v[28:31], a[244:247], v[124:127], v[28:31]
    v_and_b32 v14, v14, v124
    v_mfma_f32_16x16x32_bf16 v[32:35], a[252:255], v[124:127], v[32:35]
    s_branch L_r2_red
L_r4:
    v_lshlrev_b32 v64, 7, v0
    s_lshl_b32 s96, s4, 5
    s_add_u32 s96, s96, s5
    s_cmp_eq_u32 s98, 1
    s_cbranch_scc1 L_r4_cf_ok
    v_mov_b32 v125, 163836
    s_cmp_eq_u32 s3, 0
    s_cbranch_scc0 L_r4_cf_b
    s_waitcnt vmcnt(1)
    v_readfirstlane_b32 s97, v126
    v_mov_b32 v124, s96
    s_nop 2
    s_bitcmp1_b32 s97, s5
    s_cbranch_scc1 L_lost
    ds_write_b32 v125, v124
    s_waitcnt lgkmcnt(0)
L_r4_cf_b:
    s_barrier
    ds_read_b32 v124, v125
    s_waitcnt lgkmcnt(0)
    v_readfirstlane_b32 s97, v124
    s_barrier
    s_cmp_eq_u32 s97, s96
    s_cbranch_scc0 L_restart
L_r4_cf_ok:
    s_lshl_b32 s96, s96, 7
    s_lshl_b32 s97, s3, 3
    s_add_u32 s96, s96, s97
    v_mov_b64 v[124:125], 0
    buffer_store_dwordx2 v[124:125], off, s[8:11], s96 sc1
    s_waitcnt vmcnt(0)
    s_barrier
    s_cmp_eq_u32 s3, 0
    s_cbranch_scc0 L_r4_id
    v_mov_b32 v64, 1
    s_mov_b64 exec, 1
    buffer_atomic_add v64, off, s[12:15], s7
    s_mov_b64 exec, -1
L_r4_id:
    s_endpgm
L_lost:
    s_add_u32 s6, s7, 4
    v_mov_b32 v2, 1
    s_mov_b64 exec, 1
    buffer_atomic_add v2, off, s[12:15], s6 sc0
    s_mov_b64 exec, -1
    v_mbcnt_lo_u32_b32 v3, -1, 0
    v_mbcnt_hi_u32_b32 v3, -1, v3
    v_lshlrev_b32 v3, 2, v3
    s_waitcnt vmcnt(0)
    v_readfirstlane_b32 s58, v2
    s_mov_b32 s36, 0
L_l_w:
    buffer_load_dword v2, v3, s[12:15], 0 offen sc1
    s_waitcnt vmcnt(0)
    v_readlane_b32 s40, v2, 0
    v_readlane_b32 s48, v2, 2
    v_readlane_b32 s41, v2, 16
    v_readlane_b32 s49, v2, 18
    v_readlane_b32 s42, v2, 19
    v_readlane_b32 s50, v2, 21
    v_readlane_b32 s43, v2, 32
    v_readlane_b32 s51, v2, 34
    v_readlane_b32 s44, v2, 35
    v_readlane_b32 s52, v2, 37
    v_readlane_b32 s45, v2, 48
    v_readlane_b32 s53, v2, 50
    v_readlane_b32 s46, v2, 51
    v_readlane_b32 s54, v2, 53
    v_readlane_b32 s47, v2, 54
    v_readlane_b32 s55, v2, 56
    s_nop 3
    s_mov_b32 s37, 0
    s_bcnt1_i32_b32 s38, s40
    s_add_u32 s37, s37, s38
    s_add_u32 s37, s37, s48
    s_bcnt1_i32_b32 s38, s41
    s_add_u32 s37, s37, s38
    s_add_u32 s37, s37, s49
    s_bcnt1_i32_b32 s38, s42
    s_add_u32 s37, s37, s38
    s_add_u32 s37, s37, s50
    s_bcnt1_i32_b32 s38, s43
    s_add_u32 s37, s37, s38
    s_add_u32 s37, s37, s51
    s_bcnt1_i32_b32 s38, s44
    s_add_u32 s37, s37, s38
    s_add_u32 s37, s37, s52
    s_bcnt1_i32_b32 s38, s45
    s_add_u32 s37, s37, s38
    s_add_u32 s37, s37, s53
    s_bcnt1_i32_b32 s38, s46
    s_add_u32 s37, s37, s38
    s_add_u32 s37, s37, s54
    s_bcnt1_i32_b32 s38, s47
    s_add_u32 s37, s37, s38
    s_add_u32 s37, s37, s55
    s_cmp_eq_u32 s37, 256
    s_cbranch_scc1 L_l_all
    s_cmp_gt_u32 s37, 256
    s_cbranch_scc1 L_l_none
    s_sleep 8
    s_add_u32 s36, s36, 1
    s_cmp_lt_u32 s36, 0x40000
    s_cbranch_scc1 L_l_w
    s_branch L_l_none
L_l_all:
    s_mov_b32 s37, 0
    s_bcnt0_i32_b32 s38, s40
    s_not_b32 s56, s40
    s_cmp_eq_u32 s4, 0
    s_cbranch_scc1 L_l_mine
    s_max_u32 s39, s48, s38
    s_sub_u32 s39, s39, s38
    s_add_u32 s37, s37, s39
    s_bcnt0_i32_b32 s38, s41
    s_not_b32 s56, s41
    s_cmp_eq_u32 s4, 1
    s_cbranch_scc1 L_l_mine
    s_max_u32 s39, s49, s38
    s_sub_u32 s39, s39, s38
    s_add_u32 s37, s37, s39
    s_bcnt0_i32_b32 s38, s42
    s_not_b32 s56, s42
    s_cmp_eq_u32 s4, 2
    s_cbranch_scc1 L_l_mine
    s_max_u32 s39, s50, s38
    s_sub_u32 s39, s39, s38
    s_add_u32 s37, s37, s39
    s_bcnt0_i32_b32 s38, s43
    s_not_b32 s56, s43
    s_cmp_eq_u32 s4, 3
    s_cbranch_scc1 L_l_mine
    s_max_u32 s39, s51, s38
    s_sub_u32 s39, s39, s38
    s_add_u32 s37, s37, s39
    s_bcnt0_i32_b32 s38, s44
    s_not_b32 s56, s44
    s_cmp_eq_u32 s4, 4
    s_cbranch_scc1 L_l_mine
    s_max_u32 s39, s52, s38
    s_sub_u32 s39, s39, s38
    s_add_u32 s37, s37, s39
    s_bcnt0_i32_b32 s38, s45
    s_not_b32 s56, s45
    s_cmp_eq_u32 s4, 5
    s_cbranch_scc1 L_l_mine
    s_max_u32 s39, s53, s38
    s_sub_u32 s39, s39, s38
    s_add_u32 s37, s37, s39
    s_bcnt0_i32_b32 s38, s46
    s_not_b32 s56, s46
    s_cmp_eq_u32 s4, 6
    s_cbranch_scc1 L_l_mine
    s_max_u32 s39, s54, s38
    s_sub_u32 s39, s39, s38
    s_add_u32 s37, s37, s39
    s_bcnt0_i32_b32 s38, s47
    s_not_b32 s56, s47
    s_cmp_eq_u32 s4, 7
    s_cbranch_scc1 L_l_mine
    s_max_u32 s39, s55, s38
    s_sub_u32 s39, s39, s38
    s_add_u32 s37, s37, s39
L_l_mine:
    s_cmp_lt_u32 s58, s38
    s_cbranch_scc1 L_l_pick
    s_sub_u32 s58, s58, s38
    s_add_u32 s37, s37, s58
    s_bcnt0_i32_b32 s38, s40
    s_not_b32 s56, s40
    s_min_u32 s39, s48, s38
    s_add_u32 s58, s37, s39
    s_mov_b32 s4, 0
    s_cmp_lt_u32 s58, s38
    s_cbranch_scc1 L_l_pick
    s_sub_u32 s37, s58, s38
    s_bcnt0_i32_b32 s38, s41
    s_not_b32 s56, s41
    s_min_u32 s39, s49, s38
    s_add_u32 s58, s37, s39
    s_mov_b32 s4, 1
    s_cmp_lt_u32 s58, s38
    s_cbranch_scc1 L_l_pick
    s_sub_u32 s37, s58, s38
    s_bcnt0_i32_b32 s38, s42
    s_not_b32 s56, s42
    s_min_u32 s39, s50, s38
    s_add_u32 s58, s37, s39
    s_mov_b32 s4, 2
    s_cmp_lt_u32 s58, s38
    s_cbranch_scc1 L_l_pick
    s_sub_u32 s37, s58, s38
    s_bcnt0_i32_b32 s38, s43
    s_not_b32 s56, s43
    s_min_u32 s39, s51, s38
    s_add_u32 s58, s37, s39
    s_mov_b32 s4, 3
    s_cmp_lt_u32 s58, s38
    s_cbranch_scc1 L_l_pick
    s_sub_u32 s37, s58, s38
    s_bcnt0_i32_b32 s38, s44
    s_not_b32 s56, s44
    s_min_u32 s39, s52, s38
    s_add_u32 s58, s37, s39
    s_mov_b32 s4, 4
    s_cmp_lt_u32 s58, s38
    s_cbranch_scc1 L_l_pick
    s_sub_u32 s37, s58, s38
    s_bcnt0_i32_b32 s38, s45
    s_not_b32 s56, s45
    s_min_u32 s39, s53, s38
    s_add_u32 s58, s37, s39
    s_mov_b32 s4, 5
    s_cmp_lt_u32 s58, s38
    s_cbranch_scc1 L_l_pick
    s_sub_u32 s37, s58, s38
    s_bcnt0_i32_b32 s38, s46
    s_not_b32 s56, s46
    s_min_u32 s39, s54, s38
    s_add_u32 s58, s37, s39
    s_mov_b32 s4, 6
    s_cmp_lt_u32 s58, s38
    s_cbranch_scc1 L_l_pick
    s_sub_u32 s37, s58, s38
    s_bcnt0_i32_b32 s38, s47
    s_not_b32 s56, s47
    s_min_u32 s39, s55, s38
    s_add_u32 s58, s37, s39
    s_mov_b32 s4, 7
    s_cmp_lt_u32 s58, s38
    s_cbranch_scc1 L_l_pick
    s_sub_u32 s37, s58, s38
L_l_none:
    s_mov_b32 s97, 256
    s_branch L_l_tell
L_l_pick:
    s_ff1_i32_b32 s5, s56
    s_bitset0_b32 s56, s5
    s_sub_u32 s58, s58, 1
    s_cbranch_scc0 L_l_pick
    s_lshl_b32 s97, s4, 5
    s_add_u32 s97, s97, s5
L_l_tell:
    v_mov_b32 v2, s97
    v_mov_b32 v3, 163836
    ds_write_b32 v3, v2
    s_waitcnt lgkmcnt(0)
    s_barrier
    s_barrier
L_restart:
    s_waitcnt vmcnt(0) lgkmcnt(0)
    s_cmp_ge_u32 s97, 256
    s_cbranch_scc1 L_exit
    s_barrier
    s_lshr_b32 s4, s97, 5
    s_and_b32 s5, s97, 31
    s_mov_b32 s98, 1
    v_mbcnt_lo_u32_b32 v0, -1, 0
    v_mbcnt_hi_u32_b32 v0, -1, v0
    s_lshl_b32 s6, s3, 6
    v_add_u32 v0, s6, v0
    s_mov_b32 s96, 0x804c4000
    s_mov_b32 s97, 0xd8ccc08c
    s_lshl_b32 s7, s4, 3
    s_lshr_b64 s[96:97], s[96:97], s7
    s_and_b32 s96, s96, 255
    s_add_u32 s7, s96, 4
    s_branch L_dispatch
L_exit:
    s_endpgm
.section .rodata,"a"
.p2align 6
.amdhsa_kernel gated_mix__ssm_conv_s5__memory_aug_recurrent_mem_tr__prompt_kernel
  .amdhsa_next_free_vgpr 512
  .amdhsa_next_free_sgpr 102
  .amdhsa_accum_offset 256
  .amdhsa_group_segment_fixed_size 0
  .amdhsa_kernarg_size 160
  .amdhsa_user_sgpr_count 2
  .amdhsa_user_sgpr_kernarg_segment_ptr 1
  .amdhsa_system_sgpr_workgroup_id_x 1
.end_amdhsa_kernel
```
